```python
import torch

def _softmax(x, axis=-1):
    return torch.softmax(x, dim=axis)

def _gelu(x):
    return torch.nn.functional.gelu(x, approximate='tanh')

def _silu(x):
    return torch.nn.functional.silu(x)

def _sigmoid(x):
    return torch.sigmoid(x)

def _layernorm(x, axis=-1, eps=1e-05):
    m = x.mean(dim=axis, keepdim=True)
    v = x.var(dim=axis, keepdim=True, unbiased=False)
    return (x - m) / torch.sqrt(v + eps)

def _scatter_add(tgt, idx, src, axis=0):
    return tgt.clone().index_add_(axis, idx, src)

def _segment_sum(src, seg, n):
    out = torch.zeros((n,) + src.shape[1:], dtype=src.dtype)
    return out.index_add_(0, seg, src)

def _pad(x, pw):
    flat = tuple((v for pair in reversed(pw) for v in pair))
    return torch.nn.functional.pad(x, flat)
kernel_name = 'adaLN_cond__sliding_block_cached__glu_gated_reglu__prompt'

def setup_inputs():

    _w = lambda a: (lambda t: t.to(torch.bfloat16) if t.is_floating_point() else t)(torch.as_tensor(a))

    def _A_setup():
        B, Sq, D = (1, 2048, 576)
        Hq, Hkv, Sk, Dh = (32, 16, 2048, 128)
        assert Hq % Hkv == 0, (Hq, Hkv)
        return {'x': _w((lambda *s: torch.randn(*s, dtype=torch.bfloat16) * 0.05)(B, Sq, D)), 'k_cache': _w((lambda *s: torch.randn(*s, dtype=torch.bfloat16) * 1.6)(B, Hkv, Sk, Dh)), 'v_cache': _w((lambda *s: torch.randn(*s, dtype=torch.bfloat16) * 0.8)(B, Hkv, Sk, Dh)), 'wq': _w((lambda *s: torch.randn(*s, dtype=torch.bfloat16) * 1.6)(D, Hq * Dh) * D ** (-0.5)), 'wo': _w((lambda *s: torch.randn(*s, dtype=torch.bfloat16) * 0.8)(Hq * Dh, D) * (Hq * Dh) ** (-0.5))}
    _A_in = _A_setup()

    def _B_setup():
        B, S, D, F = (1, 2048, 576, 4608)
        return {'x': _w((lambda *s: torch.randn(*s, dtype=torch.bfloat16) * 0.05)(B, S, D)), 'W_gate': _w((lambda *s: torch.randn(*s, dtype=torch.bfloat16) * 0.4)(D, F) * (2.0 / D) ** 0.5), 'W_up': _w((lambda *s: torch.randn(*s, dtype=torch.bfloat16) * 0.4)(D, F) * (2.0 / D) ** 0.5), 'W_down': _w((lambda *s: torch.randn(*s, dtype=torch.bfloat16) * 0.4)(F, D) * (1.0 / F) ** 0.5)}
    _B_in = _B_setup()
    return {'A_x': _A_in['x'], 'A_k_cache': _A_in['k_cache'], 'A_v_cache': _A_in['v_cache'], 'A_wq': _A_in['wq'], 'A_wo': _A_in['wo'], 'B_x': _B_in['x'], 'B_W_gate': _B_in['W_gate'], 'B_W_up': _B_in['W_up'], 'B_W_down': _B_in['W_down'], 'c': _w((lambda *s: torch.randn(*s, dtype=torch.bfloat16) * 0.2)(1, 576) * 8.0), 'w_mod': _w((lambda *s: torch.randn(*s, dtype=torch.bfloat16) * 0.2)(576, 6 * 576) * 576 ** (-0.5) * 8.0)}

def reference(A_x, A_k_cache, A_v_cache, A_wq, A_wo, B_x, B_W_gate, B_W_up, B_W_down, c, w_mod):

    def _A_ref(x, k_cache, v_cache, wq, wo):
        B, Sq, D = x.shape
        Hq, Dh = (32, 128)
        Hkv, Sk = (k_cache.shape[1], k_cache.shape[2])
        W = min(4096, max(256, Sk // 4))
        rep = Hq // Hkv
        q = (lambda x, *d: x.permute(*d))((x @ wq).reshape(B, Sq, Hq, Dh), 0, 2, 1, 3)
        k = (lambda x, n, axis: torch.repeat_interleave(x, n, dim=axis))(k_cache[:, :, Sk - W:, :], rep, axis=1)
        v = (lambda x, n, axis: torch.repeat_interleave(x, n, dim=axis))(v_cache[:, :, Sk - W:, :], rep, axis=1)
        scores = torch.einsum('bhqd,bhkd->bhqk', q, k) * Dh ** (-0.5)
        p = _softmax(scores, axis=-1)
        o = torch.einsum('bhqk,bhkd->bhqd', p, v)
        return (lambda x, *d: x.permute(*d))(o, 0, 2, 1, 3).reshape(B, Sq, Hq * Dh) @ wo

    def _B_ref(x, W_gate, W_up, W_down):
        gate = torch.einsum('bsd,df->bsf', x, W_gate)
        up = torch.einsum('bsd,df->bsf', x, W_up)
        gate = gate * (lambda x, dt: x.to(dt))(gate > 0, gate.dtype)
        h = gate * up
        return torch.einsum('bsf,fd->bsd', h, W_down)
    x = A_x
    mod = (_silu(c) @ w_mod).reshape(c.shape[0], 6, 1, -1)
    sa, ca, ga, sb, cb, gb = (mod[:, 0].clone(), mod[:, 1].clone(), mod[:, 2].clone(), mod[:, 3].clone(), mod[:, 4].clone(), mod[:, 5].clone())
    h = _layernorm(x, axis=-1) * (1 + ca) + sa
    x = x + ga * _A_ref(h, A_k_cache, A_v_cache, A_wq, A_wo)
    h = _layernorm(x, axis=-1) * (1 + cb) + sb
    x = x + gb * _B_ref(h, B_W_gate, B_W_up, B_W_down)
    return x
```

```asm
; @launch kernel=k0_kernel grid=(256,1,1) block=(576,1,1) lds=17408
; @launch kernel=ka_kernel grid=(256,1,1) block=(256,1,1) lds=161024
; @launch kernel=r2_kernel grid=(256,1,1) block=(576,1,1) lds=0
.amdgcn_target "amdgcn-amd-amdhsa--gfx950"

.macro MF d, a, b, c
v_mfma_f32_16x16x32_bf16 \d, \a, \b, \c
.endm
.macro TR d, a, o
ds_read_b64_tr_b16 \d, \a offset:\o
.endm
.macro DR d, a, o
ds_read_b64 \d, \a offset:\o
.endm

.text
ka_kernel_pa31:
buffer_store_dwordx4 v[156:159], v29, s[28:31], s72 offen sc1
s_branch ka_kernel_pb32
ka_kernel_pa33:
buffer_store_dwordx4 v[160:163], v30, s[28:31], s72 offen sc1
s_branch ka_kernel_pb34
ka_kernel_pa35:
buffer_store_dwordx4 v[164:167], v29, s[28:31], s72 offen offset:1024 sc1
s_branch ka_kernel_pb36
ka_kernel_pa37:
buffer_store_dwordx4 v[168:171], v30, s[28:31], s72 offen offset:1024 sc1
s_branch ka_kernel_pb38
ka_kernel_pa39:
buffer_store_dword v255, v31, s[60:63], s64 offen offset:4 sc1
s_branch ka_kernel_pb40
ka_kernel_pa41:
buffer_store_dwordx4 v[156:159], v29, s[28:31], s73 offen sc1
s_branch ka_kernel_pb42
ka_kernel_pa43:
buffer_store_dwordx4 v[160:163], v30, s[28:31], s73 offen sc1
s_branch ka_kernel_pb44
ka_kernel_pa45:
buffer_store_dwordx4 v[164:167], v29, s[28:31], s73 offen offset:1024 sc1
s_branch ka_kernel_pb46
ka_kernel_pa47:
buffer_store_dwordx4 v[168:171], v30, s[28:31], s73 offen offset:1024 sc1
s_branch ka_kernel_pb48
ka_kernel_pa49:
buffer_store_dword v255, v31, s[60:63], s64 offen offset:4 sc1
s_branch ka_kernel_pb50
ka_kernel_pa51:
buffer_store_dwordx4 v[156:159], v29, s[28:31], s74 offen sc1
s_branch ka_kernel_pb52
ka_kernel_pa53:
buffer_store_dwordx4 v[160:163], v30, s[28:31], s74 offen sc1
s_branch ka_kernel_pb54
ka_kernel_pa55:
buffer_store_dwordx4 v[164:167], v29, s[28:31], s74 offen offset:1024 sc1
s_branch ka_kernel_pb56
ka_kernel_pa57:
buffer_store_dwordx4 v[168:171], v30, s[28:31], s74 offen offset:1024 sc1
s_branch ka_kernel_pb58
ka_kernel_pa59:
buffer_store_dword v255, v31, s[60:63], s64 offen offset:4 sc1
s_branch ka_kernel_pb60
ka_kernel_pa61:
buffer_store_dwordx4 v[156:159], v29, s[28:31], s75 offen sc1
s_branch ka_kernel_pb62
ka_kernel_pa63:
buffer_store_dwordx4 v[160:163], v30, s[28:31], s75 offen sc1
s_branch ka_kernel_pb64
ka_kernel_pa65:
buffer_store_dwordx4 v[164:167], v29, s[28:31], s75 offen offset:1024 sc1
s_branch ka_kernel_pb66
ka_kernel_pa67:
buffer_store_dwordx4 v[168:171], v30, s[28:31], s75 offen offset:1024 sc1
s_branch ka_kernel_pb68
ka_kernel_pa69:
buffer_store_dword v255, v31, s[60:63], s64 offen offset:4 sc1
s_branch ka_kernel_pb70
ka_kernel_pa71:
buffer_store_dwordx4 v[156:159], v29, s[28:31], s76 offen sc1
s_branch ka_kernel_pb72
ka_kernel_pa73:
buffer_store_dwordx4 v[160:163], v30, s[28:31], s76 offen sc1
s_branch ka_kernel_pb74
ka_kernel_pa75:
buffer_store_dwordx4 v[164:167], v29, s[28:31], s76 offen offset:1024 sc1
s_branch ka_kernel_pb76
ka_kernel_pa77:
buffer_store_dwordx4 v[168:171], v30, s[28:31], s76 offen offset:1024 sc1
s_branch ka_kernel_pb78
ka_kernel_pa79:
buffer_store_dword v255, v31, s[60:63], s64 offen offset:4 sc1
s_branch ka_kernel_pb80
ka_kernel_pa81:
buffer_store_dwordx4 v[156:159], v29, s[28:31], s77 offen sc1
s_branch ka_kernel_pb82
ka_kernel_pa83:
buffer_store_dwordx4 v[160:163], v30, s[28:31], s77 offen sc1
s_branch ka_kernel_pb84
ka_kernel_pa85:
buffer_store_dwordx4 v[164:167], v29, s[28:31], s77 offen offset:1024 sc1
s_branch ka_kernel_pb86
ka_kernel_pa87:
buffer_store_dwordx4 v[168:171], v30, s[28:31], s77 offen offset:1024 sc1
s_branch ka_kernel_pb88
ka_kernel_pa89:
buffer_store_dword v255, v31, s[60:63], s64 offen offset:4 sc1
s_branch ka_kernel_pb90
ka_kernel_pa91:
buffer_store_dwordx4 v[156:159], v29, s[28:31], s78 offen sc1
s_branch ka_kernel_pb92
ka_kernel_pa93:
buffer_store_dwordx4 v[160:163], v30, s[28:31], s78 offen sc1
s_branch ka_kernel_pb94
ka_kernel_pa95:
buffer_store_dwordx4 v[164:167], v29, s[28:31], s78 offen offset:1024 sc1
s_branch ka_kernel_pb96
ka_kernel_pa97:
buffer_store_dwordx4 v[168:171], v30, s[28:31], s78 offen offset:1024 sc1
s_branch ka_kernel_pb98
ka_kernel_pa99:
buffer_store_dword v255, v31, s[60:63], s64 offen offset:4 sc1
s_branch ka_kernel_pb100
ka_kernel_spin101:
buffer_load_dword v0, v31, s[60:63], s65 offen offset:4 sc1
s_add_u32 s3, s3, 1
s_cmp_gt_u32 s3, 0x80000
s_cbranch_scc1 ka_kernel_spb102
s_waitcnt vmcnt(0)
v_readfirstlane_b32 s68, v0
s_nop 0
s_add_u32 s68, s68, s69
s_cmp_ge_u32 s68, 3
s_cbranch_scc0 ka_kernel_spin101
s_branch ka_kernel_spb102
ka_kernel_spin103:
buffer_load_dword v0, v31, s[60:63], s65 offen offset:4 sc1
s_add_u32 s3, s3, 1
s_cmp_gt_u32 s3, 0x80000
s_cbranch_scc1 ka_kernel_spb104
s_waitcnt vmcnt(0)
v_readfirstlane_b32 s68, v0
s_nop 0
s_add_u32 s68, s68, s69
s_cmp_ge_u32 s68, 4
s_cbranch_scc0 ka_kernel_spin103
s_branch ka_kernel_spb104
ka_kernel_spin105:
buffer_load_dword v0, v31, s[60:63], s65 offen offset:4 sc1
s_add_u32 s3, s3, 1
s_cmp_gt_u32 s3, 0x80000
s_cbranch_scc1 ka_kernel_spb106
s_waitcnt vmcnt(0)
v_readfirstlane_b32 s68, v0
s_nop 0
s_add_u32 s68, s68, s69
s_cmp_ge_u32 s68, 5
s_cbranch_scc0 ka_kernel_spin105
s_branch ka_kernel_spb106
ka_kernel_spin107:
buffer_load_dword v0, v31, s[60:63], s65 offen offset:4 sc1
s_add_u32 s3, s3, 1
s_cmp_gt_u32 s3, 0x80000
s_cbranch_scc1 ka_kernel_spb108
s_waitcnt vmcnt(0)
v_readfirstlane_b32 s68, v0
s_nop 0
s_add_u32 s68, s68, s69
s_cmp_ge_u32 s68, 6
s_cbranch_scc0 ka_kernel_spin107
s_branch ka_kernel_spb108
ka_kernel_spin109:
buffer_load_dword v0, v31, s[60:63], s65 offen offset:4 sc1
s_add_u32 s3, s3, 1
s_cmp_gt_u32 s3, 0x80000
s_cbranch_scc1 ka_kernel_spb110
s_waitcnt vmcnt(0)
v_readfirstlane_b32 s68, v0
s_nop 0
s_add_u32 s68, s68, s69
s_cmp_ge_u32 s68, 7
s_cbranch_scc0 ka_kernel_spin109
s_branch ka_kernel_spb110
ka_kernel_spin111:
buffer_load_dword v0, v31, s[60:63], s65 offen offset:4 sc1
s_add_u32 s3, s3, 1
s_cmp_gt_u32 s3, 0x80000
s_cbranch_scc1 ka_kernel_spb112
s_waitcnt vmcnt(0)
v_readfirstlane_b32 s68, v0
s_nop 0
s_add_u32 s68, s68, s69
s_cmp_ge_u32 s68, 8
s_cbranch_scc0 ka_kernel_spin111
s_branch ka_kernel_spb112
ka_kernel_spin113:
buffer_load_dword v0, v31, s[60:63], s65 offen offset:4 sc1
s_add_u32 s3, s3, 1
s_cmp_gt_u32 s3, 0x80000
s_cbranch_scc1 ka_kernel_spb114
s_waitcnt vmcnt(0)
v_readfirstlane_b32 s68, v0
s_nop 0
s_add_u32 s68, s68, s69
s_cmp_ge_u32 s68, 9
s_cbranch_scc0 ka_kernel_spin113
s_branch ka_kernel_spb114
ka_kernel_again3:
s_and_b32 s40, s2, 3
s_lshl_b32 s40, s40, 2
s_bfe_u32 s41, s2, 0x20003
s_add_u32 s40, s40, s41
s_lshr_b32 s41, s2, 5
s_bitcmp1_b32 s2, 2
s_cselect_b32 vcc_lo, 8, 0
s_add_u32 s41, s41, vcc_lo
s_lshl_b32 s32, s40, 9
s_lshl_b32 s42, s39, 7
s_add_u32 s32, s32, s42
s_lshl_b32 s42, s40, 11
s_add_u32 s42, s42, 1536
s_and_b32 s43, s39, 1
s_lshl_b32 s43, s43, 5
s_add_u32 s42, s42, s43
s_lshl_b32 s42, s42, 8
s_lshr_b32 s43, s39, 1
s_lshl_b32 s43, s43, 7
s_add_u32 s33, s42, s43
s_mov_b32 s34, s33
s_lshl_b32 s42, s40, 8
s_lshl_b32 s43, s39, 5
s_add_u32 s42, s42, s43
s_mul_i32 s35, s42, 1152
s_lshl_b32 s43, s41, 3
s_lshl_b32 s42, s39, 1
s_add_u32 s43, s43, s42
s_mul_i32 s36, s43, 18432
s_lshr_b32 s42, s40, 2
s_mul_i32 s42, s42, 2359296
s_add_u32 s37, s36, s42
buffer_load_dwordx4 v[60:63], v29, s[24:27], s36 offen
buffer_load_dwordx4 v[64:67], v30, s[24:27], s36 offen
s_add_u32 s36, s36, 1024
s_add_u32 m0, s38, 0
s_nop 0
buffer_load_dwordx4 v1, s[8:11], s32 offen lds
buffer_load_dwordx4 v2, s[8:11], s32 offen offset:1024 lds
buffer_load_dwordx4 v3, s[8:11], s32 offen offset:2048 lds
buffer_load_dwordx4 v4, s[8:11], s32 offen offset:3072 lds
s_add_u32 s32, s32, 262144
buffer_load_dwordx4 v[68:71], v29, s[24:27], s36 offen
buffer_load_dwordx4 v[72:75], v30, s[24:27], s36 offen
s_add_u32 s36, s36, 1024
s_add_u32 m0, s38, 16384
s_nop 0
buffer_load_dwordx4 v1, s[8:11], s32 offen lds
buffer_load_dwordx4 v2, s[8:11], s32 offen offset:1024 lds
buffer_load_dwordx4 v3, s[8:11], s32 offen offset:2048 lds
buffer_load_dwordx4 v4, s[8:11], s32 offen offset:3072 lds
s_add_u32 s32, s32, 262144
buffer_load_dwordx4 v[76:79], v29, s[24:27], s36 offen
buffer_load_dwordx4 v[80:83], v30, s[24:27], s36 offen
s_add_u32 s36, s36, 1024
s_add_u32 m0, s38, 32768
s_nop 0
buffer_load_dwordx4 v1, s[8:11], s32 offen lds
buffer_load_dwordx4 v2, s[8:11], s32 offen offset:1024 lds
buffer_load_dwordx4 v3, s[8:11], s32 offen offset:2048 lds
buffer_load_dwordx4 v4, s[8:11], s32 offen offset:3072 lds
s_add_u32 s32, s32, 262144
buffer_load_dwordx4 v[84:87], v29, s[24:27], s36 offen
buffer_load_dwordx4 v[88:91], v30, s[24:27], s36 offen
s_add_u32 s36, s36, 1024
s_branch ka_kernel_second4
ka_kernel_slow11:
s_nop 15
v_mov_b32 v56, v52
v_mov_b32 v57, v53
v_mov_b32 v58, v54
v_mov_b32 v59, v55
v_permlane16_swap_b32 v52, v56
v_permlane16_swap_b32 v53, v57
v_permlane16_swap_b32 v54, v58
v_permlane16_swap_b32 v55, v59
v_max_f32 v52, v52, v56
v_max_f32 v53, v53, v57
v_max_f32 v54, v54, v58
v_max_f32 v55, v55, v59
v_mov_b32 v56, v52
v_mov_b32 v57, v53
v_mov_b32 v58, v54
v_mov_b32 v59, v55
v_permlane32_swap_b32 v52, v56
v_permlane32_swap_b32 v53, v57
v_permlane32_swap_b32 v54, v58
v_permlane32_swap_b32 v55, v59
v_max_f32 v52, v52, v56
v_max_f32 v53, v53, v57
v_max_f32 v54, v54, v58
v_max_f32 v55, v55, v59
v_max_f32 v52, 0, v52
v_ceil_f32 v52, v52
v_exp_f32_e64 v56, -v52
v_sub_f32 v32, v32, v52
v_sub_f32 v33, v33, v52
v_sub_f32 v34, v34, v52
v_sub_f32 v35, v35, v52
v_sub_f32 v124, v124, v52
v_sub_f32 v125, v125, v52
v_sub_f32 v126, v126, v52
v_sub_f32 v127, v127, v52
v_sub_f32 v140, v140, v52
v_sub_f32 v141, v141, v52
v_sub_f32 v142, v142, v52
v_sub_f32 v143, v143, v52
v_sub_f32 v156, v156, v52
v_sub_f32 v157, v157, v52
v_sub_f32 v158, v158, v52
v_sub_f32 v159, v159, v52
v_sub_f32 v172, v172, v52
v_sub_f32 v173, v173, v52
v_sub_f32 v174, v174, v52
v_sub_f32 v175, v175, v52
v_sub_f32 v188, v188, v52
v_sub_f32 v189, v189, v52
v_sub_f32 v190, v190, v52
v_sub_f32 v191, v191, v52
v_max_f32 v53, 0, v53
v_ceil_f32 v53, v53
v_exp_f32_e64 v57, -v53
v_sub_f32 v36, v36, v53
v_sub_f32 v37, v37, v53
v_sub_f32 v38, v38, v53
v_sub_f32 v39, v39, v53
v_sub_f32 v128, v128, v53
v_sub_f32 v129, v129, v53
v_sub_f32 v130, v130, v53
v_sub_f32 v131, v131, v53
v_sub_f32 v144, v144, v53
v_sub_f32 v145, v145, v53
v_sub_f32 v146, v146, v53
v_sub_f32 v147, v147, v53
v_sub_f32 v160, v160, v53
v_sub_f32 v161, v161, v53
v_sub_f32 v162, v162, v53
v_sub_f32 v163, v163, v53
v_sub_f32 v176, v176, v53
v_sub_f32 v177, v177, v53
v_sub_f32 v178, v178, v53
v_sub_f32 v179, v179, v53
v_sub_f32 v192, v192, v53
v_sub_f32 v193, v193, v53
v_sub_f32 v194, v194, v53
v_sub_f32 v195, v195, v53
v_max_f32 v54, 0, v54
v_ceil_f32 v54, v54
v_exp_f32_e64 v58, -v54
v_sub_f32 v40, v40, v54
v_sub_f32 v41, v41, v54
v_sub_f32 v42, v42, v54
v_sub_f32 v43, v43, v54
v_sub_f32 v132, v132, v54
v_sub_f32 v133, v133, v54
v_sub_f32 v134, v134, v54
v_sub_f32 v135, v135, v54
v_sub_f32 v148, v148, v54
v_sub_f32 v149, v149, v54
v_sub_f32 v150, v150, v54
v_sub_f32 v151, v151, v54
v_sub_f32 v164, v164, v54
v_sub_f32 v165, v165, v54
v_sub_f32 v166, v166, v54
v_sub_f32 v167, v167, v54
v_sub_f32 v180, v180, v54
v_sub_f32 v181, v181, v54
v_sub_f32 v182, v182, v54
v_sub_f32 v183, v183, v54
v_sub_f32 v196, v196, v54
v_sub_f32 v197, v197, v54
v_sub_f32 v198, v198, v54
v_sub_f32 v199, v199, v54
v_max_f32 v55, 0, v55
v_ceil_f32 v55, v55
v_exp_f32_e64 v59, -v55
v_sub_f32 v44, v44, v55
v_sub_f32 v45, v45, v55
v_sub_f32 v46, v46, v55
v_sub_f32 v47, v47, v55
v_sub_f32 v136, v136, v55
v_sub_f32 v137, v137, v55
v_sub_f32 v138, v138, v55
v_sub_f32 v139, v139, v55
v_sub_f32 v152, v152, v55
v_sub_f32 v153, v153, v55
v_sub_f32 v154, v154, v55
v_sub_f32 v155, v155, v55
v_sub_f32 v168, v168, v55
v_sub_f32 v169, v169, v55
v_sub_f32 v170, v170, v55
v_sub_f32 v171, v171, v55
v_sub_f32 v184, v184, v55
v_sub_f32 v185, v185, v55
v_sub_f32 v186, v186, v55
v_sub_f32 v187, v187, v55
s_nop 1
s_branch ka_kernel_back12
ka_kernel_slow13:
s_nop 15
v_mov_b32 v56, v52
v_mov_b32 v57, v53
v_mov_b32 v58, v54
v_mov_b32 v59, v55
v_permlane16_swap_b32 v52, v56
v_permlane16_swap_b32 v53, v57
v_permlane16_swap_b32 v54, v58
v_permlane16_swap_b32 v55, v59
v_max_f32 v52, v52, v56
v_max_f32 v53, v53, v57
v_max_f32 v54, v54, v58
v_max_f32 v55, v55, v59
v_mov_b32 v56, v52
v_mov_b32 v57, v53
v_mov_b32 v58, v54
v_mov_b32 v59, v55
v_permlane32_swap_b32 v52, v56
v_permlane32_swap_b32 v53, v57
v_permlane32_swap_b32 v54, v58
v_permlane32_swap_b32 v55, v59
v_max_f32 v52, v52, v56
v_max_f32 v53, v53, v57
v_max_f32 v54, v54, v58
v_max_f32 v55, v55, v59
v_max_f32 v52, 0, v52
v_ceil_f32 v52, v52
v_exp_f32_e64 v56, -v52
v_sub_f32 v32, v32, v52
v_sub_f32 v33, v33, v52
v_sub_f32 v34, v34, v52
v_sub_f32 v35, v35, v52
v_sub_f32 v188, v188, v52
v_sub_f32 v189, v189, v52
v_sub_f32 v190, v190, v52
v_sub_f32 v191, v191, v52
v_sub_f32 v204, v204, v52
v_sub_f32 v205, v205, v52
v_sub_f32 v206, v206, v52
v_sub_f32 v207, v207, v52
v_sub_f32 v220, v220, v52
v_sub_f32 v221, v221, v52
v_sub_f32 v222, v222, v52
v_sub_f32 v223, v223, v52
v_sub_f32 v236, v236, v52
v_sub_f32 v237, v237, v52
v_sub_f32 v238, v238, v52
v_sub_f32 v239, v239, v52
v_lshlrev_b32 v252, 16, v124
v_and_b32 v253, 0xffff0000, v124
v_mul_f32 v252, v252, v56
v_mul_f32 v253, v253, v56
v_cvt_pk_bf16_f32 v124, v252, v253
v_lshlrev_b32 v252, 16, v125
v_and_b32 v253, 0xffff0000, v125
v_mul_f32 v252, v252, v56
v_mul_f32 v253, v253, v56
v_cvt_pk_bf16_f32 v125, v252, v253
v_lshlrev_b32 v252, 16, v126
v_and_b32 v253, 0xffff0000, v126
v_mul_f32 v252, v252, v56
v_mul_f32 v253, v253, v56
v_cvt_pk_bf16_f32 v126, v252, v253
v_lshlrev_b32 v252, 16, v127
v_and_b32 v253, 0xffff0000, v127
v_mul_f32 v252, v252, v56
v_mul_f32 v253, v253, v56
v_cvt_pk_bf16_f32 v127, v252, v253
v_mul_f32 v156, v156, v56
v_sub_f32 v157, v157, v52
v_sub_f32 v158, v158, v52
v_sub_f32 v159, v159, v52
v_sub_f32 v172, v172, v52
v_sub_f32 v173, v173, v52
v_sub_f32 v174, v174, v52
v_sub_f32 v175, v175, v52
v_accvgpr_read_b32 v252, a128
v_mul_f32 v252, v252, v56
v_accvgpr_write_b32 a128, v252
v_accvgpr_read_b32 v252, a129
v_mul_f32 v252, v252, v56
v_accvgpr_write_b32 a129, v252
v_accvgpr_read_b32 v252, a130
v_mul_f32 v252, v252, v56
v_accvgpr_write_b32 a130, v252
v_accvgpr_read_b32 v252, a131
v_mul_f32 v252, v252, v56
v_accvgpr_write_b32 a131, v252
v_accvgpr_read_b32 v252, a0
v_mul_f32 v252, v252, v56
v_accvgpr_write_b32 a0, v252
v_accvgpr_read_b32 v252, a1
v_mul_f32 v252, v252, v56
v_accvgpr_write_b32 a1, v252
v_accvgpr_read_b32 v252, a2
v_mul_f32 v252, v252, v56
v_accvgpr_write_b32 a2, v252
v_accvgpr_read_b32 v252, a3
v_mul_f32 v252, v252, v56
v_accvgpr_write_b32 a3, v252
v_accvgpr_read_b32 v252, a4
v_mul_f32 v252, v252, v56
v_accvgpr_write_b32 a4, v252
v_accvgpr_read_b32 v252, a5
v_mul_f32 v252, v252, v56
v_accvgpr_write_b32 a5, v252
v_accvgpr_read_b32 v252, a6
v_mul_f32 v252, v252, v56
v_accvgpr_write_b32 a6, v252
v_accvgpr_read_b32 v252, a7
v_mul_f32 v252, v252, v56
v_accvgpr_write_b32 a7, v252
v_max_f32 v53, 0, v53
v_ceil_f32 v53, v53
v_exp_f32_e64 v57, -v53
v_sub_f32 v36, v36, v53
v_sub_f32 v37, v37, v53
v_sub_f32 v38, v38, v53
v_sub_f32 v39, v39, v53
v_sub_f32 v192, v192, v53
v_sub_f32 v193, v193, v53
v_sub_f32 v194, v194, v53
v_sub_f32 v195, v195, v53
v_sub_f32 v208, v208, v53
v_sub_f32 v209, v209, v53
v_sub_f32 v210, v210, v53
v_sub_f32 v211, v211, v53
v_sub_f32 v224, v224, v53
v_sub_f32 v225, v225, v53
v_sub_f32 v226, v226, v53
v_sub_f32 v227, v227, v53
v_sub_f32 v240, v240, v53
v_sub_f32 v241, v241, v53
v_sub_f32 v242, v242, v53
v_sub_f32 v243, v243, v53
v_lshlrev_b32 v252, 16, v128
v_and_b32 v253, 0xffff0000, v128
v_mul_f32 v252, v252, v57
v_mul_f32 v253, v253, v57
v_cvt_pk_bf16_f32 v128, v252, v253
v_lshlrev_b32 v252, 16, v129
v_and_b32 v253, 0xffff0000, v129
v_mul_f32 v252, v252, v57
v_mul_f32 v253, v253, v57
v_cvt_pk_bf16_f32 v129, v252, v253
v_lshlrev_b32 v252, 16, v130
v_and_b32 v253, 0xffff0000, v130
v_mul_f32 v252, v252, v57
v_mul_f32 v253, v253, v57
v_cvt_pk_bf16_f32 v130, v252, v253
v_lshlrev_b32 v252, 16, v131
v_and_b32 v253, 0xffff0000, v131
v_mul_f32 v252, v252, v57
v_mul_f32 v253, v253, v57
v_cvt_pk_bf16_f32 v131, v252, v253
v_sub_f32 v160, v160, v53
v_sub_f32 v161, v161, v53
v_sub_f32 v162, v162, v53
v_sub_f32 v163, v163, v53
v_sub_f32 v176, v176, v53
v_sub_f32 v177, v177, v53
v_sub_f32 v178, v178, v53
v_sub_f32 v179, v179, v53
v_accvgpr_read_b32 v252, a132
v_mul_f32 v252, v252, v57
v_accvgpr_write_b32 a132, v252
v_accvgpr_read_b32 v252, a133
v_mul_f32 v252, v252, v57
v_accvgpr_write_b32 a133, v252
v_accvgpr_read_b32 v252, a134
v_mul_f32 v252, v252, v57
v_accvgpr_write_b32 a134, v252
v_accvgpr_read_b32 v252, a135
v_mul_f32 v252, v252, v57
v_accvgpr_write_b32 a135, v252
v_accvgpr_read_b32 v252, a32
v_mul_f32 v252, v252, v57
v_accvgpr_write_b32 a32, v252
v_accvgpr_read_b32 v252, a33
v_mul_f32 v252, v252, v57
v_accvgpr_write_b32 a33, v252
v_accvgpr_read_b32 v252, a34
v_mul_f32 v252, v252, v57
v_accvgpr_write_b32 a34, v252
v_accvgpr_read_b32 v252, a35
v_mul_f32 v252, v252, v57
v_accvgpr_write_b32 a35, v252
v_accvgpr_read_b32 v252, a36
v_mul_f32 v252, v252, v57
v_accvgpr_write_b32 a36, v252
v_accvgpr_read_b32 v252, a37
v_mul_f32 v252, v252, v57
v_accvgpr_write_b32 a37, v252
v_accvgpr_read_b32 v252, a38
v_mul_f32 v252, v252, v57
v_accvgpr_write_b32 a38, v252
v_accvgpr_read_b32 v252, a39
v_mul_f32 v252, v252, v57
v_accvgpr_write_b32 a39, v252
v_max_f32 v54, 0, v54
v_ceil_f32 v54, v54
v_exp_f32_e64 v58, -v54
v_sub_f32 v40, v40, v54
v_sub_f32 v41, v41, v54
v_sub_f32 v42, v42, v54
v_sub_f32 v43, v43, v54
v_sub_f32 v196, v196, v54
v_sub_f32 v197, v197, v54
v_sub_f32 v198, v198, v54
v_sub_f32 v199, v199, v54
v_sub_f32 v212, v212, v54
v_sub_f32 v213, v213, v54
v_sub_f32 v214, v214, v54
v_sub_f32 v215, v215, v54
v_sub_f32 v228, v228, v54
v_sub_f32 v229, v229, v54
v_sub_f32 v230, v230, v54
v_sub_f32 v231, v231, v54
v_sub_f32 v244, v244, v54
v_sub_f32 v245, v245, v54
v_sub_f32 v246, v246, v54
v_sub_f32 v247, v247, v54
v_lshlrev_b32 v252, 16, v132
v_and_b32 v253, 0xffff0000, v132
v_mul_f32 v252, v252, v58
v_mul_f32 v253, v253, v58
v_cvt_pk_bf16_f32 v132, v252, v253
v_lshlrev_b32 v252, 16, v133
v_and_b32 v253, 0xffff0000, v133
v_mul_f32 v252, v252, v58
v_mul_f32 v253, v253, v58
v_cvt_pk_bf16_f32 v133, v252, v253
v_lshlrev_b32 v252, 16, v134
v_and_b32 v253, 0xffff0000, v134
v_mul_f32 v252, v252, v58
v_mul_f32 v253, v253, v58
v_cvt_pk_bf16_f32 v134, v252, v253
v_lshlrev_b32 v252, 16, v135
v_and_b32 v253, 0xffff0000, v135
v_mul_f32 v252, v252, v58
v_mul_f32 v253, v253, v58
v_cvt_pk_bf16_f32 v135, v252, v253
v_sub_f32 v164, v164, v54
v_sub_f32 v165, v165, v54
v_sub_f32 v166, v166, v54
v_sub_f32 v167, v167, v54
v_sub_f32 v180, v180, v54
v_sub_f32 v181, v181, v54
v_sub_f32 v182, v182, v54
v_sub_f32 v183, v183, v54
v_accvgpr_read_b32 v252, a136
v_mul_f32 v252, v252, v58
v_accvgpr_write_b32 a136, v252
v_accvgpr_read_b32 v252, a137
v_mul_f32 v252, v252, v58
v_accvgpr_write_b32 a137, v252
v_accvgpr_read_b32 v252, a138
v_mul_f32 v252, v252, v58
v_accvgpr_write_b32 a138, v252
v_accvgpr_read_b32 v252, a139
v_mul_f32 v252, v252, v58
v_accvgpr_write_b32 a139, v252
v_accvgpr_read_b32 v252, a64
v_mul_f32 v252, v252, v58
v_accvgpr_write_b32 a64, v252
v_accvgpr_read_b32 v252, a65
v_mul_f32 v252, v252, v58
v_accvgpr_write_b32 a65, v252
v_accvgpr_read_b32 v252, a66
v_mul_f32 v252, v252, v58
v_accvgpr_write_b32 a66, v252
v_accvgpr_read_b32 v252, a67
v_mul_f32 v252, v252, v58
v_accvgpr_write_b32 a67, v252
v_accvgpr_read_b32 v252, a68
v_mul_f32 v252, v252, v58
v_accvgpr_write_b32 a68, v252
v_accvgpr_read_b32 v252, a69
v_mul_f32 v252, v252, v58
v_accvgpr_write_b32 a69, v252
v_accvgpr_read_b32 v252, a70
v_mul_f32 v252, v252, v58
v_accvgpr_write_b32 a70, v252
v_accvgpr_read_b32 v252, a71
v_mul_f32 v252, v252, v58
v_accvgpr_write_b32 a71, v252
v_max_f32 v55, 0, v55
v_ceil_f32 v55, v55
v_exp_f32_e64 v59, -v55
v_sub_f32 v44, v44, v55
v_sub_f32 v45, v45, v55
v_sub_f32 v46, v46, v55
v_sub_f32 v47, v47, v55
v_sub_f32 v200, v200, v55
v_sub_f32 v201, v201, v55
v_sub_f32 v202, v202, v55
v_sub_f32 v203, v203, v55
v_sub_f32 v216, v216, v55
v_sub_f32 v217, v217, v55
v_sub_f32 v218, v218, v55
v_sub_f32 v219, v219, v55
v_sub_f32 v232, v232, v55
v_sub_f32 v233, v233, v55
v_sub_f32 v234, v234, v55
v_sub_f32 v235, v235, v55
v_sub_f32 v248, v248, v55
v_sub_f32 v249, v249, v55
v_sub_f32 v250, v250, v55
v_sub_f32 v251, v251, v55
v_lshlrev_b32 v252, 16, v136
v_and_b32 v253, 0xffff0000, v136
v_mul_f32 v252, v252, v59
v_mul_f32 v253, v253, v59
v_cvt_pk_bf16_f32 v136, v252, v253
v_lshlrev_b32 v252, 16, v137
v_and_b32 v253, 0xffff0000, v137
v_mul_f32 v252, v252, v59
v_mul_f32 v253, v253, v59
v_cvt_pk_bf16_f32 v137, v252, v253
v_lshlrev_b32 v252, 16, v138
v_and_b32 v253, 0xffff0000, v138
v_mul_f32 v252, v252, v59
v_mul_f32 v253, v253, v59
v_cvt_pk_bf16_f32 v138, v252, v253
v_lshlrev_b32 v252, 16, v139
v_and_b32 v253, 0xffff0000, v139
v_mul_f32 v252, v252, v59
v_mul_f32 v253, v253, v59
v_cvt_pk_bf16_f32 v139, v252, v253
v_sub_f32 v168, v168, v55
v_sub_f32 v169, v169, v55
v_sub_f32 v170, v170, v55
v_sub_f32 v171, v171, v55
v_sub_f32 v184, v184, v55
v_sub_f32 v185, v185, v55
v_sub_f32 v186, v186, v55
v_sub_f32 v187, v187, v55
v_accvgpr_read_b32 v252, a140
v_mul_f32 v252, v252, v59
v_accvgpr_write_b32 a140, v252
v_accvgpr_read_b32 v252, a141
v_mul_f32 v252, v252, v59
v_accvgpr_write_b32 a141, v252
v_accvgpr_read_b32 v252, a142
v_mul_f32 v252, v252, v59
v_accvgpr_write_b32 a142, v252
v_accvgpr_read_b32 v252, a143
v_mul_f32 v252, v252, v59
v_accvgpr_write_b32 a143, v252
v_accvgpr_read_b32 v252, a96
v_mul_f32 v252, v252, v59
v_accvgpr_write_b32 a96, v252
v_accvgpr_read_b32 v252, a97
v_mul_f32 v252, v252, v59
v_accvgpr_write_b32 a97, v252
v_accvgpr_read_b32 v252, a98
v_mul_f32 v252, v252, v59
v_accvgpr_write_b32 a98, v252
v_accvgpr_read_b32 v252, a99
v_mul_f32 v252, v252, v59
v_accvgpr_write_b32 a99, v252
s_nop 1
s_branch ka_kernel_back14
ka_kernel_slow15:
s_nop 15
v_mov_b32 v56, v52
v_mov_b32 v57, v53
v_mov_b32 v58, v54
v_mov_b32 v59, v55
v_permlane16_swap_b32 v52, v56
v_permlane16_swap_b32 v53, v57
v_permlane16_swap_b32 v54, v58
v_permlane16_swap_b32 v55, v59
v_max_f32 v52, v52, v56
v_max_f32 v53, v53, v57
v_max_f32 v54, v54, v58
v_max_f32 v55, v55, v59
v_mov_b32 v56, v52
v_mov_b32 v57, v53
v_mov_b32 v58, v54
v_mov_b32 v59, v55
v_permlane32_swap_b32 v52, v56
v_permlane32_swap_b32 v53, v57
v_permlane32_swap_b32 v54, v58
v_permlane32_swap_b32 v55, v59
v_max_f32 v52, v52, v56
v_max_f32 v53, v53, v57
v_max_f32 v54, v54, v58
v_max_f32 v55, v55, v59
v_max_f32 v52, 0, v52
v_ceil_f32 v52, v52
v_exp_f32_e64 v56, -v52
v_sub_f32 v32, v32, v52
v_sub_f32 v33, v33, v52
v_sub_f32 v34, v34, v52
v_sub_f32 v35, v35, v52
v_sub_f32 v124, v124, v52
v_sub_f32 v125, v125, v52
v_sub_f32 v126, v126, v52
v_sub_f32 v127, v127, v52
v_sub_f32 v140, v140, v52
v_sub_f32 v141, v141, v52
v_sub_f32 v142, v142, v52
v_sub_f32 v143, v143, v52
v_sub_f32 v156, v156, v52
v_sub_f32 v157, v157, v52
v_sub_f32 v158, v158, v52
v_sub_f32 v159, v159, v52
v_sub_f32 v172, v172, v52
v_sub_f32 v173, v173, v52
v_sub_f32 v174, v174, v52
v_sub_f32 v175, v175, v52
v_lshlrev_b32 v252, 16, v188
v_and_b32 v253, 0xffff0000, v188
v_mul_f32 v252, v252, v56
v_mul_f32 v253, v253, v56
v_cvt_pk_bf16_f32 v188, v252, v253
v_lshlrev_b32 v252, 16, v189
v_and_b32 v253, 0xffff0000, v189
v_mul_f32 v252, v252, v56
v_mul_f32 v253, v253, v56
v_cvt_pk_bf16_f32 v189, v252, v253
v_lshlrev_b32 v252, 16, v190
v_and_b32 v253, 0xffff0000, v190
v_mul_f32 v252, v252, v56
v_mul_f32 v253, v253, v56
v_cvt_pk_bf16_f32 v190, v252, v253
v_lshlrev_b32 v252, 16, v191
v_and_b32 v253, 0xffff0000, v191
v_mul_f32 v252, v252, v56
v_mul_f32 v253, v253, v56
v_cvt_pk_bf16_f32 v191, v252, v253
v_lshlrev_b32 v252, 16, v220
v_and_b32 v253, 0xffff0000, v220
v_mul_f32 v252, v252, v56
v_mul_f32 v253, v253, v56
v_cvt_pk_bf16_f32 v220, v252, v253
v_lshlrev_b32 v252, 16, v221
v_and_b32 v253, 0xffff0000, v221
v_mul_f32 v252, v252, v56
v_mul_f32 v253, v253, v56
v_cvt_pk_bf16_f32 v221, v252, v253
v_lshlrev_b32 v252, 16, v222
v_and_b32 v253, 0xffff0000, v222
v_mul_f32 v252, v252, v56
v_mul_f32 v253, v253, v56
v_cvt_pk_bf16_f32 v222, v252, v253
v_lshlrev_b32 v252, 16, v223
v_and_b32 v253, 0xffff0000, v223
v_mul_f32 v252, v252, v56
v_mul_f32 v253, v253, v56
v_cvt_pk_bf16_f32 v223, v252, v253
v_accvgpr_read_b32 v252, a128
v_mul_f32 v252, v252, v56
v_accvgpr_write_b32 a128, v252
v_accvgpr_read_b32 v252, a129
v_mul_f32 v252, v252, v56
v_accvgpr_write_b32 a129, v252
v_accvgpr_read_b32 v252, a130
v_mul_f32 v252, v252, v56
v_accvgpr_write_b32 a130, v252
v_accvgpr_read_b32 v252, a131
v_mul_f32 v252, v252, v56
v_accvgpr_write_b32 a131, v252
v_accvgpr_read_b32 v252, a0
v_mul_f32 v252, v252, v56
v_accvgpr_write_b32 a0, v252
v_accvgpr_read_b32 v252, a1
v_mul_f32 v252, v252, v56
v_accvgpr_write_b32 a1, v252
v_accvgpr_read_b32 v252, a2
v_mul_f32 v252, v252, v56
v_accvgpr_write_b32 a2, v252
v_accvgpr_read_b32 v252, a3
v_mul_f32 v252, v252, v56
v_accvgpr_write_b32 a3, v252
v_accvgpr_read_b32 v252, a4
v_mul_f32 v252, v252, v56
v_accvgpr_write_b32 a4, v252
v_accvgpr_read_b32 v252, a5
v_mul_f32 v252, v252, v56
v_accvgpr_write_b32 a5, v252
v_accvgpr_read_b32 v252, a6
v_mul_f32 v252, v252, v56
v_accvgpr_write_b32 a6, v252
v_accvgpr_read_b32 v252, a7
v_mul_f32 v252, v252, v56
v_accvgpr_write_b32 a7, v252
v_accvgpr_read_b32 v252, a8
v_mul_f32 v252, v252, v56
v_accvgpr_write_b32 a8, v252
v_accvgpr_read_b32 v252, a9
v_mul_f32 v252, v252, v56
v_accvgpr_write_b32 a9, v252
v_accvgpr_read_b32 v252, a10
v_mul_f32 v252, v252, v56
v_accvgpr_write_b32 a10, v252
v_accvgpr_read_b32 v252, a11
v_mul_f32 v252, v252, v56
v_accvgpr_write_b32 a11, v252
v_accvgpr_read_b32 v252, a12
v_mul_f32 v252, v252, v56
v_accvgpr_write_b32 a12, v252
v_accvgpr_read_b32 v252, a13
v_mul_f32 v252, v252, v56
v_accvgpr_write_b32 a13, v252
v_accvgpr_read_b32 v252, a14
v_mul_f32 v252, v252, v56
v_accvgpr_write_b32 a14, v252
v_accvgpr_read_b32 v252, a15
v_mul_f32 v252, v252, v56
v_accvgpr_write_b32 a15, v252
v_accvgpr_read_b32 v252, a16
v_mul_f32 v252, v252, v56
v_accvgpr_write_b32 a16, v252
v_accvgpr_read_b32 v252, a17
v_mul_f32 v252, v252, v56
v_accvgpr_write_b32 a17, v252
v_accvgpr_read_b32 v252, a18
v_mul_f32 v252, v252, v56
v_accvgpr_write_b32 a18, v252
v_accvgpr_read_b32 v252, a19
v_mul_f32 v252, v252, v56
v_accvgpr_write_b32 a19, v252
v_accvgpr_read_b32 v252, a20
v_mul_f32 v252, v252, v56
v_accvgpr_write_b32 a20, v252
v_accvgpr_read_b32 v252, a21
v_mul_f32 v252, v252, v56
v_accvgpr_write_b32 a21, v252
v_accvgpr_read_b32 v252, a22
v_mul_f32 v252, v252, v56
v_accvgpr_write_b32 a22, v252
v_accvgpr_read_b32 v252, a23
v_mul_f32 v252, v252, v56
v_accvgpr_write_b32 a23, v252
v_accvgpr_read_b32 v252, a24
v_mul_f32 v252, v252, v56
v_accvgpr_write_b32 a24, v252
v_accvgpr_read_b32 v252, a25
v_mul_f32 v252, v252, v56
v_accvgpr_write_b32 a25, v252
v_accvgpr_read_b32 v252, a26
v_mul_f32 v252, v252, v56
v_accvgpr_write_b32 a26, v252
v_accvgpr_read_b32 v252, a27
v_mul_f32 v252, v252, v56
v_accvgpr_write_b32 a27, v252
v_accvgpr_read_b32 v252, a28
v_mul_f32 v252, v252, v56
v_accvgpr_write_b32 a28, v252
v_accvgpr_read_b32 v252, a29
v_mul_f32 v252, v252, v56
v_accvgpr_write_b32 a29, v252
v_accvgpr_read_b32 v252, a30
v_mul_f32 v252, v252, v56
v_accvgpr_write_b32 a30, v252
v_accvgpr_read_b32 v252, a31
v_mul_f32 v252, v252, v56
v_accvgpr_write_b32 a31, v252
v_max_f32 v53, 0, v53
v_ceil_f32 v53, v53
v_exp_f32_e64 v57, -v53
v_sub_f32 v36, v36, v53
v_sub_f32 v37, v37, v53
v_sub_f32 v38, v38, v53
v_sub_f32 v39, v39, v53
v_sub_f32 v128, v128, v53
v_sub_f32 v129, v129, v53
v_sub_f32 v130, v130, v53
v_sub_f32 v131, v131, v53
v_sub_f32 v144, v144, v53
v_sub_f32 v145, v145, v53
v_sub_f32 v146, v146, v53
v_sub_f32 v147, v147, v53
v_sub_f32 v160, v160, v53
v_sub_f32 v161, v161, v53
v_sub_f32 v162, v162, v53
v_sub_f32 v163, v163, v53
v_sub_f32 v176, v176, v53
v_sub_f32 v177, v177, v53
v_sub_f32 v178, v178, v53
v_sub_f32 v179, v179, v53
v_lshlrev_b32 v252, 16, v192
v_and_b32 v253, 0xffff0000, v192
v_mul_f32 v252, v252, v57
v_mul_f32 v253, v253, v57
v_cvt_pk_bf16_f32 v192, v252, v253
v_lshlrev_b32 v252, 16, v193
v_and_b32 v253, 0xffff0000, v193
v_mul_f32 v252, v252, v57
v_mul_f32 v253, v253, v57
v_cvt_pk_bf16_f32 v193, v252, v253
v_lshlrev_b32 v252, 16, v194
v_and_b32 v253, 0xffff0000, v194
v_mul_f32 v252, v252, v57
v_mul_f32 v253, v253, v57
v_cvt_pk_bf16_f32 v194, v252, v253
v_lshlrev_b32 v252, 16, v195
v_and_b32 v253, 0xffff0000, v195
v_mul_f32 v252, v252, v57
v_mul_f32 v253, v253, v57
v_cvt_pk_bf16_f32 v195, v252, v253
v_lshlrev_b32 v252, 16, v224
v_and_b32 v253, 0xffff0000, v224
v_mul_f32 v252, v252, v57
v_mul_f32 v253, v253, v57
v_cvt_pk_bf16_f32 v224, v252, v253
v_lshlrev_b32 v252, 16, v225
v_and_b32 v253, 0xffff0000, v225
v_mul_f32 v252, v252, v57
v_mul_f32 v253, v253, v57
v_cvt_pk_bf16_f32 v225, v252, v253
v_lshlrev_b32 v252, 16, v226
v_and_b32 v253, 0xffff0000, v226
v_mul_f32 v252, v252, v57
v_mul_f32 v253, v253, v57
v_cvt_pk_bf16_f32 v226, v252, v253
v_mul_f32 v242, v242, v57
v_mul_f32 v243, v243, v57
v_accvgpr_read_b32 v252, a132
v_mul_f32 v252, v252, v57
v_accvgpr_write_b32 a132, v252
v_accvgpr_read_b32 v252, a133
v_mul_f32 v252, v252, v57
v_accvgpr_write_b32 a133, v252
v_accvgpr_read_b32 v252, a134
v_mul_f32 v252, v252, v57
v_accvgpr_write_b32 a134, v252
v_accvgpr_read_b32 v252, a135
v_mul_f32 v252, v252, v57
v_accvgpr_write_b32 a135, v252
v_accvgpr_read_b32 v252, a32
v_mul_f32 v252, v252, v57
v_accvgpr_write_b32 a32, v252
v_accvgpr_read_b32 v252, a33
v_mul_f32 v252, v252, v57
v_accvgpr_write_b32 a33, v252
v_accvgpr_read_b32 v252, a34
v_mul_f32 v252, v252, v57
v_accvgpr_write_b32 a34, v252
v_accvgpr_read_b32 v252, a35
v_mul_f32 v252, v252, v57
v_accvgpr_write_b32 a35, v252
v_accvgpr_read_b32 v252, a36
v_mul_f32 v252, v252, v57
v_accvgpr_write_b32 a36, v252
v_accvgpr_read_b32 v252, a37
v_mul_f32 v252, v252, v57
v_accvgpr_write_b32 a37, v252
v_accvgpr_read_b32 v252, a38
v_mul_f32 v252, v252, v57
v_accvgpr_write_b32 a38, v252
v_accvgpr_read_b32 v252, a39
v_mul_f32 v252, v252, v57
v_accvgpr_write_b32 a39, v252
v_accvgpr_read_b32 v252, a40
v_mul_f32 v252, v252, v57
v_accvgpr_write_b32 a40, v252
v_accvgpr_read_b32 v252, a41
v_mul_f32 v252, v252, v57
v_accvgpr_write_b32 a41, v252
v_accvgpr_read_b32 v252, a42
v_mul_f32 v252, v252, v57
v_accvgpr_write_b32 a42, v252
v_accvgpr_read_b32 v252, a43
v_mul_f32 v252, v252, v57
v_accvgpr_write_b32 a43, v252
v_accvgpr_read_b32 v252, a44
v_mul_f32 v252, v252, v57
v_accvgpr_write_b32 a44, v252
v_accvgpr_read_b32 v252, a45
v_mul_f32 v252, v252, v57
v_accvgpr_write_b32 a45, v252
v_accvgpr_read_b32 v252, a46
v_mul_f32 v252, v252, v57
v_accvgpr_write_b32 a46, v252
v_accvgpr_read_b32 v252, a47
v_mul_f32 v252, v252, v57
v_accvgpr_write_b32 a47, v252
v_accvgpr_read_b32 v252, a48
v_mul_f32 v252, v252, v57
v_accvgpr_write_b32 a48, v252
v_accvgpr_read_b32 v252, a49
v_mul_f32 v252, v252, v57
v_accvgpr_write_b32 a49, v252
v_accvgpr_read_b32 v252, a50
v_mul_f32 v252, v252, v57
v_accvgpr_write_b32 a50, v252
v_accvgpr_read_b32 v252, a51
v_mul_f32 v252, v252, v57
v_accvgpr_write_b32 a51, v252
v_accvgpr_read_b32 v252, a52
v_mul_f32 v252, v252, v57
v_accvgpr_write_b32 a52, v252
v_accvgpr_read_b32 v252, a53
v_mul_f32 v252, v252, v57
v_accvgpr_write_b32 a53, v252
v_accvgpr_read_b32 v252, a54
v_mul_f32 v252, v252, v57
v_accvgpr_write_b32 a54, v252
v_accvgpr_read_b32 v252, a55
v_mul_f32 v252, v252, v57
v_accvgpr_write_b32 a55, v252
v_accvgpr_read_b32 v252, a56
v_mul_f32 v252, v252, v57
v_accvgpr_write_b32 a56, v252
v_accvgpr_read_b32 v252, a57
v_mul_f32 v252, v252, v57
v_accvgpr_write_b32 a57, v252
v_accvgpr_read_b32 v252, a58
v_mul_f32 v252, v252, v57
v_accvgpr_write_b32 a58, v252
v_accvgpr_read_b32 v252, a59
v_mul_f32 v252, v252, v57
v_accvgpr_write_b32 a59, v252
v_accvgpr_read_b32 v252, a60
v_mul_f32 v252, v252, v57
v_accvgpr_write_b32 a60, v252
v_accvgpr_read_b32 v252, a61
v_mul_f32 v252, v252, v57
v_accvgpr_write_b32 a61, v252
v_accvgpr_read_b32 v252, a62
v_mul_f32 v252, v252, v57
v_accvgpr_write_b32 a62, v252
v_accvgpr_read_b32 v252, a63
v_mul_f32 v252, v252, v57
v_accvgpr_write_b32 a63, v252
v_max_f32 v54, 0, v54
v_ceil_f32 v54, v54
v_exp_f32_e64 v58, -v54
v_sub_f32 v40, v40, v54
v_sub_f32 v41, v41, v54
v_sub_f32 v42, v42, v54
v_sub_f32 v43, v43, v54
v_sub_f32 v132, v132, v54
v_sub_f32 v133, v133, v54
v_sub_f32 v134, v134, v54
v_sub_f32 v135, v135, v54
v_sub_f32 v148, v148, v54
v_sub_f32 v149, v149, v54
v_sub_f32 v150, v150, v54
v_sub_f32 v151, v151, v54
v_sub_f32 v164, v164, v54
v_sub_f32 v165, v165, v54
v_sub_f32 v166, v166, v54
v_sub_f32 v167, v167, v54
v_sub_f32 v180, v180, v54
v_sub_f32 v181, v181, v54
v_sub_f32 v182, v182, v54
v_sub_f32 v183, v183, v54
v_lshlrev_b32 v252, 16, v196
v_and_b32 v253, 0xffff0000, v196
v_mul_f32 v252, v252, v58
v_mul_f32 v253, v253, v58
v_cvt_pk_bf16_f32 v196, v252, v253
v_lshlrev_b32 v252, 16, v197
v_and_b32 v253, 0xffff0000, v197
v_mul_f32 v252, v252, v58
v_mul_f32 v253, v253, v58
v_cvt_pk_bf16_f32 v197, v252, v253
v_lshlrev_b32 v252, 16, v198
v_and_b32 v253, 0xffff0000, v198
v_mul_f32 v252, v252, v58
v_mul_f32 v253, v253, v58
v_cvt_pk_bf16_f32 v198, v252, v253
v_lshlrev_b32 v252, 16, v199
v_and_b32 v253, 0xffff0000, v199
v_mul_f32 v252, v252, v58
v_mul_f32 v253, v253, v58
v_cvt_pk_bf16_f32 v199, v252, v253
v_sub_f32 v228, v228, v54
v_sub_f32 v229, v229, v54
v_sub_f32 v230, v230, v54
v_sub_f32 v231, v231, v54
v_sub_f32 v244, v244, v54
v_sub_f32 v245, v245, v54
v_sub_f32 v246, v246, v54
v_sub_f32 v247, v247, v54
v_accvgpr_read_b32 v252, a136
v_mul_f32 v252, v252, v58
v_accvgpr_write_b32 a136, v252
v_accvgpr_read_b32 v252, a137
v_mul_f32 v252, v252, v58
v_accvgpr_write_b32 a137, v252
v_accvgpr_read_b32 v252, a138
v_mul_f32 v252, v252, v58
v_accvgpr_write_b32 a138, v252
v_accvgpr_read_b32 v252, a139
v_mul_f32 v252, v252, v58
v_accvgpr_write_b32 a139, v252
v_accvgpr_read_b32 v252, a64
v_mul_f32 v252, v252, v58
v_accvgpr_write_b32 a64, v252
v_accvgpr_read_b32 v252, a65
v_mul_f32 v252, v252, v58
v_accvgpr_write_b32 a65, v252
v_accvgpr_read_b32 v252, a66
v_mul_f32 v252, v252, v58
v_accvgpr_write_b32 a66, v252
v_accvgpr_read_b32 v252, a67
v_mul_f32 v252, v252, v58
v_accvgpr_write_b32 a67, v252
v_accvgpr_read_b32 v252, a68
v_mul_f32 v252, v252, v58
v_accvgpr_write_b32 a68, v252
v_accvgpr_read_b32 v252, a69
v_mul_f32 v252, v252, v58
v_accvgpr_write_b32 a69, v252
v_accvgpr_read_b32 v252, a70
v_mul_f32 v252, v252, v58
v_accvgpr_write_b32 a70, v252
v_accvgpr_read_b32 v252, a71
v_mul_f32 v252, v252, v58
v_accvgpr_write_b32 a71, v252
v_accvgpr_read_b32 v252, a72
v_mul_f32 v252, v252, v58
v_accvgpr_write_b32 a72, v252
v_accvgpr_read_b32 v252, a73
v_mul_f32 v252, v252, v58
v_accvgpr_write_b32 a73, v252
v_accvgpr_read_b32 v252, a74
v_mul_f32 v252, v252, v58
v_accvgpr_write_b32 a74, v252
v_accvgpr_read_b32 v252, a75
v_mul_f32 v252, v252, v58
v_accvgpr_write_b32 a75, v252
v_accvgpr_read_b32 v252, a76
v_mul_f32 v252, v252, v58
v_accvgpr_write_b32 a76, v252
v_accvgpr_read_b32 v252, a77
v_mul_f32 v252, v252, v58
v_accvgpr_write_b32 a77, v252
v_accvgpr_read_b32 v252, a78
v_mul_f32 v252, v252, v58
v_accvgpr_write_b32 a78, v252
v_accvgpr_read_b32 v252, a79
v_mul_f32 v252, v252, v58
v_accvgpr_write_b32 a79, v252
v_accvgpr_read_b32 v252, a80
v_mul_f32 v252, v252, v58
v_accvgpr_write_b32 a80, v252
v_accvgpr_read_b32 v252, a81
v_mul_f32 v252, v252, v58
v_accvgpr_write_b32 a81, v252
v_accvgpr_read_b32 v252, a82
v_mul_f32 v252, v252, v58
v_accvgpr_write_b32 a82, v252
v_accvgpr_read_b32 v252, a83
v_mul_f32 v252, v252, v58
v_accvgpr_write_b32 a83, v252
v_accvgpr_read_b32 v252, a84
v_mul_f32 v252, v252, v58
v_accvgpr_write_b32 a84, v252
v_accvgpr_read_b32 v252, a85
v_mul_f32 v252, v252, v58
v_accvgpr_write_b32 a85, v252
v_accvgpr_read_b32 v252, a86
v_mul_f32 v252, v252, v58
v_accvgpr_write_b32 a86, v252
v_accvgpr_read_b32 v252, a87
v_mul_f32 v252, v252, v58
v_accvgpr_write_b32 a87, v252
v_accvgpr_read_b32 v252, a88
v_mul_f32 v252, v252, v58
v_accvgpr_write_b32 a88, v252
v_accvgpr_read_b32 v252, a89
v_mul_f32 v252, v252, v58
v_accvgpr_write_b32 a89, v252
v_accvgpr_read_b32 v252, a90
v_mul_f32 v252, v252, v58
v_accvgpr_write_b32 a90, v252
v_accvgpr_read_b32 v252, a91
v_mul_f32 v252, v252, v58
v_accvgpr_write_b32 a91, v252
v_accvgpr_read_b32 v252, a92
v_mul_f32 v252, v252, v58
v_accvgpr_write_b32 a92, v252
v_accvgpr_read_b32 v252, a93
v_mul_f32 v252, v252, v58
v_accvgpr_write_b32 a93, v252
v_accvgpr_read_b32 v252, a94
v_mul_f32 v252, v252, v58
v_accvgpr_write_b32 a94, v252
v_accvgpr_read_b32 v252, a95
v_mul_f32 v252, v252, v58
v_accvgpr_write_b32 a95, v252
v_max_f32 v55, 0, v55
v_ceil_f32 v55, v55
v_exp_f32_e64 v59, -v55
v_sub_f32 v44, v44, v55
v_sub_f32 v45, v45, v55
v_sub_f32 v46, v46, v55
v_sub_f32 v47, v47, v55
v_sub_f32 v136, v136, v55
v_sub_f32 v137, v137, v55
v_sub_f32 v138, v138, v55
v_sub_f32 v139, v139, v55
v_sub_f32 v152, v152, v55
v_sub_f32 v153, v153, v55
v_sub_f32 v154, v154, v55
v_sub_f32 v155, v155, v55
v_sub_f32 v168, v168, v55
v_sub_f32 v169, v169, v55
v_sub_f32 v170, v170, v55
v_sub_f32 v171, v171, v55
v_sub_f32 v184, v184, v55
v_sub_f32 v185, v185, v55
v_sub_f32 v186, v186, v55
v_sub_f32 v187, v187, v55
v_lshlrev_b32 v252, 16, v200
v_and_b32 v253, 0xffff0000, v200
v_mul_f32 v252, v252, v59
v_mul_f32 v253, v253, v59
v_cvt_pk_bf16_f32 v200, v252, v253
v_lshlrev_b32 v252, 16, v201
v_and_b32 v253, 0xffff0000, v201
v_mul_f32 v252, v252, v59
v_mul_f32 v253, v253, v59
v_cvt_pk_bf16_f32 v201, v252, v253
v_lshlrev_b32 v252, 16, v202
v_and_b32 v253, 0xffff0000, v202
v_mul_f32 v252, v252, v59
v_mul_f32 v253, v253, v59
v_cvt_pk_bf16_f32 v202, v252, v253
v_lshlrev_b32 v252, 16, v203
v_and_b32 v253, 0xffff0000, v203
v_mul_f32 v252, v252, v59
v_mul_f32 v253, v253, v59
v_cvt_pk_bf16_f32 v203, v252, v253
v_sub_f32 v232, v232, v55
v_sub_f32 v233, v233, v55
v_sub_f32 v234, v234, v55
v_sub_f32 v235, v235, v55
v_sub_f32 v248, v248, v55
v_sub_f32 v249, v249, v55
v_sub_f32 v250, v250, v55
v_sub_f32 v251, v251, v55
v_accvgpr_read_b32 v252, a140
v_mul_f32 v252, v252, v59
v_accvgpr_write_b32 a140, v252
v_accvgpr_read_b32 v252, a141
v_mul_f32 v252, v252, v59
v_accvgpr_write_b32 a141, v252
v_accvgpr_read_b32 v252, a142
v_mul_f32 v252, v252, v59
v_accvgpr_write_b32 a142, v252
v_accvgpr_read_b32 v252, a143
v_mul_f32 v252, v252, v59
v_accvgpr_write_b32 a143, v252
v_accvgpr_read_b32 v252, a96
v_mul_f32 v252, v252, v59
v_accvgpr_write_b32 a96, v252
v_accvgpr_read_b32 v252, a97
v_mul_f32 v252, v252, v59
v_accvgpr_write_b32 a97, v252
v_accvgpr_read_b32 v252, a98
v_mul_f32 v252, v252, v59
v_accvgpr_write_b32 a98, v252
v_accvgpr_read_b32 v252, a99
v_mul_f32 v252, v252, v59
v_accvgpr_write_b32 a99, v252
v_accvgpr_read_b32 v252, a100
v_mul_f32 v252, v252, v59
v_accvgpr_write_b32 a100, v252
v_accvgpr_read_b32 v252, a101
v_mul_f32 v252, v252, v59
v_accvgpr_write_b32 a101, v252
v_accvgpr_read_b32 v252, a102
v_mul_f32 v252, v252, v59
v_accvgpr_write_b32 a102, v252
v_accvgpr_read_b32 v252, a103
v_mul_f32 v252, v252, v59
v_accvgpr_write_b32 a103, v252
v_accvgpr_read_b32 v252, a104
v_mul_f32 v252, v252, v59
v_accvgpr_write_b32 a104, v252
v_accvgpr_read_b32 v252, a105
v_mul_f32 v252, v252, v59
v_accvgpr_write_b32 a105, v252
v_accvgpr_read_b32 v252, a106
v_mul_f32 v252, v252, v59
v_accvgpr_write_b32 a106, v252
v_accvgpr_read_b32 v252, a107
v_mul_f32 v252, v252, v59
v_accvgpr_write_b32 a107, v252
v_accvgpr_read_b32 v252, a108
v_mul_f32 v252, v252, v59
v_accvgpr_write_b32 a108, v252
v_accvgpr_read_b32 v252, a109
v_mul_f32 v252, v252, v59
v_accvgpr_write_b32 a109, v252
v_accvgpr_read_b32 v252, a110
v_mul_f32 v252, v252, v59
v_accvgpr_write_b32 a110, v252
v_accvgpr_read_b32 v252, a111
v_mul_f32 v252, v252, v59
v_accvgpr_write_b32 a111, v252
v_accvgpr_read_b32 v252, a112
v_mul_f32 v252, v252, v59
v_accvgpr_write_b32 a112, v252
v_accvgpr_read_b32 v252, a113
v_mul_f32 v252, v252, v59
v_accvgpr_write_b32 a113, v252
v_accvgpr_read_b32 v252, a114
v_mul_f32 v252, v252, v59
v_accvgpr_write_b32 a114, v252
v_accvgpr_read_b32 v252, a115
v_mul_f32 v252, v252, v59
v_accvgpr_write_b32 a115, v252
v_accvgpr_read_b32 v252, a116
v_mul_f32 v252, v252, v59
v_accvgpr_write_b32 a116, v252
v_accvgpr_read_b32 v252, a117
v_mul_f32 v252, v252, v59
v_accvgpr_write_b32 a117, v252
v_accvgpr_read_b32 v252, a118
v_mul_f32 v252, v252, v59
v_accvgpr_write_b32 a118, v252
v_accvgpr_read_b32 v252, a119
v_mul_f32 v252, v252, v59
v_accvgpr_write_b32 a119, v252
v_accvgpr_read_b32 v252, a120
v_mul_f32 v252, v252, v59
v_accvgpr_write_b32 a120, v252
v_accvgpr_read_b32 v252, a121
v_mul_f32 v252, v252, v59
v_accvgpr_write_b32 a121, v252
v_accvgpr_read_b32 v252, a122
v_mul_f32 v252, v252, v59
v_accvgpr_write_b32 a122, v252
v_accvgpr_read_b32 v252, a123
v_mul_f32 v252, v252, v59
v_accvgpr_write_b32 a123, v252
v_accvgpr_read_b32 v252, a124
v_mul_f32 v252, v252, v59
v_accvgpr_write_b32 a124, v252
v_accvgpr_read_b32 v252, a125
v_mul_f32 v252, v252, v59
v_accvgpr_write_b32 a125, v252
v_accvgpr_read_b32 v252, a126
v_mul_f32 v252, v252, v59
v_accvgpr_write_b32 a126, v252
v_accvgpr_read_b32 v252, a127
v_mul_f32 v252, v252, v59
v_accvgpr_write_b32 a127, v252
s_nop 1
s_branch ka_kernel_back16
ka_kernel_slow17:
s_nop 15
v_mov_b32 v56, v52
v_mov_b32 v57, v53
v_mov_b32 v58, v54
v_mov_b32 v59, v55
v_permlane16_swap_b32 v52, v56
v_permlane16_swap_b32 v53, v57
v_permlane16_swap_b32 v54, v58
v_permlane16_swap_b32 v55, v59
v_max_f32 v52, v52, v56
v_max_f32 v53, v53, v57
v_max_f32 v54, v54, v58
v_max_f32 v55, v55, v59
v_mov_b32 v56, v52
v_mov_b32 v57, v53
v_mov_b32 v58, v54
v_mov_b32 v59, v55
v_permlane32_swap_b32 v52, v56
v_permlane32_swap_b32 v53, v57
v_permlane32_swap_b32 v54, v58
v_permlane32_swap_b32 v55, v59
v_max_f32 v52, v52, v56
v_max_f32 v53, v53, v57
v_max_f32 v54, v54, v58
v_max_f32 v55, v55, v59
v_max_f32 v52, 0, v52
v_ceil_f32 v52, v52
v_exp_f32_e64 v56, -v52
v_sub_f32 v32, v32, v52
v_sub_f32 v33, v33, v52
v_sub_f32 v34, v34, v52
v_sub_f32 v35, v35, v52
v_sub_f32 v188, v188, v52
v_sub_f32 v189, v189, v52
v_sub_f32 v190, v190, v52
v_sub_f32 v191, v191, v52
v_sub_f32 v204, v204, v52
v_sub_f32 v205, v205, v52
v_sub_f32 v206, v206, v52
v_sub_f32 v207, v207, v52
v_sub_f32 v220, v220, v52
v_sub_f32 v221, v221, v52
v_sub_f32 v222, v222, v52
v_sub_f32 v223, v223, v52
v_sub_f32 v236, v236, v52
v_sub_f32 v237, v237, v52
v_sub_f32 v238, v238, v52
v_sub_f32 v239, v239, v52
v_lshlrev_b32 v252, 16, v124
v_and_b32 v253, 0xffff0000, v124
v_mul_f32 v252, v252, v56
v_mul_f32 v253, v253, v56
v_cvt_pk_bf16_f32 v124, v252, v253
v_lshlrev_b32 v252, 16, v125
v_and_b32 v253, 0xffff0000, v125
v_mul_f32 v252, v252, v56
v_mul_f32 v253, v253, v56
v_cvt_pk_bf16_f32 v125, v252, v253
v_lshlrev_b32 v252, 16, v126
v_and_b32 v253, 0xffff0000, v126
v_mul_f32 v252, v252, v56
v_mul_f32 v253, v253, v56
v_cvt_pk_bf16_f32 v126, v252, v253
v_lshlrev_b32 v252, 16, v127
v_and_b32 v253, 0xffff0000, v127
v_mul_f32 v252, v252, v56
v_mul_f32 v253, v253, v56
v_cvt_pk_bf16_f32 v127, v252, v253
v_lshlrev_b32 v252, 16, v156
v_and_b32 v253, 0xffff0000, v156
v_mul_f32 v252, v252, v56
v_mul_f32 v253, v253, v56
v_cvt_pk_bf16_f32 v156, v252, v253
v_lshlrev_b32 v252, 16, v157
v_and_b32 v253, 0xffff0000, v157
v_mul_f32 v252, v252, v56
v_mul_f32 v253, v253, v56
v_cvt_pk_bf16_f32 v157, v252, v253
v_lshlrev_b32 v252, 16, v158
v_and_b32 v253, 0xffff0000, v158
v_mul_f32 v252, v252, v56
v_mul_f32 v253, v253, v56
v_cvt_pk_bf16_f32 v158, v252, v253
v_lshlrev_b32 v252, 16, v159
v_and_b32 v253, 0xffff0000, v159
v_mul_f32 v252, v252, v56
v_mul_f32 v253, v253, v56
v_cvt_pk_bf16_f32 v159, v252, v253
v_accvgpr_read_b32 v252, a128
v_mul_f32 v252, v252, v56
v_accvgpr_write_b32 a128, v252
v_accvgpr_read_b32 v252, a129
v_mul_f32 v252, v252, v56
v_accvgpr_write_b32 a129, v252
v_accvgpr_read_b32 v252, a130
v_mul_f32 v252, v252, v56
v_accvgpr_write_b32 a130, v252
v_accvgpr_read_b32 v252, a131
v_mul_f32 v252, v252, v56
v_accvgpr_write_b32 a131, v252
v_accvgpr_read_b32 v252, a0
v_mul_f32 v252, v252, v56
v_accvgpr_write_b32 a0, v252
v_accvgpr_read_b32 v252, a1
v_mul_f32 v252, v252, v56
v_accvgpr_write_b32 a1, v252
v_accvgpr_read_b32 v252, a2
v_mul_f32 v252, v252, v56
v_accvgpr_write_b32 a2, v252
v_accvgpr_read_b32 v252, a3
v_mul_f32 v252, v252, v56
v_accvgpr_write_b32 a3, v252
v_accvgpr_read_b32 v252, a4
v_mul_f32 v252, v252, v56
v_accvgpr_write_b32 a4, v252
v_accvgpr_read_b32 v252, a5
v_mul_f32 v252, v252, v56
v_accvgpr_write_b32 a5, v252
v_accvgpr_read_b32 v252, a6
v_mul_f32 v252, v252, v56
v_accvgpr_write_b32 a6, v252
v_accvgpr_read_b32 v252, a7
v_mul_f32 v252, v252, v56
v_accvgpr_write_b32 a7, v252
v_accvgpr_read_b32 v252, a8
v_mul_f32 v252, v252, v56
v_accvgpr_write_b32 a8, v252
v_accvgpr_read_b32 v252, a9
v_mul_f32 v252, v252, v56
v_accvgpr_write_b32 a9, v252
v_accvgpr_read_b32 v252, a10
v_mul_f32 v252, v252, v56
v_accvgpr_write_b32 a10, v252
v_accvgpr_read_b32 v252, a11
v_mul_f32 v252, v252, v56
v_accvgpr_write_b32 a11, v252
v_accvgpr_read_b32 v252, a12
v_mul_f32 v252, v252, v56
v_accvgpr_write_b32 a12, v252
v_accvgpr_read_b32 v252, a13
v_mul_f32 v252, v252, v56
v_accvgpr_write_b32 a13, v252
v_accvgpr_read_b32 v252, a14
v_mul_f32 v252, v252, v56
v_accvgpr_write_b32 a14, v252
v_accvgpr_read_b32 v252, a15
v_mul_f32 v252, v252, v56
v_accvgpr_write_b32 a15, v252
v_accvgpr_read_b32 v252, a16
v_mul_f32 v252, v252, v56
v_accvgpr_write_b32 a16, v252
v_accvgpr_read_b32 v252, a17
v_mul_f32 v252, v252, v56
v_accvgpr_write_b32 a17, v252
v_accvgpr_read_b32 v252, a18
v_mul_f32 v252, v252, v56
v_accvgpr_write_b32 a18, v252
v_accvgpr_read_b32 v252, a19
v_mul_f32 v252, v252, v56
v_accvgpr_write_b32 a19, v252
v_accvgpr_read_b32 v252, a20
v_mul_f32 v252, v252, v56
v_accvgpr_write_b32 a20, v252
v_accvgpr_read_b32 v252, a21
v_mul_f32 v252, v252, v56
v_accvgpr_write_b32 a21, v252
v_accvgpr_read_b32 v252, a22
v_mul_f32 v252, v252, v56
v_accvgpr_write_b32 a22, v252
v_accvgpr_read_b32 v252, a23
v_mul_f32 v252, v252, v56
v_accvgpr_write_b32 a23, v252
v_accvgpr_read_b32 v252, a24
v_mul_f32 v252, v252, v56
v_accvgpr_write_b32 a24, v252
v_accvgpr_read_b32 v252, a25
v_mul_f32 v252, v252, v56
v_accvgpr_write_b32 a25, v252
v_accvgpr_read_b32 v252, a26
v_mul_f32 v252, v252, v56
v_accvgpr_write_b32 a26, v252
v_accvgpr_read_b32 v252, a27
v_mul_f32 v252, v252, v56
v_accvgpr_write_b32 a27, v252
v_accvgpr_read_b32 v252, a28
v_mul_f32 v252, v252, v56
v_accvgpr_write_b32 a28, v252
v_accvgpr_read_b32 v252, a29
v_mul_f32 v252, v252, v56
v_accvgpr_write_b32 a29, v252
v_accvgpr_read_b32 v252, a30
v_mul_f32 v252, v252, v56
v_accvgpr_write_b32 a30, v252
v_accvgpr_read_b32 v252, a31
v_mul_f32 v252, v252, v56
v_accvgpr_write_b32 a31, v252
v_max_f32 v53, 0, v53
v_ceil_f32 v53, v53
v_exp_f32_e64 v57, -v53
v_sub_f32 v36, v36, v53
v_sub_f32 v37, v37, v53
v_sub_f32 v38, v38, v53
v_sub_f32 v39, v39, v53
v_sub_f32 v192, v192, v53
v_sub_f32 v193, v193, v53
v_sub_f32 v194, v194, v53
v_sub_f32 v195, v195, v53
v_sub_f32 v208, v208, v53
v_sub_f32 v209, v209, v53
v_sub_f32 v210, v210, v53
v_sub_f32 v211, v211, v53
v_sub_f32 v224, v224, v53
v_sub_f32 v225, v225, v53
v_sub_f32 v226, v226, v53
v_sub_f32 v227, v227, v53
v_sub_f32 v240, v240, v53
v_sub_f32 v241, v241, v53
v_sub_f32 v242, v242, v53
v_sub_f32 v243, v243, v53
v_lshlrev_b32 v252, 16, v128
v_and_b32 v253, 0xffff0000, v128
v_mul_f32 v252, v252, v57
v_mul_f32 v253, v253, v57
v_cvt_pk_bf16_f32 v128, v252, v253
v_lshlrev_b32 v252, 16, v129
v_and_b32 v253, 0xffff0000, v129
v_mul_f32 v252, v252, v57
v_mul_f32 v253, v253, v57
v_cvt_pk_bf16_f32 v129, v252, v253
v_lshlrev_b32 v252, 16, v130
v_and_b32 v253, 0xffff0000, v130
v_mul_f32 v252, v252, v57
v_mul_f32 v253, v253, v57
v_cvt_pk_bf16_f32 v130, v252, v253
v_lshlrev_b32 v252, 16, v131
v_and_b32 v253, 0xffff0000, v131
v_mul_f32 v252, v252, v57
v_mul_f32 v253, v253, v57
v_cvt_pk_bf16_f32 v131, v252, v253
v_lshlrev_b32 v252, 16, v160
v_and_b32 v253, 0xffff0000, v160
v_mul_f32 v252, v252, v57
v_mul_f32 v253, v253, v57
v_cvt_pk_bf16_f32 v160, v252, v253
v_lshlrev_b32 v252, 16, v161
v_and_b32 v253, 0xffff0000, v161
v_mul_f32 v252, v252, v57
v_mul_f32 v253, v253, v57
v_cvt_pk_bf16_f32 v161, v252, v253
v_lshlrev_b32 v252, 16, v162
v_and_b32 v253, 0xffff0000, v162
v_mul_f32 v252, v252, v57
v_mul_f32 v253, v253, v57
v_cvt_pk_bf16_f32 v162, v252, v253
v_mul_f32 v178, v178, v57
v_mul_f32 v179, v179, v57
v_accvgpr_read_b32 v252, a132
v_mul_f32 v252, v252, v57
v_accvgpr_write_b32 a132, v252
v_accvgpr_read_b32 v252, a133
v_mul_f32 v252, v252, v57
v_accvgpr_write_b32 a133, v252
v_accvgpr_read_b32 v252, a134
v_mul_f32 v252, v252, v57
v_accvgpr_write_b32 a134, v252
v_accvgpr_read_b32 v252, a135
v_mul_f32 v252, v252, v57
v_accvgpr_write_b32 a135, v252
v_accvgpr_read_b32 v252, a32
v_mul_f32 v252, v252, v57
v_accvgpr_write_b32 a32, v252
v_accvgpr_read_b32 v252, a33
v_mul_f32 v252, v252, v57
v_accvgpr_write_b32 a33, v252
v_accvgpr_read_b32 v252, a34
v_mul_f32 v252, v252, v57
v_accvgpr_write_b32 a34, v252
v_accvgpr_read_b32 v252, a35
v_mul_f32 v252, v252, v57
v_accvgpr_write_b32 a35, v252
v_accvgpr_read_b32 v252, a36
v_mul_f32 v252, v252, v57
v_accvgpr_write_b32 a36, v252
v_accvgpr_read_b32 v252, a37
v_mul_f32 v252, v252, v57
v_accvgpr_write_b32 a37, v252
v_accvgpr_read_b32 v252, a38
v_mul_f32 v252, v252, v57
v_accvgpr_write_b32 a38, v252
v_accvgpr_read_b32 v252, a39
v_mul_f32 v252, v252, v57
v_accvgpr_write_b32 a39, v252
v_accvgpr_read_b32 v252, a40
v_mul_f32 v252, v252, v57
v_accvgpr_write_b32 a40, v252
v_accvgpr_read_b32 v252, a41
v_mul_f32 v252, v252, v57
v_accvgpr_write_b32 a41, v252
v_accvgpr_read_b32 v252, a42
v_mul_f32 v252, v252, v57
v_accvgpr_write_b32 a42, v252
v_accvgpr_read_b32 v252, a43
v_mul_f32 v252, v252, v57
v_accvgpr_write_b32 a43, v252
v_accvgpr_read_b32 v252, a44
v_mul_f32 v252, v252, v57
v_accvgpr_write_b32 a44, v252
v_accvgpr_read_b32 v252, a45
v_mul_f32 v252, v252, v57
v_accvgpr_write_b32 a45, v252
v_accvgpr_read_b32 v252, a46
v_mul_f32 v252, v252, v57
v_accvgpr_write_b32 a46, v252
v_accvgpr_read_b32 v252, a47
v_mul_f32 v252, v252, v57
v_accvgpr_write_b32 a47, v252
v_accvgpr_read_b32 v252, a48
v_mul_f32 v252, v252, v57
v_accvgpr_write_b32 a48, v252
v_accvgpr_read_b32 v252, a49
v_mul_f32 v252, v252, v57
v_accvgpr_write_b32 a49, v252
v_accvgpr_read_b32 v252, a50
v_mul_f32 v252, v252, v57
v_accvgpr_write_b32 a50, v252
v_accvgpr_read_b32 v252, a51
v_mul_f32 v252, v252, v57
v_accvgpr_write_b32 a51, v252
v_accvgpr_read_b32 v252, a52
v_mul_f32 v252, v252, v57
v_accvgpr_write_b32 a52, v252
v_accvgpr_read_b32 v252, a53
v_mul_f32 v252, v252, v57
v_accvgpr_write_b32 a53, v252
v_accvgpr_read_b32 v252, a54
v_mul_f32 v252, v252, v57
v_accvgpr_write_b32 a54, v252
v_accvgpr_read_b32 v252, a55
v_mul_f32 v252, v252, v57
v_accvgpr_write_b32 a55, v252
v_accvgpr_read_b32 v252, a56
v_mul_f32 v252, v252, v57
v_accvgpr_write_b32 a56, v252
v_accvgpr_read_b32 v252, a57
v_mul_f32 v252, v252, v57
v_accvgpr_write_b32 a57, v252
v_accvgpr_read_b32 v252, a58
v_mul_f32 v252, v252, v57
v_accvgpr_write_b32 a58, v252
v_accvgpr_read_b32 v252, a59
v_mul_f32 v252, v252, v57
v_accvgpr_write_b32 a59, v252
v_accvgpr_read_b32 v252, a60
v_mul_f32 v252, v252, v57
v_accvgpr_write_b32 a60, v252
v_accvgpr_read_b32 v252, a61
v_mul_f32 v252, v252, v57
v_accvgpr_write_b32 a61, v252
v_accvgpr_read_b32 v252, a62
v_mul_f32 v252, v252, v57
v_accvgpr_write_b32 a62, v252
v_accvgpr_read_b32 v252, a63
v_mul_f32 v252, v252, v57
v_accvgpr_write_b32 a63, v252
v_max_f32 v54, 0, v54
v_ceil_f32 v54, v54
v_exp_f32_e64 v58, -v54
v_sub_f32 v40, v40, v54
v_sub_f32 v41, v41, v54
v_sub_f32 v42, v42, v54
v_sub_f32 v43, v43, v54
v_sub_f32 v196, v196, v54
v_sub_f32 v197, v197, v54
v_sub_f32 v198, v198, v54
v_sub_f32 v199, v199, v54
v_sub_f32 v212, v212, v54
v_sub_f32 v213, v213, v54
v_sub_f32 v214, v214, v54
v_sub_f32 v215, v215, v54
v_sub_f32 v228, v228, v54
v_sub_f32 v229, v229, v54
v_sub_f32 v230, v230, v54
v_sub_f32 v231, v231, v54
v_sub_f32 v244, v244, v54
v_sub_f32 v245, v245, v54
v_sub_f32 v246, v246, v54
v_sub_f32 v247, v247, v54
v_lshlrev_b32 v252, 16, v132
v_and_b32 v253, 0xffff0000, v132
v_mul_f32 v252, v252, v58
v_mul_f32 v253, v253, v58
v_cvt_pk_bf16_f32 v132, v252, v253
v_lshlrev_b32 v252, 16, v133
v_and_b32 v253, 0xffff0000, v133
v_mul_f32 v252, v252, v58
v_mul_f32 v253, v253, v58
v_cvt_pk_bf16_f32 v133, v252, v253
v_lshlrev_b32 v252, 16, v134
v_and_b32 v253, 0xffff0000, v134
v_mul_f32 v252, v252, v58
v_mul_f32 v253, v253, v58
v_cvt_pk_bf16_f32 v134, v252, v253
v_lshlrev_b32 v252, 16, v135
v_and_b32 v253, 0xffff0000, v135
v_mul_f32 v252, v252, v58
v_mul_f32 v253, v253, v58
v_cvt_pk_bf16_f32 v135, v252, v253
v_sub_f32 v164, v164, v54
v_sub_f32 v165, v165, v54
v_sub_f32 v166, v166, v54
v_sub_f32 v167, v167, v54
v_sub_f32 v180, v180, v54
v_sub_f32 v181, v181, v54
v_sub_f32 v182, v182, v54
v_sub_f32 v183, v183, v54
v_accvgpr_read_b32 v252, a136
v_mul_f32 v252, v252, v58
v_accvgpr_write_b32 a136, v252
v_accvgpr_read_b32 v252, a137
v_mul_f32 v252, v252, v58
v_accvgpr_write_b32 a137, v252
v_accvgpr_read_b32 v252, a138
v_mul_f32 v252, v252, v58
v_accvgpr_write_b32 a138, v252
v_accvgpr_read_b32 v252, a139
v_mul_f32 v252, v252, v58
v_accvgpr_write_b32 a139, v252
v_accvgpr_read_b32 v252, a64
v_mul_f32 v252, v252, v58
v_accvgpr_write_b32 a64, v252
v_accvgpr_read_b32 v252, a65
v_mul_f32 v252, v252, v58
v_accvgpr_write_b32 a65, v252
v_accvgpr_read_b32 v252, a66
v_mul_f32 v252, v252, v58
v_accvgpr_write_b32 a66, v252
v_accvgpr_read_b32 v252, a67
v_mul_f32 v252, v252, v58
v_accvgpr_write_b32 a67, v252
v_accvgpr_read_b32 v252, a68
v_mul_f32 v252, v252, v58
v_accvgpr_write_b32 a68, v252
v_accvgpr_read_b32 v252, a69
v_mul_f32 v252, v252, v58
v_accvgpr_write_b32 a69, v252
v_accvgpr_read_b32 v252, a70
v_mul_f32 v252, v252, v58
v_accvgpr_write_b32 a70, v252
v_accvgpr_read_b32 v252, a71
v_mul_f32 v252, v252, v58
v_accvgpr_write_b32 a71, v252
v_accvgpr_read_b32 v252, a72
v_mul_f32 v252, v252, v58
v_accvgpr_write_b32 a72, v252
v_accvgpr_read_b32 v252, a73
v_mul_f32 v252, v252, v58
v_accvgpr_write_b32 a73, v252
v_accvgpr_read_b32 v252, a74
v_mul_f32 v252, v252, v58
v_accvgpr_write_b32 a74, v252
v_accvgpr_read_b32 v252, a75
v_mul_f32 v252, v252, v58
v_accvgpr_write_b32 a75, v252
v_accvgpr_read_b32 v252, a76
v_mul_f32 v252, v252, v58
v_accvgpr_write_b32 a76, v252
v_accvgpr_read_b32 v252, a77
v_mul_f32 v252, v252, v58
v_accvgpr_write_b32 a77, v252
v_accvgpr_read_b32 v252, a78
v_mul_f32 v252, v252, v58
v_accvgpr_write_b32 a78, v252
v_accvgpr_read_b32 v252, a79
v_mul_f32 v252, v252, v58
v_accvgpr_write_b32 a79, v252
v_accvgpr_read_b32 v252, a80
v_mul_f32 v252, v252, v58
v_accvgpr_write_b32 a80, v252
v_accvgpr_read_b32 v252, a81
v_mul_f32 v252, v252, v58
v_accvgpr_write_b32 a81, v252
v_accvgpr_read_b32 v252, a82
v_mul_f32 v252, v252, v58
v_accvgpr_write_b32 a82, v252
v_accvgpr_read_b32 v252, a83
v_mul_f32 v252, v252, v58
v_accvgpr_write_b32 a83, v252
v_accvgpr_read_b32 v252, a84
v_mul_f32 v252, v252, v58
v_accvgpr_write_b32 a84, v252
v_accvgpr_read_b32 v252, a85
v_mul_f32 v252, v252, v58
v_accvgpr_write_b32 a85, v252
v_accvgpr_read_b32 v252, a86
v_mul_f32 v252, v252, v58
v_accvgpr_write_b32 a86, v252
v_accvgpr_read_b32 v252, a87
v_mul_f32 v252, v252, v58
v_accvgpr_write_b32 a87, v252
v_accvgpr_read_b32 v252, a88
v_mul_f32 v252, v252, v58
v_accvgpr_write_b32 a88, v252
v_accvgpr_read_b32 v252, a89
v_mul_f32 v252, v252, v58
v_accvgpr_write_b32 a89, v252
v_accvgpr_read_b32 v252, a90
v_mul_f32 v252, v252, v58
v_accvgpr_write_b32 a90, v252
v_accvgpr_read_b32 v252, a91
v_mul_f32 v252, v252, v58
v_accvgpr_write_b32 a91, v252
v_accvgpr_read_b32 v252, a92
v_mul_f32 v252, v252, v58
v_accvgpr_write_b32 a92, v252
v_accvgpr_read_b32 v252, a93
v_mul_f32 v252, v252, v58
v_accvgpr_write_b32 a93, v252
v_accvgpr_read_b32 v252, a94
v_mul_f32 v252, v252, v58
v_accvgpr_write_b32 a94, v252
v_accvgpr_read_b32 v252, a95
v_mul_f32 v252, v252, v58
v_accvgpr_write_b32 a95, v252
v_max_f32 v55, 0, v55
v_ceil_f32 v55, v55
v_exp_f32_e64 v59, -v55
v_sub_f32 v44, v44, v55
v_sub_f32 v45, v45, v55
v_sub_f32 v46, v46, v55
v_sub_f32 v47, v47, v55
v_sub_f32 v200, v200, v55
v_sub_f32 v201, v201, v55
v_sub_f32 v202, v202, v55
v_sub_f32 v203, v203, v55
v_sub_f32 v216, v216, v55
v_sub_f32 v217, v217, v55
v_sub_f32 v218, v218, v55
v_sub_f32 v219, v219, v55
v_sub_f32 v232, v232, v55
v_sub_f32 v233, v233, v55
v_sub_f32 v234, v234, v55
v_sub_f32 v235, v235, v55
v_sub_f32 v248, v248, v55
v_sub_f32 v249, v249, v55
v_sub_f32 v250, v250, v55
v_sub_f32 v251, v251, v55
v_lshlrev_b32 v252, 16, v136
v_and_b32 v253, 0xffff0000, v136
v_mul_f32 v252, v252, v59
v_mul_f32 v253, v253, v59
v_cvt_pk_bf16_f32 v136, v252, v253
v_lshlrev_b32 v252, 16, v137
v_and_b32 v253, 0xffff0000, v137
v_mul_f32 v252, v252, v59
v_mul_f32 v253, v253, v59
v_cvt_pk_bf16_f32 v137, v252, v253
v_lshlrev_b32 v252, 16, v138
v_and_b32 v253, 0xffff0000, v138
v_mul_f32 v252, v252, v59
v_mul_f32 v253, v253, v59
v_cvt_pk_bf16_f32 v138, v252, v253
v_lshlrev_b32 v252, 16, v139
v_and_b32 v253, 0xffff0000, v139
v_mul_f32 v252, v252, v59
v_mul_f32 v253, v253, v59
v_cvt_pk_bf16_f32 v139, v252, v253
v_sub_f32 v168, v168, v55
v_sub_f32 v169, v169, v55
v_sub_f32 v170, v170, v55
v_sub_f32 v171, v171, v55
v_sub_f32 v184, v184, v55
v_sub_f32 v185, v185, v55
v_sub_f32 v186, v186, v55
v_sub_f32 v187, v187, v55
v_accvgpr_read_b32 v252, a140
v_mul_f32 v252, v252, v59
v_accvgpr_write_b32 a140, v252
v_accvgpr_read_b32 v252, a141
v_mul_f32 v252, v252, v59
v_accvgpr_write_b32 a141, v252
v_accvgpr_read_b32 v252, a142
v_mul_f32 v252, v252, v59
v_accvgpr_write_b32 a142, v252
v_accvgpr_read_b32 v252, a143
v_mul_f32 v252, v252, v59
v_accvgpr_write_b32 a143, v252
v_accvgpr_read_b32 v252, a96
v_mul_f32 v252, v252, v59
v_accvgpr_write_b32 a96, v252
v_accvgpr_read_b32 v252, a97
v_mul_f32 v252, v252, v59
v_accvgpr_write_b32 a97, v252
v_accvgpr_read_b32 v252, a98
v_mul_f32 v252, v252, v59
v_accvgpr_write_b32 a98, v252
v_accvgpr_read_b32 v252, a99
v_mul_f32 v252, v252, v59
v_accvgpr_write_b32 a99, v252
v_accvgpr_read_b32 v252, a100
v_mul_f32 v252, v252, v59
v_accvgpr_write_b32 a100, v252
v_accvgpr_read_b32 v252, a101
v_mul_f32 v252, v252, v59
v_accvgpr_write_b32 a101, v252
v_accvgpr_read_b32 v252, a102
v_mul_f32 v252, v252, v59
v_accvgpr_write_b32 a102, v252
v_accvgpr_read_b32 v252, a103
v_mul_f32 v252, v252, v59
v_accvgpr_write_b32 a103, v252
v_accvgpr_read_b32 v252, a104
v_mul_f32 v252, v252, v59
v_accvgpr_write_b32 a104, v252
v_accvgpr_read_b32 v252, a105
v_mul_f32 v252, v252, v59
v_accvgpr_write_b32 a105, v252
v_accvgpr_read_b32 v252, a106
v_mul_f32 v252, v252, v59
v_accvgpr_write_b32 a106, v252
v_accvgpr_read_b32 v252, a107
v_mul_f32 v252, v252, v59
v_accvgpr_write_b32 a107, v252
v_accvgpr_read_b32 v252, a108
v_mul_f32 v252, v252, v59
v_accvgpr_write_b32 a108, v252
v_accvgpr_read_b32 v252, a109
v_mul_f32 v252, v252, v59
v_accvgpr_write_b32 a109, v252
v_accvgpr_read_b32 v252, a110
v_mul_f32 v252, v252, v59
v_accvgpr_write_b32 a110, v252
v_accvgpr_read_b32 v252, a111
v_mul_f32 v252, v252, v59
v_accvgpr_write_b32 a111, v252
v_accvgpr_read_b32 v252, a112
v_mul_f32 v252, v252, v59
v_accvgpr_write_b32 a112, v252
v_accvgpr_read_b32 v252, a113
v_mul_f32 v252, v252, v59
v_accvgpr_write_b32 a113, v252
v_accvgpr_read_b32 v252, a114
v_mul_f32 v252, v252, v59
v_accvgpr_write_b32 a114, v252
v_accvgpr_read_b32 v252, a115
v_mul_f32 v252, v252, v59
v_accvgpr_write_b32 a115, v252
v_accvgpr_read_b32 v252, a116
v_mul_f32 v252, v252, v59
v_accvgpr_write_b32 a116, v252
v_accvgpr_read_b32 v252, a117
v_mul_f32 v252, v252, v59
v_accvgpr_write_b32 a117, v252
v_accvgpr_read_b32 v252, a118
v_mul_f32 v252, v252, v59
v_accvgpr_write_b32 a118, v252
v_accvgpr_read_b32 v252, a119
v_mul_f32 v252, v252, v59
v_accvgpr_write_b32 a119, v252
v_accvgpr_read_b32 v252, a120
v_mul_f32 v252, v252, v59
v_accvgpr_write_b32 a120, v252
v_accvgpr_read_b32 v252, a121
v_mul_f32 v252, v252, v59
v_accvgpr_write_b32 a121, v252
v_accvgpr_read_b32 v252, a122
v_mul_f32 v252, v252, v59
v_accvgpr_write_b32 a122, v252
v_accvgpr_read_b32 v252, a123
v_mul_f32 v252, v252, v59
v_accvgpr_write_b32 a123, v252
v_accvgpr_read_b32 v252, a124
v_mul_f32 v252, v252, v59
v_accvgpr_write_b32 a124, v252
v_accvgpr_read_b32 v252, a125
v_mul_f32 v252, v252, v59
v_accvgpr_write_b32 a125, v252
v_accvgpr_read_b32 v252, a126
v_mul_f32 v252, v252, v59
v_accvgpr_write_b32 a126, v252
v_accvgpr_read_b32 v252, a127
v_mul_f32 v252, v252, v59
v_accvgpr_write_b32 a127, v252
s_nop 1
s_branch ka_kernel_back18
ka_kernel_slow19:
s_nop 15
v_mov_b32 v56, v52
v_mov_b32 v57, v53
v_mov_b32 v58, v54
v_mov_b32 v59, v55
v_permlane16_swap_b32 v52, v56
v_permlane16_swap_b32 v53, v57
v_permlane16_swap_b32 v54, v58
v_permlane16_swap_b32 v55, v59
v_max_f32 v52, v52, v56
v_max_f32 v53, v53, v57
v_max_f32 v54, v54, v58
v_max_f32 v55, v55, v59
v_mov_b32 v56, v52
v_mov_b32 v57, v53
v_mov_b32 v58, v54
v_mov_b32 v59, v55
v_permlane32_swap_b32 v52, v56
v_permlane32_swap_b32 v53, v57
v_permlane32_swap_b32 v54, v58
v_permlane32_swap_b32 v55, v59
v_max_f32 v52, v52, v56
v_max_f32 v53, v53, v57
v_max_f32 v54, v54, v58
v_max_f32 v55, v55, v59
v_max_f32 v52, 0, v52
v_ceil_f32 v52, v52
v_exp_f32_e64 v56, -v52
v_sub_f32 v32, v32, v52
v_sub_f32 v33, v33, v52
v_sub_f32 v34, v34, v52
v_sub_f32 v35, v35, v52
v_sub_f32 v124, v124, v52
v_sub_f32 v125, v125, v52
v_sub_f32 v126, v126, v52
v_sub_f32 v127, v127, v52
v_sub_f32 v140, v140, v52
v_sub_f32 v141, v141, v52
v_sub_f32 v142, v142, v52
v_sub_f32 v143, v143, v52
v_sub_f32 v156, v156, v52
v_sub_f32 v157, v157, v52
v_sub_f32 v158, v158, v52
v_sub_f32 v159, v159, v52
v_sub_f32 v172, v172, v52
v_sub_f32 v173, v173, v52
v_sub_f32 v174, v174, v52
v_sub_f32 v175, v175, v52
v_lshlrev_b32 v252, 16, v188
v_and_b32 v253, 0xffff0000, v188
v_mul_f32 v252, v252, v56
v_mul_f32 v253, v253, v56
v_cvt_pk_bf16_f32 v188, v252, v253
v_lshlrev_b32 v252, 16, v189
v_and_b32 v253, 0xffff0000, v189
v_mul_f32 v252, v252, v56
v_mul_f32 v253, v253, v56
v_cvt_pk_bf16_f32 v189, v252, v253
v_lshlrev_b32 v252, 16, v190
v_and_b32 v253, 0xffff0000, v190
v_mul_f32 v252, v252, v56
v_mul_f32 v253, v253, v56
v_cvt_pk_bf16_f32 v190, v252, v253
v_lshlrev_b32 v252, 16, v191
v_and_b32 v253, 0xffff0000, v191
v_mul_f32 v252, v252, v56
v_mul_f32 v253, v253, v56
v_cvt_pk_bf16_f32 v191, v252, v253
v_lshlrev_b32 v252, 16, v220
v_and_b32 v253, 0xffff0000, v220
v_mul_f32 v252, v252, v56
v_mul_f32 v253, v253, v56
v_cvt_pk_bf16_f32 v220, v252, v253
v_lshlrev_b32 v252, 16, v221
v_and_b32 v253, 0xffff0000, v221
v_mul_f32 v252, v252, v56
v_mul_f32 v253, v253, v56
v_cvt_pk_bf16_f32 v221, v252, v253
v_lshlrev_b32 v252, 16, v222
v_and_b32 v253, 0xffff0000, v222
v_mul_f32 v252, v252, v56
v_mul_f32 v253, v253, v56
v_cvt_pk_bf16_f32 v222, v252, v253
v_lshlrev_b32 v252, 16, v223
v_and_b32 v253, 0xffff0000, v223
v_mul_f32 v252, v252, v56
v_mul_f32 v253, v253, v56
v_cvt_pk_bf16_f32 v223, v252, v253
v_accvgpr_read_b32 v252, a128
v_mul_f32 v252, v252, v56
v_accvgpr_write_b32 a128, v252
v_accvgpr_read_b32 v252, a129
v_mul_f32 v252, v252, v56
v_accvgpr_write_b32 a129, v252
v_accvgpr_read_b32 v252, a130
v_mul_f32 v252, v252, v56
v_accvgpr_write_b32 a130, v252
v_accvgpr_read_b32 v252, a131
v_mul_f32 v252, v252, v56
v_accvgpr_write_b32 a131, v252
v_accvgpr_read_b32 v252, a0
v_mul_f32 v252, v252, v56
v_accvgpr_write_b32 a0, v252
v_accvgpr_read_b32 v252, a1
v_mul_f32 v252, v252, v56
v_accvgpr_write_b32 a1, v252
v_accvgpr_read_b32 v252, a2
v_mul_f32 v252, v252, v56
v_accvgpr_write_b32 a2, v252
v_accvgpr_read_b32 v252, a3
v_mul_f32 v252, v252, v56
v_accvgpr_write_b32 a3, v252
v_accvgpr_read_b32 v252, a4
v_mul_f32 v252, v252, v56
v_accvgpr_write_b32 a4, v252
v_accvgpr_read_b32 v252, a5
v_mul_f32 v252, v252, v56
v_accvgpr_write_b32 a5, v252
v_accvgpr_read_b32 v252, a6
v_mul_f32 v252, v252, v56
v_accvgpr_write_b32 a6, v252
v_accvgpr_read_b32 v252, a7
v_mul_f32 v252, v252, v56
v_accvgpr_write_b32 a7, v252
v_accvgpr_read_b32 v252, a8
v_mul_f32 v252, v252, v56
v_accvgpr_write_b32 a8, v252
v_accvgpr_read_b32 v252, a9
v_mul_f32 v252, v252, v56
v_accvgpr_write_b32 a9, v252
v_accvgpr_read_b32 v252, a10
v_mul_f32 v252, v252, v56
v_accvgpr_write_b32 a10, v252
v_accvgpr_read_b32 v252, a11
v_mul_f32 v252, v252, v56
v_accvgpr_write_b32 a11, v252
v_accvgpr_read_b32 v252, a12
v_mul_f32 v252, v252, v56
v_accvgpr_write_b32 a12, v252
v_accvgpr_read_b32 v252, a13
v_mul_f32 v252, v252, v56
v_accvgpr_write_b32 a13, v252
v_accvgpr_read_b32 v252, a14
v_mul_f32 v252, v252, v56
v_accvgpr_write_b32 a14, v252
v_accvgpr_read_b32 v252, a15
v_mul_f32 v252, v252, v56
v_accvgpr_write_b32 a15, v252
v_accvgpr_read_b32 v252, a16
v_mul_f32 v252, v252, v56
v_accvgpr_write_b32 a16, v252
v_accvgpr_read_b32 v252, a17
v_mul_f32 v252, v252, v56
v_accvgpr_write_b32 a17, v252
v_accvgpr_read_b32 v252, a18
v_mul_f32 v252, v252, v56
v_accvgpr_write_b32 a18, v252
v_accvgpr_read_b32 v252, a19
v_mul_f32 v252, v252, v56
v_accvgpr_write_b32 a19, v252
v_accvgpr_read_b32 v252, a20
v_mul_f32 v252, v252, v56
v_accvgpr_write_b32 a20, v252
v_accvgpr_read_b32 v252, a21
v_mul_f32 v252, v252, v56
v_accvgpr_write_b32 a21, v252
v_accvgpr_read_b32 v252, a22
v_mul_f32 v252, v252, v56
v_accvgpr_write_b32 a22, v252
v_accvgpr_read_b32 v252, a23
v_mul_f32 v252, v252, v56
v_accvgpr_write_b32 a23, v252
v_accvgpr_read_b32 v252, a24
v_mul_f32 v252, v252, v56
v_accvgpr_write_b32 a24, v252
v_accvgpr_read_b32 v252, a25
v_mul_f32 v252, v252, v56
v_accvgpr_write_b32 a25, v252
v_accvgpr_read_b32 v252, a26
v_mul_f32 v252, v252, v56
v_accvgpr_write_b32 a26, v252
v_accvgpr_read_b32 v252, a27
v_mul_f32 v252, v252, v56
v_accvgpr_write_b32 a27, v252
v_accvgpr_read_b32 v252, a28
v_mul_f32 v252, v252, v56
v_accvgpr_write_b32 a28, v252
v_accvgpr_read_b32 v252, a29
v_mul_f32 v252, v252, v56
v_accvgpr_write_b32 a29, v252
v_accvgpr_read_b32 v252, a30
v_mul_f32 v252, v252, v56
v_accvgpr_write_b32 a30, v252
v_accvgpr_read_b32 v252, a31
v_mul_f32 v252, v252, v56
v_accvgpr_write_b32 a31, v252
v_max_f32 v53, 0, v53
v_ceil_f32 v53, v53
v_exp_f32_e64 v57, -v53
v_sub_f32 v36, v36, v53
v_sub_f32 v37, v37, v53
v_sub_f32 v38, v38, v53
v_sub_f32 v39, v39, v53
v_sub_f32 v128, v128, v53
v_sub_f32 v129, v129, v53
v_sub_f32 v130, v130, v53
v_sub_f32 v131, v131, v53
v_sub_f32 v144, v144, v53
v_sub_f32 v145, v145, v53
v_sub_f32 v146, v146, v53
v_sub_f32 v147, v147, v53
v_sub_f32 v160, v160, v53
v_sub_f32 v161, v161, v53
v_sub_f32 v162, v162, v53
v_sub_f32 v163, v163, v53
v_sub_f32 v176, v176, v53
v_sub_f32 v177, v177, v53
v_sub_f32 v178, v178, v53
v_sub_f32 v179, v179, v53
v_lshlrev_b32 v252, 16, v192
v_and_b32 v253, 0xffff0000, v192
v_mul_f32 v252, v252, v57
v_mul_f32 v253, v253, v57
v_cvt_pk_bf16_f32 v192, v252, v253
v_lshlrev_b32 v252, 16, v193
v_and_b32 v253, 0xffff0000, v193
v_mul_f32 v252, v252, v57
v_mul_f32 v253, v253, v57
v_cvt_pk_bf16_f32 v193, v252, v253
v_lshlrev_b32 v252, 16, v194
v_and_b32 v253, 0xffff0000, v194
v_mul_f32 v252, v252, v57
v_mul_f32 v253, v253, v57
v_cvt_pk_bf16_f32 v194, v252, v253
v_lshlrev_b32 v252, 16, v195
v_and_b32 v253, 0xffff0000, v195
v_mul_f32 v252, v252, v57
v_mul_f32 v253, v253, v57
v_cvt_pk_bf16_f32 v195, v252, v253
v_lshlrev_b32 v252, 16, v224
v_and_b32 v253, 0xffff0000, v224
v_mul_f32 v252, v252, v57
v_mul_f32 v253, v253, v57
v_cvt_pk_bf16_f32 v224, v252, v253
v_lshlrev_b32 v252, 16, v225
v_and_b32 v253, 0xffff0000, v225
v_mul_f32 v252, v252, v57
v_mul_f32 v253, v253, v57
v_cvt_pk_bf16_f32 v225, v252, v253
v_mul_f32 v240, v240, v57
v_mul_f32 v241, v241, v57
v_mul_f32 v242, v242, v57
v_sub_f32 v243, v243, v53
v_accvgpr_read_b32 v252, a132
v_mul_f32 v252, v252, v57
v_accvgpr_write_b32 a132, v252
v_accvgpr_read_b32 v252, a133
v_mul_f32 v252, v252, v57
v_accvgpr_write_b32 a133, v252
v_accvgpr_read_b32 v252, a134
v_mul_f32 v252, v252, v57
v_accvgpr_write_b32 a134, v252
v_accvgpr_read_b32 v252, a135
v_mul_f32 v252, v252, v57
v_accvgpr_write_b32 a135, v252
v_accvgpr_read_b32 v252, a32
v_mul_f32 v252, v252, v57
v_accvgpr_write_b32 a32, v252
v_accvgpr_read_b32 v252, a33
v_mul_f32 v252, v252, v57
v_accvgpr_write_b32 a33, v252
v_accvgpr_read_b32 v252, a34
v_mul_f32 v252, v252, v57
v_accvgpr_write_b32 a34, v252
v_accvgpr_read_b32 v252, a35
v_mul_f32 v252, v252, v57
v_accvgpr_write_b32 a35, v252
v_accvgpr_read_b32 v252, a36
v_mul_f32 v252, v252, v57
v_accvgpr_write_b32 a36, v252
v_accvgpr_read_b32 v252, a37
v_mul_f32 v252, v252, v57
v_accvgpr_write_b32 a37, v252
v_accvgpr_read_b32 v252, a38
v_mul_f32 v252, v252, v57
v_accvgpr_write_b32 a38, v252
v_accvgpr_read_b32 v252, a39
v_mul_f32 v252, v252, v57
v_accvgpr_write_b32 a39, v252
v_accvgpr_read_b32 v252, a40
v_mul_f32 v252, v252, v57
v_accvgpr_write_b32 a40, v252
v_accvgpr_read_b32 v252, a41
v_mul_f32 v252, v252, v57
v_accvgpr_write_b32 a41, v252
v_accvgpr_read_b32 v252, a42
v_mul_f32 v252, v252, v57
v_accvgpr_write_b32 a42, v252
v_accvgpr_read_b32 v252, a43
v_mul_f32 v252, v252, v57
v_accvgpr_write_b32 a43, v252
v_accvgpr_read_b32 v252, a44
v_mul_f32 v252, v252, v57
v_accvgpr_write_b32 a44, v252
v_accvgpr_read_b32 v252, a45
v_mul_f32 v252, v252, v57
v_accvgpr_write_b32 a45, v252
v_accvgpr_read_b32 v252, a46
v_mul_f32 v252, v252, v57
v_accvgpr_write_b32 a46, v252
v_accvgpr_read_b32 v252, a47
v_mul_f32 v252, v252, v57
v_accvgpr_write_b32 a47, v252
v_accvgpr_read_b32 v252, a48
v_mul_f32 v252, v252, v57
v_accvgpr_write_b32 a48, v252
v_accvgpr_read_b32 v252, a49
v_mul_f32 v252, v252, v57
v_accvgpr_write_b32 a49, v252
v_accvgpr_read_b32 v252, a50
v_mul_f32 v252, v252, v57
v_accvgpr_write_b32 a50, v252
v_accvgpr_read_b32 v252, a51
v_mul_f32 v252, v252, v57
v_accvgpr_write_b32 a51, v252
v_accvgpr_read_b32 v252, a52
v_mul_f32 v252, v252, v57
v_accvgpr_write_b32 a52, v252
v_accvgpr_read_b32 v252, a53
v_mul_f32 v252, v252, v57
v_accvgpr_write_b32 a53, v252
v_accvgpr_read_b32 v252, a54
v_mul_f32 v252, v252, v57
v_accvgpr_write_b32 a54, v252
v_accvgpr_read_b32 v252, a55
v_mul_f32 v252, v252, v57
v_accvgpr_write_b32 a55, v252
v_accvgpr_read_b32 v252, a56
v_mul_f32 v252, v252, v57
v_accvgpr_write_b32 a56, v252
v_accvgpr_read_b32 v252, a57
v_mul_f32 v252, v252, v57
v_accvgpr_write_b32 a57, v252
v_accvgpr_read_b32 v252, a58
v_mul_f32 v252, v252, v57
v_accvgpr_write_b32 a58, v252
v_accvgpr_read_b32 v252, a59
v_mul_f32 v252, v252, v57
v_accvgpr_write_b32 a59, v252
v_accvgpr_read_b32 v252, a60
v_mul_f32 v252, v252, v57
v_accvgpr_write_b32 a60, v252
v_accvgpr_read_b32 v252, a61
v_mul_f32 v252, v252, v57
v_accvgpr_write_b32 a61, v252
v_accvgpr_read_b32 v252, a62
v_mul_f32 v252, v252, v57
v_accvgpr_write_b32 a62, v252
v_accvgpr_read_b32 v252, a63
v_mul_f32 v252, v252, v57
v_accvgpr_write_b32 a63, v252
v_max_f32 v54, 0, v54
v_ceil_f32 v54, v54
v_exp_f32_e64 v58, -v54
v_sub_f32 v40, v40, v54
v_sub_f32 v41, v41, v54
v_sub_f32 v42, v42, v54
v_sub_f32 v43, v43, v54
v_sub_f32 v132, v132, v54
v_sub_f32 v133, v133, v54
v_sub_f32 v134, v134, v54
v_sub_f32 v135, v135, v54
v_sub_f32 v148, v148, v54
v_sub_f32 v149, v149, v54
v_sub_f32 v150, v150, v54
v_sub_f32 v151, v151, v54
v_sub_f32 v164, v164, v54
v_sub_f32 v165, v165, v54
v_sub_f32 v166, v166, v54
v_sub_f32 v167, v167, v54
v_sub_f32 v180, v180, v54
v_sub_f32 v181, v181, v54
v_sub_f32 v182, v182, v54
v_sub_f32 v183, v183, v54
v_lshlrev_b32 v252, 16, v196
v_and_b32 v253, 0xffff0000, v196
v_mul_f32 v252, v252, v58
v_mul_f32 v253, v253, v58
v_cvt_pk_bf16_f32 v196, v252, v253
v_lshlrev_b32 v252, 16, v197
v_and_b32 v253, 0xffff0000, v197
v_mul_f32 v252, v252, v58
v_mul_f32 v253, v253, v58
v_cvt_pk_bf16_f32 v197, v252, v253
v_lshlrev_b32 v252, 16, v198
v_and_b32 v253, 0xffff0000, v198
v_mul_f32 v252, v252, v58
v_mul_f32 v253, v253, v58
v_cvt_pk_bf16_f32 v198, v252, v253
v_lshlrev_b32 v252, 16, v199
v_and_b32 v253, 0xffff0000, v199
v_mul_f32 v252, v252, v58
v_mul_f32 v253, v253, v58
v_cvt_pk_bf16_f32 v199, v252, v253
v_sub_f32 v228, v228, v54
v_sub_f32 v229, v229, v54
v_sub_f32 v230, v230, v54
v_sub_f32 v231, v231, v54
v_sub_f32 v244, v244, v54
v_sub_f32 v245, v245, v54
v_sub_f32 v246, v246, v54
v_sub_f32 v247, v247, v54
v_accvgpr_read_b32 v252, a136
v_mul_f32 v252, v252, v58
v_accvgpr_write_b32 a136, v252
v_accvgpr_read_b32 v252, a137
v_mul_f32 v252, v252, v58
v_accvgpr_write_b32 a137, v252
v_accvgpr_read_b32 v252, a138
v_mul_f32 v252, v252, v58
v_accvgpr_write_b32 a138, v252
v_accvgpr_read_b32 v252, a139
v_mul_f32 v252, v252, v58
v_accvgpr_write_b32 a139, v252
v_accvgpr_read_b32 v252, a64
v_mul_f32 v252, v252, v58
v_accvgpr_write_b32 a64, v252
v_accvgpr_read_b32 v252, a65
v_mul_f32 v252, v252, v58
v_accvgpr_write_b32 a65, v252
v_accvgpr_read_b32 v252, a66
v_mul_f32 v252, v252, v58
v_accvgpr_write_b32 a66, v252
v_accvgpr_read_b32 v252, a67
v_mul_f32 v252, v252, v58
v_accvgpr_write_b32 a67, v252
v_accvgpr_read_b32 v252, a68
v_mul_f32 v252, v252, v58
v_accvgpr_write_b32 a68, v252
v_accvgpr_read_b32 v252, a69
v_mul_f32 v252, v252, v58
v_accvgpr_write_b32 a69, v252
v_accvgpr_read_b32 v252, a70
v_mul_f32 v252, v252, v58
v_accvgpr_write_b32 a70, v252
v_accvgpr_read_b32 v252, a71
v_mul_f32 v252, v252, v58
v_accvgpr_write_b32 a71, v252
v_accvgpr_read_b32 v252, a72
v_mul_f32 v252, v252, v58
v_accvgpr_write_b32 a72, v252
v_accvgpr_read_b32 v252, a73
v_mul_f32 v252, v252, v58
v_accvgpr_write_b32 a73, v252
v_accvgpr_read_b32 v252, a74
v_mul_f32 v252, v252, v58
v_accvgpr_write_b32 a74, v252
v_accvgpr_read_b32 v252, a75
v_mul_f32 v252, v252, v58
v_accvgpr_write_b32 a75, v252
v_accvgpr_read_b32 v252, a76
v_mul_f32 v252, v252, v58
v_accvgpr_write_b32 a76, v252
v_accvgpr_read_b32 v252, a77
v_mul_f32 v252, v252, v58
v_accvgpr_write_b32 a77, v252
v_accvgpr_read_b32 v252, a78
v_mul_f32 v252, v252, v58
v_accvgpr_write_b32 a78, v252
v_accvgpr_read_b32 v252, a79
v_mul_f32 v252, v252, v58
v_accvgpr_write_b32 a79, v252
v_accvgpr_read_b32 v252, a80
v_mul_f32 v252, v252, v58
v_accvgpr_write_b32 a80, v252
v_accvgpr_read_b32 v252, a81
v_mul_f32 v252, v252, v58
v_accvgpr_write_b32 a81, v252
v_accvgpr_read_b32 v252, a82
v_mul_f32 v252, v252, v58
v_accvgpr_write_b32 a82, v252
v_accvgpr_read_b32 v252, a83
v_mul_f32 v252, v252, v58
v_accvgpr_write_b32 a83, v252
v_accvgpr_read_b32 v252, a84
v_mul_f32 v252, v252, v58
v_accvgpr_write_b32 a84, v252
v_accvgpr_read_b32 v252, a85
v_mul_f32 v252, v252, v58
v_accvgpr_write_b32 a85, v252
v_accvgpr_read_b32 v252, a86
v_mul_f32 v252, v252, v58
v_accvgpr_write_b32 a86, v252
v_accvgpr_read_b32 v252, a87
v_mul_f32 v252, v252, v58
v_accvgpr_write_b32 a87, v252
v_accvgpr_read_b32 v252, a88
v_mul_f32 v252, v252, v58
v_accvgpr_write_b32 a88, v252
v_accvgpr_read_b32 v252, a89
v_mul_f32 v252, v252, v58
v_accvgpr_write_b32 a89, v252
v_accvgpr_read_b32 v252, a90
v_mul_f32 v252, v252, v58
v_accvgpr_write_b32 a90, v252
v_accvgpr_read_b32 v252, a91
v_mul_f32 v252, v252, v58
v_accvgpr_write_b32 a91, v252
v_accvgpr_read_b32 v252, a92
v_mul_f32 v252, v252, v58
v_accvgpr_write_b32 a92, v252
v_accvgpr_read_b32 v252, a93
v_mul_f32 v252, v252, v58
v_accvgpr_write_b32 a93, v252
v_accvgpr_read_b32 v252, a94
v_mul_f32 v252, v252, v58
v_accvgpr_write_b32 a94, v252
v_accvgpr_read_b32 v252, a95
v_mul_f32 v252, v252, v58
v_accvgpr_write_b32 a95, v252
v_max_f32 v55, 0, v55
v_ceil_f32 v55, v55
v_exp_f32_e64 v59, -v55
v_sub_f32 v44, v44, v55
v_sub_f32 v45, v45, v55
v_sub_f32 v46, v46, v55
v_sub_f32 v47, v47, v55
v_sub_f32 v136, v136, v55
v_sub_f32 v137, v137, v55
v_sub_f32 v138, v138, v55
v_sub_f32 v139, v139, v55
v_sub_f32 v152, v152, v55
v_sub_f32 v153, v153, v55
v_sub_f32 v154, v154, v55
v_sub_f32 v155, v155, v55
v_sub_f32 v168, v168, v55
v_sub_f32 v169, v169, v55
v_sub_f32 v170, v170, v55
v_sub_f32 v171, v171, v55
v_sub_f32 v184, v184, v55
v_sub_f32 v185, v185, v55
v_sub_f32 v186, v186, v55
v_sub_f32 v187, v187, v55
v_lshlrev_b32 v252, 16, v200
v_and_b32 v253, 0xffff0000, v200
v_mul_f32 v252, v252, v59
v_mul_f32 v253, v253, v59
v_cvt_pk_bf16_f32 v200, v252, v253
v_lshlrev_b32 v252, 16, v201
v_and_b32 v253, 0xffff0000, v201
v_mul_f32 v252, v252, v59
v_mul_f32 v253, v253, v59
v_cvt_pk_bf16_f32 v201, v252, v253
v_lshlrev_b32 v252, 16, v202
v_and_b32 v253, 0xffff0000, v202
v_mul_f32 v252, v252, v59
v_mul_f32 v253, v253, v59
v_cvt_pk_bf16_f32 v202, v252, v253
v_lshlrev_b32 v252, 16, v203
v_and_b32 v253, 0xffff0000, v203
v_mul_f32 v252, v252, v59
v_mul_f32 v253, v253, v59
v_cvt_pk_bf16_f32 v203, v252, v253
v_sub_f32 v232, v232, v55
v_sub_f32 v233, v233, v55
v_sub_f32 v234, v234, v55
v_sub_f32 v235, v235, v55
v_sub_f32 v248, v248, v55
v_sub_f32 v249, v249, v55
v_sub_f32 v250, v250, v55
v_sub_f32 v251, v251, v55
v_accvgpr_read_b32 v252, a140
v_mul_f32 v252, v252, v59
v_accvgpr_write_b32 a140, v252
v_accvgpr_read_b32 v252, a141
v_mul_f32 v252, v252, v59
v_accvgpr_write_b32 a141, v252
v_accvgpr_read_b32 v252, a142
v_mul_f32 v252, v252, v59
v_accvgpr_write_b32 a142, v252
v_accvgpr_read_b32 v252, a143
v_mul_f32 v252, v252, v59
v_accvgpr_write_b32 a143, v252
v_accvgpr_read_b32 v252, a96
v_mul_f32 v252, v252, v59
v_accvgpr_write_b32 a96, v252
v_accvgpr_read_b32 v252, a97
v_mul_f32 v252, v252, v59
v_accvgpr_write_b32 a97, v252
v_accvgpr_read_b32 v252, a98
v_mul_f32 v252, v252, v59
v_accvgpr_write_b32 a98, v252
v_accvgpr_read_b32 v252, a99
v_mul_f32 v252, v252, v59
v_accvgpr_write_b32 a99, v252
v_accvgpr_read_b32 v252, a100
v_mul_f32 v252, v252, v59
v_accvgpr_write_b32 a100, v252
v_accvgpr_read_b32 v252, a101
v_mul_f32 v252, v252, v59
v_accvgpr_write_b32 a101, v252
v_accvgpr_read_b32 v252, a102
v_mul_f32 v252, v252, v59
v_accvgpr_write_b32 a102, v252
v_accvgpr_read_b32 v252, a103
v_mul_f32 v252, v252, v59
v_accvgpr_write_b32 a103, v252
v_accvgpr_read_b32 v252, a104
v_mul_f32 v252, v252, v59
v_accvgpr_write_b32 a104, v252
v_accvgpr_read_b32 v252, a105
v_mul_f32 v252, v252, v59
v_accvgpr_write_b32 a105, v252
v_accvgpr_read_b32 v252, a106
v_mul_f32 v252, v252, v59
v_accvgpr_write_b32 a106, v252
v_accvgpr_read_b32 v252, a107
v_mul_f32 v252, v252, v59
v_accvgpr_write_b32 a107, v252
v_accvgpr_read_b32 v252, a108
v_mul_f32 v252, v252, v59
v_accvgpr_write_b32 a108, v252
v_accvgpr_read_b32 v252, a109
v_mul_f32 v252, v252, v59
v_accvgpr_write_b32 a109, v252
v_accvgpr_read_b32 v252, a110
v_mul_f32 v252, v252, v59
v_accvgpr_write_b32 a110, v252
v_accvgpr_read_b32 v252, a111
v_mul_f32 v252, v252, v59
v_accvgpr_write_b32 a111, v252
v_accvgpr_read_b32 v252, a112
v_mul_f32 v252, v252, v59
v_accvgpr_write_b32 a112, v252
v_accvgpr_read_b32 v252, a113
v_mul_f32 v252, v252, v59
v_accvgpr_write_b32 a113, v252
v_accvgpr_read_b32 v252, a114
v_mul_f32 v252, v252, v59
v_accvgpr_write_b32 a114, v252
v_accvgpr_read_b32 v252, a115
v_mul_f32 v252, v252, v59
v_accvgpr_write_b32 a115, v252
v_accvgpr_read_b32 v252, a116
v_mul_f32 v252, v252, v59
v_accvgpr_write_b32 a116, v252
v_accvgpr_read_b32 v252, a117
v_mul_f32 v252, v252, v59
v_accvgpr_write_b32 a117, v252
v_accvgpr_read_b32 v252, a118
v_mul_f32 v252, v252, v59
v_accvgpr_write_b32 a118, v252
v_accvgpr_read_b32 v252, a119
v_mul_f32 v252, v252, v59
v_accvgpr_write_b32 a119, v252
v_accvgpr_read_b32 v252, a120
v_mul_f32 v252, v252, v59
v_accvgpr_write_b32 a120, v252
v_accvgpr_read_b32 v252, a121
v_mul_f32 v252, v252, v59
v_accvgpr_write_b32 a121, v252
v_accvgpr_read_b32 v252, a122
v_mul_f32 v252, v252, v59
v_accvgpr_write_b32 a122, v252
v_accvgpr_read_b32 v252, a123
v_mul_f32 v252, v252, v59
v_accvgpr_write_b32 a123, v252
v_accvgpr_read_b32 v252, a124
v_mul_f32 v252, v252, v59
v_accvgpr_write_b32 a124, v252
v_accvgpr_read_b32 v252, a125
v_mul_f32 v252, v252, v59
v_accvgpr_write_b32 a125, v252
v_accvgpr_read_b32 v252, a126
v_mul_f32 v252, v252, v59
v_accvgpr_write_b32 a126, v252
v_accvgpr_read_b32 v252, a127
v_mul_f32 v252, v252, v59
v_accvgpr_write_b32 a127, v252
s_nop 1
s_branch ka_kernel_back20
ka_kernel_slow21:
s_nop 15
v_mov_b32 v56, v52
v_mov_b32 v57, v53
v_mov_b32 v58, v54
v_mov_b32 v59, v55
v_permlane16_swap_b32 v52, v56
v_permlane16_swap_b32 v53, v57
v_permlane16_swap_b32 v54, v58
v_permlane16_swap_b32 v55, v59
v_max_f32 v52, v52, v56
v_max_f32 v53, v53, v57
v_max_f32 v54, v54, v58
v_max_f32 v55, v55, v59
v_mov_b32 v56, v52
v_mov_b32 v57, v53
v_mov_b32 v58, v54
v_mov_b32 v59, v55
v_permlane32_swap_b32 v52, v56
v_permlane32_swap_b32 v53, v57
v_permlane32_swap_b32 v54, v58
v_permlane32_swap_b32 v55, v59
v_max_f32 v52, v52, v56
v_max_f32 v53, v53, v57
v_max_f32 v54, v54, v58
v_max_f32 v55, v55, v59
v_max_f32 v52, 0, v52
v_ceil_f32 v52, v52
v_exp_f32_e64 v56, -v52
v_sub_f32 v32, v32, v52
v_sub_f32 v33, v33, v52
v_sub_f32 v34, v34, v52
v_sub_f32 v35, v35, v52
v_sub_f32 v188, v188, v52
v_sub_f32 v189, v189, v52
v_sub_f32 v190, v190, v52
v_sub_f32 v191, v191, v52
v_sub_f32 v204, v204, v52
v_sub_f32 v205, v205, v52
v_sub_f32 v206, v206, v52
v_sub_f32 v207, v207, v52
v_sub_f32 v220, v220, v52
v_sub_f32 v221, v221, v52
v_sub_f32 v222, v222, v52
v_sub_f32 v223, v223, v52
v_sub_f32 v236, v236, v52
v_sub_f32 v237, v237, v52
v_sub_f32 v238, v238, v52
v_sub_f32 v239, v239, v52
v_lshlrev_b32 v252, 16, v124
v_and_b32 v253, 0xffff0000, v124
v_mul_f32 v252, v252, v56
v_mul_f32 v253, v253, v56
v_cvt_pk_bf16_f32 v124, v252, v253
v_lshlrev_b32 v252, 16, v125
v_and_b32 v253, 0xffff0000, v125
v_mul_f32 v252, v252, v56
v_mul_f32 v253, v253, v56
v_cvt_pk_bf16_f32 v125, v252, v253
v_lshlrev_b32 v252, 16, v126
v_and_b32 v253, 0xffff0000, v126
v_mul_f32 v252, v252, v56
v_mul_f32 v253, v253, v56
v_cvt_pk_bf16_f32 v126, v252, v253
v_lshlrev_b32 v252, 16, v127
v_and_b32 v253, 0xffff0000, v127
v_mul_f32 v252, v252, v56
v_mul_f32 v253, v253, v56
v_cvt_pk_bf16_f32 v127, v252, v253
v_lshlrev_b32 v252, 16, v156
v_and_b32 v253, 0xffff0000, v156
v_mul_f32 v252, v252, v56
v_mul_f32 v253, v253, v56
v_cvt_pk_bf16_f32 v156, v252, v253
v_lshlrev_b32 v252, 16, v157
v_and_b32 v253, 0xffff0000, v157
v_mul_f32 v252, v252, v56
v_mul_f32 v253, v253, v56
v_cvt_pk_bf16_f32 v157, v252, v253
v_lshlrev_b32 v252, 16, v158
v_and_b32 v253, 0xffff0000, v158
v_mul_f32 v252, v252, v56
v_mul_f32 v253, v253, v56
v_cvt_pk_bf16_f32 v158, v252, v253
v_lshlrev_b32 v252, 16, v159
v_and_b32 v253, 0xffff0000, v159
v_mul_f32 v252, v252, v56
v_mul_f32 v253, v253, v56
v_cvt_pk_bf16_f32 v159, v252, v253
v_accvgpr_read_b32 v252, a128
v_mul_f32 v252, v252, v56
v_accvgpr_write_b32 a128, v252
v_accvgpr_read_b32 v252, a129
v_mul_f32 v252, v252, v56
v_accvgpr_write_b32 a129, v252
v_accvgpr_read_b32 v252, a130
v_mul_f32 v252, v252, v56
v_accvgpr_write_b32 a130, v252
v_accvgpr_read_b32 v252, a131
v_mul_f32 v252, v252, v56
v_accvgpr_write_b32 a131, v252
v_accvgpr_read_b32 v252, a0
v_mul_f32 v252, v252, v56
v_accvgpr_write_b32 a0, v252
v_accvgpr_read_b32 v252, a1
v_mul_f32 v252, v252, v56
v_accvgpr_write_b32 a1, v252
v_accvgpr_read_b32 v252, a2
v_mul_f32 v252, v252, v56
v_accvgpr_write_b32 a2, v252
v_accvgpr_read_b32 v252, a3
v_mul_f32 v252, v252, v56
v_accvgpr_write_b32 a3, v252
v_accvgpr_read_b32 v252, a4
v_mul_f32 v252, v252, v56
v_accvgpr_write_b32 a4, v252
v_accvgpr_read_b32 v252, a5
v_mul_f32 v252, v252, v56
v_accvgpr_write_b32 a5, v252
v_accvgpr_read_b32 v252, a6
v_mul_f32 v252, v252, v56
v_accvgpr_write_b32 a6, v252
v_accvgpr_read_b32 v252, a7
v_mul_f32 v252, v252, v56
v_accvgpr_write_b32 a7, v252
v_accvgpr_read_b32 v252, a8
v_mul_f32 v252, v252, v56
v_accvgpr_write_b32 a8, v252
v_accvgpr_read_b32 v252, a9
v_mul_f32 v252, v252, v56
v_accvgpr_write_b32 a9, v252
v_accvgpr_read_b32 v252, a10
v_mul_f32 v252, v252, v56
v_accvgpr_write_b32 a10, v252
v_accvgpr_read_b32 v252, a11
v_mul_f32 v252, v252, v56
v_accvgpr_write_b32 a11, v252
v_accvgpr_read_b32 v252, a12
v_mul_f32 v252, v252, v56
v_accvgpr_write_b32 a12, v252
v_accvgpr_read_b32 v252, a13
v_mul_f32 v252, v252, v56
v_accvgpr_write_b32 a13, v252
v_accvgpr_read_b32 v252, a14
v_mul_f32 v252, v252, v56
v_accvgpr_write_b32 a14, v252
v_accvgpr_read_b32 v252, a15
v_mul_f32 v252, v252, v56
v_accvgpr_write_b32 a15, v252
v_accvgpr_read_b32 v252, a16
v_mul_f32 v252, v252, v56
v_accvgpr_write_b32 a16, v252
v_accvgpr_read_b32 v252, a17
v_mul_f32 v252, v252, v56
v_accvgpr_write_b32 a17, v252
v_accvgpr_read_b32 v252, a18
v_mul_f32 v252, v252, v56
v_accvgpr_write_b32 a18, v252
v_accvgpr_read_b32 v252, a19
v_mul_f32 v252, v252, v56
v_accvgpr_write_b32 a19, v252
v_accvgpr_read_b32 v252, a20
v_mul_f32 v252, v252, v56
v_accvgpr_write_b32 a20, v252
v_accvgpr_read_b32 v252, a21
v_mul_f32 v252, v252, v56
v_accvgpr_write_b32 a21, v252
v_accvgpr_read_b32 v252, a22
v_mul_f32 v252, v252, v56
v_accvgpr_write_b32 a22, v252
v_accvgpr_read_b32 v252, a23
v_mul_f32 v252, v252, v56
v_accvgpr_write_b32 a23, v252
v_accvgpr_read_b32 v252, a24
v_mul_f32 v252, v252, v56
v_accvgpr_write_b32 a24, v252
v_accvgpr_read_b32 v252, a25
v_mul_f32 v252, v252, v56
v_accvgpr_write_b32 a25, v252
v_accvgpr_read_b32 v252, a26
v_mul_f32 v252, v252, v56
v_accvgpr_write_b32 a26, v252
v_accvgpr_read_b32 v252, a27
v_mul_f32 v252, v252, v56
v_accvgpr_write_b32 a27, v252
v_accvgpr_read_b32 v252, a28
v_mul_f32 v252, v252, v56
v_accvgpr_write_b32 a28, v252
v_accvgpr_read_b32 v252, a29
v_mul_f32 v252, v252, v56
v_accvgpr_write_b32 a29, v252
v_accvgpr_read_b32 v252, a30
v_mul_f32 v252, v252, v56
v_accvgpr_write_b32 a30, v252
v_accvgpr_read_b32 v252, a31
v_mul_f32 v252, v252, v56
v_accvgpr_write_b32 a31, v252
v_max_f32 v53, 0, v53
v_ceil_f32 v53, v53
v_exp_f32_e64 v57, -v53
v_sub_f32 v36, v36, v53
v_sub_f32 v37, v37, v53
v_sub_f32 v38, v38, v53
v_sub_f32 v39, v39, v53
v_sub_f32 v192, v192, v53
v_sub_f32 v193, v193, v53
v_sub_f32 v194, v194, v53
v_sub_f32 v195, v195, v53
v_sub_f32 v208, v208, v53
v_sub_f32 v209, v209, v53
v_sub_f32 v210, v210, v53
v_sub_f32 v211, v211, v53
v_sub_f32 v224, v224, v53
v_sub_f32 v225, v225, v53
v_sub_f32 v226, v226, v53
v_sub_f32 v227, v227, v53
v_sub_f32 v240, v240, v53
v_sub_f32 v241, v241, v53
v_sub_f32 v242, v242, v53
v_sub_f32 v243, v243, v53
v_lshlrev_b32 v252, 16, v128
v_and_b32 v253, 0xffff0000, v128
v_mul_f32 v252, v252, v57
v_mul_f32 v253, v253, v57
v_cvt_pk_bf16_f32 v128, v252, v253
v_lshlrev_b32 v252, 16, v129
v_and_b32 v253, 0xffff0000, v129
v_mul_f32 v252, v252, v57
v_mul_f32 v253, v253, v57
v_cvt_pk_bf16_f32 v129, v252, v253
v_lshlrev_b32 v252, 16, v130
v_and_b32 v253, 0xffff0000, v130
v_mul_f32 v252, v252, v57
v_mul_f32 v253, v253, v57
v_cvt_pk_bf16_f32 v130, v252, v253
v_lshlrev_b32 v252, 16, v131
v_and_b32 v253, 0xffff0000, v131
v_mul_f32 v252, v252, v57
v_mul_f32 v253, v253, v57
v_cvt_pk_bf16_f32 v131, v252, v253
v_lshlrev_b32 v252, 16, v160
v_and_b32 v253, 0xffff0000, v160
v_mul_f32 v252, v252, v57
v_mul_f32 v253, v253, v57
v_cvt_pk_bf16_f32 v160, v252, v253
v_lshlrev_b32 v252, 16, v161
v_and_b32 v253, 0xffff0000, v161
v_mul_f32 v252, v252, v57
v_mul_f32 v253, v253, v57
v_cvt_pk_bf16_f32 v161, v252, v253
v_lshlrev_b32 v252, 16, v162
v_and_b32 v253, 0xffff0000, v162
v_mul_f32 v252, v252, v57
v_mul_f32 v253, v253, v57
v_cvt_pk_bf16_f32 v162, v252, v253
v_mul_f32 v178, v178, v57
v_mul_f32 v179, v179, v57
v_accvgpr_read_b32 v252, a132
v_mul_f32 v252, v252, v57
v_accvgpr_write_b32 a132, v252
v_accvgpr_read_b32 v252, a133
v_mul_f32 v252, v252, v57
v_accvgpr_write_b32 a133, v252
v_accvgpr_read_b32 v252, a134
v_mul_f32 v252, v252, v57
v_accvgpr_write_b32 a134, v252
v_accvgpr_read_b32 v252, a135
v_mul_f32 v252, v252, v57
v_accvgpr_write_b32 a135, v252
v_accvgpr_read_b32 v252, a32
v_mul_f32 v252, v252, v57
v_accvgpr_write_b32 a32, v252
v_accvgpr_read_b32 v252, a33
v_mul_f32 v252, v252, v57
v_accvgpr_write_b32 a33, v252
v_accvgpr_read_b32 v252, a34
v_mul_f32 v252, v252, v57
v_accvgpr_write_b32 a34, v252
v_accvgpr_read_b32 v252, a35
v_mul_f32 v252, v252, v57
v_accvgpr_write_b32 a35, v252
v_accvgpr_read_b32 v252, a36
v_mul_f32 v252, v252, v57
v_accvgpr_write_b32 a36, v252
v_accvgpr_read_b32 v252, a37
v_mul_f32 v252, v252, v57
v_accvgpr_write_b32 a37, v252
v_accvgpr_read_b32 v252, a38
v_mul_f32 v252, v252, v57
v_accvgpr_write_b32 a38, v252
v_accvgpr_read_b32 v252, a39
v_mul_f32 v252, v252, v57
v_accvgpr_write_b32 a39, v252
v_accvgpr_read_b32 v252, a40
v_mul_f32 v252, v252, v57
v_accvgpr_write_b32 a40, v252
v_accvgpr_read_b32 v252, a41
v_mul_f32 v252, v252, v57
v_accvgpr_write_b32 a41, v252
v_accvgpr_read_b32 v252, a42
v_mul_f32 v252, v252, v57
v_accvgpr_write_b32 a42, v252
v_accvgpr_read_b32 v252, a43
v_mul_f32 v252, v252, v57
v_accvgpr_write_b32 a43, v252
v_accvgpr_read_b32 v252, a44
v_mul_f32 v252, v252, v57
v_accvgpr_write_b32 a44, v252
v_accvgpr_read_b32 v252, a45
v_mul_f32 v252, v252, v57
v_accvgpr_write_b32 a45, v252
v_accvgpr_read_b32 v252, a46
v_mul_f32 v252, v252, v57
v_accvgpr_write_b32 a46, v252
v_accvgpr_read_b32 v252, a47
v_mul_f32 v252, v252, v57
v_accvgpr_write_b32 a47, v252
v_accvgpr_read_b32 v252, a48
v_mul_f32 v252, v252, v57
v_accvgpr_write_b32 a48, v252
v_accvgpr_read_b32 v252, a49
v_mul_f32 v252, v252, v57
v_accvgpr_write_b32 a49, v252
v_accvgpr_read_b32 v252, a50
v_mul_f32 v252, v252, v57
v_accvgpr_write_b32 a50, v252
v_accvgpr_read_b32 v252, a51
v_mul_f32 v252, v252, v57
v_accvgpr_write_b32 a51, v252
v_accvgpr_read_b32 v252, a52
v_mul_f32 v252, v252, v57
v_accvgpr_write_b32 a52, v252
v_accvgpr_read_b32 v252, a53
v_mul_f32 v252, v252, v57
v_accvgpr_write_b32 a53, v252
v_accvgpr_read_b32 v252, a54
v_mul_f32 v252, v252, v57
v_accvgpr_write_b32 a54, v252
v_accvgpr_read_b32 v252, a55
v_mul_f32 v252, v252, v57
v_accvgpr_write_b32 a55, v252
v_accvgpr_read_b32 v252, a56
v_mul_f32 v252, v252, v57
v_accvgpr_write_b32 a56, v252
v_accvgpr_read_b32 v252, a57
v_mul_f32 v252, v252, v57
v_accvgpr_write_b32 a57, v252
v_accvgpr_read_b32 v252, a58
v_mul_f32 v252, v252, v57
v_accvgpr_write_b32 a58, v252
v_accvgpr_read_b32 v252, a59
v_mul_f32 v252, v252, v57
v_accvgpr_write_b32 a59, v252
v_accvgpr_read_b32 v252, a60
v_mul_f32 v252, v252, v57
v_accvgpr_write_b32 a60, v252
v_accvgpr_read_b32 v252, a61
v_mul_f32 v252, v252, v57
v_accvgpr_write_b32 a61, v252
v_accvgpr_read_b32 v252, a62
v_mul_f32 v252, v252, v57
v_accvgpr_write_b32 a62, v252
v_accvgpr_read_b32 v252, a63
v_mul_f32 v252, v252, v57
v_accvgpr_write_b32 a63, v252
v_max_f32 v54, 0, v54
v_ceil_f32 v54, v54
v_exp_f32_e64 v58, -v54
v_sub_f32 v40, v40, v54
v_sub_f32 v41, v41, v54
v_sub_f32 v42, v42, v54
v_sub_f32 v43, v43, v54
v_sub_f32 v196, v196, v54
v_sub_f32 v197, v197, v54
v_sub_f32 v198, v198, v54
v_sub_f32 v199, v199, v54
v_sub_f32 v212, v212, v54
v_sub_f32 v213, v213, v54
v_sub_f32 v214, v214, v54
v_sub_f32 v215, v215, v54
v_sub_f32 v228, v228, v54
v_sub_f32 v229, v229, v54
v_sub_f32 v230, v230, v54
v_sub_f32 v231, v231, v54
v_sub_f32 v244, v244, v54
v_sub_f32 v245, v245, v54
v_sub_f32 v246, v246, v54
v_sub_f32 v247, v247, v54
v_lshlrev_b32 v252, 16, v132
v_and_b32 v253, 0xffff0000, v132
v_mul_f32 v252, v252, v58
v_mul_f32 v253, v253, v58
v_cvt_pk_bf16_f32 v132, v252, v253
v_lshlrev_b32 v252, 16, v133
v_and_b32 v253, 0xffff0000, v133
v_mul_f32 v252, v252, v58
v_mul_f32 v253, v253, v58
v_cvt_pk_bf16_f32 v133, v252, v253
v_lshlrev_b32 v252, 16, v134
v_and_b32 v253, 0xffff0000, v134
v_mul_f32 v252, v252, v58
v_mul_f32 v253, v253, v58
v_cvt_pk_bf16_f32 v134, v252, v253
v_lshlrev_b32 v252, 16, v135
v_and_b32 v253, 0xffff0000, v135
v_mul_f32 v252, v252, v58
v_mul_f32 v253, v253, v58
v_cvt_pk_bf16_f32 v135, v252, v253
v_sub_f32 v164, v164, v54
v_sub_f32 v165, v165, v54
v_sub_f32 v166, v166, v54
v_sub_f32 v167, v167, v54
v_sub_f32 v180, v180, v54
v_sub_f32 v181, v181, v54
v_sub_f32 v182, v182, v54
v_sub_f32 v183, v183, v54
v_accvgpr_read_b32 v252, a136
v_mul_f32 v252, v252, v58
v_accvgpr_write_b32 a136, v252
v_accvgpr_read_b32 v252, a137
v_mul_f32 v252, v252, v58
v_accvgpr_write_b32 a137, v252
v_accvgpr_read_b32 v252, a138
v_mul_f32 v252, v252, v58
v_accvgpr_write_b32 a138, v252
v_accvgpr_read_b32 v252, a139
v_mul_f32 v252, v252, v58
v_accvgpr_write_b32 a139, v252
v_accvgpr_read_b32 v252, a64
v_mul_f32 v252, v252, v58
v_accvgpr_write_b32 a64, v252
v_accvgpr_read_b32 v252, a65
v_mul_f32 v252, v252, v58
v_accvgpr_write_b32 a65, v252
v_accvgpr_read_b32 v252, a66
v_mul_f32 v252, v252, v58
v_accvgpr_write_b32 a66, v252
v_accvgpr_read_b32 v252, a67
v_mul_f32 v252, v252, v58
v_accvgpr_write_b32 a67, v252
v_accvgpr_read_b32 v252, a68
v_mul_f32 v252, v252, v58
v_accvgpr_write_b32 a68, v252
v_accvgpr_read_b32 v252, a69
v_mul_f32 v252, v252, v58
v_accvgpr_write_b32 a69, v252
v_accvgpr_read_b32 v252, a70
v_mul_f32 v252, v252, v58
v_accvgpr_write_b32 a70, v252
v_accvgpr_read_b32 v252, a71
v_mul_f32 v252, v252, v58
v_accvgpr_write_b32 a71, v252
v_accvgpr_read_b32 v252, a72
v_mul_f32 v252, v252, v58
v_accvgpr_write_b32 a72, v252
v_accvgpr_read_b32 v252, a73
v_mul_f32 v252, v252, v58
v_accvgpr_write_b32 a73, v252
v_accvgpr_read_b32 v252, a74
v_mul_f32 v252, v252, v58
v_accvgpr_write_b32 a74, v252
v_accvgpr_read_b32 v252, a75
v_mul_f32 v252, v252, v58
v_accvgpr_write_b32 a75, v252
v_accvgpr_read_b32 v252, a76
v_mul_f32 v252, v252, v58
v_accvgpr_write_b32 a76, v252
v_accvgpr_read_b32 v252, a77
v_mul_f32 v252, v252, v58
v_accvgpr_write_b32 a77, v252
v_accvgpr_read_b32 v252, a78
v_mul_f32 v252, v252, v58
v_accvgpr_write_b32 a78, v252
v_accvgpr_read_b32 v252, a79
v_mul_f32 v252, v252, v58
v_accvgpr_write_b32 a79, v252
v_accvgpr_read_b32 v252, a80
v_mul_f32 v252, v252, v58
v_accvgpr_write_b32 a80, v252
v_accvgpr_read_b32 v252, a81
v_mul_f32 v252, v252, v58
v_accvgpr_write_b32 a81, v252
v_accvgpr_read_b32 v252, a82
v_mul_f32 v252, v252, v58
v_accvgpr_write_b32 a82, v252
v_accvgpr_read_b32 v252, a83
v_mul_f32 v252, v252, v58
v_accvgpr_write_b32 a83, v252
v_accvgpr_read_b32 v252, a84
v_mul_f32 v252, v252, v58
v_accvgpr_write_b32 a84, v252
v_accvgpr_read_b32 v252, a85
v_mul_f32 v252, v252, v58
v_accvgpr_write_b32 a85, v252
v_accvgpr_read_b32 v252, a86
v_mul_f32 v252, v252, v58
v_accvgpr_write_b32 a86, v252
v_accvgpr_read_b32 v252, a87
v_mul_f32 v252, v252, v58
v_accvgpr_write_b32 a87, v252
v_accvgpr_read_b32 v252, a88
v_mul_f32 v252, v252, v58
v_accvgpr_write_b32 a88, v252
v_accvgpr_read_b32 v252, a89
v_mul_f32 v252, v252, v58
v_accvgpr_write_b32 a89, v252
v_accvgpr_read_b32 v252, a90
v_mul_f32 v252, v252, v58
v_accvgpr_write_b32 a90, v252
v_accvgpr_read_b32 v252, a91
v_mul_f32 v252, v252, v58
v_accvgpr_write_b32 a91, v252
v_accvgpr_read_b32 v252, a92
v_mul_f32 v252, v252, v58
v_accvgpr_write_b32 a92, v252
v_accvgpr_read_b32 v252, a93
v_mul_f32 v252, v252, v58
v_accvgpr_write_b32 a93, v252
v_accvgpr_read_b32 v252, a94
v_mul_f32 v252, v252, v58
v_accvgpr_write_b32 a94, v252
v_accvgpr_read_b32 v252, a95
v_mul_f32 v252, v252, v58
v_accvgpr_write_b32 a95, v252
v_max_f32 v55, 0, v55
v_ceil_f32 v55, v55
v_exp_f32_e64 v59, -v55
v_sub_f32 v44, v44, v55
v_sub_f32 v45, v45, v55
v_sub_f32 v46, v46, v55
v_sub_f32 v47, v47, v55
v_sub_f32 v200, v200, v55
v_sub_f32 v201, v201, v55
v_sub_f32 v202, v202, v55
v_sub_f32 v203, v203, v55
v_sub_f32 v216, v216, v55
v_sub_f32 v217, v217, v55
v_sub_f32 v218, v218, v55
v_sub_f32 v219, v219, v55
v_sub_f32 v232, v232, v55
v_sub_f32 v233, v233, v55
v_sub_f32 v234, v234, v55
v_sub_f32 v235, v235, v55
v_sub_f32 v248, v248, v55
v_sub_f32 v249, v249, v55
v_sub_f32 v250, v250, v55
v_sub_f32 v251, v251, v55
v_lshlrev_b32 v252, 16, v136
v_and_b32 v253, 0xffff0000, v136
v_mul_f32 v252, v252, v59
v_mul_f32 v253, v253, v59
v_cvt_pk_bf16_f32 v136, v252, v253
v_lshlrev_b32 v252, 16, v137
v_and_b32 v253, 0xffff0000, v137
v_mul_f32 v252, v252, v59
v_mul_f32 v253, v253, v59
v_cvt_pk_bf16_f32 v137, v252, v253
v_lshlrev_b32 v252, 16, v138
v_and_b32 v253, 0xffff0000, v138
v_mul_f32 v252, v252, v59
v_mul_f32 v253, v253, v59
v_cvt_pk_bf16_f32 v138, v252, v253
v_lshlrev_b32 v252, 16, v139
v_and_b32 v253, 0xffff0000, v139
v_mul_f32 v252, v252, v59
v_mul_f32 v253, v253, v59
v_cvt_pk_bf16_f32 v139, v252, v253
v_sub_f32 v168, v168, v55
v_sub_f32 v169, v169, v55
v_sub_f32 v170, v170, v55
v_sub_f32 v171, v171, v55
v_sub_f32 v184, v184, v55
v_sub_f32 v185, v185, v55
v_sub_f32 v186, v186, v55
v_sub_f32 v187, v187, v55
v_accvgpr_read_b32 v252, a140
v_mul_f32 v252, v252, v59
v_accvgpr_write_b32 a140, v252
v_accvgpr_read_b32 v252, a141
v_mul_f32 v252, v252, v59
v_accvgpr_write_b32 a141, v252
v_accvgpr_read_b32 v252, a142
v_mul_f32 v252, v252, v59
v_accvgpr_write_b32 a142, v252
v_accvgpr_read_b32 v252, a143
v_mul_f32 v252, v252, v59
v_accvgpr_write_b32 a143, v252
v_accvgpr_read_b32 v252, a96
v_mul_f32 v252, v252, v59
v_accvgpr_write_b32 a96, v252
v_accvgpr_read_b32 v252, a97
v_mul_f32 v252, v252, v59
v_accvgpr_write_b32 a97, v252
v_accvgpr_read_b32 v252, a98
v_mul_f32 v252, v252, v59
v_accvgpr_write_b32 a98, v252
v_accvgpr_read_b32 v252, a99
v_mul_f32 v252, v252, v59
v_accvgpr_write_b32 a99, v252
v_accvgpr_read_b32 v252, a100
v_mul_f32 v252, v252, v59
v_accvgpr_write_b32 a100, v252
v_accvgpr_read_b32 v252, a101
v_mul_f32 v252, v252, v59
v_accvgpr_write_b32 a101, v252
v_accvgpr_read_b32 v252, a102
v_mul_f32 v252, v252, v59
v_accvgpr_write_b32 a102, v252
v_accvgpr_read_b32 v252, a103
v_mul_f32 v252, v252, v59
v_accvgpr_write_b32 a103, v252
v_accvgpr_read_b32 v252, a104
v_mul_f32 v252, v252, v59
v_accvgpr_write_b32 a104, v252
v_accvgpr_read_b32 v252, a105
v_mul_f32 v252, v252, v59
v_accvgpr_write_b32 a105, v252
v_accvgpr_read_b32 v252, a106
v_mul_f32 v252, v252, v59
v_accvgpr_write_b32 a106, v252
v_accvgpr_read_b32 v252, a107
v_mul_f32 v252, v252, v59
v_accvgpr_write_b32 a107, v252
v_accvgpr_read_b32 v252, a108
v_mul_f32 v252, v252, v59
v_accvgpr_write_b32 a108, v252
v_accvgpr_read_b32 v252, a109
v_mul_f32 v252, v252, v59
v_accvgpr_write_b32 a109, v252
v_accvgpr_read_b32 v252, a110
v_mul_f32 v252, v252, v59
v_accvgpr_write_b32 a110, v252
v_accvgpr_read_b32 v252, a111
v_mul_f32 v252, v252, v59
v_accvgpr_write_b32 a111, v252
v_accvgpr_read_b32 v252, a112
v_mul_f32 v252, v252, v59
v_accvgpr_write_b32 a112, v252
v_accvgpr_read_b32 v252, a113
v_mul_f32 v252, v252, v59
v_accvgpr_write_b32 a113, v252
v_accvgpr_read_b32 v252, a114
v_mul_f32 v252, v252, v59
v_accvgpr_write_b32 a114, v252
v_accvgpr_read_b32 v252, a115
v_mul_f32 v252, v252, v59
v_accvgpr_write_b32 a115, v252
v_accvgpr_read_b32 v252, a116
v_mul_f32 v252, v252, v59
v_accvgpr_write_b32 a116, v252
v_accvgpr_read_b32 v252, a117
v_mul_f32 v252, v252, v59
v_accvgpr_write_b32 a117, v252
v_accvgpr_read_b32 v252, a118
v_mul_f32 v252, v252, v59
v_accvgpr_write_b32 a118, v252
v_accvgpr_read_b32 v252, a119
v_mul_f32 v252, v252, v59
v_accvgpr_write_b32 a119, v252
v_accvgpr_read_b32 v252, a120
v_mul_f32 v252, v252, v59
v_accvgpr_write_b32 a120, v252
v_accvgpr_read_b32 v252, a121
v_mul_f32 v252, v252, v59
v_accvgpr_write_b32 a121, v252
v_accvgpr_read_b32 v252, a122
v_mul_f32 v252, v252, v59
v_accvgpr_write_b32 a122, v252
v_accvgpr_read_b32 v252, a123
v_mul_f32 v252, v252, v59
v_accvgpr_write_b32 a123, v252
v_accvgpr_read_b32 v252, a124
v_mul_f32 v252, v252, v59
v_accvgpr_write_b32 a124, v252
v_accvgpr_read_b32 v252, a125
v_mul_f32 v252, v252, v59
v_accvgpr_write_b32 a125, v252
v_accvgpr_read_b32 v252, a126
v_mul_f32 v252, v252, v59
v_accvgpr_write_b32 a126, v252
v_accvgpr_read_b32 v252, a127
v_mul_f32 v252, v252, v59
v_accvgpr_write_b32 a127, v252
s_nop 1
s_branch ka_kernel_back22
ka_kernel_slow23:
s_nop 15
v_mov_b32 v56, v52
v_mov_b32 v57, v53
v_mov_b32 v58, v54
v_mov_b32 v59, v55
v_permlane16_swap_b32 v52, v56
v_permlane16_swap_b32 v53, v57
v_permlane16_swap_b32 v54, v58
v_permlane16_swap_b32 v55, v59
v_max_f32 v52, v52, v56
v_max_f32 v53, v53, v57
v_max_f32 v54, v54, v58
v_max_f32 v55, v55, v59
v_mov_b32 v56, v52
v_mov_b32 v57, v53
v_mov_b32 v58, v54
v_mov_b32 v59, v55
v_permlane32_swap_b32 v52, v56
v_permlane32_swap_b32 v53, v57
v_permlane32_swap_b32 v54, v58
v_permlane32_swap_b32 v55, v59
v_max_f32 v52, v52, v56
v_max_f32 v53, v53, v57
v_max_f32 v54, v54, v58
v_max_f32 v55, v55, v59
v_max_f32 v52, 0, v52
v_ceil_f32 v52, v52
v_exp_f32_e64 v56, -v52
v_sub_f32 v32, v32, v52
v_sub_f32 v33, v33, v52
v_sub_f32 v34, v34, v52
v_sub_f32 v35, v35, v52
v_sub_f32 v124, v124, v52
v_sub_f32 v125, v125, v52
v_sub_f32 v126, v126, v52
v_sub_f32 v127, v127, v52
v_sub_f32 v140, v140, v52
v_sub_f32 v141, v141, v52
v_sub_f32 v142, v142, v52
v_sub_f32 v143, v143, v52
v_sub_f32 v156, v156, v52
v_sub_f32 v157, v157, v52
v_sub_f32 v158, v158, v52
v_sub_f32 v159, v159, v52
v_sub_f32 v172, v172, v52
v_sub_f32 v173, v173, v52
v_sub_f32 v174, v174, v52
v_sub_f32 v175, v175, v52
v_lshlrev_b32 v252, 16, v188
v_and_b32 v253, 0xffff0000, v188
v_mul_f32 v252, v252, v56
v_mul_f32 v253, v253, v56
v_cvt_pk_bf16_f32 v188, v252, v253
v_lshlrev_b32 v252, 16, v189
v_and_b32 v253, 0xffff0000, v189
v_mul_f32 v252, v252, v56
v_mul_f32 v253, v253, v56
v_cvt_pk_bf16_f32 v189, v252, v253
v_lshlrev_b32 v252, 16, v190
v_and_b32 v253, 0xffff0000, v190
v_mul_f32 v252, v252, v56
v_mul_f32 v253, v253, v56
v_cvt_pk_bf16_f32 v190, v252, v253
v_lshlrev_b32 v252, 16, v191
v_and_b32 v253, 0xffff0000, v191
v_mul_f32 v252, v252, v56
v_mul_f32 v253, v253, v56
v_cvt_pk_bf16_f32 v191, v252, v253
v_lshlrev_b32 v252, 16, v220
v_and_b32 v253, 0xffff0000, v220
v_mul_f32 v252, v252, v56
v_mul_f32 v253, v253, v56
v_cvt_pk_bf16_f32 v220, v252, v253
v_lshlrev_b32 v252, 16, v221
v_and_b32 v253, 0xffff0000, v221
v_mul_f32 v252, v252, v56
v_mul_f32 v253, v253, v56
v_cvt_pk_bf16_f32 v221, v252, v253
v_lshlrev_b32 v252, 16, v222
v_and_b32 v253, 0xffff0000, v222
v_mul_f32 v252, v252, v56
v_mul_f32 v253, v253, v56
v_cvt_pk_bf16_f32 v222, v252, v253
v_lshlrev_b32 v252, 16, v223
v_and_b32 v253, 0xffff0000, v223
v_mul_f32 v252, v252, v56
v_mul_f32 v253, v253, v56
v_cvt_pk_bf16_f32 v223, v252, v253
v_accvgpr_read_b32 v252, a128
v_mul_f32 v252, v252, v56
v_accvgpr_write_b32 a128, v252
v_accvgpr_read_b32 v252, a129
v_mul_f32 v252, v252, v56
v_accvgpr_write_b32 a129, v252
v_accvgpr_read_b32 v252, a130
v_mul_f32 v252, v252, v56
v_accvgpr_write_b32 a130, v252
v_accvgpr_read_b32 v252, a131
v_mul_f32 v252, v252, v56
v_accvgpr_write_b32 a131, v252
v_accvgpr_read_b32 v252, a0
v_mul_f32 v252, v252, v56
v_accvgpr_write_b32 a0, v252
v_accvgpr_read_b32 v252, a1
v_mul_f32 v252, v252, v56
v_accvgpr_write_b32 a1, v252
v_accvgpr_read_b32 v252, a2
v_mul_f32 v252, v252, v56
v_accvgpr_write_b32 a2, v252
v_accvgpr_read_b32 v252, a3
v_mul_f32 v252, v252, v56
v_accvgpr_write_b32 a3, v252
v_accvgpr_read_b32 v252, a4
v_mul_f32 v252, v252, v56
v_accvgpr_write_b32 a4, v252
v_accvgpr_read_b32 v252, a5
v_mul_f32 v252, v252, v56
v_accvgpr_write_b32 a5, v252
v_accvgpr_read_b32 v252, a6
v_mul_f32 v252, v252, v56
v_accvgpr_write_b32 a6, v252
v_accvgpr_read_b32 v252, a7
v_mul_f32 v252, v252, v56
v_accvgpr_write_b32 a7, v252
v_accvgpr_read_b32 v252, a8
v_mul_f32 v252, v252, v56
v_accvgpr_write_b32 a8, v252
v_accvgpr_read_b32 v252, a9
v_mul_f32 v252, v252, v56
v_accvgpr_write_b32 a9, v252
v_accvgpr_read_b32 v252, a10
v_mul_f32 v252, v252, v56
v_accvgpr_write_b32 a10, v252
v_accvgpr_read_b32 v252, a11
v_mul_f32 v252, v252, v56
v_accvgpr_write_b32 a11, v252
v_accvgpr_read_b32 v252, a12
v_mul_f32 v252, v252, v56
v_accvgpr_write_b32 a12, v252
v_accvgpr_read_b32 v252, a13
v_mul_f32 v252, v252, v56
v_accvgpr_write_b32 a13, v252
v_accvgpr_read_b32 v252, a14
v_mul_f32 v252, v252, v56
v_accvgpr_write_b32 a14, v252
v_accvgpr_read_b32 v252, a15
v_mul_f32 v252, v252, v56
v_accvgpr_write_b32 a15, v252
v_accvgpr_read_b32 v252, a16
v_mul_f32 v252, v252, v56
v_accvgpr_write_b32 a16, v252
v_accvgpr_read_b32 v252, a17
v_mul_f32 v252, v252, v56
v_accvgpr_write_b32 a17, v252
v_accvgpr_read_b32 v252, a18
v_mul_f32 v252, v252, v56
v_accvgpr_write_b32 a18, v252
v_accvgpr_read_b32 v252, a19
v_mul_f32 v252, v252, v56
v_accvgpr_write_b32 a19, v252
v_accvgpr_read_b32 v252, a20
v_mul_f32 v252, v252, v56
v_accvgpr_write_b32 a20, v252
v_accvgpr_read_b32 v252, a21
v_mul_f32 v252, v252, v56
v_accvgpr_write_b32 a21, v252
v_accvgpr_read_b32 v252, a22
v_mul_f32 v252, v252, v56
v_accvgpr_write_b32 a22, v252
v_accvgpr_read_b32 v252, a23
v_mul_f32 v252, v252, v56
v_accvgpr_write_b32 a23, v252
v_accvgpr_read_b32 v252, a24
v_mul_f32 v252, v252, v56
v_accvgpr_write_b32 a24, v252
v_accvgpr_read_b32 v252, a25
v_mul_f32 v252, v252, v56
v_accvgpr_write_b32 a25, v252
v_accvgpr_read_b32 v252, a26
v_mul_f32 v252, v252, v56
v_accvgpr_write_b32 a26, v252
v_accvgpr_read_b32 v252, a27
v_mul_f32 v252, v252, v56
v_accvgpr_write_b32 a27, v252
v_accvgpr_read_b32 v252, a28
v_mul_f32 v252, v252, v56
v_accvgpr_write_b32 a28, v252
v_accvgpr_read_b32 v252, a29
v_mul_f32 v252, v252, v56
v_accvgpr_write_b32 a29, v252
v_accvgpr_read_b32 v252, a30
v_mul_f32 v252, v252, v56
v_accvgpr_write_b32 a30, v252
v_accvgpr_read_b32 v252, a31
v_mul_f32 v252, v252, v56
v_accvgpr_write_b32 a31, v252
v_max_f32 v53, 0, v53
v_ceil_f32 v53, v53
v_exp_f32_e64 v57, -v53
v_sub_f32 v36, v36, v53
v_sub_f32 v37, v37, v53
v_sub_f32 v38, v38, v53
v_sub_f32 v39, v39, v53
v_sub_f32 v128, v128, v53
v_sub_f32 v129, v129, v53
v_sub_f32 v130, v130, v53
v_sub_f32 v131, v131, v53
v_sub_f32 v144, v144, v53
v_sub_f32 v145, v145, v53
v_sub_f32 v146, v146, v53
v_sub_f32 v147, v147, v53
v_sub_f32 v160, v160, v53
v_sub_f32 v161, v161, v53
v_sub_f32 v162, v162, v53
v_sub_f32 v163, v163, v53
v_sub_f32 v176, v176, v53
v_sub_f32 v177, v177, v53
v_sub_f32 v178, v178, v53
v_sub_f32 v179, v179, v53
v_lshlrev_b32 v252, 16, v192
v_and_b32 v253, 0xffff0000, v192
v_mul_f32 v252, v252, v57
v_mul_f32 v253, v253, v57
v_cvt_pk_bf16_f32 v192, v252, v253
v_lshlrev_b32 v252, 16, v193
v_and_b32 v253, 0xffff0000, v193
v_mul_f32 v252, v252, v57
v_mul_f32 v253, v253, v57
v_cvt_pk_bf16_f32 v193, v252, v253
v_lshlrev_b32 v252, 16, v194
v_and_b32 v253, 0xffff0000, v194
v_mul_f32 v252, v252, v57
v_mul_f32 v253, v253, v57
v_cvt_pk_bf16_f32 v194, v252, v253
v_lshlrev_b32 v252, 16, v195
v_and_b32 v253, 0xffff0000, v195
v_mul_f32 v252, v252, v57
v_mul_f32 v253, v253, v57
v_cvt_pk_bf16_f32 v195, v252, v253
v_mul_f32 v224, v224, v57
v_mul_f32 v225, v225, v57
v_mul_f32 v226, v226, v57
v_sub_f32 v227, v227, v53
v_sub_f32 v240, v240, v53
v_sub_f32 v241, v241, v53
v_sub_f32 v242, v242, v53
v_sub_f32 v243, v243, v53
v_accvgpr_read_b32 v252, a132
v_mul_f32 v252, v252, v57
v_accvgpr_write_b32 a132, v252
v_accvgpr_read_b32 v252, a133
v_mul_f32 v252, v252, v57
v_accvgpr_write_b32 a133, v252
v_accvgpr_read_b32 v252, a134
v_mul_f32 v252, v252, v57
v_accvgpr_write_b32 a134, v252
v_accvgpr_read_b32 v252, a135
v_mul_f32 v252, v252, v57
v_accvgpr_write_b32 a135, v252
v_accvgpr_read_b32 v252, a32
v_mul_f32 v252, v252, v57
v_accvgpr_write_b32 a32, v252
v_accvgpr_read_b32 v252, a33
v_mul_f32 v252, v252, v57
v_accvgpr_write_b32 a33, v252
v_accvgpr_read_b32 v252, a34
v_mul_f32 v252, v252, v57
v_accvgpr_write_b32 a34, v252
v_accvgpr_read_b32 v252, a35
v_mul_f32 v252, v252, v57
v_accvgpr_write_b32 a35, v252
v_accvgpr_read_b32 v252, a36
v_mul_f32 v252, v252, v57
v_accvgpr_write_b32 a36, v252
v_accvgpr_read_b32 v252, a37
v_mul_f32 v252, v252, v57
v_accvgpr_write_b32 a37, v252
v_accvgpr_read_b32 v252, a38
v_mul_f32 v252, v252, v57
v_accvgpr_write_b32 a38, v252
v_accvgpr_read_b32 v252, a39
v_mul_f32 v252, v252, v57
v_accvgpr_write_b32 a39, v252
v_accvgpr_read_b32 v252, a40
v_mul_f32 v252, v252, v57
v_accvgpr_write_b32 a40, v252
v_accvgpr_read_b32 v252, a41
v_mul_f32 v252, v252, v57
v_accvgpr_write_b32 a41, v252
v_accvgpr_read_b32 v252, a42
v_mul_f32 v252, v252, v57
v_accvgpr_write_b32 a42, v252
v_accvgpr_read_b32 v252, a43
v_mul_f32 v252, v252, v57
v_accvgpr_write_b32 a43, v252
v_accvgpr_read_b32 v252, a44
v_mul_f32 v252, v252, v57
v_accvgpr_write_b32 a44, v252
v_accvgpr_read_b32 v252, a45
v_mul_f32 v252, v252, v57
v_accvgpr_write_b32 a45, v252
v_accvgpr_read_b32 v252, a46
v_mul_f32 v252, v252, v57
v_accvgpr_write_b32 a46, v252
v_accvgpr_read_b32 v252, a47
v_mul_f32 v252, v252, v57
v_accvgpr_write_b32 a47, v252
v_accvgpr_read_b32 v252, a48
v_mul_f32 v252, v252, v57
v_accvgpr_write_b32 a48, v252
v_accvgpr_read_b32 v252, a49
v_mul_f32 v252, v252, v57
v_accvgpr_write_b32 a49, v252
v_accvgpr_read_b32 v252, a50
v_mul_f32 v252, v252, v57
v_accvgpr_write_b32 a50, v252
v_accvgpr_read_b32 v252, a51
v_mul_f32 v252, v252, v57
v_accvgpr_write_b32 a51, v252
v_accvgpr_read_b32 v252, a52
v_mul_f32 v252, v252, v57
v_accvgpr_write_b32 a52, v252
v_accvgpr_read_b32 v252, a53
v_mul_f32 v252, v252, v57
v_accvgpr_write_b32 a53, v252
v_accvgpr_read_b32 v252, a54
v_mul_f32 v252, v252, v57
v_accvgpr_write_b32 a54, v252
v_accvgpr_read_b32 v252, a55
v_mul_f32 v252, v252, v57
v_accvgpr_write_b32 a55, v252
v_accvgpr_read_b32 v252, a56
v_mul_f32 v252, v252, v57
v_accvgpr_write_b32 a56, v252
v_accvgpr_read_b32 v252, a57
v_mul_f32 v252, v252, v57
v_accvgpr_write_b32 a57, v252
v_accvgpr_read_b32 v252, a58
v_mul_f32 v252, v252, v57
v_accvgpr_write_b32 a58, v252
v_accvgpr_read_b32 v252, a59
v_mul_f32 v252, v252, v57
v_accvgpr_write_b32 a59, v252
v_accvgpr_read_b32 v252, a60
v_mul_f32 v252, v252, v57
v_accvgpr_write_b32 a60, v252
v_accvgpr_read_b32 v252, a61
v_mul_f32 v252, v252, v57
v_accvgpr_write_b32 a61, v252
v_accvgpr_read_b32 v252, a62
v_mul_f32 v252, v252, v57
v_accvgpr_write_b32 a62, v252
v_accvgpr_read_b32 v252, a63
v_mul_f32 v252, v252, v57
v_accvgpr_write_b32 a63, v252
v_max_f32 v54, 0, v54
v_ceil_f32 v54, v54
v_exp_f32_e64 v58, -v54
v_sub_f32 v40, v40, v54
v_sub_f32 v41, v41, v54
v_sub_f32 v42, v42, v54
v_sub_f32 v43, v43, v54
v_sub_f32 v132, v132, v54
v_sub_f32 v133, v133, v54
v_sub_f32 v134, v134, v54
v_sub_f32 v135, v135, v54
v_sub_f32 v148, v148, v54
v_sub_f32 v149, v149, v54
v_sub_f32 v150, v150, v54
v_sub_f32 v151, v151, v54
v_sub_f32 v164, v164, v54
v_sub_f32 v165, v165, v54
v_sub_f32 v166, v166, v54
v_sub_f32 v167, v167, v54
v_sub_f32 v180, v180, v54
v_sub_f32 v181, v181, v54
v_sub_f32 v182, v182, v54
v_sub_f32 v183, v183, v54
v_lshlrev_b32 v252, 16, v196
v_and_b32 v253, 0xffff0000, v196
v_mul_f32 v252, v252, v58
v_mul_f32 v253, v253, v58
v_cvt_pk_bf16_f32 v196, v252, v253
v_lshlrev_b32 v252, 16, v197
v_and_b32 v253, 0xffff0000, v197
v_mul_f32 v252, v252, v58
v_mul_f32 v253, v253, v58
v_cvt_pk_bf16_f32 v197, v252, v253
v_lshlrev_b32 v252, 16, v198
v_and_b32 v253, 0xffff0000, v198
v_mul_f32 v252, v252, v58
v_mul_f32 v253, v253, v58
v_cvt_pk_bf16_f32 v198, v252, v253
v_lshlrev_b32 v252, 16, v199
v_and_b32 v253, 0xffff0000, v199
v_mul_f32 v252, v252, v58
v_mul_f32 v253, v253, v58
v_cvt_pk_bf16_f32 v199, v252, v253
v_sub_f32 v228, v228, v54
v_sub_f32 v229, v229, v54
v_sub_f32 v230, v230, v54
v_sub_f32 v231, v231, v54
v_sub_f32 v244, v244, v54
v_sub_f32 v245, v245, v54
v_sub_f32 v246, v246, v54
v_sub_f32 v247, v247, v54
v_accvgpr_read_b32 v252, a136
v_mul_f32 v252, v252, v58
v_accvgpr_write_b32 a136, v252
v_accvgpr_read_b32 v252, a137
v_mul_f32 v252, v252, v58
v_accvgpr_write_b32 a137, v252
v_accvgpr_read_b32 v252, a138
v_mul_f32 v252, v252, v58
v_accvgpr_write_b32 a138, v252
v_accvgpr_read_b32 v252, a139
v_mul_f32 v252, v252, v58
v_accvgpr_write_b32 a139, v252
v_accvgpr_read_b32 v252, a64
v_mul_f32 v252, v252, v58
v_accvgpr_write_b32 a64, v252
v_accvgpr_read_b32 v252, a65
v_mul_f32 v252, v252, v58
v_accvgpr_write_b32 a65, v252
v_accvgpr_read_b32 v252, a66
v_mul_f32 v252, v252, v58
v_accvgpr_write_b32 a66, v252
v_accvgpr_read_b32 v252, a67
v_mul_f32 v252, v252, v58
v_accvgpr_write_b32 a67, v252
v_accvgpr_read_b32 v252, a68
v_mul_f32 v252, v252, v58
v_accvgpr_write_b32 a68, v252
v_accvgpr_read_b32 v252, a69
v_mul_f32 v252, v252, v58
v_accvgpr_write_b32 a69, v252
v_accvgpr_read_b32 v252, a70
v_mul_f32 v252, v252, v58
v_accvgpr_write_b32 a70, v252
v_accvgpr_read_b32 v252, a71
v_mul_f32 v252, v252, v58
v_accvgpr_write_b32 a71, v252
v_accvgpr_read_b32 v252, a72
v_mul_f32 v252, v252, v58
v_accvgpr_write_b32 a72, v252
v_accvgpr_read_b32 v252, a73
v_mul_f32 v252, v252, v58
v_accvgpr_write_b32 a73, v252
v_accvgpr_read_b32 v252, a74
v_mul_f32 v252, v252, v58
v_accvgpr_write_b32 a74, v252
v_accvgpr_read_b32 v252, a75
v_mul_f32 v252, v252, v58
v_accvgpr_write_b32 a75, v252
v_accvgpr_read_b32 v252, a76
v_mul_f32 v252, v252, v58
v_accvgpr_write_b32 a76, v252
v_accvgpr_read_b32 v252, a77
v_mul_f32 v252, v252, v58
v_accvgpr_write_b32 a77, v252
v_accvgpr_read_b32 v252, a78
v_mul_f32 v252, v252, v58
v_accvgpr_write_b32 a78, v252
v_accvgpr_read_b32 v252, a79
v_mul_f32 v252, v252, v58
v_accvgpr_write_b32 a79, v252
v_accvgpr_read_b32 v252, a80
v_mul_f32 v252, v252, v58
v_accvgpr_write_b32 a80, v252
v_accvgpr_read_b32 v252, a81
v_mul_f32 v252, v252, v58
v_accvgpr_write_b32 a81, v252
v_accvgpr_read_b32 v252, a82
v_mul_f32 v252, v252, v58
v_accvgpr_write_b32 a82, v252
v_accvgpr_read_b32 v252, a83
v_mul_f32 v252, v252, v58
v_accvgpr_write_b32 a83, v252
v_accvgpr_read_b32 v252, a84
v_mul_f32 v252, v252, v58
v_accvgpr_write_b32 a84, v252
v_accvgpr_read_b32 v252, a85
v_mul_f32 v252, v252, v58
v_accvgpr_write_b32 a85, v252
v_accvgpr_read_b32 v252, a86
v_mul_f32 v252, v252, v58
v_accvgpr_write_b32 a86, v252
v_accvgpr_read_b32 v252, a87
v_mul_f32 v252, v252, v58
v_accvgpr_write_b32 a87, v252
v_accvgpr_read_b32 v252, a88
v_mul_f32 v252, v252, v58
v_accvgpr_write_b32 a88, v252
v_accvgpr_read_b32 v252, a89
v_mul_f32 v252, v252, v58
v_accvgpr_write_b32 a89, v252
v_accvgpr_read_b32 v252, a90
v_mul_f32 v252, v252, v58
v_accvgpr_write_b32 a90, v252
v_accvgpr_read_b32 v252, a91
v_mul_f32 v252, v252, v58
v_accvgpr_write_b32 a91, v252
v_accvgpr_read_b32 v252, a92
v_mul_f32 v252, v252, v58
v_accvgpr_write_b32 a92, v252
v_accvgpr_read_b32 v252, a93
v_mul_f32 v252, v252, v58
v_accvgpr_write_b32 a93, v252
v_accvgpr_read_b32 v252, a94
v_mul_f32 v252, v252, v58
v_accvgpr_write_b32 a94, v252
v_accvgpr_read_b32 v252, a95
v_mul_f32 v252, v252, v58
v_accvgpr_write_b32 a95, v252
v_max_f32 v55, 0, v55
v_ceil_f32 v55, v55
v_exp_f32_e64 v59, -v55
v_sub_f32 v44, v44, v55
v_sub_f32 v45, v45, v55
v_sub_f32 v46, v46, v55
v_sub_f32 v47, v47, v55
v_sub_f32 v136, v136, v55
v_sub_f32 v137, v137, v55
v_sub_f32 v138, v138, v55
v_sub_f32 v139, v139, v55
v_sub_f32 v152, v152, v55
v_sub_f32 v153, v153, v55
v_sub_f32 v154, v154, v55
v_sub_f32 v155, v155, v55
v_sub_f32 v168, v168, v55
v_sub_f32 v169, v169, v55
v_sub_f32 v170, v170, v55
v_sub_f32 v171, v171, v55
v_sub_f32 v184, v184, v55
v_sub_f32 v185, v185, v55
v_sub_f32 v186, v186, v55
v_sub_f32 v187, v187, v55
v_lshlrev_b32 v252, 16, v200
v_and_b32 v253, 0xffff0000, v200
v_mul_f32 v252, v252, v59
v_mul_f32 v253, v253, v59
v_cvt_pk_bf16_f32 v200, v252, v253
v_lshlrev_b32 v252, 16, v201
v_and_b32 v253, 0xffff0000, v201
v_mul_f32 v252, v252, v59
v_mul_f32 v253, v253, v59
v_cvt_pk_bf16_f32 v201, v252, v253
v_lshlrev_b32 v252, 16, v202
v_and_b32 v253, 0xffff0000, v202
v_mul_f32 v252, v252, v59
v_mul_f32 v253, v253, v59
v_cvt_pk_bf16_f32 v202, v252, v253
v_lshlrev_b32 v252, 16, v203
v_and_b32 v253, 0xffff0000, v203
v_mul_f32 v252, v252, v59
v_mul_f32 v253, v253, v59
v_cvt_pk_bf16_f32 v203, v252, v253
v_sub_f32 v232, v232, v55
v_sub_f32 v233, v233, v55
v_sub_f32 v234, v234, v55
v_sub_f32 v235, v235, v55
v_sub_f32 v248, v248, v55
v_sub_f32 v249, v249, v55
v_sub_f32 v250, v250, v55
v_sub_f32 v251, v251, v55
v_accvgpr_read_b32 v252, a140
v_mul_f32 v252, v252, v59
v_accvgpr_write_b32 a140, v252
v_accvgpr_read_b32 v252, a141
v_mul_f32 v252, v252, v59
v_accvgpr_write_b32 a141, v252
v_accvgpr_read_b32 v252, a142
v_mul_f32 v252, v252, v59
v_accvgpr_write_b32 a142, v252
v_accvgpr_read_b32 v252, a143
v_mul_f32 v252, v252, v59
v_accvgpr_write_b32 a143, v252
v_accvgpr_read_b32 v252, a96
v_mul_f32 v252, v252, v59
v_accvgpr_write_b32 a96, v252
v_accvgpr_read_b32 v252, a97
v_mul_f32 v252, v252, v59
v_accvgpr_write_b32 a97, v252
v_accvgpr_read_b32 v252, a98
v_mul_f32 v252, v252, v59
v_accvgpr_write_b32 a98, v252
v_accvgpr_read_b32 v252, a99
v_mul_f32 v252, v252, v59
v_accvgpr_write_b32 a99, v252
v_accvgpr_read_b32 v252, a100
v_mul_f32 v252, v252, v59
v_accvgpr_write_b32 a100, v252
v_accvgpr_read_b32 v252, a101
v_mul_f32 v252, v252, v59
v_accvgpr_write_b32 a101, v252
v_accvgpr_read_b32 v252, a102
v_mul_f32 v252, v252, v59
v_accvgpr_write_b32 a102, v252
v_accvgpr_read_b32 v252, a103
v_mul_f32 v252, v252, v59
v_accvgpr_write_b32 a103, v252
v_accvgpr_read_b32 v252, a104
v_mul_f32 v252, v252, v59
v_accvgpr_write_b32 a104, v252
v_accvgpr_read_b32 v252, a105
v_mul_f32 v252, v252, v59
v_accvgpr_write_b32 a105, v252
v_accvgpr_read_b32 v252, a106
v_mul_f32 v252, v252, v59
v_accvgpr_write_b32 a106, v252
v_accvgpr_read_b32 v252, a107
v_mul_f32 v252, v252, v59
v_accvgpr_write_b32 a107, v252
v_accvgpr_read_b32 v252, a108
v_mul_f32 v252, v252, v59
v_accvgpr_write_b32 a108, v252
v_accvgpr_read_b32 v252, a109
v_mul_f32 v252, v252, v59
v_accvgpr_write_b32 a109, v252
v_accvgpr_read_b32 v252, a110
v_mul_f32 v252, v252, v59
v_accvgpr_write_b32 a110, v252
v_accvgpr_read_b32 v252, a111
v_mul_f32 v252, v252, v59
v_accvgpr_write_b32 a111, v252
v_accvgpr_read_b32 v252, a112
v_mul_f32 v252, v252, v59
v_accvgpr_write_b32 a112, v252
v_accvgpr_read_b32 v252, a113
v_mul_f32 v252, v252, v59
v_accvgpr_write_b32 a113, v252
v_accvgpr_read_b32 v252, a114
v_mul_f32 v252, v252, v59
v_accvgpr_write_b32 a114, v252
v_accvgpr_read_b32 v252, a115
v_mul_f32 v252, v252, v59
v_accvgpr_write_b32 a115, v252
v_accvgpr_read_b32 v252, a116
v_mul_f32 v252, v252, v59
v_accvgpr_write_b32 a116, v252
v_accvgpr_read_b32 v252, a117
v_mul_f32 v252, v252, v59
v_accvgpr_write_b32 a117, v252
v_accvgpr_read_b32 v252, a118
v_mul_f32 v252, v252, v59
v_accvgpr_write_b32 a118, v252
v_accvgpr_read_b32 v252, a119
v_mul_f32 v252, v252, v59
v_accvgpr_write_b32 a119, v252
v_accvgpr_read_b32 v252, a120
v_mul_f32 v252, v252, v59
v_accvgpr_write_b32 a120, v252
v_accvgpr_read_b32 v252, a121
v_mul_f32 v252, v252, v59
v_accvgpr_write_b32 a121, v252
v_accvgpr_read_b32 v252, a122
v_mul_f32 v252, v252, v59
v_accvgpr_write_b32 a122, v252
v_accvgpr_read_b32 v252, a123
v_mul_f32 v252, v252, v59
v_accvgpr_write_b32 a123, v252
v_accvgpr_read_b32 v252, a124
v_mul_f32 v252, v252, v59
v_accvgpr_write_b32 a124, v252
v_accvgpr_read_b32 v252, a125
v_mul_f32 v252, v252, v59
v_accvgpr_write_b32 a125, v252
v_accvgpr_read_b32 v252, a126
v_mul_f32 v252, v252, v59
v_accvgpr_write_b32 a126, v252
v_accvgpr_read_b32 v252, a127
v_mul_f32 v252, v252, v59
v_accvgpr_write_b32 a127, v252
s_nop 1
s_branch ka_kernel_back24
ka_kernel_slow25:
s_nop 15
v_mov_b32 v56, v52
v_mov_b32 v57, v53
v_mov_b32 v58, v54
v_mov_b32 v59, v55
v_permlane16_swap_b32 v52, v56
v_permlane16_swap_b32 v53, v57
v_permlane16_swap_b32 v54, v58
v_permlane16_swap_b32 v55, v59
v_max_f32 v52, v52, v56
v_max_f32 v53, v53, v57
v_max_f32 v54, v54, v58
v_max_f32 v55, v55, v59
v_mov_b32 v56, v52
v_mov_b32 v57, v53
v_mov_b32 v58, v54
v_mov_b32 v59, v55
v_permlane32_swap_b32 v52, v56
v_permlane32_swap_b32 v53, v57
v_permlane32_swap_b32 v54, v58
v_permlane32_swap_b32 v55, v59
v_max_f32 v52, v52, v56
v_max_f32 v53, v53, v57
v_max_f32 v54, v54, v58
v_max_f32 v55, v55, v59
v_max_f32 v52, 0, v52
v_ceil_f32 v52, v52
v_exp_f32_e64 v56, -v52
v_sub_f32 v32, v32, v52
v_sub_f32 v33, v33, v52
v_sub_f32 v34, v34, v52
v_sub_f32 v35, v35, v52
v_sub_f32 v188, v188, v52
v_sub_f32 v189, v189, v52
v_sub_f32 v190, v190, v52
v_sub_f32 v191, v191, v52
v_sub_f32 v204, v204, v52
v_sub_f32 v205, v205, v52
v_sub_f32 v206, v206, v52
v_sub_f32 v207, v207, v52
v_sub_f32 v220, v220, v52
v_sub_f32 v221, v221, v52
v_sub_f32 v222, v222, v52
v_sub_f32 v223, v223, v52
v_sub_f32 v236, v236, v52
v_sub_f32 v237, v237, v52
v_sub_f32 v238, v238, v52
v_sub_f32 v239, v239, v52
v_lshlrev_b32 v252, 16, v124
v_and_b32 v253, 0xffff0000, v124
v_mul_f32 v252, v252, v56
v_mul_f32 v253, v253, v56
v_cvt_pk_bf16_f32 v124, v252, v253
v_lshlrev_b32 v252, 16, v125
v_and_b32 v253, 0xffff0000, v125
v_mul_f32 v252, v252, v56
v_mul_f32 v253, v253, v56
v_cvt_pk_bf16_f32 v125, v252, v253
v_lshlrev_b32 v252, 16, v126
v_and_b32 v253, 0xffff0000, v126
v_mul_f32 v252, v252, v56
v_mul_f32 v253, v253, v56
v_cvt_pk_bf16_f32 v126, v252, v253
v_lshlrev_b32 v252, 16, v127
v_and_b32 v253, 0xffff0000, v127
v_mul_f32 v252, v252, v56
v_mul_f32 v253, v253, v56
v_cvt_pk_bf16_f32 v127, v252, v253
v_lshlrev_b32 v252, 16, v156
v_and_b32 v253, 0xffff0000, v156
v_mul_f32 v252, v252, v56
v_mul_f32 v253, v253, v56
v_cvt_pk_bf16_f32 v156, v252, v253
v_lshlrev_b32 v252, 16, v157
v_and_b32 v253, 0xffff0000, v157
v_mul_f32 v252, v252, v56
v_mul_f32 v253, v253, v56
v_cvt_pk_bf16_f32 v157, v252, v253
v_lshlrev_b32 v252, 16, v158
v_and_b32 v253, 0xffff0000, v158
v_mul_f32 v252, v252, v56
v_mul_f32 v253, v253, v56
v_cvt_pk_bf16_f32 v158, v252, v253
v_lshlrev_b32 v252, 16, v159
v_and_b32 v253, 0xffff0000, v159
v_mul_f32 v252, v252, v56
v_mul_f32 v253, v253, v56
v_cvt_pk_bf16_f32 v159, v252, v253
v_accvgpr_read_b32 v252, a128
v_mul_f32 v252, v252, v56
v_accvgpr_write_b32 a128, v252
v_accvgpr_read_b32 v252, a129
v_mul_f32 v252, v252, v56
v_accvgpr_write_b32 a129, v252
v_accvgpr_read_b32 v252, a130
v_mul_f32 v252, v252, v56
v_accvgpr_write_b32 a130, v252
v_accvgpr_read_b32 v252, a131
v_mul_f32 v252, v252, v56
v_accvgpr_write_b32 a131, v252
v_accvgpr_read_b32 v252, a0
v_mul_f32 v252, v252, v56
v_accvgpr_write_b32 a0, v252
v_accvgpr_read_b32 v252, a1
v_mul_f32 v252, v252, v56
v_accvgpr_write_b32 a1, v252
v_accvgpr_read_b32 v252, a2
v_mul_f32 v252, v252, v56
v_accvgpr_write_b32 a2, v252
v_accvgpr_read_b32 v252, a3
v_mul_f32 v252, v252, v56
v_accvgpr_write_b32 a3, v252
v_accvgpr_read_b32 v252, a4
v_mul_f32 v252, v252, v56
v_accvgpr_write_b32 a4, v252
v_accvgpr_read_b32 v252, a5
v_mul_f32 v252, v252, v56
v_accvgpr_write_b32 a5, v252
v_accvgpr_read_b32 v252, a6
v_mul_f32 v252, v252, v56
v_accvgpr_write_b32 a6, v252
v_accvgpr_read_b32 v252, a7
v_mul_f32 v252, v252, v56
v_accvgpr_write_b32 a7, v252
v_accvgpr_read_b32 v252, a8
v_mul_f32 v252, v252, v56
v_accvgpr_write_b32 a8, v252
v_accvgpr_read_b32 v252, a9
v_mul_f32 v252, v252, v56
v_accvgpr_write_b32 a9, v252
v_accvgpr_read_b32 v252, a10
v_mul_f32 v252, v252, v56
v_accvgpr_write_b32 a10, v252
v_accvgpr_read_b32 v252, a11
v_mul_f32 v252, v252, v56
v_accvgpr_write_b32 a11, v252
v_accvgpr_read_b32 v252, a12
v_mul_f32 v252, v252, v56
v_accvgpr_write_b32 a12, v252
v_accvgpr_read_b32 v252, a13
v_mul_f32 v252, v252, v56
v_accvgpr_write_b32 a13, v252
v_accvgpr_read_b32 v252, a14
v_mul_f32 v252, v252, v56
v_accvgpr_write_b32 a14, v252
v_accvgpr_read_b32 v252, a15
v_mul_f32 v252, v252, v56
v_accvgpr_write_b32 a15, v252
v_accvgpr_read_b32 v252, a16
v_mul_f32 v252, v252, v56
v_accvgpr_write_b32 a16, v252
v_accvgpr_read_b32 v252, a17
v_mul_f32 v252, v252, v56
v_accvgpr_write_b32 a17, v252
v_accvgpr_read_b32 v252, a18
v_mul_f32 v252, v252, v56
v_accvgpr_write_b32 a18, v252
v_accvgpr_read_b32 v252, a19
v_mul_f32 v252, v252, v56
v_accvgpr_write_b32 a19, v252
v_accvgpr_read_b32 v252, a20
v_mul_f32 v252, v252, v56
v_accvgpr_write_b32 a20, v252
v_accvgpr_read_b32 v252, a21
v_mul_f32 v252, v252, v56
v_accvgpr_write_b32 a21, v252
v_accvgpr_read_b32 v252, a22
v_mul_f32 v252, v252, v56
v_accvgpr_write_b32 a22, v252
v_accvgpr_read_b32 v252, a23
v_mul_f32 v252, v252, v56
v_accvgpr_write_b32 a23, v252
v_accvgpr_read_b32 v252, a24
v_mul_f32 v252, v252, v56
v_accvgpr_write_b32 a24, v252
v_accvgpr_read_b32 v252, a25
v_mul_f32 v252, v252, v56
v_accvgpr_write_b32 a25, v252
v_accvgpr_read_b32 v252, a26
v_mul_f32 v252, v252, v56
v_accvgpr_write_b32 a26, v252
v_accvgpr_read_b32 v252, a27
v_mul_f32 v252, v252, v56
v_accvgpr_write_b32 a27, v252
v_accvgpr_read_b32 v252, a28
v_mul_f32 v252, v252, v56
v_accvgpr_write_b32 a28, v252
v_accvgpr_read_b32 v252, a29
v_mul_f32 v252, v252, v56
v_accvgpr_write_b32 a29, v252
v_accvgpr_read_b32 v252, a30
v_mul_f32 v252, v252, v56
v_accvgpr_write_b32 a30, v252
v_accvgpr_read_b32 v252, a31
v_mul_f32 v252, v252, v56
v_accvgpr_write_b32 a31, v252
v_max_f32 v53, 0, v53
v_ceil_f32 v53, v53
v_exp_f32_e64 v57, -v53
v_sub_f32 v36, v36, v53
v_sub_f32 v37, v37, v53
v_sub_f32 v38, v38, v53
v_sub_f32 v39, v39, v53
v_sub_f32 v192, v192, v53
v_sub_f32 v193, v193, v53
v_sub_f32 v194, v194, v53
v_sub_f32 v195, v195, v53
v_sub_f32 v208, v208, v53
v_sub_f32 v209, v209, v53
v_sub_f32 v210, v210, v53
v_sub_f32 v211, v211, v53
v_sub_f32 v224, v224, v53
v_sub_f32 v225, v225, v53
v_sub_f32 v226, v226, v53
v_sub_f32 v227, v227, v53
v_sub_f32 v240, v240, v53
v_sub_f32 v241, v241, v53
v_sub_f32 v242, v242, v53
v_sub_f32 v243, v243, v53
v_lshlrev_b32 v252, 16, v128
v_and_b32 v253, 0xffff0000, v128
v_mul_f32 v252, v252, v57
v_mul_f32 v253, v253, v57
v_cvt_pk_bf16_f32 v128, v252, v253
v_lshlrev_b32 v252, 16, v129
v_and_b32 v253, 0xffff0000, v129
v_mul_f32 v252, v252, v57
v_mul_f32 v253, v253, v57
v_cvt_pk_bf16_f32 v129, v252, v253
v_lshlrev_b32 v252, 16, v130
v_and_b32 v253, 0xffff0000, v130
v_mul_f32 v252, v252, v57
v_mul_f32 v253, v253, v57
v_cvt_pk_bf16_f32 v130, v252, v253
v_lshlrev_b32 v252, 16, v131
v_and_b32 v253, 0xffff0000, v131
v_mul_f32 v252, v252, v57
v_mul_f32 v253, v253, v57
v_cvt_pk_bf16_f32 v131, v252, v253
v_lshlrev_b32 v252, 16, v160
v_and_b32 v253, 0xffff0000, v160
v_mul_f32 v252, v252, v57
v_mul_f32 v253, v253, v57
v_cvt_pk_bf16_f32 v160, v252, v253
v_mul_f32 v162, v162, v57
v_mul_f32 v163, v163, v57
v_mul_f32 v176, v176, v57
v_sub_f32 v177, v177, v53
v_sub_f32 v178, v178, v53
v_sub_f32 v179, v179, v53
v_accvgpr_read_b32 v252, a132
v_mul_f32 v252, v252, v57
v_accvgpr_write_b32 a132, v252
v_accvgpr_read_b32 v252, a133
v_mul_f32 v252, v252, v57
v_accvgpr_write_b32 a133, v252
v_accvgpr_read_b32 v252, a134
v_mul_f32 v252, v252, v57
v_accvgpr_write_b32 a134, v252
v_accvgpr_read_b32 v252, a135
v_mul_f32 v252, v252, v57
v_accvgpr_write_b32 a135, v252
v_accvgpr_read_b32 v252, a32
v_mul_f32 v252, v252, v57
v_accvgpr_write_b32 a32, v252
v_accvgpr_read_b32 v252, a33
v_mul_f32 v252, v252, v57
v_accvgpr_write_b32 a33, v252
v_accvgpr_read_b32 v252, a34
v_mul_f32 v252, v252, v57
v_accvgpr_write_b32 a34, v252
v_accvgpr_read_b32 v252, a35
v_mul_f32 v252, v252, v57
v_accvgpr_write_b32 a35, v252
v_accvgpr_read_b32 v252, a36
v_mul_f32 v252, v252, v57
v_accvgpr_write_b32 a36, v252
v_accvgpr_read_b32 v252, a37
v_mul_f32 v252, v252, v57
v_accvgpr_write_b32 a37, v252
v_accvgpr_read_b32 v252, a38
v_mul_f32 v252, v252, v57
v_accvgpr_write_b32 a38, v252
v_accvgpr_read_b32 v252, a39
v_mul_f32 v252, v252, v57
v_accvgpr_write_b32 a39, v252
v_accvgpr_read_b32 v252, a40
v_mul_f32 v252, v252, v57
v_accvgpr_write_b32 a40, v252
v_accvgpr_read_b32 v252, a41
v_mul_f32 v252, v252, v57
v_accvgpr_write_b32 a41, v252
v_accvgpr_read_b32 v252, a42
v_mul_f32 v252, v252, v57
v_accvgpr_write_b32 a42, v252
v_accvgpr_read_b32 v252, a43
v_mul_f32 v252, v252, v57
v_accvgpr_write_b32 a43, v252
v_accvgpr_read_b32 v252, a44
v_mul_f32 v252, v252, v57
v_accvgpr_write_b32 a44, v252
v_accvgpr_read_b32 v252, a45
v_mul_f32 v252, v252, v57
v_accvgpr_write_b32 a45, v252
v_accvgpr_read_b32 v252, a46
v_mul_f32 v252, v252, v57
v_accvgpr_write_b32 a46, v252
v_accvgpr_read_b32 v252, a47
v_mul_f32 v252, v252, v57
v_accvgpr_write_b32 a47, v252
v_accvgpr_read_b32 v252, a48
v_mul_f32 v252, v252, v57
v_accvgpr_write_b32 a48, v252
v_accvgpr_read_b32 v252, a49
v_mul_f32 v252, v252, v57
v_accvgpr_write_b32 a49, v252
v_accvgpr_read_b32 v252, a50
v_mul_f32 v252, v252, v57
v_accvgpr_write_b32 a50, v252
v_accvgpr_read_b32 v252, a51
v_mul_f32 v252, v252, v57
v_accvgpr_write_b32 a51, v252
v_accvgpr_read_b32 v252, a52
v_mul_f32 v252, v252, v57
v_accvgpr_write_b32 a52, v252
v_accvgpr_read_b32 v252, a53
v_mul_f32 v252, v252, v57
v_accvgpr_write_b32 a53, v252
v_accvgpr_read_b32 v252, a54
v_mul_f32 v252, v252, v57
v_accvgpr_write_b32 a54, v252
v_accvgpr_read_b32 v252, a55
v_mul_f32 v252, v252, v57
v_accvgpr_write_b32 a55, v252
v_accvgpr_read_b32 v252, a56
v_mul_f32 v252, v252, v57
v_accvgpr_write_b32 a56, v252
v_accvgpr_read_b32 v252, a57
v_mul_f32 v252, v252, v57
v_accvgpr_write_b32 a57, v252
v_accvgpr_read_b32 v252, a58
v_mul_f32 v252, v252, v57
v_accvgpr_write_b32 a58, v252
v_accvgpr_read_b32 v252, a59
v_mul_f32 v252, v252, v57
v_accvgpr_write_b32 a59, v252
v_accvgpr_read_b32 v252, a60
v_mul_f32 v252, v252, v57
v_accvgpr_write_b32 a60, v252
v_accvgpr_read_b32 v252, a61
v_mul_f32 v252, v252, v57
v_accvgpr_write_b32 a61, v252
v_accvgpr_read_b32 v252, a62
v_mul_f32 v252, v252, v57
v_accvgpr_write_b32 a62, v252
v_accvgpr_read_b32 v252, a63
v_mul_f32 v252, v252, v57
v_accvgpr_write_b32 a63, v252
v_max_f32 v54, 0, v54
v_ceil_f32 v54, v54
v_exp_f32_e64 v58, -v54
v_sub_f32 v40, v40, v54
v_sub_f32 v41, v41, v54
v_sub_f32 v42, v42, v54
v_sub_f32 v43, v43, v54
v_sub_f32 v196, v196, v54
v_sub_f32 v197, v197, v54
v_sub_f32 v198, v198, v54
v_sub_f32 v199, v199, v54
v_sub_f32 v212, v212, v54
v_sub_f32 v213, v213, v54
v_sub_f32 v214, v214, v54
v_sub_f32 v215, v215, v54
v_sub_f32 v228, v228, v54
v_sub_f32 v229, v229, v54
v_sub_f32 v230, v230, v54
v_sub_f32 v231, v231, v54
v_sub_f32 v244, v244, v54
v_sub_f32 v245, v245, v54
v_sub_f32 v246, v246, v54
v_sub_f32 v247, v247, v54
v_lshlrev_b32 v252, 16, v132
v_and_b32 v253, 0xffff0000, v132
v_mul_f32 v252, v252, v58
v_mul_f32 v253, v253, v58
v_cvt_pk_bf16_f32 v132, v252, v253
v_lshlrev_b32 v252, 16, v133
v_and_b32 v253, 0xffff0000, v133
v_mul_f32 v252, v252, v58
v_mul_f32 v253, v253, v58
v_cvt_pk_bf16_f32 v133, v252, v253
v_lshlrev_b32 v252, 16, v134
v_and_b32 v253, 0xffff0000, v134
v_mul_f32 v252, v252, v58
v_mul_f32 v253, v253, v58
v_cvt_pk_bf16_f32 v134, v252, v253
v_lshlrev_b32 v252, 16, v135
v_and_b32 v253, 0xffff0000, v135
v_mul_f32 v252, v252, v58
v_mul_f32 v253, v253, v58
v_cvt_pk_bf16_f32 v135, v252, v253
v_sub_f32 v164, v164, v54
v_sub_f32 v165, v165, v54
v_sub_f32 v166, v166, v54
v_sub_f32 v167, v167, v54
v_sub_f32 v180, v180, v54
v_sub_f32 v181, v181, v54
v_sub_f32 v182, v182, v54
v_sub_f32 v183, v183, v54
v_accvgpr_read_b32 v252, a136
v_mul_f32 v252, v252, v58
v_accvgpr_write_b32 a136, v252
v_accvgpr_read_b32 v252, a137
v_mul_f32 v252, v252, v58
v_accvgpr_write_b32 a137, v252
v_accvgpr_read_b32 v252, a138
v_mul_f32 v252, v252, v58
v_accvgpr_write_b32 a138, v252
v_accvgpr_read_b32 v252, a139
v_mul_f32 v252, v252, v58
v_accvgpr_write_b32 a139, v252
v_accvgpr_read_b32 v252, a64
v_mul_f32 v252, v252, v58
v_accvgpr_write_b32 a64, v252
v_accvgpr_read_b32 v252, a65
v_mul_f32 v252, v252, v58
v_accvgpr_write_b32 a65, v252
v_accvgpr_read_b32 v252, a66
v_mul_f32 v252, v252, v58
v_accvgpr_write_b32 a66, v252
v_accvgpr_read_b32 v252, a67
v_mul_f32 v252, v252, v58
v_accvgpr_write_b32 a67, v252
v_accvgpr_read_b32 v252, a68
v_mul_f32 v252, v252, v58
v_accvgpr_write_b32 a68, v252
v_accvgpr_read_b32 v252, a69
v_mul_f32 v252, v252, v58
v_accvgpr_write_b32 a69, v252
v_accvgpr_read_b32 v252, a70
v_mul_f32 v252, v252, v58
v_accvgpr_write_b32 a70, v252
v_accvgpr_read_b32 v252, a71
v_mul_f32 v252, v252, v58
v_accvgpr_write_b32 a71, v252
v_accvgpr_read_b32 v252, a72
v_mul_f32 v252, v252, v58
v_accvgpr_write_b32 a72, v252
v_accvgpr_read_b32 v252, a73
v_mul_f32 v252, v252, v58
v_accvgpr_write_b32 a73, v252
v_accvgpr_read_b32 v252, a74
v_mul_f32 v252, v252, v58
v_accvgpr_write_b32 a74, v252
v_accvgpr_read_b32 v252, a75
v_mul_f32 v252, v252, v58
v_accvgpr_write_b32 a75, v252
v_accvgpr_read_b32 v252, a76
v_mul_f32 v252, v252, v58
v_accvgpr_write_b32 a76, v252
v_accvgpr_read_b32 v252, a77
v_mul_f32 v252, v252, v58
v_accvgpr_write_b32 a77, v252
v_accvgpr_read_b32 v252, a78
v_mul_f32 v252, v252, v58
v_accvgpr_write_b32 a78, v252
v_accvgpr_read_b32 v252, a79
v_mul_f32 v252, v252, v58
v_accvgpr_write_b32 a79, v252
v_accvgpr_read_b32 v252, a80
v_mul_f32 v252, v252, v58
v_accvgpr_write_b32 a80, v252
v_accvgpr_read_b32 v252, a81
v_mul_f32 v252, v252, v58
v_accvgpr_write_b32 a81, v252
v_accvgpr_read_b32 v252, a82
v_mul_f32 v252, v252, v58
v_accvgpr_write_b32 a82, v252
v_accvgpr_read_b32 v252, a83
v_mul_f32 v252, v252, v58
v_accvgpr_write_b32 a83, v252
v_accvgpr_read_b32 v252, a84
v_mul_f32 v252, v252, v58
v_accvgpr_write_b32 a84, v252
v_accvgpr_read_b32 v252, a85
v_mul_f32 v252, v252, v58
v_accvgpr_write_b32 a85, v252
v_accvgpr_read_b32 v252, a86
v_mul_f32 v252, v252, v58
v_accvgpr_write_b32 a86, v252
v_accvgpr_read_b32 v252, a87
v_mul_f32 v252, v252, v58
v_accvgpr_write_b32 a87, v252
v_accvgpr_read_b32 v252, a88
v_mul_f32 v252, v252, v58
v_accvgpr_write_b32 a88, v252
v_accvgpr_read_b32 v252, a89
v_mul_f32 v252, v252, v58
v_accvgpr_write_b32 a89, v252
v_accvgpr_read_b32 v252, a90
v_mul_f32 v252, v252, v58
v_accvgpr_write_b32 a90, v252
v_accvgpr_read_b32 v252, a91
v_mul_f32 v252, v252, v58
v_accvgpr_write_b32 a91, v252
v_accvgpr_read_b32 v252, a92
v_mul_f32 v252, v252, v58
v_accvgpr_write_b32 a92, v252
v_accvgpr_read_b32 v252, a93
v_mul_f32 v252, v252, v58
v_accvgpr_write_b32 a93, v252
v_accvgpr_read_b32 v252, a94
v_mul_f32 v252, v252, v58
v_accvgpr_write_b32 a94, v252
v_accvgpr_read_b32 v252, a95
v_mul_f32 v252, v252, v58
v_accvgpr_write_b32 a95, v252
v_max_f32 v55, 0, v55
v_ceil_f32 v55, v55
v_exp_f32_e64 v59, -v55
v_sub_f32 v44, v44, v55
v_sub_f32 v45, v45, v55
v_sub_f32 v46, v46, v55
v_sub_f32 v47, v47, v55
v_sub_f32 v200, v200, v55
v_sub_f32 v201, v201, v55
v_sub_f32 v202, v202, v55
v_sub_f32 v203, v203, v55
v_sub_f32 v216, v216, v55
v_sub_f32 v217, v217, v55
v_sub_f32 v218, v218, v55
v_sub_f32 v219, v219, v55
v_sub_f32 v232, v232, v55
v_sub_f32 v233, v233, v55
v_sub_f32 v234, v234, v55
v_sub_f32 v235, v235, v55
v_sub_f32 v248, v248, v55
v_sub_f32 v249, v249, v55
v_sub_f32 v250, v250, v55
v_sub_f32 v251, v251, v55
v_lshlrev_b32 v252, 16, v136
v_and_b32 v253, 0xffff0000, v136
v_mul_f32 v252, v252, v59
v_mul_f32 v253, v253, v59
v_cvt_pk_bf16_f32 v136, v252, v253
v_lshlrev_b32 v252, 16, v137
v_and_b32 v253, 0xffff0000, v137
v_mul_f32 v252, v252, v59
v_mul_f32 v253, v253, v59
v_cvt_pk_bf16_f32 v137, v252, v253
v_lshlrev_b32 v252, 16, v138
v_and_b32 v253, 0xffff0000, v138
v_mul_f32 v252, v252, v59
v_mul_f32 v253, v253, v59
v_cvt_pk_bf16_f32 v138, v252, v253
v_lshlrev_b32 v252, 16, v139
v_and_b32 v253, 0xffff0000, v139
v_mul_f32 v252, v252, v59
v_mul_f32 v253, v253, v59
v_cvt_pk_bf16_f32 v139, v252, v253
v_sub_f32 v168, v168, v55
v_sub_f32 v169, v169, v55
v_sub_f32 v170, v170, v55
v_sub_f32 v171, v171, v55
v_sub_f32 v184, v184, v55
v_sub_f32 v185, v185, v55
v_sub_f32 v186, v186, v55
v_sub_f32 v187, v187, v55
v_accvgpr_read_b32 v252, a140
v_mul_f32 v252, v252, v59
v_accvgpr_write_b32 a140, v252
v_accvgpr_read_b32 v252, a141
v_mul_f32 v252, v252, v59
v_accvgpr_write_b32 a141, v252
v_accvgpr_read_b32 v252, a142
v_mul_f32 v252, v252, v59
v_accvgpr_write_b32 a142, v252
v_accvgpr_read_b32 v252, a143
v_mul_f32 v252, v252, v59
v_accvgpr_write_b32 a143, v252
v_accvgpr_read_b32 v252, a96
v_mul_f32 v252, v252, v59
v_accvgpr_write_b32 a96, v252
v_accvgpr_read_b32 v252, a97
v_mul_f32 v252, v252, v59
v_accvgpr_write_b32 a97, v252
v_accvgpr_read_b32 v252, a98
v_mul_f32 v252, v252, v59
v_accvgpr_write_b32 a98, v252
v_accvgpr_read_b32 v252, a99
v_mul_f32 v252, v252, v59
v_accvgpr_write_b32 a99, v252
v_accvgpr_read_b32 v252, a100
v_mul_f32 v252, v252, v59
v_accvgpr_write_b32 a100, v252
v_accvgpr_read_b32 v252, a101
v_mul_f32 v252, v252, v59
v_accvgpr_write_b32 a101, v252
v_accvgpr_read_b32 v252, a102
v_mul_f32 v252, v252, v59
v_accvgpr_write_b32 a102, v252
v_accvgpr_read_b32 v252, a103
v_mul_f32 v252, v252, v59
v_accvgpr_write_b32 a103, v252
v_accvgpr_read_b32 v252, a104
v_mul_f32 v252, v252, v59
v_accvgpr_write_b32 a104, v252
v_accvgpr_read_b32 v252, a105
v_mul_f32 v252, v252, v59
v_accvgpr_write_b32 a105, v252
v_accvgpr_read_b32 v252, a106
v_mul_f32 v252, v252, v59
v_accvgpr_write_b32 a106, v252
v_accvgpr_read_b32 v252, a107
v_mul_f32 v252, v252, v59
v_accvgpr_write_b32 a107, v252
v_accvgpr_read_b32 v252, a108
v_mul_f32 v252, v252, v59
v_accvgpr_write_b32 a108, v252
v_accvgpr_read_b32 v252, a109
v_mul_f32 v252, v252, v59
v_accvgpr_write_b32 a109, v252
v_accvgpr_read_b32 v252, a110
v_mul_f32 v252, v252, v59
v_accvgpr_write_b32 a110, v252
v_accvgpr_read_b32 v252, a111
v_mul_f32 v252, v252, v59
v_accvgpr_write_b32 a111, v252
v_accvgpr_read_b32 v252, a112
v_mul_f32 v252, v252, v59
v_accvgpr_write_b32 a112, v252
v_accvgpr_read_b32 v252, a113
v_mul_f32 v252, v252, v59
v_accvgpr_write_b32 a113, v252
v_accvgpr_read_b32 v252, a114
v_mul_f32 v252, v252, v59
v_accvgpr_write_b32 a114, v252
v_accvgpr_read_b32 v252, a115
v_mul_f32 v252, v252, v59
v_accvgpr_write_b32 a115, v252
v_accvgpr_read_b32 v252, a116
v_mul_f32 v252, v252, v59
v_accvgpr_write_b32 a116, v252
v_accvgpr_read_b32 v252, a117
v_mul_f32 v252, v252, v59
v_accvgpr_write_b32 a117, v252
v_accvgpr_read_b32 v252, a118
v_mul_f32 v252, v252, v59
v_accvgpr_write_b32 a118, v252
v_accvgpr_read_b32 v252, a119
v_mul_f32 v252, v252, v59
v_accvgpr_write_b32 a119, v252
v_accvgpr_read_b32 v252, a120
v_mul_f32 v252, v252, v59
v_accvgpr_write_b32 a120, v252
v_accvgpr_read_b32 v252, a121
v_mul_f32 v252, v252, v59
v_accvgpr_write_b32 a121, v252
v_accvgpr_read_b32 v252, a122
v_mul_f32 v252, v252, v59
v_accvgpr_write_b32 a122, v252
v_accvgpr_read_b32 v252, a123
v_mul_f32 v252, v252, v59
v_accvgpr_write_b32 a123, v252
v_accvgpr_read_b32 v252, a124
v_mul_f32 v252, v252, v59
v_accvgpr_write_b32 a124, v252
v_accvgpr_read_b32 v252, a125
v_mul_f32 v252, v252, v59
v_accvgpr_write_b32 a125, v252
v_accvgpr_read_b32 v252, a126
v_mul_f32 v252, v252, v59
v_accvgpr_write_b32 a126, v252
v_accvgpr_read_b32 v252, a127
v_mul_f32 v252, v252, v59
v_accvgpr_write_b32 a127, v252
s_nop 1
s_branch ka_kernel_back26
.globl ka_kernel
.p2align 8
.type ka_kernel,@function
ka_kernel:
s_cmp_ge_u32 s2, 256
s_cbranch_scc1 ka_kernel_done1
s_load_dwordx8 s[44:51], s[0:1], 8
s_load_dwordx2 s[52:53], s[0:1], 104
s_load_dwordx4 s[4:7], s[0:1], 48
s_load_dwordx2 s[54:55], s[0:1], 64
s_load_dwordx2 s[56:57], s[0:1], 0
v_lshrrev_b32 v56, 6, v0
s_nop 0
v_readfirstlane_b32 s39, v56
v_and_b32 v56, 63, v0
v_lshrrev_b32 v57, 4, v56
v_bfe_u32 v58, v56, 2, 2
v_and_b32 v59, 3, v56
s_lshl_b32 s38, s39, 12
v_lshlrev_b32 v29, 4, v56
v_add_u32 v30, 18432, v29
v_lshrrev_b32 v252, 3, v56
v_and_b32 v253, 7, v56
v_lshlrev_b32 v254, 1, v57
v_xor_b32 v253, v253, v254
v_xor_b32 v254, 1, v253
v_lshlrev_b32 v253, 4, v253
v_lshlrev_b32 v254, 4, v254
v_lshl_add_u32 v1, v252, 13, v253
v_add_u32 v1, 0, v1
v_lshl_add_u32 v2, v252, 13, v254
v_add_u32 v2, 64512, v2
v_lshl_add_u32 v3, v252, 13, v253
v_add_u32 v3, 129024, v3
v_lshl_add_u32 v4, v252, 13, v254
v_add_u32 v4, 193536, v4
s_waitcnt lgkmcnt(0)
s_add_u32 s60, s52, 9584640
s_addc_u32 s61, s53, 0
s_mov_b32 s62, 1024
s_mov_b32 s63, 0x00020000
s_getreg_b32 s64, hwreg(HW_REG_XCC_ID, 0, 3)
s_lshl_b32 s65, s64, 7
s_lshr_b32 s66, s2, 3
s_lshl_b32 s67, 1, s66
v_mov_b32 v130, s67
v_mov_b32 v131, 0
s_andn2_b32 s2, s2, 7
s_or_b32 s2, s2, s64
s_mov_b32 s3, 0
s_cmp_lg_u32 s39, 0
s_cbranch_scc1 ka_kernel_cl2
s_mov_b64 exec, 1
buffer_atomic_or v130, v131, s[60:63], s65 offen sc0 sc1
s_mov_b64 exec, -1
ka_kernel_cl2:
s_mov_b32 s8, s48
s_mov_b32 s9, s49
s_mov_b32 s10, 4718592
s_mov_b32 s11, 0x00020000
s_add_u32 s24, s52, 65536
s_addc_u32 s25, s53, 0
s_mov_b32 s26, 2359296
s_mov_b32 s27, 0x00020000
s_mov_b32 s12, s44
s_mov_b32 s13, s45
s_mov_b32 s14, 8388608
s_mov_b32 s15, 0x00020000
s_mov_b32 s16, s46
s_mov_b32 s17, s47
s_mov_b32 s18, 8388608
s_mov_b32 s19, 0x00020000
s_mov_b32 s20, s50
s_mov_b32 s21, s51
s_mov_b32 s22, 4718592
s_mov_b32 s23, 0x00020000
s_add_u32 s28, s52, 16777216
s_addc_u32 s29, s53, 0
s_mov_b32 s30, 28311552
s_mov_b32 s31, 0x00020000
s_add_u32 s44, s52, 16384
s_addc_u32 s45, s53, 0
s_mov_b32 s46, 4608
s_mov_b32 s47, 0x00020000
s_lshl_b32 s42, s39, 10
s_add_u32 m0, s42, 131072
s_nop 0
buffer_load_dwordx4 v29, s[44:47], s42 offen lds
s_mov_b32 m0, 135168
s_movk_i32 s42, 4096
buffer_load_dwordx4 v29, s[44:47], s42 offen lds
s_and_b32 s40, s2, 3
s_lshl_b32 s40, s40, 2
s_bfe_u32 s41, s2, 0x20003
s_add_u32 s40, s40, s41
s_lshr_b32 s41, s2, 5
s_bitcmp1_b32 s2, 2
s_cselect_b32 vcc_lo, 8, 0
s_add_u32 s41, s41, vcc_lo
s_lshl_b32 s32, s40, 9
s_lshl_b32 s42, s39, 7
s_add_u32 s32, s32, s42
s_lshl_b32 s42, s40, 11
s_add_u32 s42, s42, 1536
s_and_b32 s43, s39, 1
s_lshl_b32 s43, s43, 5
s_add_u32 s42, s42, s43
s_lshl_b32 s42, s42, 8
s_lshr_b32 s43, s39, 1
s_lshl_b32 s43, s43, 7
s_add_u32 s33, s42, s43
s_mov_b32 s34, s33
s_lshl_b32 s42, s40, 8
s_lshl_b32 s43, s39, 5
s_add_u32 s42, s42, s43
s_mul_i32 s35, s42, 1152
s_lshl_b32 s43, s41, 3
s_lshl_b32 s42, s39, 1
s_add_u32 s43, s43, s42
s_mul_i32 s36, s43, 18432
s_lshr_b32 s42, s40, 2
s_mul_i32 s42, s42, 2359296
s_add_u32 s37, s36, s42
buffer_load_dwordx4 v[60:63], v29, s[24:27], s36 offen
buffer_load_dwordx4 v[64:67], v30, s[24:27], s36 offen
s_add_u32 s36, s36, 1024
s_add_u32 m0, s38, 0
s_nop 0
buffer_load_dwordx4 v1, s[8:11], s32 offen lds
buffer_load_dwordx4 v2, s[8:11], s32 offen offset:1024 lds
buffer_load_dwordx4 v3, s[8:11], s32 offen offset:2048 lds
buffer_load_dwordx4 v4, s[8:11], s32 offen offset:3072 lds
s_add_u32 s32, s32, 262144
buffer_load_dwordx4 v[68:71], v29, s[24:27], s36 offen
buffer_load_dwordx4 v[72:75], v30, s[24:27], s36 offen
s_add_u32 s36, s36, 1024
s_add_u32 m0, s38, 16384
s_nop 0
buffer_load_dwordx4 v1, s[8:11], s32 offen lds
buffer_load_dwordx4 v2, s[8:11], s32 offen offset:1024 lds
buffer_load_dwordx4 v3, s[8:11], s32 offen offset:2048 lds
buffer_load_dwordx4 v4, s[8:11], s32 offen offset:3072 lds
s_add_u32 s32, s32, 262144
buffer_load_dwordx4 v[76:79], v29, s[24:27], s36 offen
buffer_load_dwordx4 v[80:83], v30, s[24:27], s36 offen
s_add_u32 s36, s36, 1024
s_add_u32 m0, s38, 32768
s_nop 0
buffer_load_dwordx4 v1, s[8:11], s32 offen lds
buffer_load_dwordx4 v2, s[8:11], s32 offen offset:1024 lds
buffer_load_dwordx4 v3, s[8:11], s32 offen offset:2048 lds
buffer_load_dwordx4 v4, s[8:11], s32 offen offset:3072 lds
s_add_u32 s32, s32, 262144
buffer_load_dwordx4 v[84:87], v29, s[24:27], s36 offen
buffer_load_dwordx4 v[88:91], v30, s[24:27], s36 offen
s_add_u32 s36, s36, 1024
v_lshlrev_b32 v48, 6, v57
v_add_u32 v48, 131072, v48
v_lshl_add_u32 v5, v252, 8, v253
v_add_u32 v5, 0, v5
v_mul_u32_u24 v9, 1152, v252
v_add_u32 v9, v9, v253
v_add_u32 v9, 0, v9
v_lshl_add_u32 v6, v252, 8, v254
v_add_u32 v6, 1024, v6
v_mul_u32_u24 v10, 1152, v252
v_add_u32 v10, v10, v254
v_add_u32 v10, 8192, v10
v_lshl_add_u32 v7, v252, 8, v253
v_add_u32 v7, 2048, v7
v_mul_u32_u24 v11, 1152, v252
v_add_u32 v11, v11, v253
v_add_u32 v11, 16384, v11
v_lshl_add_u32 v8, v252, 8, v254
v_add_u32 v8, 3072, v8
v_mul_u32_u24 v12, 1152, v252
v_add_u32 v12, v12, v254
v_add_u32 v12, 24576, v12
v_lshl_add_u32 v252, v57, 2, v58
v_bfe_u32 v253, v252, 1, 2
v_lshlrev_b32 v253, 1, v253
v_lshrrev_b32 v254, 1, v57
v_or_b32 v253, v253, v254
v_lshrrev_b32 v254, 1, v59
v_xor_b32 v253, v253, v254
v_lshlrev_b32 v252, 7, v252
v_and_b32 v254, 1, v59
v_lshl_add_u32 v252, v254, 3, v252
v_xor_b32 v254, 0, v253
v_lshl_add_u32 v13, v254, 4, v252
v_xor_b32 v254, 2, v253
v_lshl_add_u32 v14, v254, 4, v252
v_xor_b32 v254, 4, v253
v_lshl_add_u32 v15, v254, 4, v252
v_xor_b32 v254, 6, v253
v_lshl_add_u32 v16, v254, 4, v252
v_and_b32 v252, 15, v56
v_and_b32 v253, 6, v252
v_lshrrev_b32 v254, 3, v252
v_or_b32 v253, v253, v254
v_lshrrev_b32 v254, 1, v57
v_xor_b32 v253, v253, v254
v_lshlrev_b32 v252, 7, v252
v_and_b32 v254, 1, v57
v_lshl_add_u32 v252, v254, 3, v252
v_xor_b32 v254, 0, v253
v_lshl_add_u32 v21, v254, 4, v252
v_add_u32 v25, 0x10000, v21
v_add_u32 v17, 0x10000, v13
v_xor_b32 v254, 2, v253
v_lshl_add_u32 v22, v254, 4, v252
v_add_u32 v26, 0x10000, v22
v_add_u32 v18, 0x10000, v14
v_xor_b32 v254, 4, v253
v_lshl_add_u32 v23, v254, 4, v252
v_add_u32 v27, 0x10000, v23
v_add_u32 v19, 0x10000, v15
v_xor_b32 v254, 6, v253
v_lshl_add_u32 v24, v254, 4, v252
v_add_u32 v28, 0x10000, v24
v_add_u32 v20, 0x10000, v16
s_mov_b32 s58, 0x42700000
s_nop 1
v_mov_b32 v131, 136192
s_waitcnt vmcnt(22)
s_cmp_lg_u32 s39, 0
s_cbranch_scc1 ka_kernel_cv7
s_mov_b32 s42, 0
ka_kernel_cv5:
v_readfirstlane_b32 s43, v130
s_nop 0
s_and_b32 s41, s43, s67
s_cbranch_scc0 ka_kernel_cv6
s_cmp_lg_u32 s43, -1
s_cbranch_scc1 ka_kernel_cv10
s_add_u32 s42, s42, 1
s_movk_i32 s66, 32
s_cmp_ge_u32 s42, 8
s_cbranch_scc1 ka_kernel_cv6
s_add_u32 s64, s64, 1
s_and_b32 s64, s64, 7
s_lshl_b32 s65, s64, 7
s_mov_b32 s43, 0
ka_kernel_cv10:
s_ff0_i32_b32 s66, s43
s_lshl_b32 s67, 1, s66
v_mov_b32 v130, s67
v_mov_b32 v131, 0
s_mov_b64 exec, 1
buffer_atomic_or v130, v131, s[60:63], s65 offen sc0 sc1
s_mov_b64 exec, -1
v_mov_b32 v131, 136192
s_waitcnt vmcnt(0)
s_branch ka_kernel_cv5
ka_kernel_cv6:
s_lshl_b32 s43, s66, 3
s_add_u32 s43, s43, s64
v_mov_b32 v130, s43
ds_write_b32 v131, v130
s_waitcnt lgkmcnt(0)
ka_kernel_cv7:
s_barrier
ds_read_b32 v130, v131
s_waitcnt lgkmcnt(0)
v_readfirstlane_b32 s43, v130
s_nop 0
s_cmp_eq_u32 s43, s2
s_cbranch_scc1 ka_kernel_cv9
s_mov_b32 s2, s43
s_waitcnt vmcnt(0)
s_cmp_ge_u32 s2, 256
s_cbranch_scc1 ka_kernel_done1
s_branch ka_kernel_again3
ka_kernel_cv9:
s_and_b32 s40, s2, 3
s_lshl_b32 s40, s40, 2
s_bfe_u32 s41, s2, 0x20003
s_add_u32 s40, s40, s41
s_lshr_b32 s41, s2, 5
s_bitcmp1_b32 s2, 2
s_cselect_b32 vcc_lo, 8, 0
s_add_u32 s41, s41, vcc_lo
ka_kernel_second4:
s_mov_b32 s58, 2359296
s_mov_b32 s59, 0x00020000
s_add_u32 s44, s52, 24576
s_addc_u32 s45, s53, 0
s_mov_b32 s46, 6912
s_lshl_b32 s42, s39, 11
s_add_u32 m0, s42, 136448
s_lshl_b32 s43, s41, 4
buffer_load_dwordx4 v29, s[44:47], s42 offen lds
buffer_load_dwordx4 v29, s[44:47], s42 offen offset:1024 lds
s_add_u32 s43, s43, s40
s_mul_i32 s43, s43, 9216
s_add_u32 m0, s42, 151808
s_add_u32 s42, s42, s43
buffer_load_dwordx4 v29, s[56:59], s42 offen lds
buffer_load_dwordx4 v29, s[56:59], s42 offen offset:1024 lds
s_mov_b32 m0, 160000
s_add_u32 s43, s43, 8192
buffer_load_dwordx4 v29, s[56:59], s43 offen lds
s_mov_b32 s58, 0x42700000
s_add_u32 s60, s52, 9437184
s_addc_u32 s61, s53, 0
s_mov_b32 s62, 0x10000
s_mov_b32 s63, 0x00020000
s_bfe_u32 s68, s2, 131075
s_mov_b32 s3, 0
s_andn2_b32 s64, s2, 24
s_add_u32 s65, s68, 1
s_and_b32 s65, s65, 3
s_lshl_b32 s65, s65, 3
s_or_b32 s65, s65, s64
s_add_u32 s66, s68, 3
s_and_b32 s66, s66, 3
s_lshl_b32 s66, s66, 3
s_or_b32 s66, s66, s64
s_lshl_b32 s67, s39, 6
s_lshl_b32 s64, s2, 8
s_add_u32 s64, s64, s67
s_lshl_b32 s65, s65, 8
s_add_u32 s65, s65, s67
s_lshl_b32 s66, s66, 8
s_add_u32 s66, s66, s67
s_mul_i32 s70, s68, 5
s_lshr_b32 s70, s70, 1
s_cmp_eq_u32 s68, 1
s_cselect_b32 s69, 3, 2
s_getreg_b32 s67, hwreg(HW_REG_XCC_ID, 0, 4)
s_add_u32 s67, s67, 1
v_mov_b32 v31, 0
v_mov_b32 v255, s67
s_lshl_b32 s68, s70, 11
s_add_u32 s72, s37, s68
s_add_u32 s68, s68, 2048
s_cmp_eq_u32 s68, 18432
s_cselect_b32 s68, 0, s68
s_add_u32 s73, s37, s68
s_add_u32 s68, s68, 2048
s_cmp_eq_u32 s68, 18432
s_cselect_b32 s68, 0, s68
s_add_u32 s74, s37, s68
s_add_u32 s68, s68, 2048
s_cmp_eq_u32 s68, 18432
s_cselect_b32 s68, 0, s68
s_add_u32 s75, s37, s68
s_add_u32 s68, s68, 2048
s_cmp_eq_u32 s68, 18432
s_cselect_b32 s68, 0, s68
s_add_u32 s76, s37, s68
s_add_u32 s68, s68, 2048
s_cmp_eq_u32 s68, 18432
s_cselect_b32 s68, 0, s68
s_add_u32 s77, s37, s68
s_add_u32 s68, s68, 2048
s_cmp_eq_u32 s68, 18432
s_cselect_b32 s68, 0, s68
s_add_u32 s78, s37, s68
s_add_u32 s68, s68, 2048
s_cmp_eq_u32 s68, 18432
s_cselect_b32 s68, 0, s68
s_add_u32 s79, s37, s68
s_add_u32 s68, s68, 2048
s_cmp_eq_u32 s68, 18432
s_cselect_b32 s68, 0, s68
s_add_u32 s80, s37, s68
s_cmp_eq_u32 s69, 3
s_cselect_b32 s71, 1073741824, s74
s_cselect_b32 s81, s74, 1073741824
s_lshl_b32 s70, s70, 7
s_add_u32 s82, s78, 18874368
s_bfe_u32 s83, s2, 131075
s_cmp_eq_u32 s83, 2
s_cselect_b32 s82, s82, 1073741824
buffer_store_dword v255, v31, s[60:63], s64 offen sc1
s_mov_b32 s44, s4
s_mov_b32 s45, s5
s_mov_b32 s46, 5308416
s_mov_b32 s47, 0x00020000
s_mov_b32 s48, s6
s_mov_b32 s49, s7
s_mov_b32 s50, 5308416
s_mov_b32 s51, 0x00020000
s_nop 1
s_waitcnt vmcnt(20)
s_barrier
TR a[144:145], v13, 0
TR a[146:147], v13, 2048
TR a[148:149], v14, 0
TR a[150:151], v14, 2048
TR a[152:153], v15, 0
TR a[154:155], v15, 2048
TR a[156:157], v16, 0
TR a[158:159], v16, 2048
TR a[160:161], v13, 4096
TR a[162:163], v13, 6144
TR a[164:165], v14, 4096
TR a[166:167], v14, 6144
TR a[168:169], v15, 4096
TR a[170:171], v15, 6144
ds_read_b128 v[32:35], v48 offset:0
ds_read_b128 v[36:39], v48 offset:16
ds_read_b128 v[40:43], v48 offset:32
ds_read_b128 v[44:47], v48 offset:48
s_waitcnt lgkmcnt(0)
v_fma_mix_f32 v56, v60, v32, v40 op_sel:[0,0,0] op_sel_hi:[1,0,0]
v_fma_mix_f32 v57, v60, v33, v41 op_sel:[1,0,0] op_sel_hi:[1,0,0]
v_cvt_pk_bf16_f32 v60, v56, v57
v_fma_mix_f32 v58, v61, v34, v42 op_sel:[0,0,0] op_sel_hi:[1,0,0]
v_fma_mix_f32 v59, v61, v35, v43 op_sel:[1,0,0] op_sel_hi:[1,0,0]
v_cvt_pk_bf16_f32 v61, v58, v59
v_fma_mix_f32 v56, v62, v36, v44 op_sel:[0,0,0] op_sel_hi:[1,0,0]
v_fma_mix_f32 v57, v62, v37, v45 op_sel:[1,0,0] op_sel_hi:[1,0,0]
v_cvt_pk_bf16_f32 v62, v56, v57
v_fma_mix_f32 v58, v63, v38, v46 op_sel:[0,0,0] op_sel_hi:[1,0,0]
v_fma_mix_f32 v59, v63, v39, v47 op_sel:[1,0,0] op_sel_hi:[1,0,0]
v_cvt_pk_bf16_f32 v63, v58, v59
v_fma_mix_f32 v56, v64, v32, v40 op_sel:[0,0,0] op_sel_hi:[1,0,0]
v_fma_mix_f32 v57, v64, v33, v41 op_sel:[1,0,0] op_sel_hi:[1,0,0]
v_cvt_pk_bf16_f32 v64, v56, v57
v_fma_mix_f32 v58, v65, v34, v42 op_sel:[0,0,0] op_sel_hi:[1,0,0]
v_fma_mix_f32 v59, v65, v35, v43 op_sel:[1,0,0] op_sel_hi:[1,0,0]
v_cvt_pk_bf16_f32 v65, v58, v59
v_fma_mix_f32 v56, v66, v36, v44 op_sel:[0,0,0] op_sel_hi:[1,0,0]
v_fma_mix_f32 v57, v66, v37, v45 op_sel:[1,0,0] op_sel_hi:[1,0,0]
v_cvt_pk_bf16_f32 v66, v56, v57
v_fma_mix_f32 v58, v67, v38, v46 op_sel:[0,0,0] op_sel_hi:[1,0,0]
v_fma_mix_f32 v59, v67, v39, v47 op_sel:[1,0,0] op_sel_hi:[1,0,0]
v_cvt_pk_bf16_f32 v67, v58, v59
MF v[124:127], a[144:147], v[60:63], 0
TR a[172:173], v16, 4096
s_add_u32 m0, s38, 49152
MF v[128:131], a[144:147], v[64:67], 0
TR a[174:175], v16, 6144
s_add_u32 s8, s8, s32
s_addc_u32 s9, s9, 0
global_load_lds_dwordx4 v1, s[8:9]
ds_read_b128 v[108:111], v48 offset:256
ds_read_b128 v[112:115], v48 offset:272
ds_read_b128 v[116:119], v48 offset:288
ds_read_b128 v[120:123], v48 offset:304
MF v[132:135], a[148:151], v[60:63], 0
TR a[144:145], v13, 8192
s_waitcnt lgkmcnt(1)
MF v[136:139], a[148:151], v[64:67], 0
TR a[146:147], v13, 10240
global_load_lds_dwordx4 v2, s[8:9] offset:1024
s_waitcnt vmcnt(20)
MF v[140:143], a[152:155], v[60:63], 0
TR a[148:149], v14, 8192
v_fma_mix_f32 v56, v68, v108, v116 op_sel:[0,0,0] op_sel_hi:[1,0,0]
MF v[144:147], a[152:155], v[64:67], 0
TR a[150:151], v14, 10240
global_load_lds_dwordx4 v3, s[8:9] offset:2048
v_fma_mix_f32 v57, v68, v109, v117 op_sel:[1,0,0] op_sel_hi:[1,0,0]
MF v[148:151], a[156:159], v[60:63], 0
TR a[152:153], v15, 8192
v_cvt_pk_bf16_f32 v68, v56, v57
MF v[152:155], a[156:159], v[64:67], 0
TR a[154:155], v15, 10240
global_load_lds_dwordx4 v4, s[8:9] offset:3072
v_fma_mix_f32 v58, v69, v110, v118 op_sel:[0,0,0] op_sel_hi:[1,0,0]
MF v[156:159], a[160:163], v[60:63], 0
TR a[156:157], v16, 8192
v_fma_mix_f32 v59, v69, v111, v119 op_sel:[1,0,0] op_sel_hi:[1,0,0]
MF v[160:163], a[160:163], v[64:67], 0
TR a[158:159], v16, 10240
s_add_u32 s8, s8, 262144
s_addc_u32 s9, s9, 0
buffer_load_dwordx4 v[92:95], v29, s[24:27], s36 offen
v_cvt_pk_bf16_f32 v69, v58, v59
MF v[164:167], a[164:167], v[60:63], 0
TR a[160:161], v13, 12288
v_fma_mix_f32 v56, v70, v112, v120 op_sel:[0,0,0] op_sel_hi:[1,0,0]
MF v[168:171], a[164:167], v[64:67], 0
TR a[162:163], v13, 14336
buffer_load_dwordx4 v[96:99], v30, s[24:27], s36 offen
v_fma_mix_f32 v57, v70, v113, v121 op_sel:[1,0,0] op_sel_hi:[1,0,0]
MF v[172:175], a[168:171], v[60:63], 0
TR a[164:165], v14, 12288
v_cvt_pk_bf16_f32 v70, v56, v57
MF v[176:179], a[168:171], v[64:67], 0
TR a[166:167], v14, 14336
s_add_u32 s36, s36, 1024
s_add_u32 m0, s38, 65536
s_nop 0
global_load_lds_dwordx4 v1, s[8:9]
v_fma_mix_f32 v58, v71, v114, v122 op_sel:[0,0,0] op_sel_hi:[1,0,0]
MF v[180:183], a[172:175], v[60:63], 0
TR a[168:169], v15, 12288
v_fma_mix_f32 v59, v71, v115, v123 op_sel:[1,0,0] op_sel_hi:[1,0,0]
MF v[184:187], a[172:175], v[64:67], 0
TR a[170:171], v15, 14336
s_waitcnt vmcnt(21)
global_load_lds_dwordx4 v2, s[8:9] offset:1024
s_waitcnt lgkmcnt(6)
MF v[188:191], a[144:147], v[60:63], 0
TR a[172:173], v16, 12288
s_barrier
v_cvt_pk_bf16_f32 v71, v58, v59
MF v[192:195], a[144:147], v[64:67], 0
TR a[174:175], v16, 14336
global_load_lds_dwordx4 v3, s[8:9] offset:2048
v_fma_mix_f32 v56, v72, v108, v116 op_sel:[0,0,0] op_sel_hi:[1,0,0]
MF v[196:199], a[148:151], v[60:63], 0
TR a[144:145], v13, 16384
v_fma_mix_f32 v57, v72, v109, v117 op_sel:[1,0,0] op_sel_hi:[1,0,0]
MF v[200:203], a[148:151], v[64:67], 0
TR a[146:147], v13, 18432
global_load_lds_dwordx4 v4, s[8:9] offset:3072
v_cvt_pk_bf16_f32 v72, v56, v57
MF v[204:207], a[152:155], v[60:63], 0
TR a[148:149], v14, 16384
v_fma_mix_f32 v58, v73, v110, v118 op_sel:[0,0,0] op_sel_hi:[1,0,0]
MF v[208:211], a[152:155], v[64:67], 0
TR a[150:151], v14, 18432
s_add_u32 s8, s8, 262144
s_addc_u32 s9, s9, 0
buffer_load_dwordx4 v[100:103], v29, s[24:27], s36 offen
v_fma_mix_f32 v59, v73, v111, v119 op_sel:[1,0,0] op_sel_hi:[1,0,0]
MF v[212:215], a[156:159], v[60:63], 0
TR a[152:153], v15, 16384
v_cvt_pk_bf16_f32 v73, v58, v59
ds_read_b128 v[32:35], v48 offset:512
MF v[216:219], a[156:159], v[64:67], 0
TR a[154:155], v15, 18432
buffer_load_dwordx4 v[104:107], v30, s[24:27], s36 offen
v_fma_mix_f32 v56, v74, v112, v120 op_sel:[0,0,0] op_sel_hi:[1,0,0]
s_waitcnt lgkmcnt(7)
MF v[220:223], a[160:163], v[60:63], 0
TR a[156:157], v16, 16384
v_fma_mix_f32 v57, v74, v113, v121 op_sel:[1,0,0] op_sel_hi:[1,0,0]
ds_read_b128 v[36:39], v48 offset:528
MF v[224:227], a[160:163], v[64:67], 0
TR a[158:159], v16, 18432
s_add_u32 s36, s36, 1024
s_add_u32 m0, s38, 81920
s_nop 0
global_load_lds_dwordx4 v1, s[8:9]
v_cvt_pk_bf16_f32 v74, v56, v57
MF v[228:231], a[164:167], v[60:63], 0
TR a[160:161], v13, 20480
v_fma_mix_f32 v58, v75, v114, v122 op_sel:[0,0,0] op_sel_hi:[1,0,0]
ds_read_b128 v[40:43], v48 offset:544
MF v[232:235], a[164:167], v[64:67], 0
TR a[162:163], v13, 22528
global_load_lds_dwordx4 v2, s[8:9] offset:1024
v_fma_mix_f32 v59, v75, v115, v123 op_sel:[1,0,0] op_sel_hi:[1,0,0]
MF v[236:239], a[168:171], v[60:63], 0
TR a[164:165], v14, 20480
ds_read_b128 v[44:47], v48 offset:560
s_and_b32 s42, s41, 7
MF v[240:243], a[168:171], v[64:67], 0
TR a[166:167], v14, 22528
global_load_lds_dwordx4 v3, s[8:9] offset:2048
v_cvt_pk_bf16_f32 v75, v58, v59
MF v[244:247], a[172:175], v[60:63], 0
TR a[168:169], v15, 20480
MF v[248:251], a[172:175], v[64:67], 0
TR a[170:171], v15, 22528
global_load_lds_dwordx4 v4, s[8:9] offset:3072
s_waitcnt lgkmcnt(8)
MF v[124:127], a[144:147], v[68:71], v[124:127]
TR a[172:173], v16, 20480
MF v[128:131], a[144:147], v[72:75], v[128:131]
TR a[174:175], v16, 22528
s_add_u32 s8, s8, 262144
s_addc_u32 s9, s9, 0
s_add_u32 m0, s38, 98304
s_nop 0
global_load_lds_dwordx4 v1, s[8:9]
MF v[132:135], a[148:151], v[68:71], v[132:135]
TR a[144:145], v13, 24576
s_waitcnt lgkmcnt(6)
MF v[136:139], a[148:151], v[72:75], v[136:139]
TR a[146:147], v13, 26624
global_load_lds_dwordx4 v2, s[8:9] offset:1024
s_waitcnt vmcnt(30)
MF v[140:143], a[152:155], v[68:71], v[140:143]
TR a[148:149], v14, 24576
v_fma_mix_f32 v56, v76, v32, v40 op_sel:[0,0,0] op_sel_hi:[1,0,0]
s_add_u32 s24, s24, s36
s_addc_u32 s25, s25, 0
global_load_dwordx4 v[60:63], v29, s[24:25]
global_load_dwordx4 v[64:67], v30, s[24:25]
s_add_u32 s24, s24, 1024
s_addc_u32 s25, s25, 0
MF v[144:147], a[152:155], v[72:75], v[144:147]
TR a[150:151], v14, 26624
global_load_lds_dwordx4 v3, s[8:9] offset:2048
v_fma_mix_f32 v57, v76, v33, v41 op_sel:[1,0,0] op_sel_hi:[1,0,0]
MF v[148:151], a[156:159], v[68:71], v[148:151]
TR a[152:153], v15, 24576
v_cvt_pk_bf16_f32 v76, v56, v57
MF v[152:155], a[156:159], v[72:75], v[152:155]
TR a[154:155], v15, 26624
global_load_lds_dwordx4 v4, s[8:9] offset:3072
v_fma_mix_f32 v58, v77, v34, v42 op_sel:[0,0,0] op_sel_hi:[1,0,0]
s_waitcnt lgkmcnt(6)
MF v[156:159], a[160:163], v[68:71], v[156:159]
TR a[156:157], v16, 24576
v_fma_mix_f32 v59, v77, v35, v43 op_sel:[1,0,0] op_sel_hi:[1,0,0]
MF v[160:163], a[160:163], v[72:75], v[160:163]
TR a[158:159], v16, 26624
s_add_u32 s8, s8, 262144
s_addc_u32 s9, s9, 0
v_cvt_pk_bf16_f32 v77, v58, v59
MF v[164:167], a[164:167], v[68:71], v[164:167]
TR a[160:161], v13, 28672
v_fma_mix_f32 v56, v78, v36, v44 op_sel:[0,0,0] op_sel_hi:[1,0,0]
MF v[168:171], a[164:167], v[72:75], v[168:171]
TR a[162:163], v13, 30720
v_fma_mix_f32 v57, v78, v37, v45 op_sel:[1,0,0] op_sel_hi:[1,0,0]
MF v[172:175], a[168:171], v[68:71], v[172:175]
TR a[164:165], v14, 28672
v_cvt_pk_bf16_f32 v78, v56, v57
MF v[176:179], a[168:171], v[72:75], v[176:179]
TR a[166:167], v14, 30720
s_add_u32 m0, s38, 114688
s_nop 0
global_load_lds_dwordx4 v1, s[8:9]
global_load_lds_dwordx4 v2, s[8:9] offset:1024
global_load_lds_dwordx4 v3, s[8:9] offset:2048
global_load_lds_dwordx4 v4, s[8:9] offset:3072
s_add_u32 s8, s8, 262144
s_addc_u32 s9, s9, 0
v_fma_mix_f32 v58, v79, v38, v46 op_sel:[0,0,0] op_sel_hi:[1,0,0]
MF v[180:183], a[172:175], v[68:71], v[180:183]
TR a[168:169], v15, 28672
v_fma_mix_f32 v59, v79, v39, v47 op_sel:[1,0,0] op_sel_hi:[1,0,0]
MF v[184:187], a[172:175], v[72:75], v[184:187]
TR a[170:171], v15, 30720
s_waitcnt vmcnt(34)
s_waitcnt lgkmcnt(6)
MF v[188:191], a[144:147], v[68:71], v[188:191]
TR a[172:173], v16, 28672
s_barrier
v_cvt_pk_bf16_f32 v79, v58, v59
MF v[192:195], a[144:147], v[72:75], v[192:195]
TR a[174:175], v16, 30720
v_fma_mix_f32 v56, v80, v32, v40 op_sel:[0,0,0] op_sel_hi:[1,0,0]
MF v[196:199], a[148:151], v[68:71], v[196:199]
TR a[144:145], v13, 32768
v_fma_mix_f32 v57, v80, v33, v41 op_sel:[1,0,0] op_sel_hi:[1,0,0]
MF v[200:203], a[148:151], v[72:75], v[200:203]
TR a[146:147], v13, 34816
v_cvt_pk_bf16_f32 v80, v56, v57
MF v[204:207], a[152:155], v[68:71], v[204:207]
TR a[148:149], v14, 32768
v_fma_mix_f32 v58, v81, v34, v42 op_sel:[0,0,0] op_sel_hi:[1,0,0]
MF v[208:211], a[152:155], v[72:75], v[208:211]
TR a[150:151], v14, 34816
v_fma_mix_f32 v59, v81, v35, v43 op_sel:[1,0,0] op_sel_hi:[1,0,0]
MF v[212:215], a[156:159], v[68:71], v[212:215]
TR a[152:153], v15, 32768
v_cvt_pk_bf16_f32 v81, v58, v59
ds_read_b128 v[108:111], v48 offset:768
MF v[216:219], a[156:159], v[72:75], v[216:219]
TR a[154:155], v15, 34816
s_add_u32 m0, s38, 0
s_nop 0
global_load_lds_dwordx4 v1, s[8:9]
v_fma_mix_f32 v56, v82, v36, v44 op_sel:[0,0,0] op_sel_hi:[1,0,0]
s_waitcnt lgkmcnt(7)
MF v[220:223], a[160:163], v[68:71], v[220:223]
TR a[156:157], v16, 32768
v_fma_mix_f32 v57, v82, v37, v45 op_sel:[1,0,0] op_sel_hi:[1,0,0]
ds_read_b128 v[112:115], v48 offset:784
MF v[224:227], a[160:163], v[72:75], v[224:227]
TR a[158:159], v16, 34816
v_cvt_pk_bf16_f32 v82, v56, v57
MF v[228:231], a[164:167], v[68:71], v[228:231]
TR a[160:161], v13, 36864
v_fma_mix_f32 v58, v83, v38, v46 op_sel:[0,0,0] op_sel_hi:[1,0,0]
ds_read_b128 v[116:119], v48 offset:800
MF v[232:235], a[164:167], v[72:75], v[232:235]
TR a[162:163], v13, 38912
global_load_lds_dwordx4 v2, s[8:9] offset:1024
v_fma_mix_f32 v59, v83, v39, v47 op_sel:[1,0,0] op_sel_hi:[1,0,0]
MF v[236:239], a[168:171], v[68:71], v[236:239]
TR a[164:165], v14, 36864
ds_read_b128 v[120:123], v48 offset:816
MF v[240:243], a[168:171], v[72:75], v[240:243]
TR a[166:167], v14, 38912
v_cvt_pk_bf16_f32 v83, v58, v59
MF v[244:247], a[172:175], v[68:71], v[244:247]
TR a[168:169], v15, 36864
MF v[248:251], a[172:175], v[72:75], v[248:251]
TR a[170:171], v15, 38912
global_load_lds_dwordx4 v3, s[8:9] offset:2048
s_waitcnt lgkmcnt(8)
MF v[124:127], a[144:147], v[76:79], v[124:127]
TR a[172:173], v16, 36864
global_load_lds_dwordx4 v4, s[8:9] offset:3072
MF v[128:131], a[144:147], v[80:83], v[128:131]
TR a[174:175], v16, 38912
s_add_u32 s8, s8, 262144
s_addc_u32 s9, s9, 0
MF v[132:135], a[148:151], v[76:79], v[132:135]
TR a[144:145], v13, 40960
s_waitcnt lgkmcnt(6)
MF v[136:139], a[148:151], v[80:83], v[136:139]
TR a[146:147], v13, 43008
s_waitcnt vmcnt(36)
MF v[140:143], a[152:155], v[76:79], v[140:143]
TR a[148:149], v14, 40960
v_fma_mix_f32 v56, v84, v108, v116 op_sel:[0,0,0] op_sel_hi:[1,0,0]
global_load_dwordx4 v[68:71], v29, s[24:25]
global_load_dwordx4 v[72:75], v30, s[24:25]
s_add_u32 s24, s24, 1024
s_addc_u32 s25, s25, 0
MF v[144:147], a[152:155], v[80:83], v[144:147]
TR a[150:151], v14, 43008
v_fma_mix_f32 v57, v84, v109, v117 op_sel:[1,0,0] op_sel_hi:[1,0,0]
MF v[148:151], a[156:159], v[76:79], v[148:151]
TR a[152:153], v15, 40960
v_cvt_pk_bf16_f32 v84, v56, v57
MF v[152:155], a[156:159], v[80:83], v[152:155]
TR a[154:155], v15, 43008
v_fma_mix_f32 v58, v85, v110, v118 op_sel:[0,0,0] op_sel_hi:[1,0,0]
s_waitcnt lgkmcnt(6)
MF v[156:159], a[160:163], v[76:79], v[156:159]
TR a[156:157], v16, 40960
v_fma_mix_f32 v59, v85, v111, v119 op_sel:[1,0,0] op_sel_hi:[1,0,0]
MF v[160:163], a[160:163], v[80:83], v[160:163]
TR a[158:159], v16, 43008
v_cvt_pk_bf16_f32 v85, v58, v59
MF v[164:167], a[164:167], v[76:79], v[164:167]
TR a[160:161], v13, 45056
v_fma_mix_f32 v56, v86, v112, v120 op_sel:[0,0,0] op_sel_hi:[1,0,0]
MF v[168:171], a[164:167], v[80:83], v[168:171]
TR a[162:163], v13, 47104
v_fma_mix_f32 v57, v86, v113, v121 op_sel:[1,0,0] op_sel_hi:[1,0,0]
MF v[172:175], a[168:171], v[76:79], v[172:175]
TR a[164:165], v14, 45056
v_cvt_pk_bf16_f32 v86, v56, v57
MF v[176:179], a[168:171], v[80:83], v[176:179]
TR a[166:167], v14, 47104
v_fma_mix_f32 v58, v87, v114, v122 op_sel:[0,0,0] op_sel_hi:[1,0,0]
MF v[180:183], a[172:175], v[76:79], v[180:183]
TR a[168:169], v15, 45056
v_fma_mix_f32 v59, v87, v115, v123 op_sel:[1,0,0] op_sel_hi:[1,0,0]
MF v[184:187], a[172:175], v[80:83], v[184:187]
TR a[170:171], v15, 47104
s_waitcnt vmcnt(28)
s_waitcnt lgkmcnt(6)
MF v[188:191], a[144:147], v[76:79], v[188:191]
TR a[172:173], v16, 45056
s_barrier
v_cvt_pk_bf16_f32 v87, v58, v59
MF v[192:195], a[144:147], v[80:83], v[192:195]
TR a[174:175], v16, 47104
v_fma_mix_f32 v56, v88, v108, v116 op_sel:[0,0,0] op_sel_hi:[1,0,0]
MF v[196:199], a[148:151], v[76:79], v[196:199]
TR a[144:145], v13, 49152
v_fma_mix_f32 v57, v88, v109, v117 op_sel:[1,0,0] op_sel_hi:[1,0,0]
MF v[200:203], a[148:151], v[80:83], v[200:203]
TR a[146:147], v13, 51200
v_cvt_pk_bf16_f32 v88, v56, v57
MF v[204:207], a[152:155], v[76:79], v[204:207]
TR a[148:149], v14, 49152
v_fma_mix_f32 v58, v89, v110, v118 op_sel:[0,0,0] op_sel_hi:[1,0,0]
MF v[208:211], a[152:155], v[80:83], v[208:211]
TR a[150:151], v14, 51200
v_fma_mix_f32 v59, v89, v111, v119 op_sel:[1,0,0] op_sel_hi:[1,0,0]
MF v[212:215], a[156:159], v[76:79], v[212:215]
TR a[152:153], v15, 49152
v_cvt_pk_bf16_f32 v89, v58, v59
ds_read_b128 v[32:35], v48 offset:1024
MF v[216:219], a[156:159], v[80:83], v[216:219]
TR a[154:155], v15, 51200
s_add_u32 m0, s38, 16384
s_nop 0
global_load_lds_dwordx4 v1, s[8:9]
v_fma_mix_f32 v56, v90, v112, v120 op_sel:[0,0,0] op_sel_hi:[1,0,0]
s_waitcnt lgkmcnt(7)
MF v[220:223], a[160:163], v[76:79], v[220:223]
TR a[156:157], v16, 49152
v_fma_mix_f32 v57, v90, v113, v121 op_sel:[1,0,0] op_sel_hi:[1,0,0]
ds_read_b128 v[36:39], v48 offset:1040
MF v[224:227], a[160:163], v[80:83], v[224:227]
TR a[158:159], v16, 51200
v_cvt_pk_bf16_f32 v90, v56, v57
MF v[228:231], a[164:167], v[76:79], v[228:231]
TR a[160:161], v13, 53248
v_fma_mix_f32 v58, v91, v114, v122 op_sel:[0,0,0] op_sel_hi:[1,0,0]
ds_read_b128 v[40:43], v48 offset:1056
MF v[232:235], a[164:167], v[80:83], v[232:235]
TR a[162:163], v13, 55296
global_load_lds_dwordx4 v2, s[8:9] offset:1024
v_fma_mix_f32 v59, v91, v115, v123 op_sel:[1,0,0] op_sel_hi:[1,0,0]
MF v[236:239], a[168:171], v[76:79], v[236:239]
TR a[164:165], v14, 53248
ds_read_b128 v[44:47], v48 offset:1072
MF v[240:243], a[168:171], v[80:83], v[240:243]
TR a[166:167], v14, 55296
v_cvt_pk_bf16_f32 v91, v58, v59
MF v[244:247], a[172:175], v[76:79], v[244:247]
TR a[168:169], v15, 53248
MF v[248:251], a[172:175], v[80:83], v[248:251]
TR a[170:171], v15, 55296
global_load_lds_dwordx4 v3, s[8:9] offset:2048
s_waitcnt lgkmcnt(8)
MF v[124:127], a[144:147], v[84:87], v[124:127]
TR a[172:173], v16, 53248
global_load_lds_dwordx4 v4, s[8:9] offset:3072
MF v[128:131], a[144:147], v[88:91], v[128:131]
TR a[174:175], v16, 55296
s_add_u32 s8, s8, 262144
s_addc_u32 s9, s9, 0
MF v[132:135], a[148:151], v[84:87], v[132:135]
TR a[144:145], v13, 57344
s_waitcnt lgkmcnt(6)
MF v[136:139], a[148:151], v[88:91], v[136:139]
TR a[146:147], v13, 59392
s_waitcnt vmcnt(30)
MF v[140:143], a[152:155], v[84:87], v[140:143]
TR a[148:149], v14, 57344
v_fma_mix_f32 v56, v92, v32, v40 op_sel:[0,0,0] op_sel_hi:[1,0,0]
global_load_dwordx4 v[76:79], v29, s[24:25]
global_load_dwordx4 v[80:83], v30, s[24:25]
s_add_u32 s24, s24, 1024
s_addc_u32 s25, s25, 0
MF v[144:147], a[152:155], v[88:91], v[144:147]
TR a[150:151], v14, 59392
v_fma_mix_f32 v57, v92, v33, v41 op_sel:[1,0,0] op_sel_hi:[1,0,0]
MF v[148:151], a[156:159], v[84:87], v[148:151]
TR a[152:153], v15, 57344
v_cvt_pk_bf16_f32 v92, v56, v57
MF v[152:155], a[156:159], v[88:91], v[152:155]
TR a[154:155], v15, 59392
v_fma_mix_f32 v58, v93, v34, v42 op_sel:[0,0,0] op_sel_hi:[1,0,0]
s_waitcnt lgkmcnt(6)
MF v[156:159], a[160:163], v[84:87], v[156:159]
TR a[156:157], v16, 57344
v_fma_mix_f32 v59, v93, v35, v43 op_sel:[1,0,0] op_sel_hi:[1,0,0]
MF v[160:163], a[160:163], v[88:91], v[160:163]
TR a[158:159], v16, 59392
v_cvt_pk_bf16_f32 v93, v58, v59
MF v[164:167], a[164:167], v[84:87], v[164:167]
TR a[160:161], v13, 61440
v_fma_mix_f32 v56, v94, v36, v44 op_sel:[0,0,0] op_sel_hi:[1,0,0]
MF v[168:171], a[164:167], v[88:91], v[168:171]
TR a[162:163], v13, 63488
v_fma_mix_f32 v57, v94, v37, v45 op_sel:[1,0,0] op_sel_hi:[1,0,0]
MF v[172:175], a[168:171], v[84:87], v[172:175]
TR a[164:165], v14, 61440
v_cvt_pk_bf16_f32 v94, v56, v57
MF v[176:179], a[168:171], v[88:91], v[176:179]
TR a[166:167], v14, 63488
v_fma_mix_f32 v58, v95, v38, v46 op_sel:[0,0,0] op_sel_hi:[1,0,0]
MF v[180:183], a[172:175], v[84:87], v[180:183]
TR a[168:169], v15, 61440
v_fma_mix_f32 v59, v95, v39, v47 op_sel:[1,0,0] op_sel_hi:[1,0,0]
MF v[184:187], a[172:175], v[88:91], v[184:187]
TR a[170:171], v15, 63488
s_waitcnt vmcnt(28)
s_waitcnt lgkmcnt(6)
MF v[188:191], a[144:147], v[84:87], v[188:191]
TR a[172:173], v16, 61440
s_barrier
v_cvt_pk_bf16_f32 v95, v58, v59
MF v[192:195], a[144:147], v[88:91], v[192:195]
TR a[174:175], v16, 63488
v_fma_mix_f32 v56, v96, v32, v40 op_sel:[0,0,0] op_sel_hi:[1,0,0]
MF v[196:199], a[148:151], v[84:87], v[196:199]
TR a[144:145], v17, 0
v_fma_mix_f32 v57, v96, v33, v41 op_sel:[1,0,0] op_sel_hi:[1,0,0]
MF v[200:203], a[148:151], v[88:91], v[200:203]
TR a[146:147], v17, 2048
v_cvt_pk_bf16_f32 v96, v56, v57
MF v[204:207], a[152:155], v[84:87], v[204:207]
TR a[148:149], v18, 0
v_fma_mix_f32 v58, v97, v34, v42 op_sel:[0,0,0] op_sel_hi:[1,0,0]
MF v[208:211], a[152:155], v[88:91], v[208:211]
TR a[150:151], v18, 2048
v_fma_mix_f32 v59, v97, v35, v43 op_sel:[1,0,0] op_sel_hi:[1,0,0]
MF v[212:215], a[156:159], v[84:87], v[212:215]
TR a[152:153], v19, 0
v_cvt_pk_bf16_f32 v97, v58, v59
ds_read_b128 v[108:111], v48 offset:1280
MF v[216:219], a[156:159], v[88:91], v[216:219]
TR a[154:155], v19, 2048
s_add_u32 m0, s38, 32768
s_nop 0
global_load_lds_dwordx4 v1, s[8:9]
v_fma_mix_f32 v56, v98, v36, v44 op_sel:[0,0,0] op_sel_hi:[1,0,0]
s_waitcnt lgkmcnt(7)
MF v[220:223], a[160:163], v[84:87], v[220:223]
TR a[156:157], v20, 0
v_fma_mix_f32 v57, v98, v37, v45 op_sel:[1,0,0] op_sel_hi:[1,0,0]
ds_read_b128 v[112:115], v48 offset:1296
MF v[224:227], a[160:163], v[88:91], v[224:227]
TR a[158:159], v20, 2048
v_cvt_pk_bf16_f32 v98, v56, v57
MF v[228:231], a[164:167], v[84:87], v[228:231]
TR a[160:161], v17, 4096
v_fma_mix_f32 v58, v99, v38, v46 op_sel:[0,0,0] op_sel_hi:[1,0,0]
ds_read_b128 v[116:119], v48 offset:1312
MF v[232:235], a[164:167], v[88:91], v[232:235]
TR a[162:163], v17, 6144
global_load_lds_dwordx4 v2, s[8:9] offset:1024
v_fma_mix_f32 v59, v99, v39, v47 op_sel:[1,0,0] op_sel_hi:[1,0,0]
MF v[236:239], a[168:171], v[84:87], v[236:239]
TR a[164:165], v18, 4096
ds_read_b128 v[120:123], v48 offset:1328
MF v[240:243], a[168:171], v[88:91], v[240:243]
TR a[166:167], v18, 6144
v_cvt_pk_bf16_f32 v99, v58, v59
MF v[244:247], a[172:175], v[84:87], v[244:247]
TR a[168:169], v19, 4096
MF v[248:251], a[172:175], v[88:91], v[248:251]
TR a[170:171], v19, 6144
global_load_lds_dwordx4 v3, s[8:9] offset:2048
s_waitcnt lgkmcnt(8)
MF v[124:127], a[144:147], v[92:95], v[124:127]
TR a[172:173], v20, 4096
global_load_lds_dwordx4 v4, s[8:9] offset:3072
MF v[128:131], a[144:147], v[96:99], v[128:131]
TR a[174:175], v20, 6144
s_add_u32 s8, s8, 262144
s_addc_u32 s9, s9, 0
MF v[132:135], a[148:151], v[92:95], v[132:135]
TR a[144:145], v17, 8192
s_waitcnt lgkmcnt(6)
MF v[136:139], a[148:151], v[96:99], v[136:139]
TR a[146:147], v17, 10240
s_waitcnt vmcnt(30)
MF v[140:143], a[152:155], v[92:95], v[140:143]
TR a[148:149], v18, 8192
v_fma_mix_f32 v56, v100, v108, v116 op_sel:[0,0,0] op_sel_hi:[1,0,0]
global_load_dwordx4 v[84:87], v29, s[24:25]
global_load_dwordx4 v[88:91], v30, s[24:25]
s_add_u32 s24, s24, 1024
s_addc_u32 s25, s25, 0
MF v[144:147], a[152:155], v[96:99], v[144:147]
TR a[150:151], v18, 10240
v_fma_mix_f32 v57, v100, v109, v117 op_sel:[1,0,0] op_sel_hi:[1,0,0]
MF v[148:151], a[156:159], v[92:95], v[148:151]
TR a[152:153], v19, 8192
v_cvt_pk_bf16_f32 v100, v56, v57
MF v[152:155], a[156:159], v[96:99], v[152:155]
TR a[154:155], v19, 10240
v_fma_mix_f32 v58, v101, v110, v118 op_sel:[0,0,0] op_sel_hi:[1,0,0]
s_waitcnt lgkmcnt(6)
MF v[156:159], a[160:163], v[92:95], v[156:159]
TR a[156:157], v20, 8192
v_fma_mix_f32 v59, v101, v111, v119 op_sel:[1,0,0] op_sel_hi:[1,0,0]
MF v[160:163], a[160:163], v[96:99], v[160:163]
TR a[158:159], v20, 10240
v_cvt_pk_bf16_f32 v101, v58, v59
MF v[164:167], a[164:167], v[92:95], v[164:167]
TR a[160:161], v17, 12288
v_fma_mix_f32 v56, v102, v112, v120 op_sel:[0,0,0] op_sel_hi:[1,0,0]
MF v[168:171], a[164:167], v[96:99], v[168:171]
TR a[162:163], v17, 14336
v_fma_mix_f32 v57, v102, v113, v121 op_sel:[1,0,0] op_sel_hi:[1,0,0]
MF v[172:175], a[168:171], v[92:95], v[172:175]
TR a[164:165], v18, 12288
v_cvt_pk_bf16_f32 v102, v56, v57
MF v[176:179], a[168:171], v[96:99], v[176:179]
TR a[166:167], v18, 14336
v_fma_mix_f32 v58, v103, v114, v122 op_sel:[0,0,0] op_sel_hi:[1,0,0]
MF v[180:183], a[172:175], v[92:95], v[180:183]
TR a[168:169], v19, 12288
v_fma_mix_f32 v59, v103, v115, v123 op_sel:[1,0,0] op_sel_hi:[1,0,0]
MF v[184:187], a[172:175], v[96:99], v[184:187]
TR a[170:171], v19, 14336
s_waitcnt vmcnt(28)
s_waitcnt lgkmcnt(6)
MF v[188:191], a[144:147], v[92:95], v[188:191]
TR a[172:173], v20, 12288
s_barrier
v_cvt_pk_bf16_f32 v103, v58, v59
MF v[192:195], a[144:147], v[96:99], v[192:195]
TR a[174:175], v20, 14336
v_fma_mix_f32 v56, v104, v108, v116 op_sel:[0,0,0] op_sel_hi:[1,0,0]
MF v[196:199], a[148:151], v[92:95], v[196:199]
TR a[144:145], v17, 16384
v_fma_mix_f32 v57, v104, v109, v117 op_sel:[1,0,0] op_sel_hi:[1,0,0]
MF v[200:203], a[148:151], v[96:99], v[200:203]
TR a[146:147], v17, 18432
v_cvt_pk_bf16_f32 v104, v56, v57
MF v[204:207], a[152:155], v[92:95], v[204:207]
TR a[148:149], v18, 16384
v_fma_mix_f32 v58, v105, v110, v118 op_sel:[0,0,0] op_sel_hi:[1,0,0]
MF v[208:211], a[152:155], v[96:99], v[208:211]
TR a[150:151], v18, 18432
v_fma_mix_f32 v59, v105, v111, v119 op_sel:[1,0,0] op_sel_hi:[1,0,0]
MF v[212:215], a[156:159], v[92:95], v[212:215]
TR a[152:153], v19, 16384
v_cvt_pk_bf16_f32 v105, v58, v59
ds_read_b128 v[32:35], v48 offset:1536
MF v[216:219], a[156:159], v[96:99], v[216:219]
TR a[154:155], v19, 18432
s_add_u32 m0, s38, 49152
s_nop 0
global_load_lds_dwordx4 v1, s[8:9]
v_fma_mix_f32 v56, v106, v112, v120 op_sel:[0,0,0] op_sel_hi:[1,0,0]
s_waitcnt lgkmcnt(7)
MF v[220:223], a[160:163], v[92:95], v[220:223]
TR a[156:157], v20, 16384
v_fma_mix_f32 v57, v106, v113, v121 op_sel:[1,0,0] op_sel_hi:[1,0,0]
ds_read_b128 v[36:39], v48 offset:1552
MF v[224:227], a[160:163], v[96:99], v[224:227]
TR a[158:159], v20, 18432
v_cvt_pk_bf16_f32 v106, v56, v57
MF v[228:231], a[164:167], v[92:95], v[228:231]
TR a[160:161], v17, 20480
v_fma_mix_f32 v58, v107, v114, v122 op_sel:[0,0,0] op_sel_hi:[1,0,0]
ds_read_b128 v[40:43], v48 offset:1568
MF v[232:235], a[164:167], v[96:99], v[232:235]
TR a[162:163], v17, 22528
global_load_lds_dwordx4 v2, s[8:9] offset:1024
v_fma_mix_f32 v59, v107, v115, v123 op_sel:[1,0,0] op_sel_hi:[1,0,0]
MF v[236:239], a[168:171], v[92:95], v[236:239]
TR a[164:165], v18, 20480
ds_read_b128 v[44:47], v48 offset:1584
MF v[240:243], a[168:171], v[96:99], v[240:243]
TR a[166:167], v18, 22528
v_cvt_pk_bf16_f32 v107, v58, v59
MF v[244:247], a[172:175], v[92:95], v[244:247]
TR a[168:169], v19, 20480
MF v[248:251], a[172:175], v[96:99], v[248:251]
TR a[170:171], v19, 22528
global_load_lds_dwordx4 v3, s[8:9] offset:2048
s_waitcnt lgkmcnt(8)
MF v[124:127], a[144:147], v[100:103], v[124:127]
TR a[172:173], v20, 20480
global_load_lds_dwordx4 v4, s[8:9] offset:3072
MF v[128:131], a[144:147], v[104:107], v[128:131]
TR a[174:175], v20, 22528
s_add_u32 s8, s8, 262144
s_addc_u32 s9, s9, 0
MF v[132:135], a[148:151], v[100:103], v[132:135]
TR a[144:145], v17, 24576
s_waitcnt lgkmcnt(6)
MF v[136:139], a[148:151], v[104:107], v[136:139]
TR a[146:147], v17, 26624
s_waitcnt vmcnt(28)
MF v[140:143], a[152:155], v[100:103], v[140:143]
TR a[148:149], v18, 24576
v_fma_mix_f32 v56, v60, v32, v40 op_sel:[0,0,0] op_sel_hi:[1,0,0]
global_load_dwordx4 v[92:95], v29, s[24:25]
global_load_dwordx4 v[96:99], v30, s[24:25]
s_add_u32 s24, s24, 1024
s_addc_u32 s25, s25, 0
MF v[144:147], a[152:155], v[104:107], v[144:147]
TR a[150:151], v18, 26624
v_fma_mix_f32 v57, v60, v33, v41 op_sel:[1,0,0] op_sel_hi:[1,0,0]
MF v[148:151], a[156:159], v[100:103], v[148:151]
TR a[152:153], v19, 24576
v_cvt_pk_bf16_f32 v60, v56, v57
MF v[152:155], a[156:159], v[104:107], v[152:155]
TR a[154:155], v19, 26624
v_fma_mix_f32 v58, v61, v34, v42 op_sel:[0,0,0] op_sel_hi:[1,0,0]
s_waitcnt lgkmcnt(6)
MF v[156:159], a[160:163], v[100:103], v[156:159]
TR a[156:157], v20, 24576
v_fma_mix_f32 v59, v61, v35, v43 op_sel:[1,0,0] op_sel_hi:[1,0,0]
MF v[160:163], a[160:163], v[104:107], v[160:163]
TR a[158:159], v20, 26624
v_cvt_pk_bf16_f32 v61, v58, v59
MF v[164:167], a[164:167], v[100:103], v[164:167]
TR a[160:161], v17, 28672
v_fma_mix_f32 v56, v62, v36, v44 op_sel:[0,0,0] op_sel_hi:[1,0,0]
MF v[168:171], a[164:167], v[104:107], v[168:171]
TR a[162:163], v17, 30720
v_fma_mix_f32 v57, v62, v37, v45 op_sel:[1,0,0] op_sel_hi:[1,0,0]
MF v[172:175], a[168:171], v[100:103], v[172:175]
TR a[164:165], v18, 28672
v_cvt_pk_bf16_f32 v62, v56, v57
MF v[176:179], a[168:171], v[104:107], v[176:179]
TR a[166:167], v18, 30720
v_fma_mix_f32 v58, v63, v38, v46 op_sel:[0,0,0] op_sel_hi:[1,0,0]
MF v[180:183], a[172:175], v[100:103], v[180:183]
TR a[168:169], v19, 28672
v_fma_mix_f32 v59, v63, v39, v47 op_sel:[1,0,0] op_sel_hi:[1,0,0]
MF v[184:187], a[172:175], v[104:107], v[184:187]
TR a[170:171], v19, 30720
s_waitcnt vmcnt(28)
s_waitcnt lgkmcnt(6)
MF v[188:191], a[144:147], v[100:103], v[188:191]
TR a[172:173], v20, 28672
s_barrier
v_cvt_pk_bf16_f32 v63, v58, v59
MF v[192:195], a[144:147], v[104:107], v[192:195]
TR a[174:175], v20, 30720
v_fma_mix_f32 v56, v64, v32, v40 op_sel:[0,0,0] op_sel_hi:[1,0,0]
MF v[196:199], a[148:151], v[100:103], v[196:199]
TR a[144:145], v17, 32768
v_fma_mix_f32 v57, v64, v33, v41 op_sel:[1,0,0] op_sel_hi:[1,0,0]
MF v[200:203], a[148:151], v[104:107], v[200:203]
TR a[146:147], v17, 34816
v_cvt_pk_bf16_f32 v64, v56, v57
MF v[204:207], a[152:155], v[100:103], v[204:207]
TR a[148:149], v18, 32768
v_fma_mix_f32 v58, v65, v34, v42 op_sel:[0,0,0] op_sel_hi:[1,0,0]
MF v[208:211], a[152:155], v[104:107], v[208:211]
TR a[150:151], v18, 34816
v_fma_mix_f32 v59, v65, v35, v43 op_sel:[1,0,0] op_sel_hi:[1,0,0]
MF v[212:215], a[156:159], v[100:103], v[212:215]
TR a[152:153], v19, 32768
v_cvt_pk_bf16_f32 v65, v58, v59
ds_read_b128 v[108:111], v48 offset:1792
MF v[216:219], a[156:159], v[104:107], v[216:219]
TR a[154:155], v19, 34816
s_add_u32 m0, s38, 65536
s_nop 0
global_load_lds_dwordx4 v1, s[8:9]
v_fma_mix_f32 v56, v66, v36, v44 op_sel:[0,0,0] op_sel_hi:[1,0,0]
s_waitcnt lgkmcnt(7)
MF v[220:223], a[160:163], v[100:103], v[220:223]
TR a[156:157], v20, 32768
v_fma_mix_f32 v57, v66, v37, v45 op_sel:[1,0,0] op_sel_hi:[1,0,0]
ds_read_b128 v[112:115], v48 offset:1808
MF v[224:227], a[160:163], v[104:107], v[224:227]
TR a[158:159], v20, 34816
v_cvt_pk_bf16_f32 v66, v56, v57
MF v[228:231], a[164:167], v[100:103], v[228:231]
TR a[160:161], v17, 36864
v_fma_mix_f32 v58, v67, v38, v46 op_sel:[0,0,0] op_sel_hi:[1,0,0]
ds_read_b128 v[116:119], v48 offset:1824
MF v[232:235], a[164:167], v[104:107], v[232:235]
TR a[162:163], v17, 38912
global_load_lds_dwordx4 v2, s[8:9] offset:1024
v_fma_mix_f32 v59, v67, v39, v47 op_sel:[1,0,0] op_sel_hi:[1,0,0]
MF v[236:239], a[168:171], v[100:103], v[236:239]
TR a[164:165], v18, 36864
ds_read_b128 v[120:123], v48 offset:1840
MF v[240:243], a[168:171], v[104:107], v[240:243]
TR a[166:167], v18, 38912
v_cvt_pk_bf16_f32 v67, v58, v59
MF v[244:247], a[172:175], v[100:103], v[244:247]
TR a[168:169], v19, 36864
MF v[248:251], a[172:175], v[104:107], v[248:251]
TR a[170:171], v19, 38912
global_load_lds_dwordx4 v3, s[8:9] offset:2048
s_waitcnt lgkmcnt(8)
MF v[124:127], a[144:147], v[60:63], v[124:127]
TR a[172:173], v20, 36864
global_load_lds_dwordx4 v4, s[8:9] offset:3072
MF v[128:131], a[144:147], v[64:67], v[128:131]
TR a[174:175], v20, 38912
s_add_u32 s8, s8, 262144
s_addc_u32 s9, s9, 0
MF v[132:135], a[148:151], v[60:63], v[132:135]
TR a[144:145], v17, 40960
s_waitcnt lgkmcnt(6)
MF v[136:139], a[148:151], v[64:67], v[136:139]
TR a[146:147], v17, 43008
s_waitcnt vmcnt(22)
MF v[140:143], a[152:155], v[60:63], v[140:143]
TR a[148:149], v18, 40960
v_fma_mix_f32 v56, v68, v108, v116 op_sel:[0,0,0] op_sel_hi:[1,0,0]
global_load_dwordx4 v[100:103], v29, s[24:25]
global_load_dwordx4 v[104:107], v30, s[24:25]
s_add_u32 s24, s24, 1024
s_addc_u32 s25, s25, 0
MF v[144:147], a[152:155], v[64:67], v[144:147]
TR a[150:151], v18, 43008
v_fma_mix_f32 v57, v68, v109, v117 op_sel:[1,0,0] op_sel_hi:[1,0,0]
MF v[148:151], a[156:159], v[60:63], v[148:151]
TR a[152:153], v19, 40960
v_cvt_pk_bf16_f32 v68, v56, v57
MF v[152:155], a[156:159], v[64:67], v[152:155]
TR a[154:155], v19, 43008
v_fma_mix_f32 v58, v69, v110, v118 op_sel:[0,0,0] op_sel_hi:[1,0,0]
s_waitcnt lgkmcnt(6)
MF v[156:159], a[160:163], v[60:63], v[156:159]
TR a[156:157], v20, 40960
v_fma_mix_f32 v59, v69, v111, v119 op_sel:[1,0,0] op_sel_hi:[1,0,0]
MF v[160:163], a[160:163], v[64:67], v[160:163]
TR a[158:159], v20, 43008
v_cvt_pk_bf16_f32 v69, v58, v59
MF v[164:167], a[164:167], v[60:63], v[164:167]
TR a[160:161], v17, 45056
v_fma_mix_f32 v56, v70, v112, v120 op_sel:[0,0,0] op_sel_hi:[1,0,0]
MF v[168:171], a[164:167], v[64:67], v[168:171]
TR a[162:163], v17, 47104
v_fma_mix_f32 v57, v70, v113, v121 op_sel:[1,0,0] op_sel_hi:[1,0,0]
MF v[172:175], a[168:171], v[60:63], v[172:175]
TR a[164:165], v18, 45056
v_cvt_pk_bf16_f32 v70, v56, v57
MF v[176:179], a[168:171], v[64:67], v[176:179]
TR a[166:167], v18, 47104
v_fma_mix_f32 v58, v71, v114, v122 op_sel:[0,0,0] op_sel_hi:[1,0,0]
MF v[180:183], a[172:175], v[60:63], v[180:183]
TR a[168:169], v19, 45056
v_fma_mix_f32 v59, v71, v115, v123 op_sel:[1,0,0] op_sel_hi:[1,0,0]
MF v[184:187], a[172:175], v[64:67], v[184:187]
TR a[170:171], v19, 47104
s_waitcnt lgkmcnt(6)
MF v[188:191], a[144:147], v[60:63], v[188:191]
TR a[172:173], v20, 45056
s_barrier
v_cvt_pk_bf16_f32 v71, v58, v59
MF v[192:195], a[144:147], v[64:67], v[192:195]
TR a[174:175], v20, 47104
v_fma_mix_f32 v56, v72, v108, v116 op_sel:[0,0,0] op_sel_hi:[1,0,0]
MF v[196:199], a[148:151], v[60:63], v[196:199]
TR a[144:145], v17, 49152
v_fma_mix_f32 v57, v72, v109, v117 op_sel:[1,0,0] op_sel_hi:[1,0,0]
MF v[200:203], a[148:151], v[64:67], v[200:203]
TR a[146:147], v17, 51200
v_cvt_pk_bf16_f32 v72, v56, v57
MF v[204:207], a[152:155], v[60:63], v[204:207]
TR a[148:149], v18, 49152
v_fma_mix_f32 v58, v73, v110, v118 op_sel:[0,0,0] op_sel_hi:[1,0,0]
MF v[208:211], a[152:155], v[64:67], v[208:211]
TR a[150:151], v18, 51200
v_fma_mix_f32 v59, v73, v111, v119 op_sel:[1,0,0] op_sel_hi:[1,0,0]
MF v[212:215], a[156:159], v[60:63], v[212:215]
TR a[152:153], v19, 49152
v_cvt_pk_bf16_f32 v73, v58, v59
ds_read_b128 v[32:35], v48 offset:2048
MF v[216:219], a[156:159], v[64:67], v[216:219]
TR a[154:155], v19, 51200
s_add_u32 m0, s38, 81920
s_nop 0
global_load_lds_dwordx4 v1, s[8:9]
v_fma_mix_f32 v56, v74, v112, v120 op_sel:[0,0,0] op_sel_hi:[1,0,0]
s_waitcnt lgkmcnt(7)
MF v[220:223], a[160:163], v[60:63], v[220:223]
TR a[156:157], v20, 49152
v_fma_mix_f32 v57, v74, v113, v121 op_sel:[1,0,0] op_sel_hi:[1,0,0]
ds_read_b128 v[36:39], v48 offset:2064
MF v[224:227], a[160:163], v[64:67], v[224:227]
TR a[158:159], v20, 51200
v_cvt_pk_bf16_f32 v74, v56, v57
MF v[228:231], a[164:167], v[60:63], v[228:231]
TR a[160:161], v17, 53248
v_fma_mix_f32 v58, v75, v114, v122 op_sel:[0,0,0] op_sel_hi:[1,0,0]
ds_read_b128 v[40:43], v48 offset:2080
MF v[232:235], a[164:167], v[64:67], v[232:235]
TR a[162:163], v17, 55296
global_load_lds_dwordx4 v2, s[8:9] offset:1024
v_fma_mix_f32 v59, v75, v115, v123 op_sel:[1,0,0] op_sel_hi:[1,0,0]
MF v[236:239], a[168:171], v[60:63], v[236:239]
TR a[164:165], v18, 53248
ds_read_b128 v[44:47], v48 offset:2096
MF v[240:243], a[168:171], v[64:67], v[240:243]
TR a[166:167], v18, 55296
v_cvt_pk_bf16_f32 v75, v58, v59
MF v[244:247], a[172:175], v[60:63], v[244:247]
TR a[168:169], v19, 53248
MF v[248:251], a[172:175], v[64:67], v[248:251]
TR a[170:171], v19, 55296
global_load_lds_dwordx4 v3, s[8:9] offset:2048
s_waitcnt lgkmcnt(8)
MF v[124:127], a[144:147], v[68:71], v[124:127]
TR a[172:173], v20, 53248
global_load_lds_dwordx4 v4, s[8:9] offset:3072
MF v[128:131], a[144:147], v[72:75], v[128:131]
TR a[174:175], v20, 55296
s_add_u32 s8, s8, 262144
s_addc_u32 s9, s9, 0
MF v[132:135], a[148:151], v[68:71], v[132:135]
TR a[144:145], v17, 57344
s_waitcnt lgkmcnt(6)
MF v[136:139], a[148:151], v[72:75], v[136:139]
TR a[146:147], v17, 59392
s_waitcnt vmcnt(22)
MF v[140:143], a[152:155], v[68:71], v[140:143]
TR a[148:149], v18, 57344
v_fma_mix_f32 v56, v76, v32, v40 op_sel:[0,0,0] op_sel_hi:[1,0,0]
global_load_dwordx4 v[60:63], v29, s[24:25]
global_load_dwordx4 v[64:67], v30, s[24:25]
s_add_u32 s24, s24, 1024
s_addc_u32 s25, s25, 0
MF v[144:147], a[152:155], v[72:75], v[144:147]
TR a[150:151], v18, 59392
v_fma_mix_f32 v57, v76, v33, v41 op_sel:[1,0,0] op_sel_hi:[1,0,0]
MF v[148:151], a[156:159], v[68:71], v[148:151]
TR a[152:153], v19, 57344
v_cvt_pk_bf16_f32 v76, v56, v57
MF v[152:155], a[156:159], v[72:75], v[152:155]
TR a[154:155], v19, 59392
v_fma_mix_f32 v58, v77, v34, v42 op_sel:[0,0,0] op_sel_hi:[1,0,0]
s_waitcnt lgkmcnt(6)
MF v[156:159], a[160:163], v[68:71], v[156:159]
TR a[156:157], v20, 57344
v_fma_mix_f32 v59, v77, v35, v43 op_sel:[1,0,0] op_sel_hi:[1,0,0]
MF v[160:163], a[160:163], v[72:75], v[160:163]
TR a[158:159], v20, 59392
v_cvt_pk_bf16_f32 v77, v58, v59
MF v[164:167], a[164:167], v[68:71], v[164:167]
TR a[160:161], v17, 61440
v_fma_mix_f32 v56, v78, v36, v44 op_sel:[0,0,0] op_sel_hi:[1,0,0]
MF v[168:171], a[164:167], v[72:75], v[168:171]
TR a[162:163], v17, 63488
v_fma_mix_f32 v57, v78, v37, v45 op_sel:[1,0,0] op_sel_hi:[1,0,0]
MF v[172:175], a[168:171], v[68:71], v[172:175]
TR a[164:165], v18, 61440
v_cvt_pk_bf16_f32 v78, v56, v57
MF v[176:179], a[168:171], v[72:75], v[176:179]
TR a[166:167], v18, 63488
v_fma_mix_f32 v58, v79, v38, v46 op_sel:[0,0,0] op_sel_hi:[1,0,0]
MF v[180:183], a[172:175], v[68:71], v[180:183]
TR a[168:169], v19, 61440
v_fma_mix_f32 v59, v79, v39, v47 op_sel:[1,0,0] op_sel_hi:[1,0,0]
MF v[184:187], a[172:175], v[72:75], v[184:187]
TR a[170:171], v19, 63488
s_waitcnt lgkmcnt(6)
MF v[188:191], a[144:147], v[68:71], v[188:191]
TR a[172:173], v20, 61440
s_barrier
v_cvt_pk_bf16_f32 v79, v58, v59
MF v[192:195], a[144:147], v[72:75], v[192:195]
TR a[174:175], v20, 63488
v_fma_mix_f32 v56, v80, v32, v40 op_sel:[0,0,0] op_sel_hi:[1,0,0]
MF v[196:199], a[148:151], v[68:71], v[196:199]
TR a[144:145], v13, 0
v_fma_mix_f32 v57, v80, v33, v41 op_sel:[1,0,0] op_sel_hi:[1,0,0]
MF v[200:203], a[148:151], v[72:75], v[200:203]
TR a[146:147], v13, 2048
v_cvt_pk_bf16_f32 v80, v56, v57
MF v[204:207], a[152:155], v[68:71], v[204:207]
TR a[148:149], v14, 0
v_fma_mix_f32 v58, v81, v34, v42 op_sel:[0,0,0] op_sel_hi:[1,0,0]
MF v[208:211], a[152:155], v[72:75], v[208:211]
TR a[150:151], v14, 2048
v_fma_mix_f32 v59, v81, v35, v43 op_sel:[1,0,0] op_sel_hi:[1,0,0]
MF v[212:215], a[156:159], v[68:71], v[212:215]
TR a[152:153], v15, 0
v_cvt_pk_bf16_f32 v81, v58, v59
ds_read_b128 v[108:111], v48 offset:2304
MF v[216:219], a[156:159], v[72:75], v[216:219]
TR a[154:155], v15, 2048
s_add_u32 m0, s38, 98304
s_nop 0
global_load_lds_dwordx4 v1, s[8:9]
v_fma_mix_f32 v56, v82, v36, v44 op_sel:[0,0,0] op_sel_hi:[1,0,0]
s_waitcnt lgkmcnt(7)
MF v[220:223], a[160:163], v[68:71], v[220:223]
TR a[156:157], v16, 0
v_fma_mix_f32 v57, v82, v37, v45 op_sel:[1,0,0] op_sel_hi:[1,0,0]
ds_read_b128 v[112:115], v48 offset:2320
MF v[224:227], a[160:163], v[72:75], v[224:227]
TR a[158:159], v16, 2048
v_cvt_pk_bf16_f32 v82, v56, v57
MF v[228:231], a[164:167], v[68:71], v[228:231]
TR a[160:161], v13, 4096
v_fma_mix_f32 v58, v83, v38, v46 op_sel:[0,0,0] op_sel_hi:[1,0,0]
ds_read_b128 v[116:119], v48 offset:2336
MF v[232:235], a[164:167], v[72:75], v[232:235]
TR a[162:163], v13, 6144
global_load_lds_dwordx4 v2, s[8:9] offset:1024
v_fma_mix_f32 v59, v83, v39, v47 op_sel:[1,0,0] op_sel_hi:[1,0,0]
MF v[236:239], a[168:171], v[68:71], v[236:239]
TR a[164:165], v14, 4096
ds_read_b128 v[120:123], v48 offset:2352
MF v[240:243], a[168:171], v[72:75], v[240:243]
TR a[166:167], v14, 6144
v_cvt_pk_bf16_f32 v83, v58, v59
MF v[244:247], a[172:175], v[68:71], v[244:247]
TR a[168:169], v15, 4096
MF v[248:251], a[172:175], v[72:75], v[248:251]
TR a[170:171], v15, 6144
global_load_lds_dwordx4 v3, s[8:9] offset:2048
s_waitcnt lgkmcnt(8)
MF v[124:127], a[144:147], v[76:79], v[124:127]
TR a[172:173], v16, 4096
global_load_lds_dwordx4 v4, s[8:9] offset:3072
MF v[128:131], a[144:147], v[80:83], v[128:131]
TR a[174:175], v16, 6144
s_add_u32 s8, s8, 262144
s_addc_u32 s9, s9, 0
MF v[132:135], a[148:151], v[76:79], v[132:135]
TR a[144:145], v13, 8192
s_waitcnt lgkmcnt(6)
MF v[136:139], a[148:151], v[80:83], v[136:139]
TR a[146:147], v13, 10240
s_waitcnt vmcnt(22)
MF v[140:143], a[152:155], v[76:79], v[140:143]
TR a[148:149], v14, 8192
v_fma_mix_f32 v56, v84, v108, v116 op_sel:[0,0,0] op_sel_hi:[1,0,0]
global_load_dwordx4 v[68:71], v29, s[24:25]
global_load_dwordx4 v[72:75], v30, s[24:25]
s_add_u32 s24, s24, 1024
s_addc_u32 s25, s25, 0
MF v[144:147], a[152:155], v[80:83], v[144:147]
TR a[150:151], v14, 10240
v_fma_mix_f32 v57, v84, v109, v117 op_sel:[1,0,0] op_sel_hi:[1,0,0]
MF v[148:151], a[156:159], v[76:79], v[148:151]
TR a[152:153], v15, 8192
v_cvt_pk_bf16_f32 v84, v56, v57
MF v[152:155], a[156:159], v[80:83], v[152:155]
TR a[154:155], v15, 10240
v_fma_mix_f32 v58, v85, v110, v118 op_sel:[0,0,0] op_sel_hi:[1,0,0]
s_waitcnt lgkmcnt(6)
MF v[156:159], a[160:163], v[76:79], v[156:159]
TR a[156:157], v16, 8192
v_fma_mix_f32 v59, v85, v111, v119 op_sel:[1,0,0] op_sel_hi:[1,0,0]
MF v[160:163], a[160:163], v[80:83], v[160:163]
TR a[158:159], v16, 10240
v_cvt_pk_bf16_f32 v85, v58, v59
MF v[164:167], a[164:167], v[76:79], v[164:167]
TR a[160:161], v13, 12288
v_fma_mix_f32 v56, v86, v112, v120 op_sel:[0,0,0] op_sel_hi:[1,0,0]
MF v[168:171], a[164:167], v[80:83], v[168:171]
TR a[162:163], v13, 14336
v_fma_mix_f32 v57, v86, v113, v121 op_sel:[1,0,0] op_sel_hi:[1,0,0]
MF v[172:175], a[168:171], v[76:79], v[172:175]
TR a[164:165], v14, 12288
v_cvt_pk_bf16_f32 v86, v56, v57
MF v[176:179], a[168:171], v[80:83], v[176:179]
TR a[166:167], v14, 14336
v_fma_mix_f32 v58, v87, v114, v122 op_sel:[0,0,0] op_sel_hi:[1,0,0]
MF v[180:183], a[172:175], v[76:79], v[180:183]
TR a[168:169], v15, 12288
v_fma_mix_f32 v59, v87, v115, v123 op_sel:[1,0,0] op_sel_hi:[1,0,0]
MF v[184:187], a[172:175], v[80:83], v[184:187]
TR a[170:171], v15, 14336
s_waitcnt lgkmcnt(6)
MF v[188:191], a[144:147], v[76:79], v[188:191]
TR a[172:173], v16, 12288
s_barrier
v_cvt_pk_bf16_f32 v87, v58, v59
MF v[192:195], a[144:147], v[80:83], v[192:195]
TR a[174:175], v16, 14336
v_fma_mix_f32 v56, v88, v108, v116 op_sel:[0,0,0] op_sel_hi:[1,0,0]
MF v[196:199], a[148:151], v[76:79], v[196:199]
TR a[144:145], v13, 16384
v_fma_mix_f32 v57, v88, v109, v117 op_sel:[1,0,0] op_sel_hi:[1,0,0]
MF v[200:203], a[148:151], v[80:83], v[200:203]
TR a[146:147], v13, 18432
v_cvt_pk_bf16_f32 v88, v56, v57
MF v[204:207], a[152:155], v[76:79], v[204:207]
TR a[148:149], v14, 16384
v_fma_mix_f32 v58, v89, v110, v118 op_sel:[0,0,0] op_sel_hi:[1,0,0]
MF v[208:211], a[152:155], v[80:83], v[208:211]
TR a[150:151], v14, 18432
v_fma_mix_f32 v59, v89, v111, v119 op_sel:[1,0,0] op_sel_hi:[1,0,0]
MF v[212:215], a[156:159], v[76:79], v[212:215]
TR a[152:153], v15, 16384
v_cvt_pk_bf16_f32 v89, v58, v59
ds_read_b128 v[32:35], v48 offset:2560
MF v[216:219], a[156:159], v[80:83], v[216:219]
TR a[154:155], v15, 18432
s_add_u32 m0, s38, 114688
s_nop 0
global_load_lds_dwordx4 v1, s[8:9]
v_fma_mix_f32 v56, v90, v112, v120 op_sel:[0,0,0] op_sel_hi:[1,0,0]
s_waitcnt lgkmcnt(7)
MF v[220:223], a[160:163], v[76:79], v[220:223]
TR a[156:157], v16, 16384
v_fma_mix_f32 v57, v90, v113, v121 op_sel:[1,0,0] op_sel_hi:[1,0,0]
ds_read_b128 v[36:39], v48 offset:2576
MF v[224:227], a[160:163], v[80:83], v[224:227]
TR a[158:159], v16, 18432
v_cvt_pk_bf16_f32 v90, v56, v57
MF v[228:231], a[164:167], v[76:79], v[228:231]
TR a[160:161], v13, 20480
v_fma_mix_f32 v58, v91, v114, v122 op_sel:[0,0,0] op_sel_hi:[1,0,0]
ds_read_b128 v[40:43], v48 offset:2592
MF v[232:235], a[164:167], v[80:83], v[232:235]
TR a[162:163], v13, 22528
global_load_lds_dwordx4 v2, s[8:9] offset:1024
v_fma_mix_f32 v59, v91, v115, v123 op_sel:[1,0,0] op_sel_hi:[1,0,0]
MF v[236:239], a[168:171], v[76:79], v[236:239]
TR a[164:165], v14, 20480
ds_read_b128 v[44:47], v48 offset:2608
MF v[240:243], a[168:171], v[80:83], v[240:243]
TR a[166:167], v14, 22528
v_cvt_pk_bf16_f32 v91, v58, v59
MF v[244:247], a[172:175], v[76:79], v[244:247]
TR a[168:169], v15, 20480
MF v[248:251], a[172:175], v[80:83], v[248:251]
TR a[170:171], v15, 22528
global_load_lds_dwordx4 v3, s[8:9] offset:2048
s_waitcnt lgkmcnt(8)
MF v[124:127], a[144:147], v[84:87], v[124:127]
TR a[172:173], v16, 20480
global_load_lds_dwordx4 v4, s[8:9] offset:3072
MF v[128:131], a[144:147], v[88:91], v[128:131]
TR a[174:175], v16, 22528
s_add_u32 s8, s8, 262144
s_addc_u32 s9, s9, 0
MF v[132:135], a[148:151], v[84:87], v[132:135]
TR a[144:145], v13, 24576
s_waitcnt lgkmcnt(6)
MF v[136:139], a[148:151], v[88:91], v[136:139]
TR a[146:147], v13, 26624
s_waitcnt vmcnt(22)
MF v[140:143], a[152:155], v[84:87], v[140:143]
TR a[148:149], v14, 24576
v_fma_mix_f32 v56, v92, v32, v40 op_sel:[0,0,0] op_sel_hi:[1,0,0]
global_load_dwordx4 v[76:79], v29, s[24:25]
global_load_dwordx4 v[80:83], v30, s[24:25]
s_add_u32 s24, s24, 1024
s_addc_u32 s25, s25, 0
MF v[144:147], a[152:155], v[88:91], v[144:147]
TR a[150:151], v14, 26624
v_fma_mix_f32 v57, v92, v33, v41 op_sel:[1,0,0] op_sel_hi:[1,0,0]
MF v[148:151], a[156:159], v[84:87], v[148:151]
TR a[152:153], v15, 24576
v_cvt_pk_bf16_f32 v92, v56, v57
MF v[152:155], a[156:159], v[88:91], v[152:155]
TR a[154:155], v15, 26624
v_fma_mix_f32 v58, v93, v34, v42 op_sel:[0,0,0] op_sel_hi:[1,0,0]
s_waitcnt lgkmcnt(6)
MF v[156:159], a[160:163], v[84:87], v[156:159]
TR a[156:157], v16, 24576
v_fma_mix_f32 v59, v93, v35, v43 op_sel:[1,0,0] op_sel_hi:[1,0,0]
MF v[160:163], a[160:163], v[88:91], v[160:163]
TR a[158:159], v16, 26624
v_cvt_pk_bf16_f32 v93, v58, v59
MF v[164:167], a[164:167], v[84:87], v[164:167]
TR a[160:161], v13, 28672
v_fma_mix_f32 v56, v94, v36, v44 op_sel:[0,0,0] op_sel_hi:[1,0,0]
MF v[168:171], a[164:167], v[88:91], v[168:171]
TR a[162:163], v13, 30720
v_fma_mix_f32 v57, v94, v37, v45 op_sel:[1,0,0] op_sel_hi:[1,0,0]
MF v[172:175], a[168:171], v[84:87], v[172:175]
TR a[164:165], v14, 28672
v_cvt_pk_bf16_f32 v94, v56, v57
MF v[176:179], a[168:171], v[88:91], v[176:179]
TR a[166:167], v14, 30720
v_fma_mix_f32 v58, v95, v38, v46 op_sel:[0,0,0] op_sel_hi:[1,0,0]
MF v[180:183], a[172:175], v[84:87], v[180:183]
TR a[168:169], v15, 28672
v_fma_mix_f32 v59, v95, v39, v47 op_sel:[1,0,0] op_sel_hi:[1,0,0]
MF v[184:187], a[172:175], v[88:91], v[184:187]
TR a[170:171], v15, 30720
s_waitcnt lgkmcnt(6)
MF v[188:191], a[144:147], v[84:87], v[188:191]
TR a[172:173], v16, 28672
s_barrier
v_cvt_pk_bf16_f32 v95, v58, v59
MF v[192:195], a[144:147], v[88:91], v[192:195]
TR a[174:175], v16, 30720
v_fma_mix_f32 v56, v96, v32, v40 op_sel:[0,0,0] op_sel_hi:[1,0,0]
MF v[196:199], a[148:151], v[84:87], v[196:199]
TR a[144:145], v13, 32768
v_fma_mix_f32 v57, v96, v33, v41 op_sel:[1,0,0] op_sel_hi:[1,0,0]
MF v[200:203], a[148:151], v[88:91], v[200:203]
TR a[146:147], v13, 34816
v_cvt_pk_bf16_f32 v96, v56, v57
MF v[204:207], a[152:155], v[84:87], v[204:207]
TR a[148:149], v14, 32768
v_fma_mix_f32 v58, v97, v34, v42 op_sel:[0,0,0] op_sel_hi:[1,0,0]
MF v[208:211], a[152:155], v[88:91], v[208:211]
TR a[150:151], v14, 34816
v_fma_mix_f32 v59, v97, v35, v43 op_sel:[1,0,0] op_sel_hi:[1,0,0]
MF v[212:215], a[156:159], v[84:87], v[212:215]
TR a[152:153], v15, 32768
v_cvt_pk_bf16_f32 v97, v58, v59
ds_read_b128 v[108:111], v48 offset:2816
MF v[216:219], a[156:159], v[88:91], v[216:219]
TR a[154:155], v15, 34816
s_add_u32 m0, s38, 0
s_nop 0
global_load_lds_dwordx4 v1, s[8:9]
v_fma_mix_f32 v56, v98, v36, v44 op_sel:[0,0,0] op_sel_hi:[1,0,0]
s_waitcnt lgkmcnt(7)
MF v[220:223], a[160:163], v[84:87], v[220:223]
TR a[156:157], v16, 32768
v_fma_mix_f32 v57, v98, v37, v45 op_sel:[1,0,0] op_sel_hi:[1,0,0]
ds_read_b128 v[112:115], v48 offset:2832
MF v[224:227], a[160:163], v[88:91], v[224:227]
TR a[158:159], v16, 34816
v_cvt_pk_bf16_f32 v98, v56, v57
MF v[228:231], a[164:167], v[84:87], v[228:231]
TR a[160:161], v13, 36864
v_fma_mix_f32 v58, v99, v38, v46 op_sel:[0,0,0] op_sel_hi:[1,0,0]
ds_read_b128 v[116:119], v48 offset:2848
MF v[232:235], a[164:167], v[88:91], v[232:235]
TR a[162:163], v13, 38912
global_load_lds_dwordx4 v2, s[8:9] offset:1024
v_fma_mix_f32 v59, v99, v39, v47 op_sel:[1,0,0] op_sel_hi:[1,0,0]
MF v[236:239], a[168:171], v[84:87], v[236:239]
TR a[164:165], v14, 36864
ds_read_b128 v[120:123], v48 offset:2864
MF v[240:243], a[168:171], v[88:91], v[240:243]
TR a[166:167], v14, 38912
v_cvt_pk_bf16_f32 v99, v58, v59
MF v[244:247], a[172:175], v[84:87], v[244:247]
TR a[168:169], v15, 36864
MF v[248:251], a[172:175], v[88:91], v[248:251]
TR a[170:171], v15, 38912
global_load_lds_dwordx4 v3, s[8:9] offset:2048
s_waitcnt lgkmcnt(8)
MF v[124:127], a[144:147], v[92:95], v[124:127]
TR a[172:173], v16, 36864
global_load_lds_dwordx4 v4, s[8:9] offset:3072
MF v[128:131], a[144:147], v[96:99], v[128:131]
TR a[174:175], v16, 38912
s_add_u32 s8, s8, 262144
s_addc_u32 s9, s9, 0
MF v[132:135], a[148:151], v[92:95], v[132:135]
TR a[144:145], v13, 40960
s_waitcnt lgkmcnt(6)
MF v[136:139], a[148:151], v[96:99], v[136:139]
TR a[146:147], v13, 43008
s_waitcnt vmcnt(22)
MF v[140:143], a[152:155], v[92:95], v[140:143]
TR a[148:149], v14, 40960
v_fma_mix_f32 v56, v100, v108, v116 op_sel:[0,0,0] op_sel_hi:[1,0,0]
global_load_dwordx4 v[84:87], v29, s[24:25]
global_load_dwordx4 v[88:91], v30, s[24:25]
s_add_u32 s24, s24, 1024
s_addc_u32 s25, s25, 0
MF v[144:147], a[152:155], v[96:99], v[144:147]
TR a[150:151], v14, 43008
v_fma_mix_f32 v57, v100, v109, v117 op_sel:[1,0,0] op_sel_hi:[1,0,0]
MF v[148:151], a[156:159], v[92:95], v[148:151]
TR a[152:153], v15, 40960
v_cvt_pk_bf16_f32 v100, v56, v57
MF v[152:155], a[156:159], v[96:99], v[152:155]
TR a[154:155], v15, 43008
v_fma_mix_f32 v58, v101, v110, v118 op_sel:[0,0,0] op_sel_hi:[1,0,0]
s_waitcnt lgkmcnt(6)
MF v[156:159], a[160:163], v[92:95], v[156:159]
TR a[156:157], v16, 40960
v_fma_mix_f32 v59, v101, v111, v119 op_sel:[1,0,0] op_sel_hi:[1,0,0]
MF v[160:163], a[160:163], v[96:99], v[160:163]
TR a[158:159], v16, 43008
v_cvt_pk_bf16_f32 v101, v58, v59
MF v[164:167], a[164:167], v[92:95], v[164:167]
TR a[160:161], v13, 45056
v_fma_mix_f32 v56, v102, v112, v120 op_sel:[0,0,0] op_sel_hi:[1,0,0]
s_getpc_b64 s[4:5]
ka_kernel_pc27:
s_add_u32 s4, s4, ka_kernel-ka_kernel_pc27
s_addc_u32 s5, s5, (ka_kernel-ka_kernel_pc27)>>32
s_mov_b32 s6, ka_kernel_done1-ka_kernel
s_mov_b32 s7, 0x00020000
s_lshr_b32 s43, s2, 3
s_mul_i32 s43, s43, 2048
buffer_load_dwordx4 a[200:203], v29, s[4:7], s43 offen
buffer_load_dwordx4 a[200:203], v29, s[4:7], s43 offen offset:1024
MF v[168:171], a[164:167], v[96:99], v[168:171]
TR a[162:163], v13, 47104
v_fma_mix_f32 v57, v102, v113, v121 op_sel:[1,0,0] op_sel_hi:[1,0,0]
MF v[172:175], a[168:171], v[92:95], v[172:175]
TR a[164:165], v14, 45056
v_cvt_pk_bf16_f32 v102, v56, v57
MF v[176:179], a[168:171], v[96:99], v[176:179]
TR a[166:167], v14, 47104
v_fma_mix_f32 v58, v103, v114, v122 op_sel:[0,0,0] op_sel_hi:[1,0,0]
MF v[180:183], a[172:175], v[92:95], v[180:183]
TR a[168:169], v15, 45056
v_fma_mix_f32 v59, v103, v115, v123 op_sel:[1,0,0] op_sel_hi:[1,0,0]
MF v[184:187], a[172:175], v[96:99], v[184:187]
TR a[170:171], v15, 47104
s_waitcnt lgkmcnt(6)
MF v[188:191], a[144:147], v[92:95], v[188:191]
TR a[172:173], v16, 45056
s_barrier
v_cvt_pk_bf16_f32 v103, v58, v59
MF v[192:195], a[144:147], v[96:99], v[192:195]
TR a[174:175], v16, 47104
v_fma_mix_f32 v56, v104, v108, v116 op_sel:[0,0,0] op_sel_hi:[1,0,0]
MF v[196:199], a[148:151], v[92:95], v[196:199]
TR a[144:145], v13, 49152
v_fma_mix_f32 v57, v104, v109, v117 op_sel:[1,0,0] op_sel_hi:[1,0,0]
MF v[200:203], a[148:151], v[96:99], v[200:203]
TR a[146:147], v13, 51200
v_cvt_pk_bf16_f32 v104, v56, v57
MF v[204:207], a[152:155], v[92:95], v[204:207]
TR a[148:149], v14, 49152
v_fma_mix_f32 v58, v105, v110, v118 op_sel:[0,0,0] op_sel_hi:[1,0,0]
MF v[208:211], a[152:155], v[96:99], v[208:211]
TR a[150:151], v14, 51200
v_fma_mix_f32 v59, v105, v111, v119 op_sel:[1,0,0] op_sel_hi:[1,0,0]
MF v[212:215], a[156:159], v[92:95], v[212:215]
TR a[152:153], v15, 49152
v_cvt_pk_bf16_f32 v105, v58, v59
ds_read_b128 v[32:35], v48 offset:3072
MF v[216:219], a[156:159], v[96:99], v[216:219]
TR a[154:155], v15, 51200
s_add_u32 m0, s38, 16384
s_nop 0
global_load_lds_dwordx4 v1, s[8:9]
v_fma_mix_f32 v56, v106, v112, v120 op_sel:[0,0,0] op_sel_hi:[1,0,0]
s_waitcnt lgkmcnt(7)
MF v[220:223], a[160:163], v[92:95], v[220:223]
TR a[156:157], v16, 49152
v_fma_mix_f32 v57, v106, v113, v121 op_sel:[1,0,0] op_sel_hi:[1,0,0]
ds_read_b128 v[36:39], v48 offset:3088
MF v[224:227], a[160:163], v[96:99], v[224:227]
TR a[158:159], v16, 51200
v_cvt_pk_bf16_f32 v106, v56, v57
MF v[228:231], a[164:167], v[92:95], v[228:231]
TR a[160:161], v13, 53248
v_fma_mix_f32 v58, v107, v114, v122 op_sel:[0,0,0] op_sel_hi:[1,0,0]
ds_read_b128 v[40:43], v48 offset:3104
MF v[232:235], a[164:167], v[96:99], v[232:235]
TR a[162:163], v13, 55296
global_load_lds_dwordx4 v2, s[8:9] offset:1024
v_fma_mix_f32 v59, v107, v115, v123 op_sel:[1,0,0] op_sel_hi:[1,0,0]
MF v[236:239], a[168:171], v[92:95], v[236:239]
TR a[164:165], v14, 53248
ds_read_b128 v[44:47], v48 offset:3120
MF v[240:243], a[168:171], v[96:99], v[240:243]
TR a[166:167], v14, 55296
v_cvt_pk_bf16_f32 v107, v58, v59
MF v[244:247], a[172:175], v[92:95], v[244:247]
TR a[168:169], v15, 53248
MF v[248:251], a[172:175], v[96:99], v[248:251]
TR a[170:171], v15, 55296
global_load_lds_dwordx4 v3, s[8:9] offset:2048
s_waitcnt lgkmcnt(8)
MF v[124:127], a[144:147], v[100:103], v[124:127]
TR a[172:173], v16, 53248
global_load_lds_dwordx4 v4, s[8:9] offset:3072
MF v[128:131], a[144:147], v[104:107], v[128:131]
TR a[174:175], v16, 55296
s_add_u32 s8, s8, 262144
s_addc_u32 s9, s9, 0
MF v[132:135], a[148:151], v[100:103], v[132:135]
TR a[144:145], v13, 57344
s_waitcnt lgkmcnt(6)
MF v[136:139], a[148:151], v[104:107], v[136:139]
TR a[146:147], v13, 59392
s_waitcnt vmcnt(24)
MF v[140:143], a[152:155], v[100:103], v[140:143]
TR a[148:149], v14, 57344
v_fma_mix_f32 v56, v60, v32, v40 op_sel:[0,0,0] op_sel_hi:[1,0,0]
global_load_dwordx4 v[92:95], v29, s[24:25]
global_load_dwordx4 v[96:99], v30, s[24:25]
s_add_u32 s24, s24, 1024
s_addc_u32 s25, s25, 0
MF v[144:147], a[152:155], v[104:107], v[144:147]
TR a[150:151], v14, 59392
v_fma_mix_f32 v57, v60, v33, v41 op_sel:[1,0,0] op_sel_hi:[1,0,0]
MF v[148:151], a[156:159], v[100:103], v[148:151]
TR a[152:153], v15, 57344
v_cvt_pk_bf16_f32 v60, v56, v57
MF v[152:155], a[156:159], v[104:107], v[152:155]
TR a[154:155], v15, 59392
v_fma_mix_f32 v58, v61, v34, v42 op_sel:[0,0,0] op_sel_hi:[1,0,0]
s_waitcnt lgkmcnt(6)
MF v[156:159], a[160:163], v[100:103], v[156:159]
TR a[156:157], v16, 57344
v_fma_mix_f32 v59, v61, v35, v43 op_sel:[1,0,0] op_sel_hi:[1,0,0]
MF v[160:163], a[160:163], v[104:107], v[160:163]
TR a[158:159], v16, 59392
v_cvt_pk_bf16_f32 v61, v58, v59
MF v[164:167], a[164:167], v[100:103], v[164:167]
TR a[160:161], v13, 61440
v_fma_mix_f32 v56, v62, v36, v44 op_sel:[0,0,0] op_sel_hi:[1,0,0]
MF v[168:171], a[164:167], v[104:107], v[168:171]
TR a[162:163], v13, 63488
v_fma_mix_f32 v57, v62, v37, v45 op_sel:[1,0,0] op_sel_hi:[1,0,0]
MF v[172:175], a[168:171], v[100:103], v[172:175]
TR a[164:165], v14, 61440
v_cvt_pk_bf16_f32 v62, v56, v57
MF v[176:179], a[168:171], v[104:107], v[176:179]
TR a[166:167], v14, 63488
v_fma_mix_f32 v58, v63, v38, v46 op_sel:[0,0,0] op_sel_hi:[1,0,0]
MF v[180:183], a[172:175], v[100:103], v[180:183]
TR a[168:169], v15, 61440
v_fma_mix_f32 v59, v63, v39, v47 op_sel:[1,0,0] op_sel_hi:[1,0,0]
MF v[184:187], a[172:175], v[104:107], v[184:187]
TR a[170:171], v15, 63488
s_waitcnt lgkmcnt(6)
MF v[188:191], a[144:147], v[100:103], v[188:191]
TR a[172:173], v16, 61440
s_barrier
v_cvt_pk_bf16_f32 v63, v58, v59
MF v[192:195], a[144:147], v[104:107], v[192:195]
TR a[174:175], v16, 63488
v_fma_mix_f32 v56, v64, v32, v40 op_sel:[0,0,0] op_sel_hi:[1,0,0]
MF v[196:199], a[148:151], v[100:103], v[196:199]
TR a[144:145], v17, 0
v_fma_mix_f32 v57, v64, v33, v41 op_sel:[1,0,0] op_sel_hi:[1,0,0]
MF v[200:203], a[148:151], v[104:107], v[200:203]
TR a[146:147], v17, 2048
v_cvt_pk_bf16_f32 v64, v56, v57
MF v[204:207], a[152:155], v[100:103], v[204:207]
TR a[148:149], v18, 0
v_fma_mix_f32 v58, v65, v34, v42 op_sel:[0,0,0] op_sel_hi:[1,0,0]
MF v[208:211], a[152:155], v[104:107], v[208:211]
TR a[150:151], v18, 2048
v_fma_mix_f32 v59, v65, v35, v43 op_sel:[1,0,0] op_sel_hi:[1,0,0]
MF v[212:215], a[156:159], v[100:103], v[212:215]
TR a[152:153], v19, 0
v_cvt_pk_bf16_f32 v65, v58, v59
ds_read_b128 v[108:111], v48 offset:3328
MF v[216:219], a[156:159], v[104:107], v[216:219]
TR a[154:155], v19, 2048
s_add_u32 m0, s38, 32768
s_add_u32 s12, s12, s33
s_addc_u32 s13, s13, 0
global_load_lds_dwordx4 v5, s[12:13]
v_fma_mix_f32 v56, v66, v36, v44 op_sel:[0,0,0] op_sel_hi:[1,0,0]
s_waitcnt lgkmcnt(7)
MF v[220:223], a[160:163], v[100:103], v[220:223]
TR a[156:157], v20, 0
v_fma_mix_f32 v57, v66, v37, v45 op_sel:[1,0,0] op_sel_hi:[1,0,0]
ds_read_b128 v[112:115], v48 offset:3344
MF v[224:227], a[160:163], v[104:107], v[224:227]
TR a[158:159], v20, 2048
v_cvt_pk_bf16_f32 v66, v56, v57
MF v[228:231], a[164:167], v[100:103], v[228:231]
TR a[160:161], v17, 4096
v_fma_mix_f32 v58, v67, v38, v46 op_sel:[0,0,0] op_sel_hi:[1,0,0]
ds_read_b128 v[116:119], v48 offset:3360
MF v[232:235], a[164:167], v[104:107], v[232:235]
TR a[162:163], v17, 6144
global_load_lds_dwordx4 v6, s[12:13] offset:1024
v_fma_mix_f32 v59, v67, v39, v47 op_sel:[1,0,0] op_sel_hi:[1,0,0]
MF v[236:239], a[168:171], v[100:103], v[236:239]
TR a[164:165], v18, 4096
ds_read_b128 v[120:123], v48 offset:3376
MF v[240:243], a[168:171], v[104:107], v[240:243]
TR a[166:167], v18, 6144
v_cvt_pk_bf16_f32 v67, v58, v59
MF v[244:247], a[172:175], v[100:103], v[244:247]
TR a[168:169], v19, 4096
MF v[248:251], a[172:175], v[104:107], v[248:251]
TR a[170:171], v19, 6144
global_load_lds_dwordx4 v7, s[12:13] offset:2048
s_waitcnt lgkmcnt(8)
MF v[124:127], a[144:147], v[60:63], v[124:127]
TR a[172:173], v20, 4096
global_load_lds_dwordx4 v8, s[12:13] offset:3072
MF v[128:131], a[144:147], v[64:67], v[128:131]
TR a[174:175], v20, 6144
s_add_u32 s12, s12, 16384
s_addc_u32 s13, s13, 0
MF v[132:135], a[148:151], v[60:63], v[132:135]
TR a[144:145], v17, 8192
s_waitcnt lgkmcnt(6)
MF v[136:139], a[148:151], v[64:67], v[136:139]
TR a[146:147], v17, 10240
s_waitcnt vmcnt(24)
MF v[140:143], a[152:155], v[60:63], v[140:143]
TR a[148:149], v18, 8192
v_fma_mix_f32 v56, v68, v108, v116 op_sel:[0,0,0] op_sel_hi:[1,0,0]
global_load_dwordx4 v[100:103], v29, s[24:25]
global_load_dwordx4 v[104:107], v30, s[24:25]
s_add_u32 s24, s24, 1024
s_addc_u32 s25, s25, 0
MF v[144:147], a[152:155], v[64:67], v[144:147]
TR a[150:151], v18, 10240
v_fma_mix_f32 v57, v68, v109, v117 op_sel:[1,0,0] op_sel_hi:[1,0,0]
MF v[148:151], a[156:159], v[60:63], v[148:151]
TR a[152:153], v19, 8192
v_cvt_pk_bf16_f32 v68, v56, v57
MF v[152:155], a[156:159], v[64:67], v[152:155]
TR a[154:155], v19, 10240
v_fma_mix_f32 v58, v69, v110, v118 op_sel:[0,0,0] op_sel_hi:[1,0,0]
s_waitcnt lgkmcnt(6)
MF v[156:159], a[160:163], v[60:63], v[156:159]
TR a[156:157], v20, 8192
v_fma_mix_f32 v59, v69, v111, v119 op_sel:[1,0,0] op_sel_hi:[1,0,0]
MF v[160:163], a[160:163], v[64:67], v[160:163]
TR a[158:159], v20, 10240
v_cvt_pk_bf16_f32 v69, v58, v59
MF v[164:167], a[164:167], v[60:63], v[164:167]
TR a[160:161], v17, 12288
v_fma_mix_f32 v56, v70, v112, v120 op_sel:[0,0,0] op_sel_hi:[1,0,0]
MF v[168:171], a[164:167], v[64:67], v[168:171]
TR a[162:163], v17, 14336
v_fma_mix_f32 v57, v70, v113, v121 op_sel:[1,0,0] op_sel_hi:[1,0,0]
MF v[172:175], a[168:171], v[60:63], v[172:175]
TR a[164:165], v18, 12288
v_cvt_pk_bf16_f32 v70, v56, v57
MF v[176:179], a[168:171], v[64:67], v[176:179]
TR a[166:167], v18, 14336
v_fma_mix_f32 v58, v71, v114, v122 op_sel:[0,0,0] op_sel_hi:[1,0,0]
MF v[180:183], a[172:175], v[60:63], v[180:183]
TR a[168:169], v19, 12288
v_fma_mix_f32 v59, v71, v115, v123 op_sel:[1,0,0] op_sel_hi:[1,0,0]
MF v[184:187], a[172:175], v[64:67], v[184:187]
TR a[170:171], v19, 14336
s_waitcnt lgkmcnt(6)
MF v[188:191], a[144:147], v[60:63], v[188:191]
TR a[172:173], v20, 12288
s_barrier
v_cvt_pk_bf16_f32 v71, v58, v59
MF v[192:195], a[144:147], v[64:67], v[192:195]
TR a[174:175], v20, 14336
v_fma_mix_f32 v56, v72, v108, v116 op_sel:[0,0,0] op_sel_hi:[1,0,0]
MF v[196:199], a[148:151], v[60:63], v[196:199]
TR a[144:145], v17, 16384
v_fma_mix_f32 v57, v72, v109, v117 op_sel:[1,0,0] op_sel_hi:[1,0,0]
MF v[200:203], a[148:151], v[64:67], v[200:203]
TR a[146:147], v17, 18432
v_cvt_pk_bf16_f32 v72, v56, v57
MF v[204:207], a[152:155], v[60:63], v[204:207]
TR a[148:149], v18, 16384
v_fma_mix_f32 v58, v73, v110, v118 op_sel:[0,0,0] op_sel_hi:[1,0,0]
MF v[208:211], a[152:155], v[64:67], v[208:211]
TR a[150:151], v18, 18432
v_fma_mix_f32 v59, v73, v111, v119 op_sel:[1,0,0] op_sel_hi:[1,0,0]
MF v[212:215], a[156:159], v[60:63], v[212:215]
TR a[152:153], v19, 16384
v_cvt_pk_bf16_f32 v73, v58, v59
ds_read_b128 v[32:35], v48 offset:3584
MF v[216:219], a[156:159], v[64:67], v[216:219]
TR a[154:155], v19, 18432
s_add_u32 m0, s38, 49152
s_nop 0
global_load_lds_dwordx4 v5, s[12:13]
v_fma_mix_f32 v56, v74, v112, v120 op_sel:[0,0,0] op_sel_hi:[1,0,0]
s_waitcnt lgkmcnt(7)
MF v[220:223], a[160:163], v[60:63], v[220:223]
TR a[156:157], v20, 16384
v_fma_mix_f32 v57, v74, v113, v121 op_sel:[1,0,0] op_sel_hi:[1,0,0]
ds_read_b128 v[36:39], v48 offset:3600
MF v[224:227], a[160:163], v[64:67], v[224:227]
TR a[158:159], v20, 18432
v_cvt_pk_bf16_f32 v74, v56, v57
MF v[228:231], a[164:167], v[60:63], v[228:231]
TR a[160:161], v17, 20480
v_fma_mix_f32 v58, v75, v114, v122 op_sel:[0,0,0] op_sel_hi:[1,0,0]
ds_read_b128 v[40:43], v48 offset:3616
MF v[232:235], a[164:167], v[64:67], v[232:235]
TR a[162:163], v17, 22528
global_load_lds_dwordx4 v6, s[12:13] offset:1024
v_fma_mix_f32 v59, v75, v115, v123 op_sel:[1,0,0] op_sel_hi:[1,0,0]
MF v[236:239], a[168:171], v[60:63], v[236:239]
TR a[164:165], v18, 20480
ds_read_b128 v[44:47], v48 offset:3632
MF v[240:243], a[168:171], v[64:67], v[240:243]
TR a[166:167], v18, 22528
v_cvt_pk_bf16_f32 v75, v58, v59
MF v[244:247], a[172:175], v[60:63], v[244:247]
TR a[168:169], v19, 20480
MF v[248:251], a[172:175], v[64:67], v[248:251]
TR a[170:171], v19, 22528
global_load_lds_dwordx4 v7, s[12:13] offset:2048
s_waitcnt lgkmcnt(8)
MF v[124:127], a[144:147], v[68:71], v[124:127]
TR a[172:173], v20, 20480
global_load_lds_dwordx4 v8, s[12:13] offset:3072
MF v[128:131], a[144:147], v[72:75], v[128:131]
TR a[174:175], v20, 22528
s_add_u32 s12, s12, 16384
s_addc_u32 s13, s13, 0
MF v[132:135], a[148:151], v[68:71], v[132:135]
TR a[144:145], v17, 24576
s_waitcnt lgkmcnt(6)
MF v[136:139], a[148:151], v[72:75], v[136:139]
TR a[146:147], v17, 26624
s_waitcnt vmcnt(24)
MF v[140:143], a[152:155], v[68:71], v[140:143]
TR a[148:149], v18, 24576
v_fma_mix_f32 v56, v76, v32, v40 op_sel:[0,0,0] op_sel_hi:[1,0,0]
MF v[144:147], a[152:155], v[72:75], v[144:147]
TR a[150:151], v18, 26624
v_fma_mix_f32 v57, v76, v33, v41 op_sel:[1,0,0] op_sel_hi:[1,0,0]
MF v[148:151], a[156:159], v[68:71], v[148:151]
TR a[152:153], v19, 24576
v_cvt_pk_bf16_f32 v76, v56, v57
MF v[152:155], a[156:159], v[72:75], v[152:155]
TR a[154:155], v19, 26624
v_fma_mix_f32 v58, v77, v34, v42 op_sel:[0,0,0] op_sel_hi:[1,0,0]
s_waitcnt lgkmcnt(6)
MF v[156:159], a[160:163], v[68:71], v[156:159]
TR a[156:157], v20, 24576
v_fma_mix_f32 v59, v77, v35, v43 op_sel:[1,0,0] op_sel_hi:[1,0,0]
MF v[160:163], a[160:163], v[72:75], v[160:163]
TR a[158:159], v20, 26624
v_cvt_pk_bf16_f32 v77, v58, v59
MF v[164:167], a[164:167], v[68:71], v[164:167]
TR a[160:161], v17, 28672
v_fma_mix_f32 v56, v78, v36, v44 op_sel:[0,0,0] op_sel_hi:[1,0,0]
MF v[168:171], a[164:167], v[72:75], v[168:171]
TR a[162:163], v17, 30720
v_fma_mix_f32 v57, v78, v37, v45 op_sel:[1,0,0] op_sel_hi:[1,0,0]
MF v[172:175], a[168:171], v[68:71], v[172:175]
TR a[164:165], v18, 28672
v_cvt_pk_bf16_f32 v78, v56, v57
MF v[176:179], a[168:171], v[72:75], v[176:179]
TR a[166:167], v18, 30720
v_fma_mix_f32 v58, v79, v38, v46 op_sel:[0,0,0] op_sel_hi:[1,0,0]
MF v[180:183], a[172:175], v[68:71], v[180:183]
TR a[168:169], v19, 28672
v_fma_mix_f32 v59, v79, v39, v47 op_sel:[1,0,0] op_sel_hi:[1,0,0]
MF v[184:187], a[172:175], v[72:75], v[184:187]
TR a[170:171], v19, 30720
s_waitcnt lgkmcnt(6)
MF v[188:191], a[144:147], v[68:71], v[188:191]
TR a[172:173], v20, 28672
s_barrier
v_cvt_pk_bf16_f32 v79, v58, v59
MF v[192:195], a[144:147], v[72:75], v[192:195]
TR a[174:175], v20, 30720
v_fma_mix_f32 v56, v80, v32, v40 op_sel:[0,0,0] op_sel_hi:[1,0,0]
MF v[196:199], a[148:151], v[68:71], v[196:199]
TR a[144:145], v17, 32768
v_fma_mix_f32 v57, v80, v33, v41 op_sel:[1,0,0] op_sel_hi:[1,0,0]
MF v[200:203], a[148:151], v[72:75], v[200:203]
TR a[146:147], v17, 34816
v_cvt_pk_bf16_f32 v80, v56, v57
MF v[204:207], a[152:155], v[68:71], v[204:207]
TR a[148:149], v18, 32768
v_fma_mix_f32 v58, v81, v34, v42 op_sel:[0,0,0] op_sel_hi:[1,0,0]
MF v[208:211], a[152:155], v[72:75], v[208:211]
TR a[150:151], v18, 34816
v_fma_mix_f32 v59, v81, v35, v43 op_sel:[1,0,0] op_sel_hi:[1,0,0]
MF v[212:215], a[156:159], v[68:71], v[212:215]
TR a[152:153], v19, 32768
v_cvt_pk_bf16_f32 v81, v58, v59
ds_read_b128 v[108:111], v48 offset:3840
MF v[216:219], a[156:159], v[72:75], v[216:219]
TR a[154:155], v19, 34816
s_add_u32 m0, s38, 65536
s_add_u32 s16, s16, s34
s_addc_u32 s17, s17, 0
global_load_lds_dwordx4 v5, s[16:17]
v_fma_mix_f32 v56, v82, v36, v44 op_sel:[0,0,0] op_sel_hi:[1,0,0]
s_waitcnt lgkmcnt(7)
MF v[220:223], a[160:163], v[68:71], v[220:223]
TR a[156:157], v20, 32768
v_fma_mix_f32 v57, v82, v37, v45 op_sel:[1,0,0] op_sel_hi:[1,0,0]
ds_read_b128 v[112:115], v48 offset:3856
MF v[224:227], a[160:163], v[72:75], v[224:227]
TR a[158:159], v20, 34816
v_cvt_pk_bf16_f32 v82, v56, v57
MF v[228:231], a[164:167], v[68:71], v[228:231]
TR a[160:161], v17, 36864
v_fma_mix_f32 v58, v83, v38, v46 op_sel:[0,0,0] op_sel_hi:[1,0,0]
ds_read_b128 v[116:119], v48 offset:3872
MF v[232:235], a[164:167], v[72:75], v[232:235]
TR a[162:163], v17, 38912
global_load_lds_dwordx4 v6, s[16:17] offset:1024
v_fma_mix_f32 v59, v83, v39, v47 op_sel:[1,0,0] op_sel_hi:[1,0,0]
MF v[236:239], a[168:171], v[68:71], v[236:239]
TR a[164:165], v18, 36864
ds_read_b128 v[120:123], v48 offset:3888
MF v[240:243], a[168:171], v[72:75], v[240:243]
TR a[166:167], v18, 38912
v_cvt_pk_bf16_f32 v83, v58, v59
MF v[244:247], a[172:175], v[68:71], v[244:247]
TR a[168:169], v19, 36864
MF v[248:251], a[172:175], v[72:75], v[248:251]
TR a[170:171], v19, 38912
global_load_lds_dwordx4 v7, s[16:17] offset:2048
s_waitcnt lgkmcnt(8)
MF v[124:127], a[144:147], v[76:79], v[124:127]
TR a[172:173], v20, 36864
global_load_lds_dwordx4 v8, s[16:17] offset:3072
MF v[128:131], a[144:147], v[80:83], v[128:131]
TR a[174:175], v20, 38912
s_add_u32 s16, s16, 16384
s_addc_u32 s17, s17, 0
MF v[132:135], a[148:151], v[76:79], v[132:135]
TR a[144:145], v17, 40960
s_waitcnt lgkmcnt(6)
MF v[136:139], a[148:151], v[80:83], v[136:139]
TR a[146:147], v17, 43008
s_waitcnt vmcnt(22)
MF v[140:143], a[152:155], v[76:79], v[140:143]
TR a[148:149], v18, 40960
v_fma_mix_f32 v56, v84, v108, v116 op_sel:[0,0,0] op_sel_hi:[1,0,0]
MF v[144:147], a[152:155], v[80:83], v[144:147]
TR a[150:151], v18, 43008
v_fma_mix_f32 v57, v84, v109, v117 op_sel:[1,0,0] op_sel_hi:[1,0,0]
MF v[148:151], a[156:159], v[76:79], v[148:151]
TR a[152:153], v19, 40960
v_cvt_pk_bf16_f32 v84, v56, v57
MF v[152:155], a[156:159], v[80:83], v[152:155]
TR a[154:155], v19, 43008
v_fma_mix_f32 v58, v85, v110, v118 op_sel:[0,0,0] op_sel_hi:[1,0,0]
s_waitcnt lgkmcnt(6)
MF v[156:159], a[160:163], v[76:79], v[156:159]
TR a[156:157], v20, 40960
v_fma_mix_f32 v59, v85, v111, v119 op_sel:[1,0,0] op_sel_hi:[1,0,0]
MF v[160:163], a[160:163], v[80:83], v[160:163]
TR a[158:159], v20, 43008
v_cvt_pk_bf16_f32 v85, v58, v59
MF v[164:167], a[164:167], v[76:79], v[164:167]
TR a[160:161], v17, 45056
v_fma_mix_f32 v56, v86, v112, v120 op_sel:[0,0,0] op_sel_hi:[1,0,0]
MF v[168:171], a[164:167], v[80:83], v[168:171]
TR a[162:163], v17, 47104
v_fma_mix_f32 v57, v86, v113, v121 op_sel:[1,0,0] op_sel_hi:[1,0,0]
MF v[172:175], a[168:171], v[76:79], v[172:175]
TR a[164:165], v18, 45056
v_cvt_pk_bf16_f32 v86, v56, v57
MF v[176:179], a[168:171], v[80:83], v[176:179]
TR a[166:167], v18, 47104
v_fma_mix_f32 v58, v87, v114, v122 op_sel:[0,0,0] op_sel_hi:[1,0,0]
MF v[180:183], a[172:175], v[76:79], v[180:183]
TR a[168:169], v19, 45056
v_fma_mix_f32 v59, v87, v115, v123 op_sel:[1,0,0] op_sel_hi:[1,0,0]
MF v[184:187], a[172:175], v[80:83], v[184:187]
TR a[170:171], v19, 47104
s_waitcnt lgkmcnt(6)
MF v[188:191], a[144:147], v[76:79], v[188:191]
TR a[172:173], v20, 45056
s_barrier
v_cvt_pk_bf16_f32 v87, v58, v59
MF v[192:195], a[144:147], v[80:83], v[192:195]
TR a[174:175], v20, 47104
v_fma_mix_f32 v56, v88, v108, v116 op_sel:[0,0,0] op_sel_hi:[1,0,0]
MF v[196:199], a[148:151], v[76:79], v[196:199]
TR a[144:145], v17, 49152
v_fma_mix_f32 v57, v88, v109, v117 op_sel:[1,0,0] op_sel_hi:[1,0,0]
MF v[200:203], a[148:151], v[80:83], v[200:203]
TR a[146:147], v17, 51200
v_cvt_pk_bf16_f32 v88, v56, v57
MF v[204:207], a[152:155], v[76:79], v[204:207]
TR a[148:149], v18, 49152
v_fma_mix_f32 v58, v89, v110, v118 op_sel:[0,0,0] op_sel_hi:[1,0,0]
MF v[208:211], a[152:155], v[80:83], v[208:211]
TR a[150:151], v18, 51200
v_fma_mix_f32 v59, v89, v111, v119 op_sel:[1,0,0] op_sel_hi:[1,0,0]
MF v[212:215], a[156:159], v[76:79], v[212:215]
TR a[152:153], v19, 49152
v_cvt_pk_bf16_f32 v89, v58, v59
ds_read_b128 v[32:35], v48 offset:4096
MF v[216:219], a[156:159], v[80:83], v[216:219]
TR a[154:155], v19, 51200
s_add_u32 m0, s38, 81920
s_nop 0
global_load_lds_dwordx4 v5, s[12:13]
v_fma_mix_f32 v56, v90, v112, v120 op_sel:[0,0,0] op_sel_hi:[1,0,0]
s_waitcnt lgkmcnt(7)
MF v[220:223], a[160:163], v[76:79], v[220:223]
TR a[156:157], v20, 49152
v_fma_mix_f32 v57, v90, v113, v121 op_sel:[1,0,0] op_sel_hi:[1,0,0]
ds_read_b128 v[36:39], v48 offset:4112
MF v[224:227], a[160:163], v[80:83], v[224:227]
TR a[158:159], v20, 51200
v_cvt_pk_bf16_f32 v90, v56, v57
MF v[228:231], a[164:167], v[76:79], v[228:231]
TR a[160:161], v17, 53248
v_fma_mix_f32 v58, v91, v114, v122 op_sel:[0,0,0] op_sel_hi:[1,0,0]
ds_read_b128 v[40:43], v48 offset:4128
MF v[232:235], a[164:167], v[80:83], v[232:235]
TR a[162:163], v17, 55296
global_load_lds_dwordx4 v6, s[12:13] offset:1024
v_fma_mix_f32 v59, v91, v115, v123 op_sel:[1,0,0] op_sel_hi:[1,0,0]
MF v[236:239], a[168:171], v[76:79], v[236:239]
TR a[164:165], v18, 53248
ds_read_b128 v[44:47], v48 offset:4144
MF v[240:243], a[168:171], v[80:83], v[240:243]
TR a[166:167], v18, 55296
v_cvt_pk_bf16_f32 v91, v58, v59
MF v[244:247], a[172:175], v[76:79], v[244:247]
TR a[168:169], v19, 53248
MF v[248:251], a[172:175], v[80:83], v[248:251]
TR a[170:171], v19, 55296
global_load_lds_dwordx4 v7, s[12:13] offset:2048
s_waitcnt lgkmcnt(8)
MF v[124:127], a[144:147], v[84:87], v[124:127]
TR a[172:173], v20, 53248
global_load_lds_dwordx4 v8, s[12:13] offset:3072
MF v[128:131], a[144:147], v[88:91], v[128:131]
TR a[174:175], v20, 55296
s_add_u32 s12, s12, 16384
s_addc_u32 s13, s13, 0
MF v[132:135], a[148:151], v[84:87], v[132:135]
TR a[144:145], v17, 57344
s_waitcnt lgkmcnt(6)
MF v[136:139], a[148:151], v[88:91], v[136:139]
TR a[146:147], v17, 59392
s_waitcnt vmcnt(18)
MF v[140:143], a[152:155], v[84:87], v[140:143]
TR a[148:149], v18, 57344
v_fma_mix_f32 v56, v92, v32, v40 op_sel:[0,0,0] op_sel_hi:[1,0,0]
MF v[144:147], a[152:155], v[88:91], v[144:147]
TR a[150:151], v18, 59392
v_fma_mix_f32 v57, v92, v33, v41 op_sel:[1,0,0] op_sel_hi:[1,0,0]
MF v[148:151], a[156:159], v[84:87], v[148:151]
TR a[152:153], v19, 57344
v_cvt_pk_bf16_f32 v92, v56, v57
MF v[152:155], a[156:159], v[88:91], v[152:155]
TR a[154:155], v19, 59392
v_fma_mix_f32 v58, v93, v34, v42 op_sel:[0,0,0] op_sel_hi:[1,0,0]
s_waitcnt lgkmcnt(6)
MF v[156:159], a[160:163], v[84:87], v[156:159]
TR a[156:157], v20, 57344
v_fma_mix_f32 v59, v93, v35, v43 op_sel:[1,0,0] op_sel_hi:[1,0,0]
MF v[160:163], a[160:163], v[88:91], v[160:163]
TR a[158:159], v20, 59392
v_cvt_pk_bf16_f32 v93, v58, v59
MF v[164:167], a[164:167], v[84:87], v[164:167]
TR a[160:161], v17, 61440
v_fma_mix_f32 v56, v94, v36, v44 op_sel:[0,0,0] op_sel_hi:[1,0,0]
MF v[168:171], a[164:167], v[88:91], v[168:171]
TR a[162:163], v17, 63488
v_fma_mix_f32 v57, v94, v37, v45 op_sel:[1,0,0] op_sel_hi:[1,0,0]
MF v[172:175], a[168:171], v[84:87], v[172:175]
TR a[164:165], v18, 61440
v_cvt_pk_bf16_f32 v94, v56, v57
MF v[176:179], a[168:171], v[88:91], v[176:179]
TR a[166:167], v18, 63488
v_fma_mix_f32 v58, v95, v38, v46 op_sel:[0,0,0] op_sel_hi:[1,0,0]
MF v[180:183], a[172:175], v[84:87], v[180:183]
TR a[168:169], v19, 61440
v_fma_mix_f32 v59, v95, v39, v47 op_sel:[1,0,0] op_sel_hi:[1,0,0]
MF v[184:187], a[172:175], v[88:91], v[184:187]
TR a[170:171], v19, 63488
s_waitcnt lgkmcnt(6)
MF v[188:191], a[144:147], v[84:87], v[188:191]
TR a[172:173], v20, 61440
s_barrier
v_cvt_pk_bf16_f32 v95, v58, v59
MF v[192:195], a[144:147], v[88:91], v[192:195]
TR a[174:175], v20, 63488
v_fma_mix_f32 v56, v96, v32, v40 op_sel:[0,0,0] op_sel_hi:[1,0,0]
MF v[196:199], a[148:151], v[84:87], v[196:199]
TR a[144:145], v13, 0
v_fma_mix_f32 v57, v96, v33, v41 op_sel:[1,0,0] op_sel_hi:[1,0,0]
MF v[200:203], a[148:151], v[88:91], v[200:203]
TR a[146:147], v13, 2048
v_cvt_pk_bf16_f32 v96, v56, v57
MF v[204:207], a[152:155], v[84:87], v[204:207]
TR a[148:149], v14, 0
v_fma_mix_f32 v58, v97, v34, v42 op_sel:[0,0,0] op_sel_hi:[1,0,0]
MF v[208:211], a[152:155], v[88:91], v[208:211]
TR a[150:151], v14, 2048
v_fma_mix_f32 v59, v97, v35, v43 op_sel:[1,0,0] op_sel_hi:[1,0,0]
MF v[212:215], a[156:159], v[84:87], v[212:215]
TR a[152:153], v15, 0
v_cvt_pk_bf16_f32 v97, v58, v59
ds_read_b128 v[108:111], v48 offset:4352
MF v[216:219], a[156:159], v[88:91], v[216:219]
TR a[154:155], v15, 2048
s_add_u32 m0, s38, 98304
s_nop 0
global_load_lds_dwordx4 v5, s[16:17]
v_fma_mix_f32 v56, v98, v36, v44 op_sel:[0,0,0] op_sel_hi:[1,0,0]
s_waitcnt lgkmcnt(7)
MF v[220:223], a[160:163], v[84:87], v[220:223]
TR a[156:157], v16, 0
v_fma_mix_f32 v57, v98, v37, v45 op_sel:[1,0,0] op_sel_hi:[1,0,0]
ds_read_b128 v[112:115], v48 offset:4368
MF v[224:227], a[160:163], v[88:91], v[224:227]
TR a[158:159], v16, 2048
v_cvt_pk_bf16_f32 v98, v56, v57
MF v[228:231], a[164:167], v[84:87], v[228:231]
TR a[160:161], v13, 4096
v_fma_mix_f32 v58, v99, v38, v46 op_sel:[0,0,0] op_sel_hi:[1,0,0]
ds_read_b128 v[116:119], v48 offset:4384
MF v[232:235], a[164:167], v[88:91], v[232:235]
TR a[162:163], v13, 6144
global_load_lds_dwordx4 v6, s[16:17] offset:1024
v_fma_mix_f32 v59, v99, v39, v47 op_sel:[1,0,0] op_sel_hi:[1,0,0]
MF v[236:239], a[168:171], v[84:87], v[236:239]
TR a[164:165], v14, 4096
ds_read_b128 v[120:123], v48 offset:4400
MF v[240:243], a[168:171], v[88:91], v[240:243]
TR a[166:167], v14, 6144
v_cvt_pk_bf16_f32 v99, v58, v59
MF v[244:247], a[172:175], v[84:87], v[244:247]
TR a[168:169], v15, 4096
MF v[248:251], a[172:175], v[88:91], v[248:251]
TR a[170:171], v15, 6144
global_load_lds_dwordx4 v7, s[16:17] offset:2048
s_waitcnt lgkmcnt(8)
MF v[124:127], a[144:147], v[92:95], v[124:127]
TR a[172:173], v16, 4096
global_load_lds_dwordx4 v8, s[16:17] offset:3072
MF v[128:131], a[144:147], v[96:99], v[128:131]
TR a[174:175], v16, 6144
s_add_u32 s16, s16, 16384
s_addc_u32 s17, s17, 0
MF v[132:135], a[148:151], v[92:95], v[132:135]
TR a[144:145], v13, 8192
s_waitcnt lgkmcnt(6)
MF v[136:139], a[148:151], v[96:99], v[136:139]
TR a[146:147], v13, 10240
s_waitcnt vmcnt(16)
MF v[140:143], a[152:155], v[92:95], v[140:143]
TR a[148:149], v14, 8192
v_fma_mix_f32 v56, v100, v108, v116 op_sel:[0,0,0] op_sel_hi:[1,0,0]
MF v[144:147], a[152:155], v[96:99], v[144:147]
TR a[150:151], v14, 10240
v_fma_mix_f32 v57, v100, v109, v117 op_sel:[1,0,0] op_sel_hi:[1,0,0]
MF v[148:151], a[156:159], v[92:95], v[148:151]
TR a[152:153], v15, 8192
v_cvt_pk_bf16_f32 v100, v56, v57
MF v[152:155], a[156:159], v[96:99], v[152:155]
TR a[154:155], v15, 10240
v_fma_mix_f32 v58, v101, v110, v118 op_sel:[0,0,0] op_sel_hi:[1,0,0]
s_waitcnt lgkmcnt(6)
MF v[156:159], a[160:163], v[92:95], v[156:159]
TR a[156:157], v16, 8192
v_fma_mix_f32 v59, v101, v111, v119 op_sel:[1,0,0] op_sel_hi:[1,0,0]
MF v[160:163], a[160:163], v[96:99], v[160:163]
TR a[158:159], v16, 10240
v_cvt_pk_bf16_f32 v101, v58, v59
MF v[164:167], a[164:167], v[92:95], v[164:167]
TR a[160:161], v13, 12288
v_fma_mix_f32 v56, v102, v112, v120 op_sel:[0,0,0] op_sel_hi:[1,0,0]
MF v[168:171], a[164:167], v[96:99], v[168:171]
TR a[162:163], v13, 14336
v_fma_mix_f32 v57, v102, v113, v121 op_sel:[1,0,0] op_sel_hi:[1,0,0]
MF v[172:175], a[168:171], v[92:95], v[172:175]
TR a[164:165], v14, 12288
v_cvt_pk_bf16_f32 v102, v56, v57
MF v[176:179], a[168:171], v[96:99], v[176:179]
TR a[166:167], v14, 14336
v_fma_mix_f32 v58, v103, v114, v122 op_sel:[0,0,0] op_sel_hi:[1,0,0]
MF v[180:183], a[172:175], v[92:95], v[180:183]
TR a[168:169], v15, 12288
v_fma_mix_f32 v59, v103, v115, v123 op_sel:[1,0,0] op_sel_hi:[1,0,0]
MF v[184:187], a[172:175], v[96:99], v[184:187]
TR a[170:171], v15, 14336
s_waitcnt lgkmcnt(6)
MF v[188:191], a[144:147], v[92:95], v[188:191]
TR a[172:173], v16, 12288
s_barrier
v_cvt_pk_bf16_f32 v103, v58, v59
MF v[192:195], a[144:147], v[96:99], v[192:195]
TR a[174:175], v16, 14336
v_fma_mix_f32 v56, v104, v108, v116 op_sel:[0,0,0] op_sel_hi:[1,0,0]
MF v[196:199], a[148:151], v[92:95], v[196:199]
TR a[144:145], v13, 16384
v_fma_mix_f32 v57, v104, v109, v117 op_sel:[1,0,0] op_sel_hi:[1,0,0]
MF v[200:203], a[148:151], v[96:99], v[200:203]
TR a[146:147], v13, 18432
v_cvt_pk_bf16_f32 v104, v56, v57
MF v[204:207], a[152:155], v[92:95], v[204:207]
TR a[148:149], v14, 16384
v_fma_mix_f32 v58, v105, v110, v118 op_sel:[0,0,0] op_sel_hi:[1,0,0]
MF v[208:211], a[152:155], v[96:99], v[208:211]
TR a[150:151], v14, 18432
v_fma_mix_f32 v59, v105, v111, v119 op_sel:[1,0,0] op_sel_hi:[1,0,0]
MF v[212:215], a[156:159], v[92:95], v[212:215]
TR a[152:153], v15, 16384
v_cvt_pk_bf16_f32 v105, v58, v59
MF v[216:219], a[156:159], v[96:99], v[216:219]
TR a[154:155], v15, 18432
s_add_u32 m0, s38, 114688
s_nop 0
global_load_lds_dwordx4 v5, s[12:13]
v_fma_mix_f32 v56, v106, v112, v120 op_sel:[0,0,0] op_sel_hi:[1,0,0]
s_waitcnt lgkmcnt(6)
MF v[220:223], a[160:163], v[92:95], v[220:223]
TR a[156:157], v16, 16384
v_fma_mix_f32 v57, v106, v113, v121 op_sel:[1,0,0] op_sel_hi:[1,0,0]
MF v[224:227], a[160:163], v[96:99], v[224:227]
TR a[158:159], v16, 18432
v_cvt_pk_bf16_f32 v106, v56, v57
MF v[228:231], a[164:167], v[92:95], v[228:231]
TR a[160:161], v13, 20480
v_fma_mix_f32 v58, v107, v114, v122 op_sel:[0,0,0] op_sel_hi:[1,0,0]
MF v[232:235], a[164:167], v[96:99], v[232:235]
TR a[162:163], v13, 22528
global_load_lds_dwordx4 v6, s[12:13] offset:1024
v_fma_mix_f32 v59, v107, v115, v123 op_sel:[1,0,0] op_sel_hi:[1,0,0]
MF v[236:239], a[168:171], v[92:95], v[236:239]
TR a[164:165], v14, 20480
MF v[240:243], a[168:171], v[96:99], v[240:243]
TR a[166:167], v14, 22528
v_cvt_pk_bf16_f32 v107, v58, v59
MF v[244:247], a[172:175], v[92:95], v[244:247]
TR a[168:169], v15, 20480
global_load_lds_dwordx4 v7, s[12:13] offset:2048
MF v[248:251], a[172:175], v[96:99], v[248:251]
TR a[170:171], v15, 22528
s_waitcnt lgkmcnt(6)
MF v[124:127], a[144:147], v[100:103], v[124:127]
TR a[172:173], v16, 20480
global_load_lds_dwordx4 v8, s[12:13] offset:3072
MF v[128:131], a[144:147], v[104:107], v[128:131]
TR a[174:175], v16, 22528
s_add_u32 s12, s12, 16384
s_addc_u32 s13, s13, 0
MF v[132:135], a[148:151], v[100:103], v[132:135]
TR a[144:145], v13, 24576
MF v[136:139], a[148:151], v[104:107], v[136:139]
TR a[146:147], v13, 26624
MF v[140:143], a[152:155], v[100:103], v[140:143]
TR a[148:149], v14, 24576
v_cvt_pk_bf16_f32 v60, v124, v125
MF v[144:147], a[152:155], v[104:107], v[144:147]
TR a[150:151], v14, 26624
v_cvt_pk_bf16_f32 v61, v126, v127
MF v[148:151], a[156:159], v[100:103], v[148:151]
TR a[152:153], v15, 24576
v_cvt_pk_bf16_f32 v62, v132, v133
MF v[152:155], a[156:159], v[104:107], v[152:155]
TR a[154:155], v15, 26624
s_waitcnt lgkmcnt(6)
MF v[156:159], a[160:163], v[100:103], v[156:159]
TR a[156:157], v16, 24576
v_cvt_pk_bf16_f32 v63, v134, v135
MF v[160:163], a[160:163], v[104:107], v[160:163]
TR a[158:159], v16, 26624
v_cvt_pk_bf16_f32 v76, v128, v129
MF v[164:167], a[164:167], v[100:103], v[164:167]
TR a[160:161], v13, 28672
v_cvt_pk_bf16_f32 v77, v130, v131
MF v[168:171], a[164:167], v[104:107], v[168:171]
TR a[162:163], v13, 30720
v_cvt_pk_bf16_f32 v78, v136, v137
MF v[172:175], a[168:171], v[100:103], v[172:175]
TR a[164:165], v14, 28672
v_cvt_pk_bf16_f32 v79, v138, v139
MF v[176:179], a[168:171], v[104:107], v[176:179]
TR a[166:167], v14, 30720
v_cvt_pk_bf16_f32 v64, v140, v141
MF v[180:183], a[172:175], v[100:103], v[180:183]
TR a[168:169], v15, 28672
MF v[184:187], a[172:175], v[104:107], v[184:187]
TR a[170:171], v15, 30720
s_waitcnt lgkmcnt(6)
MF v[188:191], a[144:147], v[100:103], v[188:191]
TR a[172:173], v16, 28672
s_barrier
MF v[192:195], a[144:147], v[104:107], v[192:195]
TR a[174:175], v16, 30720
s_add_u32 m0, s38, 0
MF v[196:199], a[148:151], v[100:103], v[196:199]
DR a[144:145], v21, 32768
global_load_lds_dwordx4 v5, s[16:17]
MF v[200:203], a[148:151], v[104:107], v[200:203]
DR a[146:147], v22, 32768
v_cvt_pk_bf16_f32 v65, v142, v143
MF v[204:207], a[152:155], v[100:103], v[204:207]
DR a[148:149], v23, 32768
v_cvt_pk_bf16_f32 v66, v148, v149
MF v[208:211], a[152:155], v[104:107], v[208:211]
DR a[150:151], v24, 32768
global_load_lds_dwordx4 v6, s[16:17] offset:1024
MF v[212:215], a[156:159], v[100:103], v[212:215]
DR a[152:153], v21, 40960
v_cvt_pk_bf16_f32 v67, v150, v151
MF v[216:219], a[156:159], v[104:107], v[216:219]
DR a[154:155], v22, 40960
s_waitcnt lgkmcnt(6)
MF v[220:223], a[160:163], v[100:103], v[220:223]
DR a[156:157], v23, 40960
v_cvt_pk_bf16_f32 v80, v144, v145
MF v[224:227], a[160:163], v[104:107], v[224:227]
DR a[158:159], v24, 40960
global_load_lds_dwordx4 v7, s[16:17] offset:2048
MF v[228:231], a[164:167], v[100:103], v[228:231]
DR a[160:161], v21, 34816
v_cvt_pk_bf16_f32 v81, v146, v147
MF v[232:235], a[164:167], v[104:107], v[232:235]
DR a[162:163], v22, 34816
v_cvt_pk_bf16_f32 v82, v152, v153
MF v[236:239], a[168:171], v[100:103], v[236:239]
DR a[164:165], v23, 34816
v_cvt_pk_bf16_f32 v83, v154, v155
MF v[240:243], a[168:171], v[104:107], v[240:243]
DR a[166:167], v24, 34816
global_load_lds_dwordx4 v8, s[16:17] offset:3072
MF v[244:247], a[172:175], v[100:103], v[244:247]
DR a[168:169], v21, 43008
s_add_u32 s16, s16, 16384
s_addc_u32 s17, s17, 0
MF v[248:251], a[172:175], v[104:107], v[248:251]
DR a[170:171], v22, 43008
v_cvt_pk_bf16_f32 v68, v156, v157
v_cvt_pk_bf16_f32 v69, v158, v159
v_cvt_pk_bf16_f32 v70, v164, v165
v_cvt_pk_bf16_f32 v71, v166, v167
v_cvt_pk_bf16_f32 v84, v160, v161
v_cvt_pk_bf16_f32 v85, v162, v163
v_cvt_pk_bf16_f32 v86, v168, v169
v_cvt_pk_bf16_f32 v87, v170, v171
v_cvt_pk_bf16_f32 v72, v172, v173
v_cvt_pk_bf16_f32 v73, v174, v175
v_cvt_pk_bf16_f32 v74, v180, v181
v_cvt_pk_bf16_f32 v75, v182, v183
v_cvt_pk_bf16_f32 v88, v176, v177
v_cvt_pk_bf16_f32 v89, v178, v179
v_cvt_pk_bf16_f32 v90, v184, v185
v_cvt_pk_bf16_f32 v91, v186, v187
v_cvt_pk_bf16_f32 v92, v188, v189
v_cvt_pk_bf16_f32 v93, v190, v191
v_cvt_pk_bf16_f32 v94, v196, v197
v_cvt_pk_bf16_f32 v95, v198, v199
v_cvt_pk_bf16_f32 v108, v192, v193
v_cvt_pk_bf16_f32 v109, v194, v195
v_cvt_pk_bf16_f32 v110, v200, v201
v_cvt_pk_bf16_f32 v111, v202, v203
v_cvt_pk_bf16_f32 v96, v204, v205
v_cvt_pk_bf16_f32 v97, v206, v207
v_cvt_pk_bf16_f32 v98, v212, v213
v_cvt_pk_bf16_f32 v99, v214, v215
v_cvt_pk_bf16_f32 v112, v208, v209
v_cvt_pk_bf16_f32 v113, v210, v211
v_cvt_pk_bf16_f32 v114, v216, v217
v_cvt_pk_bf16_f32 v115, v218, v219
v_cvt_pk_bf16_f32 v100, v220, v221
v_cvt_pk_bf16_f32 v101, v222, v223
v_cvt_pk_bf16_f32 v102, v228, v229
v_cvt_pk_bf16_f32 v103, v230, v231
v_cvt_pk_bf16_f32 v116, v224, v225
v_cvt_pk_bf16_f32 v117, v226, v227
v_cvt_pk_bf16_f32 v118, v232, v233
v_cvt_pk_bf16_f32 v119, v234, v235
v_cvt_pk_bf16_f32 v104, v236, v237
v_cvt_pk_bf16_f32 v105, v238, v239
v_cvt_pk_bf16_f32 v106, v244, v245
v_cvt_pk_bf16_f32 v107, v246, v247
v_cvt_pk_bf16_f32 v120, v240, v241
v_cvt_pk_bf16_f32 v121, v242, v243
v_cvt_pk_bf16_f32 v122, v248, v249
v_cvt_pk_bf16_f32 v123, v250, v251
v_mov_b32 v48, 0x3f803f80
v_mov_b32 v49, 0x3f803f80
v_mov_b32 v50, 0x3f803f80
v_mov_b32 v51, 0x3f803f80
s_waitcnt lgkmcnt(6)
MF v[124:127], a[144:147], v[60:63], 0
DR a[172:173], v23, 43008
MF v[124:127], a[148:151], v[64:67], v[124:127]
DR a[174:175], v24, 43008
MF v[124:127], a[152:155], v[68:71], v[124:127]
MF v[124:127], a[156:159], v[72:75], v[124:127]
MF v[128:131], a[144:147], v[76:79], 0
v_lshrrev_b32 v254, 4, v29
v_mov_b32 v252, 0
MF v[128:131], a[148:151], v[80:83], v[128:131]
v_min_u32 v253, 35, v254
s_mov_b32 s57, 9216
MF v[128:131], a[152:155], v[84:87], v[128:131]
v_lshlrev_b32 v253, 4, v253
v_mad_u32_u24 v252, v252, s57, v253
MF v[128:131], a[156:159], v[88:91], v[128:131]
v_max3_f32 v52, v124, v125, v126
v_max_f32 v52, v52, v127
MF v[132:135], a[144:147], v[92:95], 0
s_mul_i32 s56, s41, 36
s_mul_i32 s57, s39, 1
MF v[132:135], a[148:151], v[96:99], v[132:135]
s_add_u32 s56, s56, s57
s_mul_i32 s56, s56, 9216
MF v[132:135], a[152:155], v[100:103], v[132:135]
s_mul_i32 s57, s40, 576
s_add_u32 s56, s56, s57
MF v[132:135], a[156:159], v[104:107], v[132:135]
v_max3_f32 v53, v128, v129, v130
v_max_f32 v53, v53, v131
MF v[136:139], a[144:147], v[108:111], 0
DR a[144:145], v21, 36864
buffer_load_dwordx4 a[200:203], v252, s[44:47], s56 offen
MF v[136:139], a[148:151], v[112:115], v[136:139]
DR a[146:147], v22, 36864
MF v[136:139], a[152:155], v[116:119], v[136:139]
DR a[148:149], v23, 36864
MF v[136:139], a[156:159], v[120:123], v[136:139]
DR a[150:151], v24, 36864
s_waitcnt lgkmcnt(4)
MF v[140:143], a[160:163], v[60:63], 0
DR a[152:153], v21, 45056
v_max3_f32 v54, v132, v133, v134
MF v[140:143], a[164:167], v[64:67], v[140:143]
DR a[154:155], v22, 45056
v_max_f32 v54, v54, v135
MF v[140:143], a[168:171], v[68:71], v[140:143]
DR a[156:157], v23, 45056
MF v[140:143], a[172:175], v[72:75], v[140:143]
DR a[158:159], v24, 45056
v_max3_f32 v55, v136, v137, v138
MF v[144:147], a[160:163], v[76:79], 0
v_max_f32 v55, v55, v139
v_mov_b32 v56, v52
MF v[144:147], a[164:167], v[80:83], v[144:147]
v_mov_b32 v57, v53
v_mov_b32 v58, v54
MF v[144:147], a[168:171], v[84:87], v[144:147]
v_mov_b32 v59, v55
v_permlane16_swap_b32 v52, v56
MF v[144:147], a[172:175], v[88:91], v[144:147]
v_permlane16_swap_b32 v53, v57
v_permlane16_swap_b32 v54, v58
MF v[148:151], a[160:163], v[92:95], 0
v_permlane16_swap_b32 v55, v59
v_max_f32 v52, v52, v56
MF v[148:151], a[164:167], v[96:99], v[148:151]
v_max_f32 v53, v53, v57
v_max_f32 v54, v54, v58
MF v[148:151], a[168:171], v[100:103], v[148:151]
v_max_f32 v55, v55, v59
v_mov_b32 v56, v52
MF v[148:151], a[172:175], v[104:107], v[148:151]
v_mov_b32 v57, v53
v_mov_b32 v58, v54
MF v[152:155], a[160:163], v[108:111], 0
DR a[160:161], v21, 38912
v_mov_b32 v59, v55
MF v[152:155], a[164:167], v[112:115], v[152:155]
DR a[162:163], v22, 38912
v_permlane32_swap_b32 v52, v56
MF v[152:155], a[168:171], v[116:119], v[152:155]
DR a[164:165], v23, 38912
v_permlane32_swap_b32 v53, v57
MF v[152:155], a[172:175], v[120:123], v[152:155]
DR a[166:167], v24, 38912
v_permlane32_swap_b32 v54, v58
v_permlane32_swap_b32 v55, v59
v_max_f32 v52, v52, v56
v_max_f32 v53, v53, v57
v_max_f32 v54, v54, v58
v_max_f32 v55, v55, v59
v_sub_f32 v32, 0, v52
v_sub_f32 v33, 0, v52
v_sub_f32 v34, 0, v52
v_sub_f32 v35, 0, v52
v_sub_f32 v36, 0, v53
v_sub_f32 v37, 0, v53
v_sub_f32 v38, 0, v53
v_sub_f32 v39, 0, v53
v_sub_f32 v40, 0, v54
v_sub_f32 v41, 0, v54
v_sub_f32 v42, 0, v54
v_sub_f32 v43, 0, v54
v_sub_f32 v44, 0, v55
v_sub_f32 v45, 0, v55
v_sub_f32 v46, 0, v55
v_sub_f32 v47, 0, v55
s_waitcnt lgkmcnt(4)
MF v[156:159], a[144:147], v[60:63], v[32:35]
DR a[168:169], v21, 47104
MF v[156:159], a[148:151], v[64:67], v[156:159]
DR a[170:171], v22, 47104
MF v[156:159], a[152:155], v[68:71], v[156:159]
DR a[172:173], v23, 47104
v_add_f32 v124, v124, v32
MF v[156:159], a[156:159], v[72:75], v[156:159]
DR a[174:175], v24, 47104
v_add_f32 v125, v125, v32
MF v[160:163], a[144:147], v[76:79], v[36:39]
v_add_f32 v126, v126, v32
v_add_f32 v127, v127, v32
MF v[160:163], a[148:151], v[80:83], v[160:163]
v_add_f32 v128, v128, v36
v_add_f32 v129, v129, v36
MF v[160:163], a[152:155], v[84:87], v[160:163]
v_add_f32 v130, v130, v36
v_add_f32 v131, v131, v36
MF v[160:163], a[156:159], v[88:91], v[160:163]
v_add_f32 v132, v132, v40
v_add_f32 v133, v133, v40
MF v[164:167], a[144:147], v[92:95], v[40:43]
v_add_f32 v134, v134, v40
v_add_f32 v135, v135, v40
MF v[164:167], a[148:151], v[96:99], v[164:167]
s_waitcnt vmcnt(21)
v_add_f32 v136, v136, v44
MF v[164:167], a[152:155], v[100:103], v[164:167]
s_barrier
v_add_f32 v137, v137, v44
MF v[164:167], a[156:159], v[104:107], v[164:167]
v_add_f32 v138, v138, v44
v_add_f32 v139, v139, v44
MF v[168:171], a[144:147], v[108:111], v[44:47]
DR a[144:145], v21, 49152
s_add_u32 m0, s38, 16384
MF v[168:171], a[148:151], v[112:115], v[168:171]
DR a[146:147], v22, 49152
global_load_lds_dwordx4 v5, s[12:13]
MF v[168:171], a[152:155], v[116:119], v[168:171]
DR a[148:149], v23, 49152
v_add_f32 v140, v140, v32
MF v[168:171], a[156:159], v[120:123], v[168:171]
DR a[150:151], v24, 49152
s_waitcnt lgkmcnt(4)
MF v[172:175], a[160:163], v[60:63], v[32:35]
DR a[152:153], v21, 57344
v_add_f32 v141, v141, v32
MF v[172:175], a[164:167], v[64:67], v[172:175]
DR a[154:155], v22, 57344
v_add_f32 v142, v142, v32
MF v[172:175], a[168:171], v[68:71], v[172:175]
DR a[156:157], v23, 57344
v_add_f32 v143, v143, v32
MF v[172:175], a[172:175], v[72:75], v[172:175]
DR a[158:159], v24, 57344
v_add_f32 v144, v144, v36
MF v[176:179], a[160:163], v[76:79], v[36:39]
global_load_lds_dwordx4 v6, s[12:13] offset:1024
v_add_f32 v145, v145, v36
MF v[176:179], a[164:167], v[80:83], v[176:179]
v_add_f32 v146, v146, v36
v_add_f32 v147, v147, v36
MF v[176:179], a[168:171], v[84:87], v[176:179]
v_add_f32 v148, v148, v40
v_add_f32 v149, v149, v40
MF v[176:179], a[172:175], v[88:91], v[176:179]
v_add_f32 v150, v150, v40
v_add_f32 v151, v151, v40
MF v[180:183], a[160:163], v[92:95], v[40:43]
v_add_f32 v152, v152, v44
v_add_f32 v153, v153, v44
MF v[180:183], a[164:167], v[96:99], v[180:183]
v_add_f32 v154, v154, v44
v_add_f32 v155, v155, v44
MF v[180:183], a[168:171], v[100:103], v[180:183]
v_max3_f32 v52, v124, v125, v126
v_max_f32 v52, v52, v127
MF v[180:183], a[172:175], v[104:107], v[180:183]
buffer_load_dwordx4 a[200:203], v252, s[48:51], s56 offen
v_max3_f32 v53, v128, v129, v130
MF v[184:187], a[160:163], v[108:111], v[44:47]
DR a[160:161], v21, 51200
global_load_lds_dwordx4 v7, s[12:13] offset:2048
MF v[184:187], a[164:167], v[112:115], v[184:187]
DR a[162:163], v22, 51200
v_max_f32 v53, v53, v131
MF v[184:187], a[168:171], v[116:119], v[184:187]
DR a[164:165], v23, 51200
v_max3_f32 v54, v132, v133, v134
MF v[184:187], a[172:175], v[120:123], v[184:187]
DR a[166:167], v24, 51200
s_waitcnt lgkmcnt(4)
MF v[188:191], a[144:147], v[60:63], v[32:35]
DR a[168:169], v21, 59392
v_max_f32 v54, v54, v135
MF v[188:191], a[148:151], v[64:67], v[188:191]
DR a[170:171], v22, 59392
v_max3_f32 v55, v136, v137, v138
MF v[188:191], a[152:155], v[68:71], v[188:191]
DR a[172:173], v23, 59392
v_max_f32 v55, v55, v139
MF v[188:191], a[156:159], v[72:75], v[188:191]
DR a[174:175], v24, 59392
v_max3_f32 v52, v52, v140, v141
MF v[192:195], a[144:147], v[76:79], v[36:39]
global_load_lds_dwordx4 v8, s[12:13] offset:3072
s_add_u32 s12, s12, 16384
s_addc_u32 s13, s13, 0
MF v[192:195], a[148:151], v[80:83], v[192:195]
v_max3_f32 v52, v52, v142, v143
v_max3_f32 v53, v53, v144, v145
MF v[192:195], a[152:155], v[84:87], v[192:195]
v_max3_f32 v53, v53, v146, v147
v_max3_f32 v54, v54, v148, v149
MF v[192:195], a[156:159], v[88:91], v[192:195]
v_max3_f32 v54, v54, v150, v151
v_max3_f32 v55, v55, v152, v153
v_max3_f32 v55, v55, v154, v155
v_max3_f32 v52, v52, v156, v157
v_max3_f32 v52, v52, v158, v159
v_max3_f32 v53, v53, v160, v161
v_max3_f32 v53, v53, v162, v163
v_max3_f32 v54, v54, v164, v165
v_max3_f32 v54, v54, v166, v167
v_max3_f32 v55, v55, v168, v169
v_max3_f32 v55, v55, v170, v171
v_max3_f32 v52, v52, v172, v173
v_max3_f32 v52, v52, v174, v175
v_max3_f32 v53, v53, v176, v177
v_max3_f32 v53, v53, v178, v179
v_max3_f32 v54, v54, v180, v181
v_max3_f32 v54, v54, v182, v183
v_max3_f32 v55, v55, v184, v185
v_max3_f32 v55, v55, v186, v187
MF v[196:199], a[144:147], v[92:95], v[40:43]
v_max3_f32 v56, v52, v53, v54
v_max_f32 v56, v56, v55
MF v[196:199], a[148:151], v[96:99], v[196:199]
v_cmp_lt_f32 vcc, s58, v56
MF v[196:199], a[152:155], v[100:103], v[196:199]
s_cbranch_vccnz ka_kernel_slow11
ka_kernel_back12:
MF v[196:199], a[156:159], v[104:107], v[196:199]
v_exp_f32 v124, v124
MF v[200:203], a[144:147], v[108:111], v[44:47]
DR a[144:145], v21, 53248
v_max3_f32 v52, v188, v189, v190
MF v[200:203], a[148:151], v[112:115], v[200:203]
DR a[146:147], v22, 53248
v_max_f32 v52, v52, v191
MF v[200:203], a[152:155], v[116:119], v[200:203]
DR a[148:149], v23, 53248
v_max3_f32 v53, v192, v193, v194
MF v[200:203], a[156:159], v[120:123], v[200:203]
DR a[150:151], v24, 53248
s_waitcnt lgkmcnt(4)
MF v[204:207], a[160:163], v[60:63], v[32:35]
DR a[152:153], v21, 61440
v_max_f32 v53, v53, v195
MF v[204:207], a[164:167], v[64:67], v[204:207]
DR a[154:155], v22, 61440
v_max3_f32 v54, v196, v197, v198
MF v[204:207], a[168:171], v[68:71], v[204:207]
DR a[156:157], v23, 61440
v_max_f32 v54, v54, v199
MF v[204:207], a[172:175], v[72:75], v[204:207]
DR a[158:159], v24, 61440
v_max3_f32 v55, v200, v201, v202
MF v[208:211], a[160:163], v[76:79], v[36:39]
v_exp_f32 v125, v125
MF v[208:211], a[164:167], v[80:83], v[208:211]
v_exp_f32 v126, v126
MF v[208:211], a[168:171], v[84:87], v[208:211]
v_exp_f32 v127, v127
MF v[208:211], a[172:175], v[88:91], v[208:211]
v_exp_f32 v140, v140
MF v[212:215], a[160:163], v[92:95], v[40:43]
v_exp_f32 v141, v141
MF v[212:215], a[164:167], v[96:99], v[212:215]
v_exp_f32 v142, v142
MF v[212:215], a[168:171], v[100:103], v[212:215]
v_exp_f32 v143, v143
MF v[212:215], a[172:175], v[104:107], v[212:215]
v_exp_f32 v128, v128
MF v[216:219], a[160:163], v[108:111], v[44:47]
DR a[160:161], v21, 55296
v_cvt_pk_bf16_f32 v124, v124, v125
MF v[216:219], a[164:167], v[112:115], v[216:219]
DR a[162:163], v22, 55296
v_cvt_pk_bf16_f32 v125, v126, v127
MF v[216:219], a[168:171], v[116:119], v[216:219]
DR a[164:165], v23, 55296
s_add_u32 s56, s56, 36864
buffer_load_dwordx4 a[200:203], v252, s[44:47], s56 offen
MF v[216:219], a[172:175], v[120:123], v[216:219]
DR a[166:167], v24, 55296
s_waitcnt lgkmcnt(4)
MF v[220:223], a[144:147], v[60:63], v[32:35]
DR a[168:169], v21, 63488
MF v[220:223], a[148:151], v[64:67], v[220:223]
DR a[170:171], v22, 63488
v_cvt_pk_bf16_f32 v126, v140, v141
MF v[220:223], a[152:155], v[68:71], v[220:223]
DR a[172:173], v23, 63488
v_cvt_pk_bf16_f32 v127, v142, v143
MF v[220:223], a[156:159], v[72:75], v[220:223]
DR a[174:175], v24, 63488
v_max_f32 v55, v55, v203
MF v[224:227], a[144:147], v[76:79], v[36:39]
v_exp_f32 v129, v129
MF v[224:227], a[148:151], v[80:83], v[224:227]
v_exp_f32 v130, v130
MF v[224:227], a[152:155], v[84:87], v[224:227]
v_exp_f32 v131, v131
MF v[224:227], a[156:159], v[88:91], v[224:227]
v_exp_f32 v144, v144
MF v[228:231], a[144:147], v[92:95], v[40:43]
v_exp_f32 v145, v145
MF v[228:231], a[148:151], v[96:99], v[228:231]
s_waitcnt vmcnt(23)
v_cvt_pk_bf16_f32 v128, v128, v129
MF v[228:231], a[152:155], v[100:103], v[228:231]
s_barrier
v_cvt_pk_bf16_f32 v129, v130, v131
MF v[228:231], a[156:159], v[104:107], v[228:231]
v_exp_f32 v146, v146
MF v[232:235], a[144:147], v[108:111], v[44:47]
TR a[144:145], v17, 0
s_add_u32 m0, s38, 32768
MF v[232:235], a[148:151], v[112:115], v[232:235]
TR a[146:147], v17, 2048
global_load_lds_dwordx4 v5, s[16:17]
MF v[232:235], a[152:155], v[116:119], v[232:235]
TR a[148:149], v18, 0
v_cvt_pk_bf16_f32 v130, v144, v145
MF v[232:235], a[156:159], v[120:123], v[232:235]
TR a[150:151], v18, 2048
s_waitcnt lgkmcnt(4)
MF v[236:239], a[160:163], v[60:63], v[32:35]
TR a[152:153], v19, 0
v_max3_f32 v52, v52, v204, v205
MF v[236:239], a[164:167], v[64:67], v[236:239]
TR a[154:155], v19, 2048
v_max3_f32 v52, v52, v206, v207
MF v[236:239], a[168:171], v[68:71], v[236:239]
TR a[156:157], v20, 0
v_max3_f32 v53, v53, v208, v209
MF v[236:239], a[172:175], v[72:75], v[236:239]
TR a[158:159], v20, 2048
v_max3_f32 v53, v53, v210, v211
MF v[240:243], a[160:163], v[76:79], v[36:39]
global_load_lds_dwordx4 v6, s[16:17] offset:1024
v_max3_f32 v54, v54, v212, v213
MF v[240:243], a[164:167], v[80:83], v[240:243]
v_exp_f32 v147, v147
MF v[240:243], a[168:171], v[84:87], v[240:243]
v_exp_f32 v132, v132
MF v[240:243], a[172:175], v[88:91], v[240:243]
v_exp_f32 v133, v133
MF v[244:247], a[160:163], v[92:95], v[40:43]
v_exp_f32 v134, v134
MF v[244:247], a[164:167], v[96:99], v[244:247]
v_exp_f32 v135, v135
MF v[244:247], a[168:171], v[100:103], v[244:247]
v_exp_f32 v148, v148
MF v[244:247], a[172:175], v[104:107], v[244:247]
v_exp_f32 v149, v149
MF v[248:251], a[160:163], v[108:111], v[44:47]
TR a[160:161], v17, 8192
global_load_lds_dwordx4 v7, s[16:17] offset:2048
MF v[248:251], a[164:167], v[112:115], v[248:251]
TR a[162:163], v17, 10240
v_cvt_pk_bf16_f32 v131, v146, v147
MF v[248:251], a[168:171], v[116:119], v[248:251]
TR a[164:165], v18, 8192
v_cvt_pk_bf16_f32 v132, v132, v133
MF v[248:251], a[172:175], v[120:123], v[248:251]
TR a[166:167], v18, 10240
v_exp_f32 v150, v150
v_exp_f32 v151, v151
MF a[128:131], v[48:51], v[124:127], 0
TR a[168:169], v19, 8192
v_exp_f32 v136, v136
v_exp_f32 v137, v137
v_exp_f32 v138, v138
v_exp_f32 v139, v139
v_exp_f32 v152, v152
v_exp_f32 v153, v153
v_exp_f32 v154, v154
v_exp_f32 v155, v155
v_cvt_pk_bf16_f32 v133, v134, v135
v_cvt_pk_bf16_f32 v134, v148, v149
v_cvt_pk_bf16_f32 v135, v150, v151
MF a[132:135], v[48:51], v[128:131], 0
TR a[170:171], v19, 10240
v_cvt_pk_bf16_f32 v136, v136, v137
v_cvt_pk_bf16_f32 v137, v138, v139
v_cvt_pk_bf16_f32 v138, v152, v153
v_cvt_pk_bf16_f32 v139, v154, v155
buffer_load_dwordx4 a[200:203], v252, s[48:51], s56 offen
MF a[136:139], v[48:51], v[132:135], 0
TR a[172:173], v20, 8192
MF a[140:143], v[48:51], v[136:139], 0
TR a[174:175], v20, 10240
s_waitcnt lgkmcnt(8)
MF a[0:3], a[144:147], v[124:127], 0
global_load_lds_dwordx4 v8, s[16:17] offset:3072
MF a[32:35], a[144:147], v[128:131], 0
s_add_u32 s16, s16, 16384
s_addc_u32 s17, s17, 0
v_max3_f32 v54, v54, v214, v215
MF a[64:67], a[144:147], v[132:135], 0
v_exp_f32 v156, v156
MF a[96:99], a[144:147], v[136:139], 0
TR a[144:145], v17, 4096
v_max3_f32 v55, v55, v216, v217
v_max3_f32 v55, v55, v218, v219
v_max3_f32 v52, v52, v220, v221
v_max3_f32 v52, v52, v222, v223
v_max3_f32 v53, v53, v224, v225
v_max3_f32 v53, v53, v226, v227
v_max3_f32 v54, v54, v228, v229
v_max3_f32 v54, v54, v230, v231
v_max3_f32 v55, v55, v232, v233
v_max3_f32 v55, v55, v234, v235
v_max3_f32 v52, v52, v236, v237
v_max3_f32 v52, v52, v238, v239
v_max3_f32 v53, v53, v240, v241
v_max3_f32 v53, v53, v242, v243
v_max3_f32 v54, v54, v244, v245
v_max3_f32 v54, v54, v246, v247
v_max3_f32 v55, v55, v248, v249
v_max3_f32 v55, v55, v250, v251
MF a[4:7], a[148:151], v[124:127], 0
TR a[146:147], v17, 6144
v_max3_f32 v56, v52, v53, v54
v_max_f32 v56, v56, v55
MF a[36:39], a[148:151], v[128:131], 0
v_cmp_lt_f32 vcc, s58, v56
MF a[68:71], a[148:151], v[132:135], 0
s_cbranch_vccnz ka_kernel_slow13
ka_kernel_back14:
MF a[100:103], a[148:151], v[136:139], 0
TR a[148:149], v18, 4096
MF a[8:11], a[152:155], v[124:127], 0
TR a[150:151], v18, 6144
MF a[40:43], a[152:155], v[128:131], 0
v_exp_f32 v157, v157
MF a[72:75], a[152:155], v[132:135], 0
v_exp_f32 v158, v158
MF a[104:107], a[152:155], v[136:139], 0
TR a[152:153], v19, 4096
v_cvt_pk_bf16_f32 v156, v156, v157
MF a[12:15], a[156:159], v[124:127], 0
TR a[154:155], v19, 6144
s_add_u32 s56, s56, 36864
MF a[44:47], a[156:159], v[128:131], 0
v_exp_f32 v159, v159
MF a[76:79], a[156:159], v[132:135], 0
v_exp_f32 v172, v172
MF a[108:111], a[156:159], v[136:139], 0
TR a[156:157], v20, 4096
s_waitcnt lgkmcnt(7)
MF a[16:19], a[160:163], v[124:127], 0
TR a[158:159], v20, 6144
v_cvt_pk_bf16_f32 v157, v158, v159
MF a[48:51], a[160:163], v[128:131], 0
v_exp_f32 v173, v173
MF a[80:83], a[160:163], v[132:135], 0
v_exp_f32 v174, v174
MF a[112:115], a[160:163], v[136:139], 0
TR a[160:161], v17, 12288
v_cvt_pk_bf16_f32 v158, v172, v173
MF a[20:23], a[164:167], v[124:127], 0
TR a[162:163], v17, 14336
buffer_load_dwordx4 a[200:203], v252, s[44:47], s56 offen
MF a[52:55], a[164:167], v[128:131], 0
v_exp_f32 v175, v175
MF a[84:87], a[164:167], v[132:135], 0
v_exp_f32 v160, v160
MF a[116:119], a[164:167], v[136:139], 0
TR a[164:165], v18, 12288
v_cvt_pk_bf16_f32 v159, v174, v175
MF a[24:27], a[168:171], v[124:127], 0
TR a[166:167], v18, 14336
MF a[56:59], a[168:171], v[128:131], 0
v_exp_f32 v161, v161
MF a[88:91], a[168:171], v[132:135], 0
v_exp_f32 v162, v162
MF a[120:123], a[168:171], v[136:139], 0
TR a[168:169], v19, 12288
v_cvt_pk_bf16_f32 v160, v160, v161
MF a[28:31], a[172:175], v[124:127], 0
TR a[170:171], v19, 14336
MF a[60:63], a[172:175], v[128:131], 0
v_exp_f32 v163, v163
MF a[92:95], a[172:175], v[132:135], 0
v_exp_f32 v176, v176
v_exp_f32 v177, v177
v_exp_f32 v178, v178
v_exp_f32 v179, v179
MF a[124:127], a[172:175], v[136:139], 0
TR a[172:173], v20, 12288
v_exp_f32 v164, v164
v_exp_f32 v165, v165
v_exp_f32 v166, v166
v_exp_f32 v167, v167
v_exp_f32 v180, v180
v_exp_f32 v181, v181
v_exp_f32 v182, v182
v_exp_f32 v183, v183
v_cvt_pk_bf16_f32 v161, v162, v163
v_cvt_pk_bf16_f32 v162, v176, v177
v_cvt_pk_bf16_f32 v163, v178, v179
MF a[128:131], v[48:51], v[156:159], a[128:131]
TR a[174:175], v20, 14336
v_exp_f32 v168, v168
v_exp_f32 v169, v169
v_exp_f32 v170, v170
v_exp_f32 v171, v171
v_exp_f32 v184, v184
v_exp_f32 v185, v185
v_exp_f32 v186, v186
v_exp_f32 v187, v187
v_cvt_pk_bf16_f32 v164, v164, v165
v_cvt_pk_bf16_f32 v165, v166, v167
v_cvt_pk_bf16_f32 v166, v180, v181
v_cvt_pk_bf16_f32 v167, v182, v183
MF a[132:135], v[48:51], v[160:163], a[132:135]
v_cvt_pk_bf16_f32 v168, v168, v169
v_cvt_pk_bf16_f32 v169, v170, v171
v_cvt_pk_bf16_f32 v170, v184, v185
v_cvt_pk_bf16_f32 v171, v186, v187
MF a[136:139], v[48:51], v[164:167], a[136:139]
s_nop 0
MF a[140:143], v[48:51], v[168:171], a[140:143]
s_waitcnt lgkmcnt(8)
MF a[0:3], a[144:147], v[156:159], a[0:3]
s_waitcnt vmcnt(25)
MF a[32:35], a[144:147], v[160:163], a[32:35]
s_barrier
MF a[64:67], a[144:147], v[164:167], a[64:67]
v_exp_f32 v188, v188
MF a[96:99], a[144:147], v[168:171], a[96:99]
DR a[144:145], v25, 16384
s_add_u32 m0, s38, 49152
MF a[4:7], a[148:151], v[156:159], a[4:7]
DR a[146:147], v26, 16384
global_load_lds_dwordx4 v5, s[12:13]
MF a[36:39], a[148:151], v[160:163], a[36:39]
v_exp_f32 v189, v189
MF a[68:71], a[148:151], v[164:167], a[68:71]
v_exp_f32 v190, v190
MF a[100:103], a[148:151], v[168:171], a[100:103]
DR a[148:149], v27, 16384
v_cvt_pk_bf16_f32 v188, v188, v189
MF a[8:11], a[152:155], v[156:159], a[8:11]
DR a[150:151], v28, 16384
MF a[40:43], a[152:155], v[160:163], a[40:43]
v_exp_f32 v191, v191
MF a[72:75], a[152:155], v[164:167], a[72:75]
v_exp_f32 v204, v204
MF a[104:107], a[152:155], v[168:171], a[104:107]
DR a[152:153], v25, 24576
global_load_lds_dwordx4 v6, s[12:13] offset:1024
MF a[12:15], a[156:159], v[156:159], a[12:15]
DR a[154:155], v26, 24576
v_cvt_pk_bf16_f32 v189, v190, v191
MF a[44:47], a[156:159], v[160:163], a[44:47]
v_exp_f32 v205, v205
MF a[76:79], a[156:159], v[164:167], a[76:79]
v_exp_f32 v206, v206
MF a[108:111], a[156:159], v[168:171], a[108:111]
DR a[156:157], v27, 24576
s_waitcnt lgkmcnt(7)
MF a[16:19], a[160:163], v[156:159], a[16:19]
DR a[158:159], v28, 24576
v_cvt_pk_bf16_f32 v190, v204, v205
MF a[48:51], a[160:163], v[160:163], a[48:51]
v_exp_f32 v207, v207
MF a[80:83], a[160:163], v[164:167], a[80:83]
v_exp_f32 v192, v192
MF a[112:115], a[160:163], v[168:171], a[112:115]
DR a[160:161], v25, 18432
global_load_lds_dwordx4 v7, s[12:13] offset:2048
MF a[20:23], a[164:167], v[156:159], a[20:23]
DR a[162:163], v26, 18432
v_cvt_pk_bf16_f32 v191, v206, v207
MF a[52:55], a[164:167], v[160:163], a[52:55]
v_exp_f32 v193, v193
MF a[84:87], a[164:167], v[164:167], a[84:87]
v_exp_f32 v194, v194
MF a[116:119], a[164:167], v[168:171], a[116:119]
DR a[164:165], v27, 18432
v_cvt_pk_bf16_f32 v192, v192, v193
MF a[24:27], a[168:171], v[156:159], a[24:27]
DR a[166:167], v28, 18432
buffer_load_dwordx4 a[200:203], v252, s[48:51], s56 offen
MF a[56:59], a[168:171], v[160:163], a[56:59]
v_exp_f32 v195, v195
MF a[88:91], a[168:171], v[164:167], a[88:91]
v_exp_f32 v208, v208
MF a[120:123], a[168:171], v[168:171], a[120:123]
DR a[168:169], v25, 26624
global_load_lds_dwordx4 v8, s[12:13] offset:3072
MF a[28:31], a[172:175], v[156:159], a[28:31]
DR a[170:171], v26, 26624
s_add_u32 s12, s12, 16384
s_addc_u32 s13, s13, 0
MF a[60:63], a[172:175], v[160:163], a[60:63]
v_exp_f32 v209, v209
MF a[92:95], a[172:175], v[164:167], a[92:95]
v_exp_f32 v210, v210
MF a[124:127], a[172:175], v[168:171], a[124:127]
DR a[172:173], v27, 26624
s_waitcnt lgkmcnt(7)
MF v[124:127], a[144:147], v[60:63], v[32:35]
DR a[174:175], v28, 26624
v_cvt_pk_bf16_f32 v193, v194, v195
MF v[124:127], a[148:151], v[64:67], v[124:127]
v_exp_f32 v211, v211
MF v[124:127], a[152:155], v[68:71], v[124:127]
v_exp_f32 v196, v196
MF v[124:127], a[156:159], v[72:75], v[124:127]
v_exp_f32 v197, v197
MF v[128:131], a[144:147], v[76:79], v[36:39]
v_exp_f32 v198, v198
MF v[128:131], a[148:151], v[80:83], v[128:131]
v_exp_f32 v199, v199
MF v[128:131], a[152:155], v[84:87], v[128:131]
v_exp_f32 v212, v212
MF v[128:131], a[156:159], v[88:91], v[128:131]
v_exp_f32 v213, v213
MF v[132:135], a[144:147], v[92:95], v[40:43]
v_exp_f32 v214, v214
MF v[132:135], a[148:151], v[96:99], v[132:135]
v_exp_f32 v215, v215
MF v[132:135], a[152:155], v[100:103], v[132:135]
v_exp_f32 v200, v200
MF v[132:135], a[156:159], v[104:107], v[132:135]
v_exp_f32 v201, v201
MF v[136:139], a[144:147], v[108:111], v[44:47]
DR a[144:145], v25, 20480
v_cvt_pk_bf16_f32 v194, v208, v209
MF v[136:139], a[148:151], v[112:115], v[136:139]
DR a[146:147], v26, 20480
v_cvt_pk_bf16_f32 v195, v210, v211
MF v[136:139], a[152:155], v[116:119], v[136:139]
DR a[148:149], v27, 20480
v_cvt_pk_bf16_f32 v196, v196, v197
MF v[136:139], a[156:159], v[120:123], v[136:139]
DR a[150:151], v28, 20480
s_waitcnt lgkmcnt(4)
MF v[140:143], a[160:163], v[60:63], v[32:35]
DR a[152:153], v25, 28672
v_cvt_pk_bf16_f32 v197, v198, v199
MF v[140:143], a[164:167], v[64:67], v[140:143]
DR a[154:155], v26, 28672
v_cvt_pk_bf16_f32 v198, v212, v213
MF v[140:143], a[168:171], v[68:71], v[140:143]
DR a[156:157], v27, 28672
v_cvt_pk_bf16_f32 v199, v214, v215
MF v[140:143], a[172:175], v[72:75], v[140:143]
DR a[158:159], v28, 28672
v_cvt_pk_bf16_f32 v200, v200, v201
MF v[144:147], a[160:163], v[76:79], v[36:39]
v_exp_f32 v202, v202
MF v[144:147], a[164:167], v[80:83], v[144:147]
v_exp_f32 v203, v203
MF v[144:147], a[168:171], v[84:87], v[144:147]
v_exp_f32 v216, v216
MF v[144:147], a[172:175], v[88:91], v[144:147]
v_exp_f32 v217, v217
MF v[148:151], a[160:163], v[92:95], v[40:43]
v_exp_f32 v218, v218
MF v[148:151], a[164:167], v[96:99], v[148:151]
v_exp_f32 v219, v219
MF v[148:151], a[168:171], v[100:103], v[148:151]
v_exp_f32 v220, v220
MF v[148:151], a[172:175], v[104:107], v[148:151]
v_exp_f32 v221, v221
MF v[152:155], a[160:163], v[108:111], v[44:47]
DR a[160:161], v25, 22528
v_cvt_pk_bf16_f32 v201, v202, v203
MF v[152:155], a[164:167], v[112:115], v[152:155]
DR a[162:163], v26, 22528
v_cvt_pk_bf16_f32 v202, v216, v217
MF v[152:155], a[168:171], v[116:119], v[152:155]
DR a[164:165], v27, 22528
v_cvt_pk_bf16_f32 v203, v218, v219
MF v[152:155], a[172:175], v[120:123], v[152:155]
DR a[166:167], v28, 22528
s_waitcnt lgkmcnt(4)
MF v[156:159], a[144:147], v[60:63], v[32:35]
DR a[168:169], v25, 30720
v_cvt_pk_bf16_f32 v220, v220, v221
MF v[156:159], a[148:151], v[64:67], v[156:159]
DR a[170:171], v26, 30720
v_max3_f32 v52, v124, v125, v126
MF v[156:159], a[152:155], v[68:71], v[156:159]
DR a[172:173], v27, 30720
s_add_u32 s56, s56, 36864
buffer_load_dwordx4 a[200:203], v252, s[44:47], s56 offen
MF v[156:159], a[156:159], v[72:75], v[156:159]
DR a[174:175], v28, 30720
MF v[160:163], a[144:147], v[76:79], v[36:39]
v_exp_f32 v222, v222
MF v[160:163], a[148:151], v[80:83], v[160:163]
v_exp_f32 v223, v223
MF v[160:163], a[152:155], v[84:87], v[160:163]
v_exp_f32 v236, v236
MF v[160:163], a[156:159], v[88:91], v[160:163]
v_exp_f32 v237, v237
MF v[164:167], a[144:147], v[92:95], v[40:43]
v_exp_f32 v238, v238
MF v[164:167], a[148:151], v[96:99], v[164:167]
s_waitcnt vmcnt(27)
v_cvt_pk_bf16_f32 v221, v222, v223
MF v[164:167], a[152:155], v[100:103], v[164:167]
s_barrier
v_cvt_pk_bf16_f32 v222, v236, v237
MF v[164:167], a[156:159], v[104:107], v[164:167]
v_exp_f32 v239, v239
MF v[168:171], a[144:147], v[108:111], v[44:47]
TR a[144:145], v17, 32768
s_add_u32 m0, s38, 65536
MF v[168:171], a[148:151], v[112:115], v[168:171]
TR a[146:147], v17, 34816
global_load_lds_dwordx4 v5, s[16:17]
MF v[168:171], a[152:155], v[116:119], v[168:171]
TR a[148:149], v18, 32768
v_cvt_pk_bf16_f32 v223, v238, v239
MF v[168:171], a[156:159], v[120:123], v[168:171]
TR a[150:151], v18, 34816
s_waitcnt lgkmcnt(4)
MF v[172:175], a[160:163], v[60:63], v[32:35]
TR a[152:153], v19, 32768
v_max_f32 v52, v52, v127
MF v[172:175], a[164:167], v[64:67], v[172:175]
TR a[154:155], v19, 34816
v_max3_f32 v53, v128, v129, v130
MF v[172:175], a[168:171], v[68:71], v[172:175]
TR a[156:157], v20, 32768
v_max_f32 v53, v53, v131
MF v[172:175], a[172:175], v[72:75], v[172:175]
TR a[158:159], v20, 34816
v_max3_f32 v54, v132, v133, v134
MF v[176:179], a[160:163], v[76:79], v[36:39]
global_load_lds_dwordx4 v6, s[16:17] offset:1024
v_max_f32 v54, v54, v135
MF v[176:179], a[164:167], v[80:83], v[176:179]
v_exp_f32 v224, v224
MF v[176:179], a[168:171], v[84:87], v[176:179]
v_exp_f32 v225, v225
MF v[176:179], a[172:175], v[88:91], v[176:179]
v_exp_f32 v226, v226
MF v[180:183], a[160:163], v[92:95], v[40:43]
v_exp_f32 v227, v227
MF v[180:183], a[164:167], v[96:99], v[180:183]
v_exp_f32 v240, v240
MF v[180:183], a[168:171], v[100:103], v[180:183]
v_exp_f32 v241, v241
MF v[180:183], a[172:175], v[104:107], v[180:183]
v_exp_f32 v242, v242
MF v[184:187], a[160:163], v[108:111], v[44:47]
TR a[160:161], v17, 40960
global_load_lds_dwordx4 v7, s[16:17] offset:2048
MF v[184:187], a[164:167], v[112:115], v[184:187]
TR a[162:163], v17, 43008
v_cvt_pk_bf16_f32 v224, v224, v225
MF v[184:187], a[168:171], v[116:119], v[184:187]
TR a[164:165], v18, 40960
v_cvt_pk_bf16_f32 v225, v226, v227
MF v[184:187], a[172:175], v[120:123], v[184:187]
TR a[166:167], v18, 43008
v_cvt_pk_bf16_f32 v226, v240, v241
MF a[128:131], v[48:51], v[188:191], a[128:131]
TR a[168:169], v19, 40960
v_max3_f32 v55, v136, v137, v138
MF a[132:135], v[48:51], v[192:195], a[132:135]
TR a[170:171], v19, 43008
v_max_f32 v55, v55, v139
MF a[136:139], v[48:51], v[196:199], a[136:139]
TR a[172:173], v20, 40960
v_max3_f32 v52, v52, v140, v141
MF a[140:143], v[48:51], v[200:203], a[140:143]
TR a[174:175], v20, 43008
s_waitcnt lgkmcnt(8)
MF a[0:3], a[144:147], v[188:191], a[0:3]
global_load_lds_dwordx4 v8, s[16:17] offset:3072
s_add_u32 s16, s16, 16384
s_addc_u32 s17, s17, 0
MF a[32:35], a[144:147], v[192:195], a[32:35]
buffer_load_dwordx4 a[200:203], v252, s[48:51], s56 offen
v_max3_f32 v52, v52, v142, v143
MF a[64:67], a[144:147], v[196:199], a[64:67]
v_exp_f32 v243, v243
MF a[96:99], a[144:147], v[200:203], a[96:99]
TR a[144:145], v17, 36864
v_max3_f32 v53, v53, v144, v145
v_max3_f32 v53, v53, v146, v147
v_max3_f32 v54, v54, v148, v149
v_max3_f32 v54, v54, v150, v151
v_max3_f32 v55, v55, v152, v153
v_max3_f32 v55, v55, v154, v155
v_max3_f32 v52, v52, v156, v157
v_max3_f32 v52, v52, v158, v159
v_max3_f32 v53, v53, v160, v161
v_max3_f32 v53, v53, v162, v163
v_max3_f32 v54, v54, v164, v165
v_max3_f32 v54, v54, v166, v167
v_max3_f32 v55, v55, v168, v169
v_max3_f32 v55, v55, v170, v171
v_max3_f32 v52, v52, v172, v173
v_max3_f32 v52, v52, v174, v175
v_max3_f32 v53, v53, v176, v177
v_max3_f32 v53, v53, v178, v179
v_max3_f32 v54, v54, v180, v181
v_max3_f32 v54, v54, v182, v183
v_max3_f32 v55, v55, v184, v185
v_max3_f32 v55, v55, v186, v187
MF a[4:7], a[148:151], v[188:191], a[4:7]
TR a[146:147], v17, 38912
v_max3_f32 v56, v52, v53, v54
v_max_f32 v56, v56, v55
MF a[36:39], a[148:151], v[192:195], a[36:39]
v_cmp_lt_f32 vcc, s58, v56
MF a[68:71], a[148:151], v[196:199], a[68:71]
s_cbranch_vccnz ka_kernel_slow15
ka_kernel_back16:
MF a[100:103], a[148:151], v[200:203], a[100:103]
TR a[148:149], v18, 36864
v_cvt_pk_bf16_f32 v227, v242, v243
MF a[8:11], a[152:155], v[188:191], a[8:11]
TR a[150:151], v18, 38912
s_getpc_b64 s[4:5]
ka_kernel_pc28:
s_add_u32 s4, s4, ka_kernel-ka_kernel_pc28
s_addc_u32 s5, s5, (ka_kernel-ka_kernel_pc28)>>32
MF a[40:43], a[152:155], v[192:195], a[40:43]
v_exp_f32 v228, v228
MF a[72:75], a[152:155], v[196:199], a[72:75]
v_exp_f32 v229, v229
MF a[104:107], a[152:155], v[200:203], a[104:107]
TR a[152:153], v19, 36864
v_cvt_pk_bf16_f32 v228, v228, v229
MF a[12:15], a[156:159], v[188:191], a[12:15]
TR a[154:155], v19, 38912
s_mov_b32 s6, ka_kernel_done1-ka_kernel
s_mov_b32 s7, 0x00020000
s_lshr_b32 s43, s2, 3
s_mul_i32 s43, s43, 2048
buffer_load_dwordx4 a[200:203], v29, s[4:7], s43 offen
buffer_load_dwordx4 a[200:203], v29, s[4:7], s43 offen offset:1024
MF a[44:47], a[156:159], v[192:195], a[44:47]
MF a[76:79], a[156:159], v[196:199], a[76:79]
v_exp_f32 v230, v230
MF a[108:111], a[156:159], v[200:203], a[108:111]
TR a[156:157], v20, 36864
s_waitcnt lgkmcnt(7)
MF a[16:19], a[160:163], v[188:191], a[16:19]
TR a[158:159], v20, 38912
s_add_u32 s56, s56, 36864
MF a[48:51], a[160:163], v[192:195], a[48:51]
v_exp_f32 v231, v231
MF a[80:83], a[160:163], v[196:199], a[80:83]
v_exp_f32 v244, v244
MF a[112:115], a[160:163], v[200:203], a[112:115]
TR a[160:161], v17, 45056
v_cvt_pk_bf16_f32 v229, v230, v231
MF a[20:23], a[164:167], v[188:191], a[20:23]
TR a[162:163], v17, 47104
buffer_load_dwordx4 a[200:203], v252, s[44:47], s56 offen
MF a[52:55], a[164:167], v[192:195], a[52:55]
v_exp_f32 v245, v245
MF a[84:87], a[164:167], v[196:199], a[84:87]
v_exp_f32 v246, v246
MF a[116:119], a[164:167], v[200:203], a[116:119]
TR a[164:165], v18, 45056
v_cvt_pk_bf16_f32 v230, v244, v245
MF a[24:27], a[168:171], v[188:191], a[24:27]
TR a[166:167], v18, 47104
MF a[56:59], a[168:171], v[192:195], a[56:59]
v_exp_f32 v247, v247
MF a[88:91], a[168:171], v[196:199], a[88:91]
v_exp_f32 v232, v232
MF a[120:123], a[168:171], v[200:203], a[120:123]
TR a[168:169], v19, 45056
v_cvt_pk_bf16_f32 v231, v246, v247
MF a[28:31], a[172:175], v[188:191], a[28:31]
TR a[170:171], v19, 47104
MF a[60:63], a[172:175], v[192:195], a[60:63]
v_exp_f32 v233, v233
MF a[92:95], a[172:175], v[196:199], a[92:95]
v_exp_f32 v234, v234
MF a[124:127], a[172:175], v[200:203], a[124:127]
TR a[172:173], v20, 45056
v_cvt_pk_bf16_f32 v232, v232, v233
MF a[128:131], v[48:51], v[220:223], a[128:131]
TR a[174:175], v20, 47104
v_exp_f32 v235, v235
v_exp_f32 v248, v248
v_exp_f32 v249, v249
v_exp_f32 v250, v250
v_exp_f32 v251, v251
MF a[132:135], v[48:51], v[224:227], a[132:135]
v_cvt_pk_bf16_f32 v233, v234, v235
v_cvt_pk_bf16_f32 v234, v248, v249
v_cvt_pk_bf16_f32 v235, v250, v251
MF a[136:139], v[48:51], v[228:231], a[136:139]
s_nop 0
MF a[140:143], v[48:51], v[232:235], a[140:143]
s_waitcnt lgkmcnt(8)
MF a[0:3], a[144:147], v[220:223], a[0:3]
s_waitcnt vmcnt(31)
MF a[32:35], a[144:147], v[224:227], a[32:35]
s_barrier
MF a[64:67], a[144:147], v[228:231], a[64:67]
v_exp_f32 v124, v124
MF a[96:99], a[144:147], v[232:235], a[96:99]
DR a[144:145], v25, 49152
s_add_u32 m0, s38, 81920
MF a[4:7], a[148:151], v[220:223], a[4:7]
DR a[146:147], v26, 49152
global_load_lds_dwordx4 v5, s[12:13]
MF a[36:39], a[148:151], v[224:227], a[36:39]
v_exp_f32 v125, v125
MF a[68:71], a[148:151], v[228:231], a[68:71]
v_exp_f32 v126, v126
MF a[100:103], a[148:151], v[232:235], a[100:103]
DR a[148:149], v27, 49152
v_cvt_pk_bf16_f32 v124, v124, v125
MF a[8:11], a[152:155], v[220:223], a[8:11]
DR a[150:151], v28, 49152
MF a[40:43], a[152:155], v[224:227], a[40:43]
v_exp_f32 v127, v127
MF a[72:75], a[152:155], v[228:231], a[72:75]
v_exp_f32 v140, v140
MF a[104:107], a[152:155], v[232:235], a[104:107]
DR a[152:153], v25, 57344
global_load_lds_dwordx4 v6, s[12:13] offset:1024
MF a[12:15], a[156:159], v[220:223], a[12:15]
DR a[154:155], v26, 57344
v_cvt_pk_bf16_f32 v125, v126, v127
MF a[44:47], a[156:159], v[224:227], a[44:47]
v_exp_f32 v141, v141
MF a[76:79], a[156:159], v[228:231], a[76:79]
v_exp_f32 v142, v142
MF a[108:111], a[156:159], v[232:235], a[108:111]
DR a[156:157], v27, 57344
s_waitcnt lgkmcnt(7)
MF a[16:19], a[160:163], v[220:223], a[16:19]
DR a[158:159], v28, 57344
v_cvt_pk_bf16_f32 v126, v140, v141
MF a[48:51], a[160:163], v[224:227], a[48:51]
v_exp_f32 v143, v143
MF a[80:83], a[160:163], v[228:231], a[80:83]
v_exp_f32 v128, v128
MF a[112:115], a[160:163], v[232:235], a[112:115]
DR a[160:161], v25, 51200
global_load_lds_dwordx4 v7, s[12:13] offset:2048
MF a[20:23], a[164:167], v[220:223], a[20:23]
DR a[162:163], v26, 51200
v_cvt_pk_bf16_f32 v127, v142, v143
MF a[52:55], a[164:167], v[224:227], a[52:55]
v_exp_f32 v129, v129
MF a[84:87], a[164:167], v[228:231], a[84:87]
v_exp_f32 v130, v130
MF a[116:119], a[164:167], v[232:235], a[116:119]
DR a[164:165], v27, 51200
v_cvt_pk_bf16_f32 v128, v128, v129
MF a[24:27], a[168:171], v[220:223], a[24:27]
DR a[166:167], v28, 51200
buffer_load_dwordx4 a[200:203], v252, s[48:51], s56 offen
MF a[56:59], a[168:171], v[224:227], a[56:59]
v_exp_f32 v131, v131
MF a[88:91], a[168:171], v[228:231], a[88:91]
v_exp_f32 v144, v144
MF a[120:123], a[168:171], v[232:235], a[120:123]
DR a[168:169], v25, 59392
global_load_lds_dwordx4 v8, s[12:13] offset:3072
MF a[28:31], a[172:175], v[220:223], a[28:31]
DR a[170:171], v26, 59392
s_add_u32 s12, s12, 16384
s_addc_u32 s13, s13, 0
MF a[60:63], a[172:175], v[224:227], a[60:63]
v_exp_f32 v145, v145
MF a[92:95], a[172:175], v[228:231], a[92:95]
v_exp_f32 v146, v146
MF a[124:127], a[172:175], v[232:235], a[124:127]
DR a[172:173], v27, 59392
s_waitcnt lgkmcnt(7)
MF v[188:191], a[144:147], v[60:63], v[32:35]
DR a[174:175], v28, 59392
v_cvt_pk_bf16_f32 v129, v130, v131
MF v[188:191], a[148:151], v[64:67], v[188:191]
v_exp_f32 v147, v147
MF v[188:191], a[152:155], v[68:71], v[188:191]
v_exp_f32 v132, v132
MF v[188:191], a[156:159], v[72:75], v[188:191]
v_exp_f32 v133, v133
MF v[192:195], a[144:147], v[76:79], v[36:39]
v_exp_f32 v134, v134
MF v[192:195], a[148:151], v[80:83], v[192:195]
v_exp_f32 v135, v135
MF v[192:195], a[152:155], v[84:87], v[192:195]
v_exp_f32 v148, v148
MF v[192:195], a[156:159], v[88:91], v[192:195]
v_exp_f32 v149, v149
MF v[196:199], a[144:147], v[92:95], v[40:43]
v_exp_f32 v150, v150
MF v[196:199], a[148:151], v[96:99], v[196:199]
v_exp_f32 v151, v151
MF v[196:199], a[152:155], v[100:103], v[196:199]
v_exp_f32 v136, v136
MF v[196:199], a[156:159], v[104:107], v[196:199]
v_exp_f32 v137, v137
MF v[200:203], a[144:147], v[108:111], v[44:47]
DR a[144:145], v25, 53248
v_cvt_pk_bf16_f32 v130, v144, v145
MF v[200:203], a[148:151], v[112:115], v[200:203]
DR a[146:147], v26, 53248
v_cvt_pk_bf16_f32 v131, v146, v147
MF v[200:203], a[152:155], v[116:119], v[200:203]
DR a[148:149], v27, 53248
v_cvt_pk_bf16_f32 v132, v132, v133
MF v[200:203], a[156:159], v[120:123], v[200:203]
DR a[150:151], v28, 53248
s_waitcnt lgkmcnt(4)
MF v[204:207], a[160:163], v[60:63], v[32:35]
DR a[152:153], v25, 61440
v_cvt_pk_bf16_f32 v133, v134, v135
MF v[204:207], a[164:167], v[64:67], v[204:207]
DR a[154:155], v26, 61440
v_cvt_pk_bf16_f32 v134, v148, v149
MF v[204:207], a[168:171], v[68:71], v[204:207]
DR a[156:157], v27, 61440
v_cvt_pk_bf16_f32 v135, v150, v151
MF v[204:207], a[172:175], v[72:75], v[204:207]
DR a[158:159], v28, 61440
v_cvt_pk_bf16_f32 v136, v136, v137
MF v[208:211], a[160:163], v[76:79], v[36:39]
v_exp_f32 v138, v138
MF v[208:211], a[164:167], v[80:83], v[208:211]
v_exp_f32 v139, v139
MF v[208:211], a[168:171], v[84:87], v[208:211]
v_exp_f32 v152, v152
MF v[208:211], a[172:175], v[88:91], v[208:211]
v_exp_f32 v153, v153
MF v[212:215], a[160:163], v[92:95], v[40:43]
v_exp_f32 v154, v154
MF v[212:215], a[164:167], v[96:99], v[212:215]
v_exp_f32 v155, v155
MF v[212:215], a[168:171], v[100:103], v[212:215]
v_exp_f32 v156, v156
MF v[212:215], a[172:175], v[104:107], v[212:215]
v_exp_f32 v157, v157
MF v[216:219], a[160:163], v[108:111], v[44:47]
DR a[160:161], v25, 55296
v_cvt_pk_bf16_f32 v137, v138, v139
MF v[216:219], a[164:167], v[112:115], v[216:219]
DR a[162:163], v26, 55296
v_cvt_pk_bf16_f32 v138, v152, v153
MF v[216:219], a[168:171], v[116:119], v[216:219]
DR a[164:165], v27, 55296
v_cvt_pk_bf16_f32 v139, v154, v155
MF v[216:219], a[172:175], v[120:123], v[216:219]
DR a[166:167], v28, 55296
s_waitcnt lgkmcnt(4)
MF v[220:223], a[144:147], v[60:63], v[32:35]
DR a[168:169], v25, 63488
v_cvt_pk_bf16_f32 v156, v156, v157
MF v[220:223], a[148:151], v[64:67], v[220:223]
DR a[170:171], v26, 63488
v_max3_f32 v52, v188, v189, v190
MF v[220:223], a[152:155], v[68:71], v[220:223]
DR a[172:173], v27, 63488
v_max_f32 v52, v52, v191
MF v[220:223], a[156:159], v[72:75], v[220:223]
DR a[174:175], v28, 63488
v_max3_f32 v53, v192, v193, v194
MF v[224:227], a[144:147], v[76:79], v[36:39]
v_exp_f32 v158, v158
MF v[224:227], a[148:151], v[80:83], v[224:227]
v_exp_f32 v159, v159
MF v[224:227], a[152:155], v[84:87], v[224:227]
s_add_u32 s56, s56, 36864
buffer_load_dwordx4 a[200:203], v252, s[44:47], s56 offen
MF v[224:227], a[156:159], v[88:91], v[224:227]
v_exp_f32 v172, v172
MF v[228:231], a[144:147], v[92:95], v[40:43]
v_exp_f32 v173, v173
MF v[228:231], a[148:151], v[96:99], v[228:231]
s_waitcnt vmcnt(33)
v_cvt_pk_bf16_f32 v157, v158, v159
MF v[228:231], a[152:155], v[100:103], v[228:231]
s_barrier
v_cvt_pk_bf16_f32 v158, v172, v173
MF v[228:231], a[156:159], v[104:107], v[228:231]
v_exp_f32 v174, v174
MF v[232:235], a[144:147], v[108:111], v[44:47]
TR a[144:145], v13, 0
s_add_u32 m0, s38, 98304
MF v[232:235], a[148:151], v[112:115], v[232:235]
TR a[146:147], v13, 2048
global_load_lds_dwordx4 v5, s[16:17]
MF v[232:235], a[152:155], v[116:119], v[232:235]
TR a[148:149], v14, 0
v_max_f32 v53, v53, v195
MF v[232:235], a[156:159], v[120:123], v[232:235]
TR a[150:151], v14, 2048
s_waitcnt lgkmcnt(4)
MF v[236:239], a[160:163], v[60:63], v[32:35]
TR a[152:153], v15, 0
v_max3_f32 v54, v196, v197, v198
MF v[236:239], a[164:167], v[64:67], v[236:239]
TR a[154:155], v15, 2048
v_max_f32 v54, v54, v199
MF v[236:239], a[168:171], v[68:71], v[236:239]
TR a[156:157], v16, 0
v_max3_f32 v55, v200, v201, v202
MF v[236:239], a[172:175], v[72:75], v[236:239]
TR a[158:159], v16, 2048
v_max_f32 v55, v55, v203
MF v[240:243], a[160:163], v[76:79], v[36:39]
global_load_lds_dwordx4 v6, s[16:17] offset:1024
v_max3_f32 v52, v52, v204, v205
MF v[240:243], a[164:167], v[80:83], v[240:243]
v_exp_f32 v175, v175
MF v[240:243], a[168:171], v[84:87], v[240:243]
v_exp_f32 v160, v160
MF v[240:243], a[172:175], v[88:91], v[240:243]
v_exp_f32 v161, v161
MF v[244:247], a[160:163], v[92:95], v[40:43]
v_exp_f32 v162, v162
MF v[244:247], a[164:167], v[96:99], v[244:247]
v_exp_f32 v163, v163
MF v[244:247], a[168:171], v[100:103], v[244:247]
v_exp_f32 v176, v176
MF v[244:247], a[172:175], v[104:107], v[244:247]
v_exp_f32 v177, v177
MF v[248:251], a[160:163], v[108:111], v[44:47]
TR a[160:161], v13, 8192
global_load_lds_dwordx4 v7, s[16:17] offset:2048
MF v[248:251], a[164:167], v[112:115], v[248:251]
TR a[162:163], v13, 10240
v_cvt_pk_bf16_f32 v159, v174, v175
MF v[248:251], a[168:171], v[116:119], v[248:251]
TR a[164:165], v14, 8192
v_cvt_pk_bf16_f32 v160, v160, v161
MF v[248:251], a[172:175], v[120:123], v[248:251]
TR a[166:167], v14, 10240
v_cvt_pk_bf16_f32 v161, v162, v163
MF a[128:131], v[48:51], v[124:127], a[128:131]
TR a[168:169], v15, 8192
v_cvt_pk_bf16_f32 v162, v176, v177
MF a[132:135], v[48:51], v[128:131], a[132:135]
TR a[170:171], v15, 10240
v_max3_f32 v52, v52, v206, v207
MF a[136:139], v[48:51], v[132:135], a[136:139]
TR a[172:173], v16, 8192
v_max3_f32 v53, v53, v208, v209
MF a[140:143], v[48:51], v[136:139], a[140:143]
TR a[174:175], v16, 10240
s_waitcnt lgkmcnt(8)
MF a[0:3], a[144:147], v[124:127], a[0:3]
global_load_lds_dwordx4 v8, s[16:17] offset:3072
s_add_u32 s16, s16, 16384
s_addc_u32 s17, s17, 0
MF a[32:35], a[144:147], v[128:131], a[32:35]
v_exp_f32 v178, v178
MF a[64:67], a[144:147], v[132:135], a[64:67]
v_exp_f32 v179, v179
MF a[96:99], a[144:147], v[136:139], a[96:99]
TR a[144:145], v13, 4096
v_max3_f32 v53, v53, v210, v211
v_max3_f32 v54, v54, v212, v213
v_max3_f32 v54, v54, v214, v215
v_max3_f32 v55, v55, v216, v217
v_max3_f32 v55, v55, v218, v219
v_max3_f32 v52, v52, v220, v221
v_max3_f32 v52, v52, v222, v223
v_max3_f32 v53, v53, v224, v225
v_max3_f32 v53, v53, v226, v227
v_max3_f32 v54, v54, v228, v229
v_max3_f32 v54, v54, v230, v231
v_max3_f32 v55, v55, v232, v233
v_max3_f32 v55, v55, v234, v235
v_max3_f32 v52, v52, v236, v237
v_max3_f32 v52, v52, v238, v239
v_max3_f32 v53, v53, v240, v241
v_max3_f32 v53, v53, v242, v243
v_max3_f32 v54, v54, v244, v245
v_max3_f32 v54, v54, v246, v247
v_max3_f32 v55, v55, v248, v249
v_max3_f32 v55, v55, v250, v251
MF a[4:7], a[148:151], v[124:127], a[4:7]
TR a[146:147], v13, 6144
v_max3_f32 v56, v52, v53, v54
v_max_f32 v56, v56, v55
MF a[36:39], a[148:151], v[128:131], a[36:39]
v_cmp_lt_f32 vcc, s58, v56
buffer_load_dwordx4 a[200:203], v252, s[48:51], s56 offen
MF a[68:71], a[148:151], v[132:135], a[68:71]
s_cbranch_vccnz ka_kernel_slow17
ka_kernel_back18:
MF a[100:103], a[148:151], v[136:139], a[100:103]
TR a[148:149], v14, 4096
MF a[8:11], a[152:155], v[124:127], a[8:11]
TR a[150:151], v14, 6144
v_cvt_pk_bf16_f32 v163, v178, v179
MF a[40:43], a[152:155], v[128:131], a[40:43]
v_exp_f32 v164, v164
MF a[72:75], a[152:155], v[132:135], a[72:75]
v_exp_f32 v165, v165
MF a[104:107], a[152:155], v[136:139], a[104:107]
TR a[152:153], v15, 4096
v_cvt_pk_bf16_f32 v164, v164, v165
MF a[12:15], a[156:159], v[124:127], a[12:15]
TR a[154:155], v15, 6144
MF a[44:47], a[156:159], v[128:131], a[44:47]
v_exp_f32 v166, v166
MF a[76:79], a[156:159], v[132:135], a[76:79]
v_exp_f32 v167, v167
MF a[108:111], a[156:159], v[136:139], a[108:111]
TR a[156:157], v16, 4096
s_waitcnt lgkmcnt(7)
MF a[16:19], a[160:163], v[124:127], a[16:19]
TR a[158:159], v16, 6144
v_cvt_pk_bf16_f32 v165, v166, v167
MF a[48:51], a[160:163], v[128:131], a[48:51]
v_exp_f32 v180, v180
MF a[80:83], a[160:163], v[132:135], a[80:83]
v_exp_f32 v181, v181
MF a[112:115], a[160:163], v[136:139], a[112:115]
TR a[160:161], v13, 12288
v_cvt_pk_bf16_f32 v166, v180, v181
MF a[20:23], a[164:167], v[124:127], a[20:23]
TR a[162:163], v13, 14336
s_add_u32 s56, s56, 36864
MF a[52:55], a[164:167], v[128:131], a[52:55]
v_exp_f32 v182, v182
MF a[84:87], a[164:167], v[132:135], a[84:87]
v_exp_f32 v183, v183
MF a[116:119], a[164:167], v[136:139], a[116:119]
TR a[164:165], v14, 12288
v_cvt_pk_bf16_f32 v167, v182, v183
MF a[24:27], a[168:171], v[124:127], a[24:27]
TR a[166:167], v14, 14336
buffer_load_dwordx4 a[200:203], v252, s[44:47], s56 offen
MF a[56:59], a[168:171], v[128:131], a[56:59]
v_exp_f32 v168, v168
MF a[88:91], a[168:171], v[132:135], a[88:91]
v_exp_f32 v169, v169
MF a[120:123], a[168:171], v[136:139], a[120:123]
TR a[168:169], v15, 12288
v_cvt_pk_bf16_f32 v168, v168, v169
MF a[28:31], a[172:175], v[124:127], a[28:31]
TR a[170:171], v15, 14336
MF a[60:63], a[172:175], v[128:131], a[60:63]
v_exp_f32 v170, v170
MF a[92:95], a[172:175], v[132:135], a[92:95]
v_exp_f32 v171, v171
MF a[124:127], a[172:175], v[136:139], a[124:127]
TR a[172:173], v16, 12288
v_cvt_pk_bf16_f32 v169, v170, v171
MF a[128:131], v[48:51], v[156:159], a[128:131]
TR a[174:175], v16, 14336
v_exp_f32 v184, v184
v_exp_f32 v185, v185
v_exp_f32 v186, v186
v_exp_f32 v187, v187
MF a[132:135], v[48:51], v[160:163], a[132:135]
v_cvt_pk_bf16_f32 v170, v184, v185
v_cvt_pk_bf16_f32 v171, v186, v187
MF a[136:139], v[48:51], v[164:167], a[136:139]
s_nop 0
MF a[140:143], v[48:51], v[168:171], a[140:143]
s_waitcnt lgkmcnt(8)
MF a[0:3], a[144:147], v[156:159], a[0:3]
s_waitcnt vmcnt(33)
MF a[32:35], a[144:147], v[160:163], a[32:35]
s_barrier
MF a[64:67], a[144:147], v[164:167], a[64:67]
v_exp_f32 v188, v188
MF a[96:99], a[144:147], v[168:171], a[96:99]
DR a[144:145], v21, 16384
s_add_u32 m0, s38, 114688
MF a[4:7], a[148:151], v[156:159], a[4:7]
DR a[146:147], v22, 16384
global_load_lds_dwordx4 v5, s[12:13]
MF a[36:39], a[148:151], v[160:163], a[36:39]
v_exp_f32 v189, v189
MF a[68:71], a[148:151], v[164:167], a[68:71]
v_exp_f32 v190, v190
MF a[100:103], a[148:151], v[168:171], a[100:103]
DR a[148:149], v23, 16384
v_cvt_pk_bf16_f32 v188, v188, v189
MF a[8:11], a[152:155], v[156:159], a[8:11]
DR a[150:151], v24, 16384
MF a[40:43], a[152:155], v[160:163], a[40:43]
v_exp_f32 v191, v191
MF a[72:75], a[152:155], v[164:167], a[72:75]
v_exp_f32 v204, v204
MF a[104:107], a[152:155], v[168:171], a[104:107]
DR a[152:153], v21, 24576
global_load_lds_dwordx4 v6, s[12:13] offset:1024
MF a[12:15], a[156:159], v[156:159], a[12:15]
DR a[154:155], v22, 24576
v_cvt_pk_bf16_f32 v189, v190, v191
MF a[44:47], a[156:159], v[160:163], a[44:47]
v_exp_f32 v205, v205
MF a[76:79], a[156:159], v[164:167], a[76:79]
v_exp_f32 v206, v206
MF a[108:111], a[156:159], v[168:171], a[108:111]
DR a[156:157], v23, 24576
s_waitcnt lgkmcnt(7)
MF a[16:19], a[160:163], v[156:159], a[16:19]
DR a[158:159], v24, 24576
v_cvt_pk_bf16_f32 v190, v204, v205
MF a[48:51], a[160:163], v[160:163], a[48:51]
v_exp_f32 v207, v207
MF a[80:83], a[160:163], v[164:167], a[80:83]
v_exp_f32 v192, v192
MF a[112:115], a[160:163], v[168:171], a[112:115]
DR a[160:161], v21, 18432
global_load_lds_dwordx4 v7, s[12:13] offset:2048
MF a[20:23], a[164:167], v[156:159], a[20:23]
DR a[162:163], v22, 18432
v_cvt_pk_bf16_f32 v191, v206, v207
MF a[52:55], a[164:167], v[160:163], a[52:55]
v_exp_f32 v193, v193
MF a[84:87], a[164:167], v[164:167], a[84:87]
v_exp_f32 v194, v194
MF a[116:119], a[164:167], v[168:171], a[116:119]
DR a[164:165], v23, 18432
v_cvt_pk_bf16_f32 v192, v192, v193
MF a[24:27], a[168:171], v[156:159], a[24:27]
DR a[166:167], v24, 18432
buffer_load_dwordx4 a[200:203], v252, s[48:51], s56 offen
MF a[56:59], a[168:171], v[160:163], a[56:59]
v_exp_f32 v195, v195
MF a[88:91], a[168:171], v[164:167], a[88:91]
v_exp_f32 v208, v208
MF a[120:123], a[168:171], v[168:171], a[120:123]
DR a[168:169], v21, 26624
global_load_lds_dwordx4 v8, s[12:13] offset:3072
MF a[28:31], a[172:175], v[156:159], a[28:31]
DR a[170:171], v22, 26624
s_add_u32 s12, s12, 16384
s_addc_u32 s13, s13, 0
MF a[60:63], a[172:175], v[160:163], a[60:63]
v_exp_f32 v209, v209
MF a[92:95], a[172:175], v[164:167], a[92:95]
v_exp_f32 v210, v210
MF a[124:127], a[172:175], v[168:171], a[124:127]
DR a[172:173], v23, 26624
s_waitcnt lgkmcnt(7)
MF v[124:127], a[144:147], v[60:63], v[32:35]
DR a[174:175], v24, 26624
v_cvt_pk_bf16_f32 v193, v194, v195
MF v[124:127], a[148:151], v[64:67], v[124:127]
v_exp_f32 v211, v211
MF v[124:127], a[152:155], v[68:71], v[124:127]
v_exp_f32 v196, v196
MF v[124:127], a[156:159], v[72:75], v[124:127]
v_exp_f32 v197, v197
MF v[128:131], a[144:147], v[76:79], v[36:39]
v_exp_f32 v198, v198
MF v[128:131], a[148:151], v[80:83], v[128:131]
v_exp_f32 v199, v199
MF v[128:131], a[152:155], v[84:87], v[128:131]
v_exp_f32 v212, v212
MF v[128:131], a[156:159], v[88:91], v[128:131]
v_exp_f32 v213, v213
MF v[132:135], a[144:147], v[92:95], v[40:43]
v_exp_f32 v214, v214
MF v[132:135], a[148:151], v[96:99], v[132:135]
v_exp_f32 v215, v215
MF v[132:135], a[152:155], v[100:103], v[132:135]
v_exp_f32 v200, v200
MF v[132:135], a[156:159], v[104:107], v[132:135]
v_exp_f32 v201, v201
MF v[136:139], a[144:147], v[108:111], v[44:47]
DR a[144:145], v21, 20480
v_cvt_pk_bf16_f32 v194, v208, v209
MF v[136:139], a[148:151], v[112:115], v[136:139]
DR a[146:147], v22, 20480
v_cvt_pk_bf16_f32 v195, v210, v211
MF v[136:139], a[152:155], v[116:119], v[136:139]
DR a[148:149], v23, 20480
v_cvt_pk_bf16_f32 v196, v196, v197
MF v[136:139], a[156:159], v[120:123], v[136:139]
DR a[150:151], v24, 20480
s_waitcnt lgkmcnt(4)
MF v[140:143], a[160:163], v[60:63], v[32:35]
DR a[152:153], v21, 28672
v_cvt_pk_bf16_f32 v197, v198, v199
MF v[140:143], a[164:167], v[64:67], v[140:143]
DR a[154:155], v22, 28672
v_cvt_pk_bf16_f32 v198, v212, v213
MF v[140:143], a[168:171], v[68:71], v[140:143]
DR a[156:157], v23, 28672
v_cvt_pk_bf16_f32 v199, v214, v215
MF v[140:143], a[172:175], v[72:75], v[140:143]
DR a[158:159], v24, 28672
v_cvt_pk_bf16_f32 v200, v200, v201
MF v[144:147], a[160:163], v[76:79], v[36:39]
v_exp_f32 v202, v202
MF v[144:147], a[164:167], v[80:83], v[144:147]
v_exp_f32 v203, v203
MF v[144:147], a[168:171], v[84:87], v[144:147]
v_exp_f32 v216, v216
MF v[144:147], a[172:175], v[88:91], v[144:147]
v_exp_f32 v217, v217
MF v[148:151], a[160:163], v[92:95], v[40:43]
v_exp_f32 v218, v218
MF v[148:151], a[164:167], v[96:99], v[148:151]
v_exp_f32 v219, v219
MF v[148:151], a[168:171], v[100:103], v[148:151]
v_exp_f32 v220, v220
MF v[148:151], a[172:175], v[104:107], v[148:151]
v_exp_f32 v221, v221
MF v[152:155], a[160:163], v[108:111], v[44:47]
DR a[160:161], v21, 22528
v_cvt_pk_bf16_f32 v201, v202, v203
MF v[152:155], a[164:167], v[112:115], v[152:155]
DR a[162:163], v22, 22528
v_cvt_pk_bf16_f32 v202, v216, v217
MF v[152:155], a[168:171], v[116:119], v[152:155]
DR a[164:165], v23, 22528
v_cvt_pk_bf16_f32 v203, v218, v219
MF v[152:155], a[172:175], v[120:123], v[152:155]
DR a[166:167], v24, 22528
s_waitcnt lgkmcnt(4)
MF v[156:159], a[144:147], v[60:63], v[32:35]
DR a[168:169], v21, 30720
v_cvt_pk_bf16_f32 v220, v220, v221
MF v[156:159], a[148:151], v[64:67], v[156:159]
DR a[170:171], v22, 30720
v_max3_f32 v52, v124, v125, v126
MF v[156:159], a[152:155], v[68:71], v[156:159]
DR a[172:173], v23, 30720
v_max_f32 v52, v52, v127
MF v[156:159], a[156:159], v[72:75], v[156:159]
DR a[174:175], v24, 30720
v_max3_f32 v53, v128, v129, v130
MF v[160:163], a[144:147], v[76:79], v[36:39]
v_exp_f32 v222, v222
MF v[160:163], a[148:151], v[80:83], v[160:163]
v_exp_f32 v223, v223
MF v[160:163], a[152:155], v[84:87], v[160:163]
buffer_load_dwordx4 a[200:203], v29, s[28:31], s72 offen
v_cvt_pk_bf16_f32 v221, v222, v223
MF v[160:163], a[156:159], v[88:91], v[160:163]
v_exp_f32 v236, v236
MF v[164:167], a[144:147], v[92:95], v[40:43]
v_exp_f32 v237, v237
MF v[164:167], a[148:151], v[96:99], v[164:167]
s_waitcnt vmcnt(33)
v_cvt_pk_bf16_f32 v222, v236, v237
MF v[164:167], a[152:155], v[100:103], v[164:167]
s_add_u32 s56, s56, 36864
buffer_load_dwordx4 a[200:203], v252, s[44:47], s56 offen
MF v[164:167], a[156:159], v[104:107], v[164:167]
s_barrier
v_max_f32 v53, v53, v131
MF v[168:171], a[144:147], v[108:111], v[44:47]
TR a[144:145], v13, 32768
s_add_u32 m0, s38, 0
MF v[168:171], a[148:151], v[112:115], v[168:171]
TR a[146:147], v13, 34816
global_load_lds_dwordx4 v5, s[16:17]
MF v[168:171], a[152:155], v[116:119], v[168:171]
TR a[148:149], v14, 32768
v_max3_f32 v54, v132, v133, v134
MF v[168:171], a[156:159], v[120:123], v[168:171]
TR a[150:151], v14, 34816
s_waitcnt lgkmcnt(4)
MF v[172:175], a[160:163], v[60:63], v[32:35]
TR a[152:153], v15, 32768
v_max_f32 v54, v54, v135
MF v[172:175], a[164:167], v[64:67], v[172:175]
TR a[154:155], v15, 34816
v_max3_f32 v55, v136, v137, v138
MF v[172:175], a[168:171], v[68:71], v[172:175]
TR a[156:157], v16, 32768
v_max_f32 v55, v55, v139
MF v[172:175], a[172:175], v[72:75], v[172:175]
TR a[158:159], v16, 34816
v_max3_f32 v52, v52, v140, v141
MF v[176:179], a[160:163], v[76:79], v[36:39]
global_load_lds_dwordx4 v6, s[16:17] offset:1024
v_max3_f32 v52, v52, v142, v143
MF v[176:179], a[164:167], v[80:83], v[176:179]
v_exp_f32 v238, v238
MF v[176:179], a[168:171], v[84:87], v[176:179]
v_exp_f32 v239, v239
MF v[176:179], a[172:175], v[88:91], v[176:179]
v_exp_f32 v224, v224
MF v[180:183], a[160:163], v[92:95], v[40:43]
v_exp_f32 v225, v225
MF v[180:183], a[164:167], v[96:99], v[180:183]
v_exp_f32 v226, v226
MF v[180:183], a[168:171], v[100:103], v[180:183]
v_exp_f32 v227, v227
MF v[180:183], a[172:175], v[104:107], v[180:183]
v_exp_f32 v240, v240
MF v[184:187], a[160:163], v[108:111], v[44:47]
TR a[160:161], v13, 40960
global_load_lds_dwordx4 v7, s[16:17] offset:2048
MF v[184:187], a[164:167], v[112:115], v[184:187]
TR a[162:163], v13, 43008
v_cvt_pk_bf16_f32 v223, v238, v239
MF v[184:187], a[168:171], v[116:119], v[184:187]
TR a[164:165], v14, 40960
v_cvt_pk_bf16_f32 v224, v224, v225
MF v[184:187], a[172:175], v[120:123], v[184:187]
TR a[166:167], v14, 43008
v_cvt_pk_bf16_f32 v225, v226, v227
MF a[128:131], v[48:51], v[188:191], a[128:131]
TR a[168:169], v15, 40960
v_max3_f32 v53, v53, v144, v145
MF a[132:135], v[48:51], v[192:195], a[132:135]
TR a[170:171], v15, 43008
v_max3_f32 v53, v53, v146, v147
MF a[136:139], v[48:51], v[196:199], a[136:139]
TR a[172:173], v16, 40960
v_max3_f32 v54, v54, v148, v149
MF a[140:143], v[48:51], v[200:203], a[140:143]
TR a[174:175], v16, 43008
s_waitcnt lgkmcnt(8)
MF a[0:3], a[144:147], v[188:191], a[0:3]
global_load_lds_dwordx4 v8, s[16:17] offset:3072
s_add_u32 s16, s16, 16384
s_addc_u32 s17, s17, 0
MF a[32:35], a[144:147], v[192:195], a[32:35]
v_exp_f32 v241, v241
MF a[64:67], a[144:147], v[196:199], a[64:67]
v_exp_f32 v242, v242
MF a[96:99], a[144:147], v[200:203], a[96:99]
TR a[144:145], v13, 36864
v_max3_f32 v54, v54, v150, v151
v_max3_f32 v55, v55, v152, v153
v_max3_f32 v55, v55, v154, v155
v_max3_f32 v52, v52, v156, v157
v_max3_f32 v52, v52, v158, v159
v_max3_f32 v53, v53, v160, v161
v_max3_f32 v53, v53, v162, v163
v_max3_f32 v54, v54, v164, v165
v_max3_f32 v54, v54, v166, v167
v_max3_f32 v55, v55, v168, v169
v_max3_f32 v55, v55, v170, v171
v_max3_f32 v52, v52, v172, v173
v_max3_f32 v52, v52, v174, v175
v_max3_f32 v53, v53, v176, v177
v_max3_f32 v53, v53, v178, v179
v_max3_f32 v54, v54, v180, v181
v_max3_f32 v54, v54, v182, v183
v_max3_f32 v55, v55, v184, v185
v_max3_f32 v55, v55, v186, v187
MF a[4:7], a[148:151], v[188:191], a[4:7]
TR a[146:147], v13, 38912
v_max3_f32 v56, v52, v53, v54
v_max_f32 v56, v56, v55
MF a[36:39], a[148:151], v[192:195], a[36:39]
v_cmp_lt_f32 vcc, s58, v56
MF a[68:71], a[148:151], v[196:199], a[68:71]
s_cbranch_vccnz ka_kernel_slow19
ka_kernel_back20:
buffer_load_dwordx4 a[200:203], v30, s[28:31], s72 offen
MF a[100:103], a[148:151], v[200:203], a[100:103]
TR a[148:149], v14, 36864
MF a[8:11], a[152:155], v[188:191], a[8:11]
TR a[150:151], v14, 38912
v_cvt_pk_bf16_f32 v226, v240, v241
MF a[40:43], a[152:155], v[192:195], a[40:43]
buffer_load_dwordx4 a[200:203], v252, s[48:51], s56 offen
MF a[72:75], a[152:155], v[196:199], a[72:75]
v_exp_f32 v243, v243
MF a[104:107], a[152:155], v[200:203], a[104:107]
TR a[152:153], v15, 36864
v_cvt_pk_bf16_f32 v227, v242, v243
MF a[12:15], a[156:159], v[188:191], a[12:15]
TR a[154:155], v15, 38912
MF a[44:47], a[156:159], v[192:195], a[44:47]
v_exp_f32 v228, v228
MF a[76:79], a[156:159], v[196:199], a[76:79]
v_exp_f32 v229, v229
MF a[108:111], a[156:159], v[200:203], a[108:111]
TR a[156:157], v16, 36864
s_waitcnt lgkmcnt(7)
MF a[16:19], a[160:163], v[188:191], a[16:19]
TR a[158:159], v16, 38912
v_cvt_pk_bf16_f32 v228, v228, v229
MF a[48:51], a[160:163], v[192:195], a[48:51]
v_exp_f32 v230, v230
MF a[80:83], a[160:163], v[196:199], a[80:83]
v_exp_f32 v231, v231
MF a[112:115], a[160:163], v[200:203], a[112:115]
TR a[160:161], v13, 45056
v_cvt_pk_bf16_f32 v229, v230, v231
MF a[20:23], a[164:167], v[188:191], a[20:23]
TR a[162:163], v13, 47104
MF a[52:55], a[164:167], v[192:195], a[52:55]
v_exp_f32 v244, v244
MF a[84:87], a[164:167], v[196:199], a[84:87]
v_exp_f32 v245, v245
MF a[116:119], a[164:167], v[200:203], a[116:119]
TR a[164:165], v14, 45056
v_cvt_pk_bf16_f32 v230, v244, v245
MF a[24:27], a[168:171], v[188:191], a[24:27]
TR a[166:167], v14, 47104
s_add_u32 s56, s56, 36864
MF a[56:59], a[168:171], v[192:195], a[56:59]
v_exp_f32 v246, v246
MF a[88:91], a[168:171], v[196:199], a[88:91]
v_exp_f32 v247, v247
MF a[120:123], a[168:171], v[200:203], a[120:123]
TR a[168:169], v15, 45056
v_cvt_pk_bf16_f32 v231, v246, v247
MF a[28:31], a[172:175], v[188:191], a[28:31]
TR a[170:171], v15, 47104
buffer_load_dwordx4 a[200:203], v252, s[44:47], s56 offen
MF a[60:63], a[172:175], v[192:195], a[60:63]
v_exp_f32 v232, v232
MF a[92:95], a[172:175], v[196:199], a[92:95]
v_exp_f32 v233, v233
MF a[124:127], a[172:175], v[200:203], a[124:127]
TR a[172:173], v16, 45056
v_cvt_pk_bf16_f32 v232, v232, v233
MF a[128:131], v[48:51], v[220:223], a[128:131]
TR a[174:175], v16, 47104
v_exp_f32 v234, v234
v_exp_f32 v235, v235
v_exp_f32 v248, v248
v_exp_f32 v249, v249
v_exp_f32 v250, v250
v_exp_f32 v251, v251
MF a[132:135], v[48:51], v[224:227], a[132:135]
v_cvt_pk_bf16_f32 v233, v234, v235
v_cvt_pk_bf16_f32 v234, v248, v249
v_cvt_pk_bf16_f32 v235, v250, v251
MF a[136:139], v[48:51], v[228:231], a[136:139]
s_nop 0
MF a[140:143], v[48:51], v[232:235], a[140:143]
buffer_load_dwordx4 a[200:203], v29, s[28:31], s72 offen offset:1024
s_waitcnt lgkmcnt(8)
MF a[0:3], a[144:147], v[220:223], a[0:3]
s_waitcnt vmcnt(36)
MF a[32:35], a[144:147], v[224:227], a[32:35]
s_barrier
MF a[64:67], a[144:147], v[228:231], a[64:67]
v_exp_f32 v124, v124
MF a[96:99], a[144:147], v[232:235], a[96:99]
DR a[144:145], v21, 49152
s_add_u32 m0, s38, 16384
MF a[4:7], a[148:151], v[220:223], a[4:7]
DR a[146:147], v22, 49152
global_load_lds_dwordx4 v5, s[16:17]
MF a[36:39], a[148:151], v[224:227], a[36:39]
v_exp_f32 v125, v125
MF a[68:71], a[148:151], v[228:231], a[68:71]
v_exp_f32 v126, v126
MF a[100:103], a[148:151], v[232:235], a[100:103]
DR a[148:149], v23, 49152
v_cvt_pk_bf16_f32 v124, v124, v125
MF a[8:11], a[152:155], v[220:223], a[8:11]
DR a[150:151], v24, 49152
MF a[40:43], a[152:155], v[224:227], a[40:43]
v_exp_f32 v127, v127
MF a[72:75], a[152:155], v[228:231], a[72:75]
v_exp_f32 v140, v140
MF a[104:107], a[152:155], v[232:235], a[104:107]
DR a[152:153], v21, 57344
global_load_lds_dwordx4 v6, s[16:17] offset:1024
MF a[12:15], a[156:159], v[220:223], a[12:15]
DR a[154:155], v22, 57344
v_cvt_pk_bf16_f32 v125, v126, v127
MF a[44:47], a[156:159], v[224:227], a[44:47]
v_exp_f32 v141, v141
MF a[76:79], a[156:159], v[228:231], a[76:79]
v_exp_f32 v142, v142
MF a[108:111], a[156:159], v[232:235], a[108:111]
DR a[156:157], v23, 57344
s_waitcnt lgkmcnt(7)
MF a[16:19], a[160:163], v[220:223], a[16:19]
DR a[158:159], v24, 57344
v_cvt_pk_bf16_f32 v126, v140, v141
MF a[48:51], a[160:163], v[224:227], a[48:51]
v_exp_f32 v143, v143
MF a[80:83], a[160:163], v[228:231], a[80:83]
v_exp_f32 v128, v128
MF a[112:115], a[160:163], v[232:235], a[112:115]
DR a[160:161], v21, 51200
global_load_lds_dwordx4 v7, s[16:17] offset:2048
MF a[20:23], a[164:167], v[220:223], a[20:23]
DR a[162:163], v22, 51200
v_cvt_pk_bf16_f32 v127, v142, v143
MF a[52:55], a[164:167], v[224:227], a[52:55]
v_exp_f32 v129, v129
MF a[84:87], a[164:167], v[228:231], a[84:87]
v_exp_f32 v130, v130
MF a[116:119], a[164:167], v[232:235], a[116:119]
DR a[164:165], v23, 51200
v_cvt_pk_bf16_f32 v128, v128, v129
MF a[24:27], a[168:171], v[220:223], a[24:27]
DR a[166:167], v24, 51200
buffer_load_dwordx4 a[200:203], v252, s[48:51], s56 offen
MF a[56:59], a[168:171], v[224:227], a[56:59]
v_exp_f32 v131, v131
MF a[88:91], a[168:171], v[228:231], a[88:91]
v_exp_f32 v144, v144
MF a[120:123], a[168:171], v[232:235], a[120:123]
DR a[168:169], v21, 59392
global_load_lds_dwordx4 v8, s[16:17] offset:3072
MF a[28:31], a[172:175], v[220:223], a[28:31]
DR a[170:171], v22, 59392
s_add_u32 s16, s16, 16384
s_addc_u32 s17, s17, 0
MF a[60:63], a[172:175], v[224:227], a[60:63]
v_exp_f32 v145, v145
MF a[92:95], a[172:175], v[228:231], a[92:95]
v_exp_f32 v146, v146
MF a[124:127], a[172:175], v[232:235], a[124:127]
DR a[172:173], v23, 59392
s_waitcnt lgkmcnt(7)
MF v[188:191], a[144:147], v[60:63], v[32:35]
DR a[174:175], v24, 59392
v_cvt_pk_bf16_f32 v129, v130, v131
MF v[188:191], a[148:151], v[64:67], v[188:191]
v_exp_f32 v147, v147
MF v[188:191], a[152:155], v[68:71], v[188:191]
v_exp_f32 v132, v132
MF v[188:191], a[156:159], v[72:75], v[188:191]
v_exp_f32 v133, v133
MF v[192:195], a[144:147], v[76:79], v[36:39]
v_exp_f32 v134, v134
MF v[192:195], a[148:151], v[80:83], v[192:195]
v_exp_f32 v135, v135
MF v[192:195], a[152:155], v[84:87], v[192:195]
v_exp_f32 v148, v148
MF v[192:195], a[156:159], v[88:91], v[192:195]
v_exp_f32 v149, v149
MF v[196:199], a[144:147], v[92:95], v[40:43]
v_exp_f32 v150, v150
MF v[196:199], a[148:151], v[96:99], v[196:199]
v_exp_f32 v151, v151
MF v[196:199], a[152:155], v[100:103], v[196:199]
v_exp_f32 v136, v136
MF v[196:199], a[156:159], v[104:107], v[196:199]
buffer_load_dwordx4 a[200:203], v30, s[28:31], s72 offen offset:1024
v_cvt_pk_bf16_f32 v130, v144, v145
MF v[200:203], a[144:147], v[108:111], v[44:47]
DR a[144:145], v21, 53248
v_cvt_pk_bf16_f32 v131, v146, v147
MF v[200:203], a[148:151], v[112:115], v[200:203]
DR a[146:147], v22, 53248
v_cvt_pk_bf16_f32 v132, v132, v133
MF v[200:203], a[152:155], v[116:119], v[200:203]
DR a[148:149], v23, 53248
v_cvt_pk_bf16_f32 v133, v134, v135
MF v[200:203], a[156:159], v[120:123], v[200:203]
DR a[150:151], v24, 53248
s_waitcnt lgkmcnt(4)
MF v[204:207], a[160:163], v[60:63], v[32:35]
DR a[152:153], v21, 61440
v_cvt_pk_bf16_f32 v134, v148, v149
MF v[204:207], a[164:167], v[64:67], v[204:207]
DR a[154:155], v22, 61440
v_cvt_pk_bf16_f32 v135, v150, v151
MF v[204:207], a[168:171], v[68:71], v[204:207]
DR a[156:157], v23, 61440
v_max3_f32 v52, v188, v189, v190
MF v[204:207], a[172:175], v[72:75], v[204:207]
DR a[158:159], v24, 61440
v_max_f32 v52, v52, v191
MF v[208:211], a[160:163], v[76:79], v[36:39]
v_exp_f32 v137, v137
MF v[208:211], a[164:167], v[80:83], v[208:211]
v_exp_f32 v138, v138
MF v[208:211], a[168:171], v[84:87], v[208:211]
v_exp_f32 v139, v139
MF v[208:211], a[172:175], v[88:91], v[208:211]
v_exp_f32 v152, v152
MF v[212:215], a[160:163], v[92:95], v[40:43]
v_exp_f32 v153, v153
MF v[212:215], a[164:167], v[96:99], v[212:215]
v_exp_f32 v154, v154
MF v[212:215], a[168:171], v[100:103], v[212:215]
v_exp_f32 v155, v155
MF v[212:215], a[172:175], v[104:107], v[212:215]
v_exp_f32 v156, v156
MF v[216:219], a[160:163], v[108:111], v[44:47]
DR a[160:161], v21, 55296
v_cvt_pk_bf16_f32 v136, v136, v137
MF v[216:219], a[164:167], v[112:115], v[216:219]
DR a[162:163], v22, 55296
v_cvt_pk_bf16_f32 v137, v138, v139
MF v[216:219], a[168:171], v[116:119], v[216:219]
DR a[164:165], v23, 55296
v_cvt_pk_bf16_f32 v138, v152, v153
MF v[216:219], a[172:175], v[120:123], v[216:219]
DR a[166:167], v24, 55296
s_waitcnt lgkmcnt(4)
MF v[220:223], a[144:147], v[60:63], v[32:35]
DR a[168:169], v21, 63488
v_cvt_pk_bf16_f32 v139, v154, v155
MF v[220:223], a[148:151], v[64:67], v[220:223]
DR a[170:171], v22, 63488
v_max3_f32 v53, v192, v193, v194
MF v[220:223], a[152:155], v[68:71], v[220:223]
DR a[172:173], v23, 63488
v_max_f32 v53, v53, v195
MF v[220:223], a[156:159], v[72:75], v[220:223]
DR a[174:175], v24, 63488
v_max3_f32 v54, v196, v197, v198
MF v[224:227], a[144:147], v[76:79], v[36:39]
v_exp_f32 v157, v157
MF v[224:227], a[148:151], v[80:83], v[224:227]
v_exp_f32 v158, v158
MF v[224:227], a[152:155], v[84:87], v[224:227]
v_exp_f32 v159, v159
MF v[224:227], a[156:159], v[88:91], v[224:227]
v_exp_f32 v172, v172
MF v[228:231], a[144:147], v[92:95], v[40:43]
v_exp_f32 v173, v173
MF v[228:231], a[148:151], v[96:99], v[228:231]
s_waitcnt vmcnt(37)
v_cvt_pk_bf16_f32 v156, v156, v157
MF v[228:231], a[152:155], v[100:103], v[228:231]
s_barrier
v_cvt_pk_bf16_f32 v157, v158, v159
MF v[228:231], a[156:159], v[104:107], v[228:231]
v_exp_f32 v174, v174
MF v[232:235], a[144:147], v[108:111], v[44:47]
TR a[144:145], v17, 0
s_add_u32 s59, s35, s70
MF v[232:235], a[148:151], v[112:115], v[232:235]
TR a[146:147], v17, 2048
s_add_u32 s10, s20, s59
s_addc_u32 s11, s21, 0
MF v[232:235], a[152:155], v[116:119], v[232:235]
TR a[148:149], v18, 0
s_mov_b32 s44, s54
s_mov_b32 s45, s55
s_mov_b32 s46, 5308416
s_mov_b32 s47, 0x00020000
s_mul_i32 s56, s40, 331776
s_mul_i32 s57, s41, 20736
s_add_u32 s56, s56, s57
s_lshl_b32 s57, s39, 10
s_add_u32 s56, s56, s57
buffer_load_dwordx4 a[200:203], v29, s[44:47], s56 offen
MF v[232:235], a[156:159], v[120:123], v[232:235]
TR a[150:151], v18, 2048
s_waitcnt lgkmcnt(4)
MF v[236:239], a[160:163], v[60:63], v[32:35]
TR a[152:153], v19, 0
buffer_load_dwordx4 a[200:203], v29, s[28:31], s73 offen
MF v[236:239], a[164:167], v[64:67], v[236:239]
TR a[154:155], v19, 2048
MF v[236:239], a[168:171], v[68:71], v[236:239]
TR a[156:157], v20, 0
s_add_u32 m0, s38, 32768
s_nop 0
global_load_lds_dwordx4 v9, s[10:11]
MF v[236:239], a[172:175], v[72:75], v[236:239]
TR a[158:159], v20, 2048
MF v[240:243], a[160:163], v[76:79], v[36:39]
global_load_lds_dwordx4 v10, s[10:11] offset:1024
MF v[240:243], a[164:167], v[80:83], v[240:243]
v_exp_f32 v175, v175
MF v[240:243], a[168:171], v[84:87], v[240:243]
v_exp_f32 v160, v160
MF v[240:243], a[172:175], v[88:91], v[240:243]
v_exp_f32 v161, v161
MF v[244:247], a[160:163], v[92:95], v[40:43]
v_exp_f32 v162, v162
MF v[244:247], a[164:167], v[96:99], v[244:247]
v_exp_f32 v163, v163
MF v[244:247], a[168:171], v[100:103], v[244:247]
v_exp_f32 v176, v176
MF v[244:247], a[172:175], v[104:107], v[244:247]
v_exp_f32 v177, v177
MF v[248:251], a[160:163], v[108:111], v[44:47]
TR a[160:161], v17, 8192
global_load_lds_dwordx4 v11, s[10:11] offset:2048
MF v[248:251], a[164:167], v[112:115], v[248:251]
TR a[162:163], v17, 10240
v_cvt_pk_bf16_f32 v158, v172, v173
MF v[248:251], a[168:171], v[116:119], v[248:251]
TR a[164:165], v18, 8192
v_cvt_pk_bf16_f32 v159, v174, v175
MF v[248:251], a[172:175], v[120:123], v[248:251]
TR a[166:167], v18, 10240
v_cvt_pk_bf16_f32 v160, v160, v161
MF a[128:131], v[48:51], v[124:127], a[128:131]
TR a[168:169], v19, 8192
v_cvt_pk_bf16_f32 v161, v162, v163
MF a[132:135], v[48:51], v[128:131], a[132:135]
TR a[170:171], v19, 10240
v_cvt_pk_bf16_f32 v162, v176, v177
MF a[136:139], v[48:51], v[132:135], a[136:139]
TR a[172:173], v20, 8192
v_max_f32 v54, v54, v199
MF a[140:143], v[48:51], v[136:139], a[140:143]
TR a[174:175], v20, 10240
s_waitcnt lgkmcnt(8)
MF a[0:3], a[144:147], v[124:127], a[0:3]
global_load_lds_dwordx4 v12, s[10:11] offset:3072
v_max3_f32 v55, v200, v201, v202
MF a[32:35], a[144:147], v[128:131], a[32:35]
v_exp_f32 v178, v178
MF a[64:67], a[144:147], v[132:135], a[64:67]
v_exp_f32 v179, v179
MF a[96:99], a[144:147], v[136:139], a[96:99]
TR a[144:145], v17, 4096
v_max_f32 v55, v55, v203
v_max3_f32 v52, v52, v204, v205
v_max3_f32 v52, v52, v206, v207
v_max3_f32 v53, v53, v208, v209
v_max3_f32 v53, v53, v210, v211
v_max3_f32 v54, v54, v212, v213
v_max3_f32 v54, v54, v214, v215
v_max3_f32 v55, v55, v216, v217
v_max3_f32 v55, v55, v218, v219
v_max3_f32 v52, v52, v220, v221
v_max3_f32 v52, v52, v222, v223
v_max3_f32 v53, v53, v224, v225
v_max3_f32 v53, v53, v226, v227
v_max3_f32 v54, v54, v228, v229
v_max3_f32 v54, v54, v230, v231
v_max3_f32 v55, v55, v232, v233
v_max3_f32 v55, v55, v234, v235
v_max3_f32 v52, v52, v236, v237
v_max3_f32 v52, v52, v238, v239
v_max3_f32 v53, v53, v240, v241
v_max3_f32 v53, v53, v242, v243
v_max3_f32 v54, v54, v244, v245
v_max3_f32 v54, v54, v246, v247
v_max3_f32 v55, v55, v248, v249
v_max3_f32 v55, v55, v250, v251
MF a[4:7], a[148:151], v[124:127], a[4:7]
TR a[146:147], v17, 6144
v_max3_f32 v56, v52, v53, v54
v_max_f32 v56, v56, v55
MF a[36:39], a[148:151], v[128:131], a[36:39]
v_cmp_lt_f32 vcc, s58, v56
MF a[68:71], a[148:151], v[132:135], a[68:71]
s_cbranch_vccnz ka_kernel_slow21
ka_kernel_back22:
MF a[100:103], a[148:151], v[136:139], a[100:103]
TR a[148:149], v18, 4096
v_cvt_pk_bf16_f32 v163, v178, v179
MF a[8:11], a[152:155], v[124:127], a[8:11]
TR a[150:151], v18, 6144
s_add_u32 s56, s56, 4096
MF a[40:43], a[152:155], v[128:131], a[40:43]
v_exp_f32 v164, v164
MF a[72:75], a[152:155], v[132:135], a[72:75]
v_exp_f32 v165, v165
MF a[104:107], a[152:155], v[136:139], a[104:107]
TR a[152:153], v19, 4096
v_cvt_pk_bf16_f32 v164, v164, v165
MF a[12:15], a[156:159], v[124:127], a[12:15]
TR a[154:155], v19, 6144
buffer_load_dwordx4 a[200:203], v29, s[44:47], s56 offen
MF a[44:47], a[156:159], v[128:131], a[44:47]
v_exp_f32 v166, v166
MF a[76:79], a[156:159], v[132:135], a[76:79]
v_exp_f32 v167, v167
MF a[108:111], a[156:159], v[136:139], a[108:111]
TR a[156:157], v20, 4096
s_waitcnt lgkmcnt(7)
MF a[16:19], a[160:163], v[124:127], a[16:19]
TR a[158:159], v20, 6144
buffer_load_dwordx4 a[200:203], v30, s[28:31], s73 offen
MF a[48:51], a[160:163], v[128:131], a[48:51]
v_exp_f32 v180, v180
MF a[80:83], a[160:163], v[132:135], a[80:83]
v_exp_f32 v181, v181
MF a[112:115], a[160:163], v[136:139], a[112:115]
TR a[160:161], v17, 12288
v_cvt_pk_bf16_f32 v165, v166, v167
MF a[20:23], a[164:167], v[124:127], a[20:23]
TR a[162:163], v17, 14336
v_cvt_pk_bf16_f32 v166, v180, v181
MF a[52:55], a[164:167], v[128:131], a[52:55]
v_exp_f32 v182, v182
MF a[84:87], a[164:167], v[132:135], a[84:87]
v_exp_f32 v183, v183
MF a[116:119], a[164:167], v[136:139], a[116:119]
TR a[164:165], v18, 12288
v_cvt_pk_bf16_f32 v167, v182, v183
MF a[24:27], a[168:171], v[124:127], a[24:27]
TR a[166:167], v18, 14336
MF a[56:59], a[168:171], v[128:131], a[56:59]
v_exp_f32 v168, v168
MF a[88:91], a[168:171], v[132:135], a[88:91]
v_exp_f32 v169, v169
MF a[120:123], a[168:171], v[136:139], a[120:123]
TR a[168:169], v19, 12288
v_cvt_pk_bf16_f32 v168, v168, v169
MF a[28:31], a[172:175], v[124:127], a[28:31]
TR a[170:171], v19, 14336
s_add_u32 s56, s56, 4096
MF a[60:63], a[172:175], v[128:131], a[60:63]
v_exp_f32 v170, v170
MF a[92:95], a[172:175], v[132:135], a[92:95]
v_exp_f32 v171, v171
MF a[124:127], a[172:175], v[136:139], a[124:127]
TR a[172:173], v20, 12288
v_cvt_pk_bf16_f32 v169, v170, v171
MF a[128:131], v[48:51], v[156:159], a[128:131]
TR a[174:175], v20, 14336
v_exp_f32 v184, v184
v_exp_f32 v185, v185
v_exp_f32 v186, v186
v_exp_f32 v187, v187
MF a[132:135], v[48:51], v[160:163], a[132:135]
v_cvt_pk_bf16_f32 v170, v184, v185
v_cvt_pk_bf16_f32 v171, v186, v187
MF a[136:139], v[48:51], v[164:167], a[136:139]
s_nop 0
MF a[140:143], v[48:51], v[168:171], a[140:143]
buffer_load_dwordx4 a[200:203], v29, s[44:47], s56 offen
s_waitcnt lgkmcnt(8)
MF a[0:3], a[144:147], v[156:159], a[0:3]
s_waitcnt vmcnt(37)
MF a[32:35], a[144:147], v[160:163], a[32:35]
s_barrier
MF a[64:67], a[144:147], v[164:167], a[64:67]
v_exp_f32 v188, v188
MF a[96:99], a[144:147], v[168:171], a[96:99]
DR a[144:145], v25, 16384
s_add_u32 s10, s10, 147456
s_addc_u32 s11, s11, 0
MF a[4:7], a[148:151], v[156:159], a[4:7]
DR a[146:147], v26, 16384
s_add_u32 m0, s38, 49152
MF a[36:39], a[148:151], v[160:163], a[36:39]
global_load_lds_dwordx4 v9, s[10:11]
MF a[68:71], a[148:151], v[164:167], a[68:71]
v_exp_f32 v189, v189
MF a[100:103], a[148:151], v[168:171], a[100:103]
DR a[148:149], v27, 16384
v_cvt_pk_bf16_f32 v188, v188, v189
MF a[8:11], a[152:155], v[156:159], a[8:11]
DR a[150:151], v28, 16384
buffer_load_dwordx4 a[200:203], v29, s[28:31], s73 offen offset:1024
MF a[40:43], a[152:155], v[160:163], a[40:43]
v_exp_f32 v190, v190
MF a[72:75], a[152:155], v[164:167], a[72:75]
v_exp_f32 v191, v191
MF a[104:107], a[152:155], v[168:171], a[104:107]
DR a[152:153], v25, 24576
global_load_lds_dwordx4 v10, s[10:11] offset:1024
MF a[12:15], a[156:159], v[156:159], a[12:15]
DR a[154:155], v26, 24576
v_cvt_pk_bf16_f32 v189, v190, v191
MF a[44:47], a[156:159], v[160:163], a[44:47]
v_exp_f32 v204, v204
MF a[76:79], a[156:159], v[164:167], a[76:79]
v_exp_f32 v205, v205
MF a[108:111], a[156:159], v[168:171], a[108:111]
DR a[156:157], v27, 24576
s_waitcnt lgkmcnt(7)
MF a[16:19], a[160:163], v[156:159], a[16:19]
DR a[158:159], v28, 24576
v_cvt_pk_bf16_f32 v190, v204, v205
MF a[48:51], a[160:163], v[160:163], a[48:51]
v_exp_f32 v206, v206
MF a[80:83], a[160:163], v[164:167], a[80:83]
v_exp_f32 v207, v207
MF a[112:115], a[160:163], v[168:171], a[112:115]
DR a[160:161], v25, 18432
global_load_lds_dwordx4 v11, s[10:11] offset:2048
MF a[20:23], a[164:167], v[156:159], a[20:23]
DR a[162:163], v26, 18432
v_cvt_pk_bf16_f32 v191, v206, v207
MF a[52:55], a[164:167], v[160:163], a[52:55]
v_exp_f32 v192, v192
MF a[84:87], a[164:167], v[164:167], a[84:87]
v_exp_f32 v193, v193
MF a[116:119], a[164:167], v[168:171], a[116:119]
DR a[164:165], v27, 18432
v_cvt_pk_bf16_f32 v192, v192, v193
MF a[24:27], a[168:171], v[156:159], a[24:27]
DR a[166:167], v28, 18432
MF a[56:59], a[168:171], v[160:163], a[56:59]
v_exp_f32 v194, v194
MF a[88:91], a[168:171], v[164:167], a[88:91]
v_exp_f32 v195, v195
MF a[120:123], a[168:171], v[168:171], a[120:123]
DR a[168:169], v25, 26624
global_load_lds_dwordx4 v12, s[10:11] offset:3072
MF a[28:31], a[172:175], v[156:159], a[28:31]
DR a[170:171], v26, 26624
s_add_u32 s70, s70, 128
MF a[60:63], a[172:175], v[160:163], a[60:63]
s_cmp_eq_u32 s70, 1152
s_cselect_b32 s70, 0, s70
v_cvt_pk_bf16_f32 v193, v194, v195
MF a[92:95], a[172:175], v[164:167], a[92:95]
v_exp_f32 v208, v208
MF a[124:127], a[172:175], v[168:171], a[124:127]
DR a[172:173], v27, 26624
s_waitcnt lgkmcnt(7)
MF v[124:127], a[144:147], v[60:63], v[32:35]
DR a[174:175], v28, 26624
s_add_u32 s56, s56, 4096
MF v[124:127], a[148:151], v[64:67], v[124:127]
v_exp_f32 v209, v209
MF v[124:127], a[152:155], v[68:71], v[124:127]
v_exp_f32 v210, v210
MF v[124:127], a[156:159], v[72:75], v[124:127]
v_exp_f32 v211, v211
MF v[128:131], a[144:147], v[76:79], v[36:39]
v_exp_f32 v196, v196
MF v[128:131], a[148:151], v[80:83], v[128:131]
v_exp_f32 v197, v197
MF v[128:131], a[152:155], v[84:87], v[128:131]
v_exp_f32 v198, v198
MF v[128:131], a[156:159], v[88:91], v[128:131]
v_exp_f32 v199, v199
MF v[132:135], a[144:147], v[92:95], v[40:43]
v_exp_f32 v212, v212
MF v[132:135], a[148:151], v[96:99], v[132:135]
v_exp_f32 v213, v213
MF v[132:135], a[152:155], v[100:103], v[132:135]
v_exp_f32 v214, v214
MF v[132:135], a[156:159], v[104:107], v[132:135]
v_exp_f32 v215, v215
MF v[136:139], a[144:147], v[108:111], v[44:47]
DR a[144:145], v25, 20480
v_cvt_pk_bf16_f32 v194, v208, v209
MF v[136:139], a[148:151], v[112:115], v[136:139]
DR a[146:147], v26, 20480
v_cvt_pk_bf16_f32 v195, v210, v211
MF v[136:139], a[152:155], v[116:119], v[136:139]
DR a[148:149], v27, 20480
v_cvt_pk_bf16_f32 v196, v196, v197
MF v[136:139], a[156:159], v[120:123], v[136:139]
DR a[150:151], v28, 20480
buffer_load_dwordx4 a[200:203], v29, s[44:47], s56 offen
s_waitcnt lgkmcnt(4)
MF v[140:143], a[160:163], v[60:63], v[32:35]
DR a[152:153], v25, 28672
MF v[140:143], a[164:167], v[64:67], v[140:143]
DR a[154:155], v26, 28672
v_cvt_pk_bf16_f32 v197, v198, v199
MF v[140:143], a[168:171], v[68:71], v[140:143]
DR a[156:157], v27, 28672
v_cvt_pk_bf16_f32 v198, v212, v213
MF v[140:143], a[172:175], v[72:75], v[140:143]
DR a[158:159], v28, 28672
v_cvt_pk_bf16_f32 v199, v214, v215
MF v[144:147], a[160:163], v[76:79], v[36:39]
v_exp_f32 v200, v200
MF v[144:147], a[164:167], v[80:83], v[144:147]
buffer_load_dwordx4 a[200:203], v30, s[28:31], s73 offen offset:1024
v_max3_f32 v52, v124, v125, v126
MF v[144:147], a[168:171], v[84:87], v[144:147]
v_exp_f32 v201, v201
MF v[144:147], a[172:175], v[88:91], v[144:147]
v_exp_f32 v202, v202
MF v[148:151], a[160:163], v[92:95], v[40:43]
v_exp_f32 v203, v203
MF v[148:151], a[164:167], v[96:99], v[148:151]
v_exp_f32 v216, v216
MF v[148:151], a[168:171], v[100:103], v[148:151]
v_exp_f32 v217, v217
MF v[148:151], a[172:175], v[104:107], v[148:151]
v_exp_f32 v218, v218
MF v[152:155], a[160:163], v[108:111], v[44:47]
DR a[160:161], v25, 22528
v_cvt_pk_bf16_f32 v200, v200, v201
MF v[152:155], a[164:167], v[112:115], v[152:155]
DR a[162:163], v26, 22528
v_cvt_pk_bf16_f32 v201, v202, v203
MF v[152:155], a[168:171], v[116:119], v[152:155]
DR a[164:165], v27, 22528
v_cvt_pk_bf16_f32 v202, v216, v217
MF v[152:155], a[172:175], v[120:123], v[152:155]
DR a[166:167], v28, 22528
s_waitcnt lgkmcnt(4)
MF v[156:159], a[144:147], v[60:63], v[32:35]
DR a[168:169], v25, 30720
v_max_f32 v52, v52, v127
MF v[156:159], a[148:151], v[64:67], v[156:159]
DR a[170:171], v26, 30720
v_max3_f32 v53, v128, v129, v130
MF v[156:159], a[152:155], v[68:71], v[156:159]
DR a[172:173], v27, 30720
v_max_f32 v53, v53, v131
MF v[156:159], a[156:159], v[72:75], v[156:159]
DR a[174:175], v28, 30720
v_max3_f32 v54, v132, v133, v134
MF v[160:163], a[144:147], v[76:79], v[36:39]
s_getpc_b64 s[4:5]
ka_kernel_pc29:
s_add_u32 s4, s4, ka_kernel-ka_kernel_pc29
s_addc_u32 s5, s5, (ka_kernel-ka_kernel_pc29)>>32
s_mov_b32 s6, ka_kernel_done1-ka_kernel
s_mov_b32 s7, 0x00020000
s_lshr_b32 s43, s2, 3
s_mul_i32 s43, s43, 2048
buffer_load_dwordx4 a[200:203], v29, s[4:7], s43 offen
buffer_load_dwordx4 a[200:203], v29, s[4:7], s43 offen offset:1024
MF v[160:163], a[148:151], v[80:83], v[160:163]
MF v[160:163], a[152:155], v[84:87], v[160:163]
v_exp_f32 v219, v219
MF v[160:163], a[156:159], v[88:91], v[160:163]
v_exp_f32 v220, v220
MF v[164:167], a[144:147], v[92:95], v[40:43]
v_exp_f32 v221, v221
MF v[164:167], a[148:151], v[96:99], v[164:167]
s_waitcnt vmcnt(41)
v_cvt_pk_bf16_f32 v203, v218, v219
MF v[164:167], a[152:155], v[100:103], v[164:167]
s_barrier
v_cvt_pk_bf16_f32 v220, v220, v221
MF v[164:167], a[156:159], v[104:107], v[164:167]
v_exp_f32 v222, v222
MF v[168:171], a[144:147], v[108:111], v[44:47]
TR a[144:145], v17, 32768
s_add_u32 s59, s35, s70
MF v[168:171], a[148:151], v[112:115], v[168:171]
TR a[146:147], v17, 34816
s_add_u32 s10, s20, s59
s_addc_u32 s11, s21, 0
MF v[168:171], a[152:155], v[116:119], v[168:171]
TR a[148:149], v18, 32768
s_add_u32 m0, s38, 65536
MF v[168:171], a[156:159], v[120:123], v[168:171]
TR a[150:151], v18, 34816
s_waitcnt lgkmcnt(4)
MF v[172:175], a[160:163], v[60:63], v[32:35]
TR a[152:153], v19, 32768
global_load_lds_dwordx4 v9, s[10:11]
MF v[172:175], a[164:167], v[64:67], v[172:175]
TR a[154:155], v19, 34816
v_max_f32 v54, v54, v135
MF v[172:175], a[168:171], v[68:71], v[172:175]
TR a[156:157], v20, 32768
s_add_u32 s56, s56, 4096
buffer_load_dwordx4 a[200:203], v29, s[44:47], s56 offen
MF v[172:175], a[172:175], v[72:75], v[172:175]
TR a[158:159], v20, 34816
MF v[176:179], a[160:163], v[76:79], v[36:39]
global_load_lds_dwordx4 v10, s[10:11] offset:1024
v_max3_f32 v55, v136, v137, v138
MF v[176:179], a[164:167], v[80:83], v[176:179]
v_exp_f32 v223, v223
MF v[176:179], a[168:171], v[84:87], v[176:179]
v_exp_f32 v236, v236
MF v[176:179], a[172:175], v[88:91], v[176:179]
v_exp_f32 v237, v237
MF v[180:183], a[160:163], v[92:95], v[40:43]
v_exp_f32 v238, v238
MF v[180:183], a[164:167], v[96:99], v[180:183]
v_exp_f32 v239, v239
MF v[180:183], a[168:171], v[100:103], v[180:183]
buffer_load_dwordx4 a[200:203], v29, s[28:31], s81 offen
v_cvt_pk_bf16_f32 v221, v222, v223
MF v[180:183], a[172:175], v[104:107], v[180:183]
v_exp_f32 v224, v224
MF v[184:187], a[160:163], v[108:111], v[44:47]
TR a[160:161], v17, 40960
global_load_lds_dwordx4 v11, s[10:11] offset:2048
MF v[184:187], a[164:167], v[112:115], v[184:187]
TR a[162:163], v17, 43008
v_cvt_pk_bf16_f32 v222, v236, v237
MF v[184:187], a[168:171], v[116:119], v[184:187]
TR a[164:165], v18, 40960
v_cvt_pk_bf16_f32 v223, v238, v239
MF v[184:187], a[172:175], v[120:123], v[184:187]
TR a[166:167], v18, 43008
v_max_f32 v55, v55, v139
MF a[128:131], v[48:51], v[188:191], a[128:131]
TR a[168:169], v19, 40960
v_max3_f32 v52, v52, v140, v141
MF a[132:135], v[48:51], v[192:195], a[132:135]
TR a[170:171], v19, 43008
v_max3_f32 v52, v52, v142, v143
MF a[136:139], v[48:51], v[196:199], a[136:139]
TR a[172:173], v20, 40960
v_max3_f32 v53, v53, v144, v145
MF a[140:143], v[48:51], v[200:203], a[140:143]
TR a[174:175], v20, 43008
s_waitcnt lgkmcnt(8)
MF a[0:3], a[144:147], v[188:191], a[0:3]
global_load_lds_dwordx4 v12, s[10:11] offset:3072
v_max3_f32 v53, v53, v146, v147
MF a[32:35], a[144:147], v[192:195], a[32:35]
v_exp_f32 v225, v225
MF a[64:67], a[144:147], v[196:199], a[64:67]
v_exp_f32 v226, v226
MF a[96:99], a[144:147], v[200:203], a[96:99]
TR a[144:145], v17, 36864
v_max3_f32 v54, v54, v148, v149
v_max3_f32 v54, v54, v150, v151
v_max3_f32 v55, v55, v152, v153
v_max3_f32 v55, v55, v154, v155
v_max3_f32 v52, v52, v156, v157
v_max3_f32 v52, v52, v158, v159
v_max3_f32 v53, v53, v160, v161
v_max3_f32 v53, v53, v162, v163
v_max3_f32 v54, v54, v164, v165
v_max3_f32 v54, v54, v166, v167
v_max3_f32 v55, v55, v168, v169
v_max3_f32 v55, v55, v170, v171
v_max3_f32 v52, v52, v172, v173
v_max3_f32 v52, v52, v174, v175
v_max3_f32 v53, v53, v176, v177
v_max3_f32 v53, v53, v178, v179
v_max3_f32 v54, v54, v180, v181
v_max3_f32 v54, v54, v182, v183
v_max3_f32 v55, v55, v184, v185
v_max3_f32 v55, v55, v186, v187
MF a[4:7], a[148:151], v[188:191], a[4:7]
TR a[146:147], v17, 38912
v_max3_f32 v56, v52, v53, v54
v_max_f32 v56, v56, v55
MF a[36:39], a[148:151], v[192:195], a[36:39]
v_cmp_lt_f32 vcc, s58, v56
MF a[68:71], a[148:151], v[196:199], a[68:71]
s_cbranch_vccnz ka_kernel_slow23
ka_kernel_back24:
MF a[100:103], a[148:151], v[200:203], a[100:103]
TR a[148:149], v18, 36864
v_cvt_pk_bf16_f32 v224, v224, v225
MF a[8:11], a[152:155], v[188:191], a[8:11]
TR a[150:151], v18, 38912
s_add_u32 s56, s56, 4096
MF a[40:43], a[152:155], v[192:195], a[40:43]
v_exp_f32 v227, v227
MF a[72:75], a[152:155], v[196:199], a[72:75]
v_exp_f32 v240, v240
MF a[104:107], a[152:155], v[200:203], a[104:107]
TR a[152:153], v19, 36864
v_cvt_pk_bf16_f32 v225, v226, v227
MF a[12:15], a[156:159], v[188:191], a[12:15]
TR a[154:155], v19, 38912
buffer_load_dwordx4 a[200:203], v29, s[44:47], s56 offen
MF a[44:47], a[156:159], v[192:195], a[44:47]
v_exp_f32 v241, v241
MF a[76:79], a[156:159], v[196:199], a[76:79]
v_exp_f32 v242, v242
MF a[108:111], a[156:159], v[200:203], a[108:111]
TR a[156:157], v20, 36864
s_waitcnt lgkmcnt(7)
MF a[16:19], a[160:163], v[188:191], a[16:19]
TR a[158:159], v20, 38912
v_cvt_pk_bf16_f32 v226, v240, v241
MF a[48:51], a[160:163], v[192:195], a[48:51]
v_exp_f32 v243, v243
MF a[80:83], a[160:163], v[196:199], a[80:83]
v_exp_f32 v228, v228
MF a[112:115], a[160:163], v[200:203], a[112:115]
TR a[160:161], v17, 45056
v_cvt_pk_bf16_f32 v227, v242, v243
MF a[20:23], a[164:167], v[188:191], a[20:23]
TR a[162:163], v17, 47104
buffer_load_dwordx4 a[200:203], v30, s[28:31], s81 offen
MF a[52:55], a[164:167], v[192:195], a[52:55]
v_exp_f32 v229, v229
MF a[84:87], a[164:167], v[196:199], a[84:87]
v_exp_f32 v230, v230
MF a[116:119], a[164:167], v[200:203], a[116:119]
TR a[164:165], v18, 45056
v_cvt_pk_bf16_f32 v228, v228, v229
MF a[24:27], a[168:171], v[188:191], a[24:27]
TR a[166:167], v18, 47104
MF a[56:59], a[168:171], v[192:195], a[56:59]
v_exp_f32 v231, v231
MF a[88:91], a[168:171], v[196:199], a[88:91]
v_exp_f32 v244, v244
MF a[120:123], a[168:171], v[200:203], a[120:123]
TR a[168:169], v19, 45056
v_cvt_pk_bf16_f32 v229, v230, v231
MF a[28:31], a[172:175], v[188:191], a[28:31]
TR a[170:171], v19, 47104
MF a[60:63], a[172:175], v[192:195], a[60:63]
v_exp_f32 v245, v245
MF a[92:95], a[172:175], v[196:199], a[92:95]
v_exp_f32 v246, v246
MF a[124:127], a[172:175], v[200:203], a[124:127]
TR a[172:173], v20, 45056
v_exp_f32 v247, v247
MF a[128:131], v[48:51], v[220:223], a[128:131]
TR a[174:175], v20, 47104
v_exp_f32 v232, v232
v_exp_f32 v233, v233
v_exp_f32 v234, v234
v_exp_f32 v235, v235
v_exp_f32 v248, v248
v_exp_f32 v249, v249
v_exp_f32 v250, v250
v_exp_f32 v251, v251
v_cvt_pk_bf16_f32 v230, v244, v245
v_cvt_pk_bf16_f32 v231, v246, v247
MF a[132:135], v[48:51], v[224:227], a[132:135]
v_cvt_pk_bf16_f32 v232, v232, v233
v_cvt_pk_bf16_f32 v233, v234, v235
v_cvt_pk_bf16_f32 v234, v248, v249
v_cvt_pk_bf16_f32 v235, v250, v251
MF a[136:139], v[48:51], v[228:231], a[136:139]
s_nop 0
MF a[140:143], v[48:51], v[232:235], a[140:143]
s_waitcnt lgkmcnt(8)
MF a[0:3], a[144:147], v[220:223], a[0:3]
s_waitcnt vmcnt(42)
MF a[32:35], a[144:147], v[224:227], a[32:35]
s_barrier
MF a[64:67], a[144:147], v[228:231], a[64:67]
v_exp_f32 v124, v124
MF a[96:99], a[144:147], v[232:235], a[96:99]
DR a[144:145], v25, 49152
s_add_u32 s10, s10, 147456
s_addc_u32 s11, s11, 0
MF a[4:7], a[148:151], v[220:223], a[4:7]
DR a[146:147], v26, 49152
s_add_u32 m0, s38, 81920
MF a[36:39], a[148:151], v[224:227], a[36:39]
global_load_lds_dwordx4 v9, s[10:11]
MF a[68:71], a[148:151], v[228:231], a[68:71]
v_exp_f32 v125, v125
MF a[100:103], a[148:151], v[232:235], a[100:103]
DR a[148:149], v27, 49152
v_cvt_pk_bf16_f32 v124, v124, v125
MF a[8:11], a[152:155], v[220:223], a[8:11]
DR a[150:151], v28, 49152
MF a[40:43], a[152:155], v[224:227], a[40:43]
v_exp_f32 v126, v126
MF a[72:75], a[152:155], v[228:231], a[72:75]
v_exp_f32 v127, v127
MF a[104:107], a[152:155], v[232:235], a[104:107]
DR a[152:153], v25, 57344
global_load_lds_dwordx4 v10, s[10:11] offset:1024
MF a[12:15], a[156:159], v[220:223], a[12:15]
DR a[154:155], v26, 57344
v_cvt_pk_bf16_f32 v125, v126, v127
MF a[44:47], a[156:159], v[224:227], a[44:47]
v_exp_f32 v140, v140
MF a[76:79], a[156:159], v[228:231], a[76:79]
v_exp_f32 v141, v141
MF a[108:111], a[156:159], v[232:235], a[108:111]
DR a[156:157], v27, 57344
s_waitcnt lgkmcnt(7)
MF a[16:19], a[160:163], v[220:223], a[16:19]
DR a[158:159], v28, 57344
v_cvt_pk_bf16_f32 v126, v140, v141
MF a[48:51], a[160:163], v[224:227], a[48:51]
v_exp_f32 v142, v142
MF a[80:83], a[160:163], v[228:231], a[80:83]
v_exp_f32 v143, v143
MF a[112:115], a[160:163], v[232:235], a[112:115]
DR a[160:161], v25, 51200
global_load_lds_dwordx4 v11, s[10:11] offset:2048
MF a[20:23], a[164:167], v[220:223], a[20:23]
DR a[162:163], v26, 51200
v_cvt_pk_bf16_f32 v127, v142, v143
MF a[52:55], a[164:167], v[224:227], a[52:55]
v_exp_f32 v128, v128
MF a[84:87], a[164:167], v[228:231], a[84:87]
v_exp_f32 v129, v129
MF a[116:119], a[164:167], v[232:235], a[116:119]
DR a[164:165], v27, 51200
v_cvt_pk_bf16_f32 v128, v128, v129
MF a[24:27], a[168:171], v[220:223], a[24:27]
DR a[166:167], v28, 51200
s_mul_i32 s56, s40, 294912
MF a[56:59], a[168:171], v[224:227], a[56:59]
v_exp_f32 v130, v130
MF a[88:91], a[168:171], v[228:231], a[88:91]
v_exp_f32 v131, v131
MF a[120:123], a[168:171], v[232:235], a[120:123]
DR a[168:169], v25, 59392
buffer_load_dwordx4 a[200:203], v29, s[28:31], s81 offen offset:1024
MF a[28:31], a[172:175], v[220:223], a[28:31]
DR a[170:171], v26, 59392
global_load_lds_dwordx4 v12, s[10:11] offset:3072
MF a[60:63], a[172:175], v[224:227], a[60:63]
s_add_u32 s70, s70, 128
s_cmp_eq_u32 s70, 1152
s_cselect_b32 s70, 0, s70
MF a[92:95], a[172:175], v[228:231], a[92:95]
v_exp_f32 v144, v144
MF a[124:127], a[172:175], v[232:235], a[124:127]
DR a[172:173], v27, 59392
s_waitcnt lgkmcnt(7)
MF v[188:191], a[144:147], v[60:63], v[32:35]
DR a[174:175], v28, 59392
s_mul_i32 s57, s42, 36864
s_add_u32 s56, s56, s57
s_lshl_b32 s57, s39, 10
s_add_u32 s56, s56, s57
buffer_load_dwordx4 a[200:203], v29, s[20:23], s56 offen
MF v[188:191], a[148:151], v[64:67], v[188:191]
MF v[188:191], a[152:155], v[68:71], v[188:191]
v_exp_f32 v145, v145
MF v[188:191], a[156:159], v[72:75], v[188:191]
v_exp_f32 v146, v146
MF v[192:195], a[144:147], v[76:79], v[36:39]
v_exp_f32 v147, v147
MF v[192:195], a[148:151], v[80:83], v[192:195]
v_exp_f32 v132, v132
MF v[192:195], a[152:155], v[84:87], v[192:195]
v_exp_f32 v133, v133
MF v[192:195], a[156:159], v[88:91], v[192:195]
v_exp_f32 v134, v134
MF v[196:199], a[144:147], v[92:95], v[40:43]
v_exp_f32 v135, v135
MF v[196:199], a[148:151], v[96:99], v[196:199]
v_exp_f32 v148, v148
MF v[196:199], a[152:155], v[100:103], v[196:199]
v_exp_f32 v149, v149
MF v[196:199], a[156:159], v[104:107], v[196:199]
v_exp_f32 v150, v150
MF v[200:203], a[144:147], v[108:111], v[44:47]
DR a[144:145], v25, 53248
v_cvt_pk_bf16_f32 v129, v130, v131
MF v[200:203], a[148:151], v[112:115], v[200:203]
DR a[146:147], v26, 53248
v_cvt_pk_bf16_f32 v130, v144, v145
MF v[200:203], a[152:155], v[116:119], v[200:203]
DR a[148:149], v27, 53248
v_cvt_pk_bf16_f32 v131, v146, v147
MF v[200:203], a[156:159], v[120:123], v[200:203]
DR a[150:151], v28, 53248
s_waitcnt lgkmcnt(4)
MF v[204:207], a[160:163], v[60:63], v[32:35]
DR a[152:153], v25, 61440
v_cvt_pk_bf16_f32 v132, v132, v133
MF v[204:207], a[164:167], v[64:67], v[204:207]
DR a[154:155], v26, 61440
v_cvt_pk_bf16_f32 v133, v134, v135
MF v[204:207], a[168:171], v[68:71], v[204:207]
DR a[156:157], v27, 61440
v_cvt_pk_bf16_f32 v134, v148, v149
MF v[204:207], a[172:175], v[72:75], v[204:207]
DR a[158:159], v28, 61440
v_max3_f32 v52, v188, v189, v190
MF v[208:211], a[160:163], v[76:79], v[36:39]
v_exp_f32 v151, v151
MF v[208:211], a[164:167], v[80:83], v[208:211]
v_exp_f32 v136, v136
MF v[208:211], a[168:171], v[84:87], v[208:211]
s_add_u32 s56, s56, 4096
buffer_load_dwordx4 a[200:203], v29, s[20:23], s56 offen
MF v[208:211], a[172:175], v[88:91], v[208:211]
v_exp_f32 v137, v137
MF v[212:215], a[160:163], v[92:95], v[40:43]
v_exp_f32 v138, v138
MF v[212:215], a[164:167], v[96:99], v[212:215]
v_exp_f32 v139, v139
MF v[212:215], a[168:171], v[100:103], v[212:215]
v_exp_f32 v152, v152
MF v[212:215], a[172:175], v[104:107], v[212:215]
v_exp_f32 v153, v153
MF v[216:219], a[160:163], v[108:111], v[44:47]
DR a[160:161], v25, 55296
v_cvt_pk_bf16_f32 v135, v150, v151
MF v[216:219], a[164:167], v[112:115], v[216:219]
DR a[162:163], v26, 55296
v_cvt_pk_bf16_f32 v136, v136, v137
MF v[216:219], a[168:171], v[116:119], v[216:219]
DR a[164:165], v27, 55296
v_cvt_pk_bf16_f32 v137, v138, v139
MF v[216:219], a[172:175], v[120:123], v[216:219]
DR a[166:167], v28, 55296
buffer_load_dwordx4 a[200:203], v30, s[28:31], s81 offen offset:1024
s_waitcnt lgkmcnt(4)
MF v[220:223], a[144:147], v[60:63], v[32:35]
DR a[168:169], v25, 63488
MF v[220:223], a[148:151], v[64:67], v[220:223]
DR a[170:171], v26, 63488
v_cvt_pk_bf16_f32 v138, v152, v153
MF v[220:223], a[152:155], v[68:71], v[220:223]
DR a[172:173], v27, 63488
v_max_f32 v52, v52, v191
MF v[220:223], a[156:159], v[72:75], v[220:223]
DR a[174:175], v28, 63488
v_max3_f32 v53, v192, v193, v194
MF v[224:227], a[144:147], v[76:79], v[36:39]
v_exp_f32 v154, v154
MF v[224:227], a[148:151], v[80:83], v[224:227]
v_exp_f32 v155, v155
MF v[224:227], a[152:155], v[84:87], v[224:227]
v_exp_f32 v156, v156
MF v[224:227], a[156:159], v[88:91], v[224:227]
v_exp_f32 v157, v157
MF v[228:231], a[144:147], v[92:95], v[40:43]
v_exp_f32 v158, v158
MF v[228:231], a[148:151], v[96:99], v[228:231]
s_waitcnt vmcnt(44)
v_cvt_pk_bf16_f32 v139, v154, v155
MF v[228:231], a[152:155], v[100:103], v[228:231]
s_barrier
v_cvt_pk_bf16_f32 v156, v156, v157
MF v[228:231], a[156:159], v[104:107], v[228:231]
v_exp_f32 v159, v159
MF v[232:235], a[144:147], v[108:111], v[44:47]
TR a[144:145], v13, 0
s_add_u32 s56, s56, 4096
buffer_load_dwordx4 a[200:203], v29, s[20:23], s56 offen
MF v[232:235], a[148:151], v[112:115], v[232:235]
TR a[146:147], v13, 2048
MF v[232:235], a[152:155], v[116:119], v[232:235]
TR a[148:149], v14, 0
s_add_u32 s59, s35, s70
MF v[232:235], a[156:159], v[120:123], v[232:235]
TR a[150:151], v14, 2048
s_waitcnt lgkmcnt(4)
MF v[236:239], a[160:163], v[60:63], v[32:35]
TR a[152:153], v15, 0
s_add_u32 s10, s20, s59
s_addc_u32 s11, s21, 0
MF v[236:239], a[164:167], v[64:67], v[236:239]
TR a[154:155], v15, 2048
s_add_u32 m0, s38, 98304
MF v[236:239], a[168:171], v[68:71], v[236:239]
TR a[156:157], v16, 0
global_load_lds_dwordx4 v9, s[10:11]
MF v[236:239], a[172:175], v[72:75], v[236:239]
TR a[158:159], v16, 2048
v_cvt_pk_bf16_f32 v157, v158, v159
MF v[240:243], a[160:163], v[76:79], v[36:39]
global_load_lds_dwordx4 v10, s[10:11] offset:1024
v_max_f32 v53, v53, v195
MF v[240:243], a[164:167], v[80:83], v[240:243]
v_exp_f32 v172, v172
MF v[240:243], a[168:171], v[84:87], v[240:243]
v_exp_f32 v173, v173
MF v[240:243], a[172:175], v[88:91], v[240:243]
v_exp_f32 v174, v174
MF v[244:247], a[160:163], v[92:95], v[40:43]
v_exp_f32 v175, v175
MF v[244:247], a[164:167], v[96:99], v[244:247]
v_exp_f32 v160, v160
MF v[244:247], a[168:171], v[100:103], v[244:247]
v_exp_f32 v161, v161
MF v[244:247], a[172:175], v[104:107], v[244:247]
v_exp_f32 v162, v162
MF v[248:251], a[160:163], v[108:111], v[44:47]
TR a[160:161], v13, 8192
global_load_lds_dwordx4 v11, s[10:11] offset:2048
MF v[248:251], a[164:167], v[112:115], v[248:251]
TR a[162:163], v13, 10240
v_cvt_pk_bf16_f32 v158, v172, v173
MF v[248:251], a[168:171], v[116:119], v[248:251]
TR a[164:165], v14, 8192
v_cvt_pk_bf16_f32 v159, v174, v175
MF v[248:251], a[172:175], v[120:123], v[248:251]
TR a[166:167], v14, 10240
v_cvt_pk_bf16_f32 v160, v160, v161
MF a[128:131], v[48:51], v[124:127], a[128:131]
TR a[168:169], v15, 8192
v_max3_f32 v54, v196, v197, v198
MF a[132:135], v[48:51], v[128:131], a[132:135]
TR a[170:171], v15, 10240
v_max_f32 v54, v54, v199
MF a[136:139], v[48:51], v[132:135], a[136:139]
TR a[172:173], v16, 8192
s_add_u32 s56, s56, 4096
buffer_load_dwordx4 a[200:203], v29, s[20:23], s56 offen
MF a[140:143], v[48:51], v[136:139], a[140:143]
TR a[174:175], v16, 10240
s_waitcnt lgkmcnt(8)
MF a[0:3], a[144:147], v[124:127], a[0:3]
global_load_lds_dwordx4 v12, s[10:11] offset:3072
MF a[32:35], a[144:147], v[128:131], a[32:35]
v_exp_f32 v163, v163
MF a[64:67], a[144:147], v[132:135], a[64:67]
v_exp_f32 v176, v176
MF a[96:99], a[144:147], v[136:139], a[96:99]
TR a[144:145], v13, 4096
v_max3_f32 v55, v200, v201, v202
v_max_f32 v55, v55, v203
v_max3_f32 v52, v52, v204, v205
v_max3_f32 v52, v52, v206, v207
v_max3_f32 v53, v53, v208, v209
v_max3_f32 v53, v53, v210, v211
v_max3_f32 v54, v54, v212, v213
v_max3_f32 v54, v54, v214, v215
v_max3_f32 v55, v55, v216, v217
v_max3_f32 v55, v55, v218, v219
v_max3_f32 v52, v52, v220, v221
v_max3_f32 v52, v52, v222, v223
v_max3_f32 v53, v53, v224, v225
v_max3_f32 v53, v53, v226, v227
v_max3_f32 v54, v54, v228, v229
v_max3_f32 v54, v54, v230, v231
v_max3_f32 v55, v55, v232, v233
v_max3_f32 v55, v55, v234, v235
v_max3_f32 v52, v52, v236, v237
v_max3_f32 v52, v52, v238, v239
v_max3_f32 v53, v53, v240, v241
v_max3_f32 v53, v53, v242, v243
v_max3_f32 v54, v54, v244, v245
v_max3_f32 v54, v54, v246, v247
v_max3_f32 v55, v55, v248, v249
v_max3_f32 v55, v55, v250, v251
MF a[4:7], a[148:151], v[124:127], a[4:7]
TR a[146:147], v13, 6144
v_max3_f32 v56, v52, v53, v54
v_max_f32 v56, v56, v55
buffer_load_dword v0, v31, s[60:63], s66 offen sc1
MF a[36:39], a[148:151], v[128:131], a[36:39]
v_cmp_lt_f32 vcc, s58, v56
MF a[68:71], a[148:151], v[132:135], a[68:71]
s_cbranch_vccnz ka_kernel_slow25
ka_kernel_back26:
MF a[100:103], a[148:151], v[136:139], a[100:103]
TR a[148:149], v14, 4096
v_cvt_pk_bf16_f32 v161, v162, v163
MF a[8:11], a[152:155], v[124:127], a[8:11]
TR a[150:151], v14, 6144
s_add_u32 s56, s56, 4096
MF a[40:43], a[152:155], v[128:131], a[40:43]
v_exp_f32 v177, v177
MF a[72:75], a[152:155], v[132:135], a[72:75]
v_exp_f32 v178, v178
MF a[104:107], a[152:155], v[136:139], a[104:107]
TR a[152:153], v15, 4096
v_cvt_pk_bf16_f32 v162, v176, v177
MF a[12:15], a[156:159], v[124:127], a[12:15]
TR a[154:155], v15, 6144
buffer_load_dwordx4 a[200:203], v29, s[20:23], s56 offen
MF a[44:47], a[156:159], v[128:131], a[44:47]
v_exp_f32 v179, v179
MF a[76:79], a[156:159], v[132:135], a[76:79]
v_exp_f32 v164, v164
MF a[108:111], a[156:159], v[136:139], a[108:111]
TR a[156:157], v16, 4096
s_waitcnt lgkmcnt(7)
MF a[16:19], a[160:163], v[124:127], a[16:19]
TR a[158:159], v16, 6144
v_cvt_pk_bf16_f32 v163, v178, v179
MF a[48:51], a[160:163], v[128:131], a[48:51]
v_exp_f32 v165, v165
MF a[80:83], a[160:163], v[132:135], a[80:83]
v_exp_f32 v166, v166
MF a[112:115], a[160:163], v[136:139], a[112:115]
TR a[160:161], v13, 12288
v_cvt_pk_bf16_f32 v164, v164, v165
MF a[20:23], a[164:167], v[124:127], a[20:23]
TR a[162:163], v13, 14336
MF a[52:55], a[164:167], v[128:131], a[52:55]
v_exp_f32 v167, v167
MF a[84:87], a[164:167], v[132:135], a[84:87]
v_exp_f32 v180, v180
MF a[116:119], a[164:167], v[136:139], a[116:119]
TR a[164:165], v14, 12288
v_cvt_pk_bf16_f32 v165, v166, v167
MF a[24:27], a[168:171], v[124:127], a[24:27]
TR a[166:167], v14, 14336
s_add_u32 s56, s56, 4096
MF a[56:59], a[168:171], v[128:131], a[56:59]
v_exp_f32 v181, v181
MF a[88:91], a[168:171], v[132:135], a[88:91]
v_exp_f32 v182, v182
MF a[120:123], a[168:171], v[136:139], a[120:123]
TR a[168:169], v15, 12288
v_cvt_pk_bf16_f32 v166, v180, v181
MF a[28:31], a[172:175], v[124:127], a[28:31]
TR a[170:171], v15, 14336
buffer_load_dwordx4 a[200:203], v29, s[20:23], s56 offen
MF a[60:63], a[172:175], v[128:131], a[60:63]
v_exp_f32 v183, v183
MF a[92:95], a[172:175], v[132:135], a[92:95]
v_exp_f32 v168, v168
MF a[124:127], a[172:175], v[136:139], a[124:127]
TR a[172:173], v16, 12288
v_cvt_pk_bf16_f32 v167, v182, v183
MF a[128:131], v[48:51], v[156:159], a[128:131]
TR a[174:175], v16, 14336
v_exp_f32 v169, v169
v_exp_f32 v170, v170
v_exp_f32 v171, v171
v_exp_f32 v184, v184
v_exp_f32 v185, v185
v_exp_f32 v186, v186
v_exp_f32 v187, v187
MF a[132:135], v[48:51], v[160:163], a[132:135]
v_cvt_pk_bf16_f32 v168, v168, v169
v_cvt_pk_bf16_f32 v169, v170, v171
v_cvt_pk_bf16_f32 v170, v184, v185
v_cvt_pk_bf16_f32 v171, v186, v187
MF a[136:139], v[48:51], v[164:167], a[136:139]
s_nop 0
MF a[140:143], v[48:51], v[168:171], a[140:143]
s_waitcnt lgkmcnt(8)
MF a[0:3], a[144:147], v[156:159], a[0:3]
s_waitcnt vmcnt(44)
MF a[32:35], a[144:147], v[160:163], a[32:35]
s_barrier
MF a[64:67], a[144:147], v[164:167], a[64:67]
v_exp_f32 v188, v188
MF a[96:99], a[144:147], v[168:171], a[96:99]
TR a[144:145], v13, 16384
s_add_u32 s10, s10, 147456
s_addc_u32 s11, s11, 0
MF a[4:7], a[148:151], v[156:159], a[4:7]
TR a[146:147], v13, 18432
s_add_u32 m0, s38, 114688
MF a[36:39], a[148:151], v[160:163], a[36:39]
global_load_lds_dwordx4 v9, s[10:11]
MF a[68:71], a[148:151], v[164:167], a[68:71]
v_exp_f32 v189, v189
MF a[100:103], a[148:151], v[168:171], a[100:103]
TR a[148:149], v14, 16384
v_cvt_pk_bf16_f32 v188, v188, v189
MF a[8:11], a[152:155], v[156:159], a[8:11]
TR a[150:151], v14, 18432
s_add_u32 s56, s56, 4096
MF a[40:43], a[152:155], v[160:163], a[40:43]
v_exp_f32 v190, v190
MF a[72:75], a[152:155], v[164:167], a[72:75]
v_exp_f32 v191, v191
MF a[104:107], a[152:155], v[168:171], a[104:107]
TR a[152:153], v15, 16384
global_load_lds_dwordx4 v10, s[10:11] offset:1024
MF a[12:15], a[156:159], v[156:159], a[12:15]
TR a[154:155], v15, 18432
v_cvt_pk_bf16_f32 v189, v190, v191
MF a[44:47], a[156:159], v[160:163], a[44:47]
v_exp_f32 v204, v204
MF a[76:79], a[156:159], v[164:167], a[76:79]
v_exp_f32 v205, v205
MF a[108:111], a[156:159], v[168:171], a[108:111]
TR a[156:157], v16, 16384
s_waitcnt lgkmcnt(7)
MF a[16:19], a[160:163], v[156:159], a[16:19]
TR a[158:159], v16, 18432
v_cvt_pk_bf16_f32 v190, v204, v205
MF a[48:51], a[160:163], v[160:163], a[48:51]
v_exp_f32 v206, v206
MF a[80:83], a[160:163], v[164:167], a[80:83]
v_exp_f32 v207, v207
MF a[112:115], a[160:163], v[168:171], a[112:115]
TR a[160:161], v13, 24576
global_load_lds_dwordx4 v11, s[10:11] offset:2048
MF a[20:23], a[164:167], v[156:159], a[20:23]
TR a[162:163], v13, 26624
v_cvt_pk_bf16_f32 v191, v206, v207
MF a[52:55], a[164:167], v[160:163], a[52:55]
v_exp_f32 v192, v192
MF a[84:87], a[164:167], v[164:167], a[84:87]
v_exp_f32 v193, v193
MF a[116:119], a[164:167], v[168:171], a[116:119]
TR a[164:165], v14, 24576
v_cvt_pk_bf16_f32 v192, v192, v193
MF a[24:27], a[168:171], v[156:159], a[24:27]
TR a[166:167], v14, 26624
buffer_load_dwordx4 a[200:203], v29, s[20:23], s56 offen
MF a[56:59], a[168:171], v[160:163], a[56:59]
v_exp_f32 v194, v194
MF a[88:91], a[168:171], v[164:167], a[88:91]
v_exp_f32 v195, v195
MF a[120:123], a[168:171], v[168:171], a[120:123]
TR a[168:169], v15, 24576
global_load_lds_dwordx4 v12, s[10:11] offset:3072
MF a[28:31], a[172:175], v[156:159], a[28:31]
TR a[170:171], v15, 26624
s_add_u32 s70, s70, 128
MF a[60:63], a[172:175], v[160:163], a[60:63]
s_cmp_eq_u32 s70, 1152
s_cselect_b32 s70, 0, s70
v_cvt_pk_bf16_f32 v193, v194, v195
MF a[92:95], a[172:175], v[164:167], a[92:95]
v_exp_f32 v208, v208
v_exp_f32 v209, v209
v_exp_f32 v210, v210
v_exp_f32 v211, v211
MF a[124:127], a[172:175], v[168:171], a[124:127]
TR a[172:173], v16, 24576
v_exp_f32 v196, v196
v_exp_f32 v197, v197
v_exp_f32 v198, v198
v_exp_f32 v199, v199
v_exp_f32 v212, v212
v_exp_f32 v213, v213
v_exp_f32 v214, v214
v_exp_f32 v215, v215
v_cvt_pk_bf16_f32 v194, v208, v209
v_cvt_pk_bf16_f32 v195, v210, v211
MF a[128:131], v[48:51], v[188:191], a[128:131]
TR a[174:175], v16, 26624
v_exp_f32 v200, v200
v_exp_f32 v201, v201
v_exp_f32 v202, v202
v_exp_f32 v203, v203
v_exp_f32 v216, v216
v_exp_f32 v217, v217
v_exp_f32 v218, v218
v_exp_f32 v219, v219
v_cvt_pk_bf16_f32 v196, v196, v197
v_cvt_pk_bf16_f32 v197, v198, v199
v_cvt_pk_bf16_f32 v198, v212, v213
v_cvt_pk_bf16_f32 v199, v214, v215
MF a[132:135], v[48:51], v[192:195], a[132:135]
v_cvt_pk_bf16_f32 v200, v200, v201
v_cvt_pk_bf16_f32 v201, v202, v203
v_cvt_pk_bf16_f32 v202, v216, v217
v_cvt_pk_bf16_f32 v203, v218, v219
MF a[136:139], v[48:51], v[196:199], a[136:139]
s_nop 0
MF a[140:143], v[48:51], v[200:203], a[140:143]
s_add_u32 s56, s56, 4096
s_waitcnt lgkmcnt(8)
MF a[0:3], a[144:147], v[188:191], a[0:3]
v_exp_f32 v220, v220
MF a[32:35], a[144:147], v[192:195], a[32:35]
v_exp_f32 v221, v221
MF a[64:67], a[144:147], v[196:199], a[64:67]
v_exp_f32 v222, v222
MF a[96:99], a[144:147], v[200:203], a[96:99]
TR a[144:145], v13, 20480
v_cvt_pk_bf16_f32 v220, v220, v221
MF a[4:7], a[148:151], v[188:191], a[4:7]
TR a[146:147], v13, 22528
buffer_load_dwordx4 a[200:203], v29, s[20:23], s56 offen
MF a[36:39], a[148:151], v[192:195], a[36:39]
v_exp_f32 v223, v223
MF a[68:71], a[148:151], v[196:199], a[68:71]
v_exp_f32 v236, v236
MF a[100:103], a[148:151], v[200:203], a[100:103]
TR a[148:149], v14, 20480
v_cvt_pk_bf16_f32 v221, v222, v223
MF a[8:11], a[152:155], v[188:191], a[8:11]
TR a[150:151], v14, 22528
MF a[40:43], a[152:155], v[192:195], a[40:43]
v_exp_f32 v237, v237
MF a[72:75], a[152:155], v[196:199], a[72:75]
v_exp_f32 v238, v238
MF a[104:107], a[152:155], v[200:203], a[104:107]
TR a[152:153], v15, 20480
v_cvt_pk_bf16_f32 v222, v236, v237
MF a[12:15], a[156:159], v[188:191], a[12:15]
TR a[154:155], v15, 22528
MF a[44:47], a[156:159], v[192:195], a[44:47]
v_exp_f32 v239, v239
MF a[76:79], a[156:159], v[196:199], a[76:79]
v_exp_f32 v224, v224
MF a[108:111], a[156:159], v[200:203], a[108:111]
TR a[156:157], v16, 20480
s_waitcnt lgkmcnt(7)
MF a[16:19], a[160:163], v[188:191], a[16:19]
TR a[158:159], v16, 22528
v_cvt_pk_bf16_f32 v223, v238, v239
MF a[48:51], a[160:163], v[192:195], a[48:51]
v_exp_f32 v225, v225
MF a[80:83], a[160:163], v[196:199], a[80:83]
v_exp_f32 v226, v226
MF a[112:115], a[160:163], v[200:203], a[112:115]
TR a[160:161], v13, 28672
v_cvt_pk_bf16_f32 v224, v224, v225
MF a[20:23], a[164:167], v[188:191], a[20:23]
TR a[162:163], v13, 30720
s_add_u32 s56, s56, 4096
MF a[52:55], a[164:167], v[192:195], a[52:55]
v_exp_f32 v227, v227
MF a[84:87], a[164:167], v[196:199], a[84:87]
v_exp_f32 v240, v240
MF a[116:119], a[164:167], v[200:203], a[116:119]
TR a[164:165], v14, 28672
v_cvt_pk_bf16_f32 v225, v226, v227
MF a[24:27], a[168:171], v[188:191], a[24:27]
TR a[166:167], v14, 30720
buffer_load_dwordx4 a[200:203], v29, s[20:23], s56 offen
MF a[56:59], a[168:171], v[192:195], a[56:59]
v_exp_f32 v241, v241
MF a[88:91], a[168:171], v[196:199], a[88:91]
v_exp_f32 v242, v242
MF a[120:123], a[168:171], v[200:203], a[120:123]
TR a[168:169], v15, 28672
v_cvt_pk_bf16_f32 v226, v240, v241
MF a[28:31], a[172:175], v[188:191], a[28:31]
TR a[170:171], v15, 30720
MF a[60:63], a[172:175], v[192:195], a[60:63]
v_exp_f32 v243, v243
MF a[92:95], a[172:175], v[196:199], a[92:95]
v_exp_f32 v228, v228
MF a[124:127], a[172:175], v[200:203], a[124:127]
TR a[172:173], v16, 28672
v_exp_f32 v229, v229
v_exp_f32 v230, v230
v_exp_f32 v231, v231
v_exp_f32 v244, v244
v_exp_f32 v245, v245
v_exp_f32 v246, v246
v_exp_f32 v247, v247
v_cvt_pk_bf16_f32 v227, v242, v243
MF a[128:131], v[48:51], v[220:223], a[128:131]
TR a[174:175], v16, 30720
v_exp_f32 v232, v232
v_exp_f32 v233, v233
v_exp_f32 v234, v234
v_exp_f32 v235, v235
v_exp_f32 v248, v248
v_exp_f32 v249, v249
v_exp_f32 v250, v250
v_exp_f32 v251, v251
v_cvt_pk_bf16_f32 v228, v228, v229
v_cvt_pk_bf16_f32 v229, v230, v231
v_cvt_pk_bf16_f32 v230, v244, v245
v_cvt_pk_bf16_f32 v231, v246, v247
MF a[132:135], v[48:51], v[224:227], a[132:135]
v_cvt_pk_bf16_f32 v232, v232, v233
v_cvt_pk_bf16_f32 v233, v234, v235
v_cvt_pk_bf16_f32 v234, v248, v249
v_cvt_pk_bf16_f32 v235, v250, v251
MF a[136:139], v[48:51], v[228:231], a[136:139]
s_nop 0
MF a[140:143], v[48:51], v[232:235], a[140:143]
s_waitcnt lgkmcnt(8)
MF a[0:3], a[144:147], v[220:223], a[0:3]
s_waitcnt vmcnt(44)
v_accvgpr_read_b32 v52, a128
MF a[32:35], a[144:147], v[224:227], a[32:35]
s_barrier
v_accvgpr_read_b32 v53, a132
MF a[64:67], a[144:147], v[228:231], a[64:67]
v_accvgpr_read_b32 v54, a136
MF a[96:99], a[144:147], v[232:235], a[96:99]
TR a[144:145], v13, 32768
s_add_u32 s59, s35, s70
MF a[4:7], a[148:151], v[220:223], a[4:7]
TR a[146:147], v13, 34816
s_add_u32 s10, s20, s59
s_addc_u32 s11, s21, 0
MF a[36:39], a[148:151], v[224:227], a[36:39]
s_add_u32 m0, s38, 0
s_nop 0
global_load_lds_dwordx4 v9, s[10:11]
MF a[68:71], a[148:151], v[228:231], a[68:71]
v_accvgpr_read_b32 v55, a140
v_accvgpr_read_b32 v124, a0
MF a[100:103], a[148:151], v[232:235], a[100:103]
TR a[148:149], v14, 32768
v_accvgpr_read_b32 v125, a1
MF a[8:11], a[152:155], v[220:223], a[8:11]
TR a[150:151], v14, 34816
v_accvgpr_read_b32 v126, a2
MF a[40:43], a[152:155], v[224:227], a[40:43]
v_rcp_f32 v52, v52
MF a[72:75], a[152:155], v[228:231], a[72:75]
v_rcp_f32 v53, v53
MF a[104:107], a[152:155], v[232:235], a[104:107]
TR a[152:153], v13, 36864
global_load_lds_dwordx4 v10, s[10:11] offset:1024
MF a[12:15], a[156:159], v[220:223], a[12:15]
TR a[154:155], v13, 38912
v_accvgpr_read_b32 v127, a3
MF a[44:47], a[156:159], v[224:227], a[44:47]
v_rcp_f32 v54, v54
MF a[76:79], a[156:159], v[228:231], a[76:79]
v_rcp_f32 v55, v55
MF a[108:111], a[156:159], v[232:235], a[108:111]
TR a[156:157], v14, 36864
s_waitcnt lgkmcnt(7)
MF a[16:19], a[160:163], v[220:223], a[16:19]
TR a[158:159], v14, 38912
v_accvgpr_read_b32 v156, a32
MF a[48:51], a[160:163], v[224:227], a[48:51]
v_accvgpr_read_b32 v157, a33
v_accvgpr_read_b32 v158, a34
MF a[80:83], a[160:163], v[228:231], a[80:83]
v_accvgpr_read_b32 v159, a35
v_accvgpr_read_b32 v128, a4
MF a[112:115], a[160:163], v[232:235], a[112:115]
TR a[160:161], v13, 40960
global_load_lds_dwordx4 v11, s[10:11] offset:2048
MF a[20:23], a[164:167], v[220:223], a[20:23]
TR a[162:163], v13, 43008
v_accvgpr_read_b32 v129, a5
MF a[52:55], a[164:167], v[224:227], a[52:55]
v_accvgpr_read_b32 v130, a6
v_accvgpr_read_b32 v131, a7
MF a[84:87], a[164:167], v[228:231], a[84:87]
v_accvgpr_read_b32 v160, a36
v_accvgpr_read_b32 v161, a37
MF a[116:119], a[164:167], v[232:235], a[116:119]
TR a[164:165], v14, 40960
v_accvgpr_read_b32 v162, a38
MF a[24:27], a[168:171], v[220:223], a[24:27]
TR a[166:167], v14, 43008
v_accvgpr_read_b32 v163, a39
MF a[56:59], a[168:171], v[224:227], a[56:59]
v_accvgpr_read_b32 v132, a8
v_accvgpr_read_b32 v133, a9
MF a[88:91], a[168:171], v[228:231], a[88:91]
v_accvgpr_read_b32 v134, a10
v_accvgpr_read_b32 v135, a11
MF a[120:123], a[168:171], v[232:235], a[120:123]
TR a[168:169], v13, 45056
global_load_lds_dwordx4 v12, s[10:11] offset:3072
MF a[28:31], a[172:175], v[220:223], a[28:31]
TR a[170:171], v13, 47104
v_accvgpr_read_b32 v164, a40
MF a[60:63], a[172:175], v[224:227], a[60:63]
v_accvgpr_read_b32 v165, a41
v_accvgpr_read_b32 v166, a42
MF a[92:95], a[172:175], v[228:231], a[92:95]
v_accvgpr_read_b32 v167, a43
v_accvgpr_read_b32 v136, a12
MF a[124:127], a[172:175], v[232:235], a[124:127]
TR a[172:173], v14, 45056
v_accvgpr_read_b32 v137, a13
v_accvgpr_read_b32 v138, a14
v_accvgpr_read_b32 v139, a15
v_accvgpr_read_b32 v168, a44
v_accvgpr_read_b32 v169, a45
v_accvgpr_read_b32 v170, a46
v_accvgpr_read_b32 v171, a47
v_accvgpr_read_b32 v140, a16
v_accvgpr_read_b32 v141, a17
v_accvgpr_read_b32 v142, a18
v_accvgpr_read_b32 v143, a19
v_accvgpr_read_b32 v172, a48
v_accvgpr_read_b32 v173, a49
v_accvgpr_read_b32 v174, a50
v_accvgpr_read_b32 v175, a51
v_accvgpr_read_b32 v144, a20
v_accvgpr_read_b32 v145, a21
v_accvgpr_read_b32 v146, a22
v_accvgpr_read_b32 v147, a23
v_accvgpr_read_b32 v176, a52
v_accvgpr_read_b32 v177, a53
v_accvgpr_read_b32 v178, a54
v_accvgpr_read_b32 v179, a55
v_accvgpr_read_b32 v148, a24
v_accvgpr_read_b32 v149, a25
v_accvgpr_read_b32 v150, a26
v_accvgpr_read_b32 v151, a27
v_accvgpr_read_b32 v180, a56
v_accvgpr_read_b32 v181, a57
v_accvgpr_read_b32 v182, a58
v_accvgpr_read_b32 v183, a59
v_accvgpr_read_b32 v152, a28
v_accvgpr_read_b32 v153, a29
v_accvgpr_read_b32 v154, a30
v_accvgpr_read_b32 v155, a31
v_accvgpr_read_b32 v184, a60
v_accvgpr_read_b32 v185, a61
v_accvgpr_read_b32 v186, a62
v_accvgpr_read_b32 v187, a63
v_mov_b32 v32, v52
v_mov_b32 v33, v52
v_mov_b32 v34, v53
v_mov_b32 v35, v53
v_mov_b32 v36, v54
v_mov_b32 v37, v54
v_mov_b32 v38, v55
v_mov_b32 v39, v55
v_pk_mul_f32 v[124:125], v[124:125], v[32:33]
v_pk_mul_f32 v[126:127], v[126:127], v[32:33]
v_cvt_pk_bf16_f32 v60, v124, v125
v_cvt_pk_bf16_f32 v61, v126, v127
v_pk_mul_f32 v[156:157], v[156:157], v[34:35]
v_pk_mul_f32 v[158:159], v[158:159], v[34:35]
v_cvt_pk_bf16_f32 v76, v156, v157
v_cvt_pk_bf16_f32 v77, v158, v159
v_pk_mul_f32 v[128:129], v[128:129], v[32:33]
v_pk_mul_f32 v[130:131], v[130:131], v[32:33]
v_cvt_pk_bf16_f32 v62, v128, v129
v_cvt_pk_bf16_f32 v63, v130, v131
v_pk_mul_f32 v[160:161], v[160:161], v[34:35]
v_pk_mul_f32 v[162:163], v[162:163], v[34:35]
v_cvt_pk_bf16_f32 v78, v160, v161
v_cvt_pk_bf16_f32 v79, v162, v163
v_pk_mul_f32 v[132:133], v[132:133], v[32:33]
v_pk_mul_f32 v[134:135], v[134:135], v[32:33]
v_cvt_pk_bf16_f32 v64, v132, v133
v_cvt_pk_bf16_f32 v65, v134, v135
v_pk_mul_f32 v[164:165], v[164:165], v[34:35]
v_pk_mul_f32 v[166:167], v[166:167], v[34:35]
v_cvt_pk_bf16_f32 v80, v164, v165
v_cvt_pk_bf16_f32 v81, v166, v167
v_pk_mul_f32 v[136:137], v[136:137], v[32:33]
v_pk_mul_f32 v[138:139], v[138:139], v[32:33]
v_cvt_pk_bf16_f32 v66, v136, v137
v_cvt_pk_bf16_f32 v67, v138, v139
v_pk_mul_f32 v[168:169], v[168:169], v[34:35]
v_pk_mul_f32 v[170:171], v[170:171], v[34:35]
v_cvt_pk_bf16_f32 v82, v168, v169
v_cvt_pk_bf16_f32 v83, v170, v171
v_pk_mul_f32 v[140:141], v[140:141], v[32:33]
v_pk_mul_f32 v[142:143], v[142:143], v[32:33]
v_cvt_pk_bf16_f32 v68, v140, v141
v_cvt_pk_bf16_f32 v69, v142, v143
v_pk_mul_f32 v[172:173], v[172:173], v[34:35]
v_pk_mul_f32 v[174:175], v[174:175], v[34:35]
v_cvt_pk_bf16_f32 v84, v172, v173
v_cvt_pk_bf16_f32 v85, v174, v175
v_pk_mul_f32 v[144:145], v[144:145], v[32:33]
v_pk_mul_f32 v[146:147], v[146:147], v[32:33]
v_cvt_pk_bf16_f32 v70, v144, v145
v_cvt_pk_bf16_f32 v71, v146, v147
v_pk_mul_f32 v[176:177], v[176:177], v[34:35]
v_pk_mul_f32 v[178:179], v[178:179], v[34:35]
v_cvt_pk_bf16_f32 v86, v176, v177
v_cvt_pk_bf16_f32 v87, v178, v179
v_pk_mul_f32 v[148:149], v[148:149], v[32:33]
v_pk_mul_f32 v[150:151], v[150:151], v[32:33]
v_cvt_pk_bf16_f32 v72, v148, v149
v_cvt_pk_bf16_f32 v73, v150, v151
v_pk_mul_f32 v[180:181], v[180:181], v[34:35]
v_pk_mul_f32 v[182:183], v[182:183], v[34:35]
v_cvt_pk_bf16_f32 v88, v180, v181
v_cvt_pk_bf16_f32 v89, v182, v183
v_pk_mul_f32 v[152:153], v[152:153], v[32:33]
v_pk_mul_f32 v[154:155], v[154:155], v[32:33]
v_cvt_pk_bf16_f32 v74, v152, v153
v_cvt_pk_bf16_f32 v75, v154, v155
v_pk_mul_f32 v[184:185], v[184:185], v[34:35]
v_pk_mul_f32 v[186:187], v[186:187], v[34:35]
v_cvt_pk_bf16_f32 v90, v184, v185
v_cvt_pk_bf16_f32 v91, v186, v187
v_accvgpr_read_b32 v188, a64
v_accvgpr_read_b32 v189, a65
v_accvgpr_read_b32 v190, a66
v_accvgpr_read_b32 v191, a67
v_pk_mul_f32 v[188:189], v[188:189], v[36:37]
v_pk_mul_f32 v[190:191], v[190:191], v[36:37]
v_cvt_pk_bf16_f32 v92, v188, v189
v_cvt_pk_bf16_f32 v93, v190, v191
v_accvgpr_read_b32 v220, a96
v_accvgpr_read_b32 v221, a97
v_accvgpr_read_b32 v222, a98
v_accvgpr_read_b32 v223, a99
v_pk_mul_f32 v[220:221], v[220:221], v[38:39]
v_pk_mul_f32 v[222:223], v[222:223], v[38:39]
v_cvt_pk_bf16_f32 v108, v220, v221
v_cvt_pk_bf16_f32 v109, v222, v223
v_accvgpr_read_b32 v192, a68
v_accvgpr_read_b32 v193, a69
v_accvgpr_read_b32 v194, a70
v_accvgpr_read_b32 v195, a71
v_pk_mul_f32 v[192:193], v[192:193], v[36:37]
v_pk_mul_f32 v[194:195], v[194:195], v[36:37]
v_cvt_pk_bf16_f32 v94, v192, v193
v_cvt_pk_bf16_f32 v95, v194, v195
v_accvgpr_read_b32 v224, a100
v_accvgpr_read_b32 v225, a101
v_accvgpr_read_b32 v226, a102
v_accvgpr_read_b32 v227, a103
v_pk_mul_f32 v[224:225], v[224:225], v[38:39]
v_pk_mul_f32 v[226:227], v[226:227], v[38:39]
v_cvt_pk_bf16_f32 v110, v224, v225
v_cvt_pk_bf16_f32 v111, v226, v227
v_accvgpr_read_b32 v196, a72
v_accvgpr_read_b32 v197, a73
v_accvgpr_read_b32 v198, a74
v_accvgpr_read_b32 v199, a75
v_pk_mul_f32 v[196:197], v[196:197], v[36:37]
v_pk_mul_f32 v[198:199], v[198:199], v[36:37]
v_cvt_pk_bf16_f32 v96, v196, v197
v_cvt_pk_bf16_f32 v97, v198, v199
v_accvgpr_read_b32 v228, a104
v_accvgpr_read_b32 v229, a105
v_accvgpr_read_b32 v230, a106
v_accvgpr_read_b32 v231, a107
v_pk_mul_f32 v[228:229], v[228:229], v[38:39]
v_pk_mul_f32 v[230:231], v[230:231], v[38:39]
v_cvt_pk_bf16_f32 v112, v228, v229
v_cvt_pk_bf16_f32 v113, v230, v231
v_accvgpr_read_b32 v200, a76
v_accvgpr_read_b32 v201, a77
v_accvgpr_read_b32 v202, a78
v_accvgpr_read_b32 v203, a79
v_pk_mul_f32 v[200:201], v[200:201], v[36:37]
v_pk_mul_f32 v[202:203], v[202:203], v[36:37]
v_cvt_pk_bf16_f32 v98, v200, v201
v_cvt_pk_bf16_f32 v99, v202, v203
v_accvgpr_read_b32 v232, a108
v_accvgpr_read_b32 v233, a109
v_accvgpr_read_b32 v234, a110
v_accvgpr_read_b32 v235, a111
v_pk_mul_f32 v[232:233], v[232:233], v[38:39]
v_pk_mul_f32 v[234:235], v[234:235], v[38:39]
v_cvt_pk_bf16_f32 v114, v232, v233
v_cvt_pk_bf16_f32 v115, v234, v235
v_mbcnt_lo_u32_b32 v58, -1, 0
v_mbcnt_hi_u32_b32 v58, -1, v58
v_lshrrev_b32 v56, 4, v58
v_bfe_u32 v57, v58, 2, 2
v_cmp_eq_u32 vcc, v56, v57
v_and_b32 v56, 1, v58
v_lshlrev_b32 v56, 4, v56
v_mov_b32 v57, 0x3f80
v_lshlrev_b32 v56, v56, v57
v_cndmask_b32 v56, 0, v56, vcc
v_and_b32 v57, 2, v58
v_cmp_eq_u32 vcc, 0, v57
v_mov_b32 v40, 0
v_mov_b32 v41, 0
v_cndmask_b32 v42, 0, v56, vcc
v_cndmask_b32 v43, v56, 0, vcc
v_mov_b32 v44, 0
v_mov_b32 v45, 0
s_waitcnt lgkmcnt(7)
MF v[124:127], a[144:147], v[60:63], 0
TR a[174:175], v14, 47104
MF v[128:131], a[144:147], v[76:79], 0
TR a[144:145], v15, 32768
MF v[132:135], a[148:151], v[60:63], 0
TR a[146:147], v15, 34816
v_accvgpr_read_b32 v204, a80
MF v[136:139], a[148:151], v[76:79], 0
TR a[148:149], v16, 32768
v_accvgpr_read_b32 v205, a81
MF v[124:127], a[152:155], v[64:67], v[124:127]
TR a[150:151], v16, 34816
v_accvgpr_read_b32 v206, a82
MF v[128:131], a[152:155], v[80:83], v[128:131]
TR a[152:153], v15, 36864
v_accvgpr_read_b32 v207, a83
MF v[132:135], a[156:159], v[64:67], v[132:135]
TR a[154:155], v15, 38912
v_mul_f32 v204, v204, v54
MF v[136:139], a[156:159], v[80:83], v[136:139]
TR a[156:157], v16, 36864
s_waitcnt lgkmcnt(7)
MF v[124:127], a[160:163], v[68:71], v[124:127]
TR a[158:159], v16, 38912
v_mul_f32 v205, v205, v54
MF v[128:131], a[160:163], v[84:87], v[128:131]
TR a[160:161], v15, 40960
v_mul_f32 v206, v206, v54
MF v[132:135], a[164:167], v[68:71], v[132:135]
TR a[162:163], v15, 43008
v_mul_f32 v207, v207, v54
MF v[136:139], a[164:167], v[84:87], v[136:139]
TR a[164:165], v16, 40960
v_cvt_pk_bf16_f32 v100, v204, v205
MF v[124:127], a[168:171], v[72:75], v[124:127]
TR a[166:167], v16, 43008
v_cvt_pk_bf16_f32 v101, v206, v207
MF v[128:131], a[168:171], v[88:91], v[128:131]
TR a[168:169], v15, 45056
v_accvgpr_read_b32 v236, a112
MF v[132:135], a[172:175], v[72:75], v[132:135]
TR a[170:171], v15, 47104
s_waitcnt vmcnt(40)
MF v[136:139], a[172:175], v[88:91], v[136:139]
TR a[172:173], v16, 45056
s_waitcnt lgkmcnt(7)
MF v[140:143], a[144:147], v[60:63], 0
TR a[174:175], v16, 47104
s_barrier
MF v[144:147], a[144:147], v[76:79], 0
TR a[144:145], v13, 49152
s_add_u32 s10, s10, 147456
s_addc_u32 s11, s11, 0
MF v[148:151], a[148:151], v[60:63], 0
TR a[146:147], v13, 51200
s_add_u32 m0, s38, 16384
MF v[152:155], a[148:151], v[76:79], 0
TR a[148:149], v14, 49152
global_load_lds_dwordx4 v9, s[10:11]
MF v[140:143], a[152:155], v[64:67], v[140:143]
TR a[150:151], v14, 51200
s_waitcnt vmcnt(14)
v_readfirstlane_b32 s68, v0
s_nop 0
s_cmp_eq_u32 s68, s67
s_cselect_b64 vcc, 0, -1
MF v[144:147], a[152:155], v[80:83], v[144:147]
TR a[152:153], v13, 53248
MF v[148:151], a[156:159], v[64:67], v[148:151]
TR a[154:155], v13, 55296
MF v[152:155], a[156:159], v[80:83], v[152:155]
TR a[156:157], v14, 53248
s_waitcnt lgkmcnt(7)
MF v[140:143], a[160:163], v[68:71], v[140:143]
TR a[158:159], v14, 55296
global_load_lds_dwordx4 v10, s[10:11] offset:1024
MF v[144:147], a[160:163], v[84:87], v[144:147]
TR a[160:161], v13, 57344
global_load_lds_dwordx4 v11, s[10:11] offset:2048
MF v[148:151], a[164:167], v[68:71], v[148:151]
TR a[162:163], v13, 59392
v_accvgpr_read_b32 v237, a113
MF v[152:155], a[164:167], v[84:87], v[152:155]
TR a[164:165], v14, 57344
v_accvgpr_read_b32 v238, a114
MF v[140:143], a[168:171], v[72:75], v[140:143]
TR a[166:167], v14, 59392
v_accvgpr_read_b32 v239, a115
MF v[144:147], a[168:171], v[88:91], v[144:147]
TR a[168:169], v13, 61440
global_load_lds_dwordx4 v12, s[10:11] offset:3072
MF v[148:151], a[172:175], v[72:75], v[148:151]
TR a[170:171], v13, 63488
s_add_u32 s70, s70, 128
MF v[152:155], a[172:175], v[88:91], v[152:155]
TR a[172:173], v14, 61440
s_waitcnt lgkmcnt(7)
MF v[124:127], a[144:147], v[92:95], v[124:127]
TR a[174:175], v14, 63488
s_cmp_eq_u32 s70, 1152
s_cselect_b32 s70, 0, s70
MF v[128:131], a[144:147], v[108:111], v[128:131]
TR a[144:145], v15, 49152
v_mul_f32 v236, v236, v55
MF v[132:135], a[148:151], v[92:95], v[132:135]
TR a[146:147], v15, 51200
v_mul_f32 v237, v237, v55
MF v[136:139], a[148:151], v[108:111], v[136:139]
TR a[148:149], v16, 49152
v_mul_f32 v238, v238, v55
MF v[124:127], a[152:155], v[96:99], v[124:127]
TR a[150:151], v16, 51200
v_mul_f32 v239, v239, v55
MF v[128:131], a[152:155], v[112:115], v[128:131]
TR a[152:153], v15, 53248
v_cvt_pk_bf16_f32 v116, v236, v237
MF v[132:135], a[156:159], v[96:99], v[132:135]
TR a[154:155], v15, 55296
v_cvt_pk_bf16_f32 v117, v238, v239
MF v[136:139], a[156:159], v[112:115], v[136:139]
TR a[156:157], v16, 53248
v_accvgpr_read_b32 v208, a84
v_accvgpr_read_b32 v209, a85
v_accvgpr_read_b32 v210, a86
v_accvgpr_read_b32 v211, a87
v_mul_f32 v208, v208, v54
v_mul_f32 v209, v209, v54
v_mul_f32 v210, v210, v54
v_mul_f32 v211, v211, v54
v_cvt_pk_bf16_f32 v102, v208, v209
v_cvt_pk_bf16_f32 v103, v210, v211
v_accvgpr_read_b32 v240, a116
v_accvgpr_read_b32 v241, a117
v_accvgpr_read_b32 v242, a118
v_accvgpr_read_b32 v243, a119
v_mul_f32 v240, v240, v55
v_mul_f32 v241, v241, v55
v_mul_f32 v242, v242, v55
v_mul_f32 v243, v243, v55
v_cvt_pk_bf16_f32 v118, v240, v241
v_cvt_pk_bf16_f32 v119, v242, v243
s_waitcnt lgkmcnt(7)
MF v[124:127], a[160:163], v[100:103], v[124:127]
TR a[158:159], v16, 55296
MF v[128:131], a[160:163], v[116:119], v[128:131]
TR a[160:161], v15, 57344
MF v[132:135], a[164:167], v[100:103], v[132:135]
TR a[162:163], v15, 59392
v_accvgpr_read_b32 v212, a88
MF v[136:139], a[164:167], v[116:119], v[136:139]
TR a[164:165], v16, 57344
v_accvgpr_read_b32 v213, a89
v_accvgpr_read_b32 v214, a90
v_accvgpr_read_b32 v215, a91
v_mul_f32 v212, v212, v54
v_mul_f32 v213, v213, v54
v_mul_f32 v214, v214, v54
v_mul_f32 v215, v215, v54
v_cvt_pk_bf16_f32 v104, v212, v213
v_cvt_pk_bf16_f32 v105, v214, v215
v_accvgpr_read_b32 v244, a120
v_accvgpr_read_b32 v245, a121
v_accvgpr_read_b32 v246, a122
v_accvgpr_read_b32 v247, a123
v_mul_f32 v244, v244, v55
v_mul_f32 v245, v245, v55
v_mul_f32 v246, v246, v55
v_mul_f32 v247, v247, v55
v_cvt_pk_bf16_f32 v120, v244, v245
v_cvt_pk_bf16_f32 v121, v246, v247
v_accvgpr_read_b32 v216, a92
v_accvgpr_read_b32 v217, a93
v_accvgpr_read_b32 v218, a94
v_accvgpr_read_b32 v219, a95
v_mul_f32 v216, v216, v54
v_mul_f32 v217, v217, v54
v_mul_f32 v218, v218, v54
v_mul_f32 v219, v219, v54
v_cvt_pk_bf16_f32 v106, v216, v217
v_cvt_pk_bf16_f32 v107, v218, v219
v_accvgpr_read_b32 v248, a124
v_accvgpr_read_b32 v249, a125
v_accvgpr_read_b32 v250, a126
v_accvgpr_read_b32 v251, a127
v_mul_f32 v248, v248, v55
v_mul_f32 v249, v249, v55
v_mul_f32 v250, v250, v55
v_mul_f32 v251, v251, v55
v_cvt_pk_bf16_f32 v122, v248, v249
v_cvt_pk_bf16_f32 v123, v250, v251
MF v[124:127], a[168:171], v[104:107], v[124:127]
TR a[166:167], v16, 59392
MF v[128:131], a[168:171], v[120:123], v[128:131]
TR a[168:169], v15, 61440
MF v[132:135], a[172:175], v[104:107], v[132:135]
TR a[170:171], v15, 63488
MF v[136:139], a[172:175], v[120:123], v[136:139]
TR a[172:173], v16, 61440
s_waitcnt lgkmcnt(7)
MF v[140:143], a[144:147], v[92:95], v[140:143]
TR a[174:175], v16, 63488
s_barrier
MF v[144:147], a[144:147], v[108:111], v[144:147]
TR a[144:145], v17, 0
s_add_u32 s59, s35, s70
MF v[148:151], a[148:151], v[92:95], v[148:151]
TR a[146:147], v17, 2048
s_add_u32 s10, s20, s59
s_addc_u32 s11, s21, 0
MF v[152:155], a[148:151], v[108:111], v[152:155]
TR a[148:149], v18, 0
s_add_u32 m0, s38, 32768
MF v[140:143], a[152:155], v[96:99], v[140:143]
TR a[150:151], v18, 2048
global_load_lds_dwordx4 v9, s[10:11]
MF v[144:147], a[152:155], v[112:115], v[144:147]
TR a[152:153], v17, 4096
global_load_lds_dwordx4 v10, s[10:11] offset:1024
MF v[148:151], a[156:159], v[96:99], v[148:151]
TR a[154:155], v17, 6144
v_cvt_pk_bf16_f32 v156, v124, v125
MF v[152:155], a[156:159], v[112:115], v[152:155]
TR a[156:157], v18, 4096
s_waitcnt lgkmcnt(7)
MF v[140:143], a[160:163], v[100:103], v[140:143]
TR a[158:159], v18, 6144
v_cvt_pk_bf16_f32 v157, v126, v127
MF v[144:147], a[160:163], v[116:119], v[144:147]
TR a[160:161], v17, 8192
global_load_lds_dwordx4 v11, s[10:11] offset:2048
MF v[148:151], a[164:167], v[100:103], v[148:151]
TR a[162:163], v17, 10240
v_cvt_pk_bf16_f32 v158, v132, v133
MF v[152:155], a[164:167], v[116:119], v[152:155]
TR a[164:165], v18, 8192
v_cvt_pk_bf16_f32 v159, v134, v135
MF v[140:143], a[168:171], v[104:107], v[140:143]
TR a[166:167], v18, 10240
s_cbranch_vccnz ka_kernel_pa31
buffer_store_dwordx4 v[156:159], v29, s[28:31], s72 offen
ka_kernel_pb32:
MF v[144:147], a[168:171], v[120:123], v[144:147]
TR a[168:169], v17, 12288
global_load_lds_dwordx4 v12, s[10:11] offset:3072
MF v[148:151], a[172:175], v[104:107], v[148:151]
TR a[170:171], v17, 14336
v_cvt_pk_bf16_f32 v160, v128, v129
MF v[152:155], a[172:175], v[120:123], v[152:155]
TR a[172:173], v18, 12288
v_cvt_pk_bf16_f32 v161, v130, v131
v_cvt_pk_bf16_f32 v162, v136, v137
v_cvt_pk_bf16_f32 v163, v138, v139
s_waitcnt lgkmcnt(7)
MF v[124:127], a[144:147], v[60:63], 0
TR a[174:175], v18, 14336
MF v[128:131], a[144:147], v[76:79], 0
TR a[144:145], v19, 0
MF v[132:135], a[148:151], v[60:63], 0
TR a[146:147], v19, 2048
s_cbranch_vccnz ka_kernel_pa33
buffer_store_dwordx4 v[160:163], v30, s[28:31], s72 offen
ka_kernel_pb34:
MF v[136:139], a[148:151], v[76:79], 0
TR a[148:149], v20, 0
v_cvt_pk_bf16_f32 v164, v140, v141
MF v[124:127], a[152:155], v[64:67], v[124:127]
TR a[150:151], v20, 2048
v_cvt_pk_bf16_f32 v165, v142, v143
MF v[128:131], a[152:155], v[80:83], v[128:131]
TR a[152:153], v19, 4096
v_cvt_pk_bf16_f32 v166, v148, v149
MF v[132:135], a[156:159], v[64:67], v[132:135]
TR a[154:155], v19, 6144
v_cvt_pk_bf16_f32 v167, v150, v151
MF v[136:139], a[156:159], v[80:83], v[136:139]
TR a[156:157], v20, 4096
s_waitcnt lgkmcnt(7)
MF v[124:127], a[160:163], v[68:71], v[124:127]
TR a[158:159], v20, 6144
s_cbranch_vccnz ka_kernel_pa35
buffer_store_dwordx4 v[164:167], v29, s[28:31], s72 offen offset:1024
ka_kernel_pb36:
MF v[128:131], a[160:163], v[84:87], v[128:131]
TR a[160:161], v19, 8192
v_cvt_pk_bf16_f32 v168, v144, v145
MF v[132:135], a[164:167], v[68:71], v[132:135]
TR a[162:163], v19, 10240
v_cvt_pk_bf16_f32 v169, v146, v147
MF v[136:139], a[164:167], v[84:87], v[136:139]
TR a[164:165], v20, 8192
v_cvt_pk_bf16_f32 v170, v152, v153
MF v[124:127], a[168:171], v[72:75], v[124:127]
TR a[166:167], v20, 10240
v_cvt_pk_bf16_f32 v171, v154, v155
MF v[128:131], a[168:171], v[88:91], v[128:131]
TR a[168:169], v19, 12288
s_cbranch_vccnz ka_kernel_pa37
buffer_store_dwordx4 v[168:171], v30, s[28:31], s72 offen offset:1024
ka_kernel_pb38:
MF v[132:135], a[172:175], v[72:75], v[132:135]
TR a[170:171], v19, 14336
MF v[136:139], a[172:175], v[88:91], v[136:139]
TR a[172:173], v20, 12288
s_waitcnt lgkmcnt(7)
MF v[140:143], a[144:147], v[60:63], 0
TR a[174:175], v20, 14336
s_barrier
MF v[144:147], a[144:147], v[76:79], 0
TR a[144:145], v17, 16384
s_add_u32 s10, s10, 147456
s_addc_u32 s11, s11, 0
MF v[148:151], a[148:151], v[60:63], 0
TR a[146:147], v17, 18432
s_add_u32 m0, s38, 49152
MF v[152:155], a[148:151], v[76:79], 0
TR a[148:149], v18, 16384
global_load_lds_dwordx4 v9, s[10:11]
MF v[140:143], a[152:155], v[64:67], v[140:143]
TR a[150:151], v18, 18432
MF v[144:147], a[152:155], v[80:83], v[144:147]
TR a[152:153], v17, 20480
global_load_lds_dwordx4 v10, s[10:11] offset:1024
MF v[148:151], a[156:159], v[64:67], v[148:151]
TR a[154:155], v17, 22528
MF v[152:155], a[156:159], v[80:83], v[152:155]
TR a[156:157], v18, 20480
s_waitcnt lgkmcnt(7)
MF v[140:143], a[160:163], v[68:71], v[140:143]
TR a[158:159], v18, 22528
MF v[144:147], a[160:163], v[84:87], v[144:147]
TR a[160:161], v17, 24576
global_load_lds_dwordx4 v11, s[10:11] offset:2048
MF v[148:151], a[164:167], v[68:71], v[148:151]
TR a[162:163], v17, 26624
MF v[152:155], a[164:167], v[84:87], v[152:155]
TR a[164:165], v18, 24576
MF v[140:143], a[168:171], v[72:75], v[140:143]
TR a[166:167], v18, 26624
MF v[144:147], a[168:171], v[88:91], v[144:147]
TR a[168:169], v17, 28672
global_load_lds_dwordx4 v12, s[10:11] offset:3072
MF v[148:151], a[172:175], v[72:75], v[148:151]
TR a[170:171], v17, 30720
s_add_u32 s70, s70, 128
MF v[152:155], a[172:175], v[88:91], v[152:155]
TR a[172:173], v18, 28672
s_waitcnt lgkmcnt(7)
MF v[124:127], a[144:147], v[92:95], v[124:127]
TR a[174:175], v18, 30720
s_cmp_eq_u32 s70, 1152
s_cselect_b32 s70, 0, s70
MF v[128:131], a[144:147], v[108:111], v[128:131]
TR a[144:145], v19, 16384
v_mov_b32 v255, 1
MF v[132:135], a[148:151], v[92:95], v[132:135]
TR a[146:147], v19, 18432
MF v[136:139], a[148:151], v[108:111], v[136:139]
TR a[148:149], v20, 16384
s_waitcnt vmcnt(4)
MF v[124:127], a[152:155], v[96:99], v[124:127]
TR a[150:151], v20, 18432
s_cbranch_vccnz ka_kernel_pa39
buffer_store_dword v255, v31, s[60:63], s64 offen offset:4
ka_kernel_pb40:
MF v[128:131], a[152:155], v[112:115], v[128:131]
TR a[152:153], v19, 20480
MF v[132:135], a[156:159], v[96:99], v[132:135]
TR a[154:155], v19, 22528
MF v[136:139], a[156:159], v[112:115], v[136:139]
TR a[156:157], v20, 20480
s_waitcnt lgkmcnt(7)
MF v[124:127], a[160:163], v[100:103], v[124:127]
TR a[158:159], v20, 22528
MF v[128:131], a[160:163], v[116:119], v[128:131]
TR a[160:161], v19, 24576
MF v[132:135], a[164:167], v[100:103], v[132:135]
TR a[162:163], v19, 26624
MF v[136:139], a[164:167], v[116:119], v[136:139]
TR a[164:165], v20, 24576
MF v[124:127], a[168:171], v[104:107], v[124:127]
TR a[166:167], v20, 26624
MF v[128:131], a[168:171], v[120:123], v[128:131]
TR a[168:169], v19, 28672
MF v[132:135], a[172:175], v[104:107], v[132:135]
TR a[170:171], v19, 30720
MF v[136:139], a[172:175], v[120:123], v[136:139]
TR a[172:173], v20, 28672
s_waitcnt lgkmcnt(7)
MF v[140:143], a[144:147], v[92:95], v[140:143]
TR a[174:175], v20, 30720
s_barrier
MF v[144:147], a[144:147], v[108:111], v[144:147]
TR a[144:145], v17, 32768
s_add_u32 s59, s35, s70
MF v[148:151], a[148:151], v[92:95], v[148:151]
TR a[146:147], v17, 34816
s_add_u32 s10, s20, s59
s_addc_u32 s11, s21, 0
MF v[152:155], a[148:151], v[108:111], v[152:155]
TR a[148:149], v18, 32768
s_add_u32 m0, s38, 65536
MF v[140:143], a[152:155], v[96:99], v[140:143]
TR a[150:151], v18, 34816
global_load_lds_dwordx4 v9, s[10:11]
MF v[144:147], a[152:155], v[112:115], v[144:147]
TR a[152:153], v17, 36864
global_load_lds_dwordx4 v10, s[10:11] offset:1024
MF v[148:151], a[156:159], v[96:99], v[148:151]
TR a[154:155], v17, 38912
v_cvt_pk_bf16_f32 v156, v124, v125
MF v[152:155], a[156:159], v[112:115], v[152:155]
TR a[156:157], v18, 36864
s_waitcnt lgkmcnt(7)
MF v[140:143], a[160:163], v[100:103], v[140:143]
TR a[158:159], v18, 38912
v_cvt_pk_bf16_f32 v157, v126, v127
MF v[144:147], a[160:163], v[116:119], v[144:147]
TR a[160:161], v17, 40960
global_load_lds_dwordx4 v11, s[10:11] offset:2048
MF v[148:151], a[164:167], v[100:103], v[148:151]
TR a[162:163], v17, 43008
v_cvt_pk_bf16_f32 v158, v132, v133
MF v[152:155], a[164:167], v[116:119], v[152:155]
TR a[164:165], v18, 40960
v_cvt_pk_bf16_f32 v159, v134, v135
MF v[140:143], a[168:171], v[104:107], v[140:143]
TR a[166:167], v18, 43008
s_cbranch_vccnz ka_kernel_pa41
buffer_store_dwordx4 v[156:159], v29, s[28:31], s73 offen
ka_kernel_pb42:
MF v[144:147], a[168:171], v[120:123], v[144:147]
TR a[168:169], v17, 45056
global_load_lds_dwordx4 v12, s[10:11] offset:3072
MF v[148:151], a[172:175], v[104:107], v[148:151]
TR a[170:171], v17, 47104
v_cvt_pk_bf16_f32 v160, v128, v129
MF v[152:155], a[172:175], v[120:123], v[152:155]
TR a[172:173], v18, 45056
v_cvt_pk_bf16_f32 v161, v130, v131
v_cvt_pk_bf16_f32 v162, v136, v137
v_cvt_pk_bf16_f32 v163, v138, v139
s_waitcnt lgkmcnt(7)
MF v[124:127], a[144:147], v[60:63], 0
TR a[174:175], v18, 47104
MF v[128:131], a[144:147], v[76:79], 0
TR a[144:145], v19, 32768
MF v[132:135], a[148:151], v[60:63], 0
TR a[146:147], v19, 34816
s_cbranch_vccnz ka_kernel_pa43
buffer_store_dwordx4 v[160:163], v30, s[28:31], s73 offen
ka_kernel_pb44:
MF v[136:139], a[148:151], v[76:79], 0
TR a[148:149], v20, 32768
v_cvt_pk_bf16_f32 v164, v140, v141
MF v[124:127], a[152:155], v[64:67], v[124:127]
TR a[150:151], v20, 34816
v_cvt_pk_bf16_f32 v165, v142, v143
MF v[128:131], a[152:155], v[80:83], v[128:131]
TR a[152:153], v19, 36864
v_cvt_pk_bf16_f32 v166, v148, v149
MF v[132:135], a[156:159], v[64:67], v[132:135]
TR a[154:155], v19, 38912
v_cvt_pk_bf16_f32 v167, v150, v151
MF v[136:139], a[156:159], v[80:83], v[136:139]
TR a[156:157], v20, 36864
s_waitcnt lgkmcnt(7)
MF v[124:127], a[160:163], v[68:71], v[124:127]
TR a[158:159], v20, 38912
buffer_load_dword v0, v31, s[60:63], s65 offen offset:4 sc1
MF v[128:131], a[160:163], v[84:87], v[128:131]
TR a[160:161], v19, 40960
s_cbranch_vccnz ka_kernel_pa45
buffer_store_dwordx4 v[164:167], v29, s[28:31], s73 offen offset:1024
ka_kernel_pb46:
MF v[132:135], a[164:167], v[68:71], v[132:135]
TR a[162:163], v19, 43008
v_cvt_pk_bf16_f32 v168, v144, v145
MF v[136:139], a[164:167], v[84:87], v[136:139]
TR a[164:165], v20, 40960
v_cvt_pk_bf16_f32 v169, v146, v147
MF v[124:127], a[168:171], v[72:75], v[124:127]
TR a[166:167], v20, 43008
v_cvt_pk_bf16_f32 v170, v152, v153
MF v[128:131], a[168:171], v[88:91], v[128:131]
TR a[168:169], v19, 45056
v_cvt_pk_bf16_f32 v171, v154, v155
MF v[132:135], a[172:175], v[72:75], v[132:135]
TR a[170:171], v19, 47104
MF v[136:139], a[172:175], v[88:91], v[136:139]
TR a[172:173], v20, 45056
s_waitcnt lgkmcnt(7)
MF v[140:143], a[144:147], v[60:63], 0
TR a[174:175], v20, 47104
s_barrier
MF v[144:147], a[144:147], v[76:79], 0
TR a[144:145], v17, 49152
s_add_u32 s10, s10, 147456
s_addc_u32 s11, s11, 0
MF v[148:151], a[148:151], v[60:63], 0
TR a[146:147], v17, 51200
s_add_u32 m0, s38, 81920
MF v[152:155], a[148:151], v[76:79], 0
TR a[148:149], v18, 49152
global_load_lds_dwordx4 v9, s[10:11]
MF v[140:143], a[152:155], v[64:67], v[140:143]
TR a[150:151], v18, 51200
s_cbranch_vccnz ka_kernel_pa47
buffer_store_dwordx4 v[168:171], v30, s[28:31], s73 offen offset:1024
ka_kernel_pb48:
MF v[144:147], a[152:155], v[80:83], v[144:147]
TR a[152:153], v17, 53248
global_load_lds_dwordx4 v10, s[10:11] offset:1024
MF v[148:151], a[156:159], v[64:67], v[148:151]
TR a[154:155], v17, 55296
MF v[152:155], a[156:159], v[80:83], v[152:155]
TR a[156:157], v18, 53248
s_waitcnt lgkmcnt(7)
MF v[140:143], a[160:163], v[68:71], v[140:143]
TR a[158:159], v18, 55296
MF v[144:147], a[160:163], v[84:87], v[144:147]
TR a[160:161], v17, 57344
global_load_lds_dwordx4 v11, s[10:11] offset:2048
MF v[148:151], a[164:167], v[68:71], v[148:151]
TR a[162:163], v17, 59392
MF v[152:155], a[164:167], v[84:87], v[152:155]
TR a[164:165], v18, 57344
MF v[140:143], a[168:171], v[72:75], v[140:143]
TR a[166:167], v18, 59392
s_waitcnt vmcnt(5)
v_readfirstlane_b32 s68, v0
MF v[144:147], a[168:171], v[88:91], v[144:147]
TR a[168:169], v17, 61440
s_nop 0
s_add_u32 s68, s68, s69
s_cmp_ge_u32 s68, 3
s_cbranch_scc0 ka_kernel_spin101
ka_kernel_spb102:
MF v[148:151], a[172:175], v[72:75], v[148:151]
TR a[170:171], v17, 63488
buffer_load_dwordx4 v[172:175], v29, s[28:31], s71 offen sc1
MF v[152:155], a[172:175], v[88:91], v[152:155]
TR a[172:173], v18, 61440
s_waitcnt lgkmcnt(7)
MF v[124:127], a[144:147], v[92:95], v[124:127]
TR a[174:175], v18, 63488
buffer_load_dwordx4 v[176:179], v30, s[28:31], s71 offen sc1
MF v[128:131], a[144:147], v[108:111], v[128:131]
TR a[144:145], v19, 49152
MF v[132:135], a[148:151], v[92:95], v[132:135]
TR a[146:147], v19, 51200
buffer_load_dwordx4 v[180:183], v29, s[28:31], s71 offen offset:1024 sc1
MF v[136:139], a[148:151], v[108:111], v[136:139]
TR a[148:149], v20, 49152
global_load_lds_dwordx4 v12, s[10:11] offset:3072
s_add_u32 s70, s70, 128
s_cmp_eq_u32 s70, 1152
s_cselect_b32 s70, 0, s70
v_mov_b32 v255, 2
s_waitcnt vmcnt(6)
MF v[124:127], a[152:155], v[96:99], v[124:127]
TR a[150:151], v20, 51200
s_cbranch_vccnz ka_kernel_pa49
buffer_store_dword v255, v31, s[60:63], s64 offen offset:4
ka_kernel_pb50:
buffer_load_dwordx4 v[184:187], v30, s[28:31], s71 offen offset:1024 sc1
MF v[128:131], a[152:155], v[112:115], v[128:131]
TR a[152:153], v19, 53248
MF v[132:135], a[156:159], v[96:99], v[132:135]
TR a[154:155], v19, 55296
MF v[136:139], a[156:159], v[112:115], v[136:139]
TR a[156:157], v20, 53248
s_waitcnt lgkmcnt(7)
MF v[124:127], a[160:163], v[100:103], v[124:127]
TR a[158:159], v20, 55296
MF v[128:131], a[160:163], v[116:119], v[128:131]
TR a[160:161], v19, 57344
MF v[132:135], a[164:167], v[100:103], v[132:135]
TR a[162:163], v19, 59392
MF v[136:139], a[164:167], v[116:119], v[136:139]
TR a[164:165], v20, 57344
MF v[124:127], a[168:171], v[104:107], v[124:127]
TR a[166:167], v20, 59392
MF v[128:131], a[168:171], v[120:123], v[128:131]
TR a[168:169], v19, 61440
MF v[132:135], a[172:175], v[104:107], v[132:135]
TR a[170:171], v19, 63488
MF v[136:139], a[172:175], v[120:123], v[136:139]
TR a[172:173], v20, 61440
s_waitcnt vmcnt(4)
MF v[124:127], v[42:45], v[172:175], v[124:127]
TR a[174:175], v20, 63488
MF v[128:131], v[42:45], v[176:179], v[128:131]
MF v[132:135], v[40:43], v[172:175], v[132:135]
MF v[136:139], v[40:43], v[176:179], v[136:139]
s_barrier
s_waitcnt lgkmcnt(8)
MF v[140:143], a[144:147], v[92:95], v[140:143]
MF v[144:147], a[144:147], v[108:111], v[144:147]
TR a[144:145], v13, 0
s_add_u32 s59, s35, s70
MF v[148:151], a[148:151], v[92:95], v[148:151]
TR a[146:147], v13, 2048
s_add_u32 s10, s20, s59
s_addc_u32 s11, s21, 0
MF v[152:155], a[148:151], v[108:111], v[152:155]
TR a[148:149], v14, 0
s_add_u32 m0, s38, 98304
MF v[140:143], a[152:155], v[96:99], v[140:143]
TR a[150:151], v14, 2048
global_load_lds_dwordx4 v9, s[10:11]
MF v[144:147], a[152:155], v[112:115], v[144:147]
TR a[152:153], v13, 4096
global_load_lds_dwordx4 v10, s[10:11] offset:1024
MF v[148:151], a[156:159], v[96:99], v[148:151]
TR a[154:155], v13, 6144
v_cvt_pk_bf16_f32 v156, v124, v125
MF v[152:155], a[156:159], v[112:115], v[152:155]
TR a[156:157], v14, 4096
s_waitcnt lgkmcnt(7)
MF v[140:143], a[160:163], v[100:103], v[140:143]
TR a[158:159], v14, 6144
v_cvt_pk_bf16_f32 v157, v126, v127
MF v[144:147], a[160:163], v[116:119], v[144:147]
TR a[160:161], v13, 8192
global_load_lds_dwordx4 v11, s[10:11] offset:2048
MF v[148:151], a[164:167], v[100:103], v[148:151]
TR a[162:163], v13, 10240
v_cvt_pk_bf16_f32 v158, v132, v133
MF v[152:155], a[164:167], v[116:119], v[152:155]
TR a[164:165], v14, 8192
v_cvt_pk_bf16_f32 v159, v134, v135
MF v[140:143], a[168:171], v[104:107], v[140:143]
TR a[166:167], v14, 10240
s_cbranch_vccnz ka_kernel_pa51
buffer_store_dwordx4 v[156:159], v29, s[28:31], s74 offen
ka_kernel_pb52:
MF v[144:147], a[168:171], v[120:123], v[144:147]
TR a[168:169], v13, 12288
global_load_lds_dwordx4 v12, s[10:11] offset:3072
MF v[148:151], a[172:175], v[104:107], v[148:151]
TR a[170:171], v13, 14336
v_cvt_pk_bf16_f32 v160, v128, v129
MF v[152:155], a[172:175], v[120:123], v[152:155]
TR a[172:173], v14, 12288
s_waitcnt vmcnt(5)
MF v[140:143], v[42:45], v[180:183], v[140:143]
TR a[174:175], v14, 14336
v_cvt_pk_bf16_f32 v161, v130, v131
MF v[144:147], v[42:45], v[184:187], v[144:147]
v_cvt_pk_bf16_f32 v162, v136, v137
v_cvt_pk_bf16_f32 v163, v138, v139
MF v[148:151], v[40:43], v[180:183], v[148:151]
s_cbranch_vccnz ka_kernel_pa53
buffer_store_dwordx4 v[160:163], v30, s[28:31], s74 offen
ka_kernel_pb54:
MF v[152:155], v[40:43], v[184:187], v[152:155]
buffer_load_dword v0, v31, s[60:63], s65 offen offset:4 sc1
s_waitcnt lgkmcnt(8)
MF v[124:127], a[144:147], v[60:63], 0
MF v[128:131], a[144:147], v[76:79], 0
TR a[144:145], v15, 0
MF v[132:135], a[148:151], v[60:63], 0
TR a[146:147], v15, 2048
MF v[136:139], a[148:151], v[76:79], 0
TR a[148:149], v16, 0
v_cvt_pk_bf16_f32 v164, v140, v141
MF v[124:127], a[152:155], v[64:67], v[124:127]
TR a[150:151], v16, 2048
v_cvt_pk_bf16_f32 v165, v142, v143
MF v[128:131], a[152:155], v[80:83], v[128:131]
TR a[152:153], v15, 4096
v_cvt_pk_bf16_f32 v166, v148, v149
MF v[132:135], a[156:159], v[64:67], v[132:135]
TR a[154:155], v15, 6144
v_cvt_pk_bf16_f32 v167, v150, v151
MF v[136:139], a[156:159], v[80:83], v[136:139]
TR a[156:157], v16, 4096
s_waitcnt lgkmcnt(7)
MF v[124:127], a[160:163], v[68:71], v[124:127]
TR a[158:159], v16, 6144
s_cbranch_vccnz ka_kernel_pa55
buffer_store_dwordx4 v[164:167], v29, s[28:31], s74 offen offset:1024
ka_kernel_pb56:
MF v[128:131], a[160:163], v[84:87], v[128:131]
TR a[160:161], v15, 8192
v_cvt_pk_bf16_f32 v168, v144, v145
MF v[132:135], a[164:167], v[68:71], v[132:135]
TR a[162:163], v15, 10240
v_cvt_pk_bf16_f32 v169, v146, v147
MF v[136:139], a[164:167], v[84:87], v[136:139]
TR a[164:165], v16, 8192
v_cvt_pk_bf16_f32 v170, v152, v153
MF v[124:127], a[168:171], v[72:75], v[124:127]
TR a[166:167], v16, 10240
v_cvt_pk_bf16_f32 v171, v154, v155
MF v[128:131], a[168:171], v[88:91], v[128:131]
TR a[168:169], v15, 12288
s_cbranch_vccnz ka_kernel_pa57
buffer_store_dwordx4 v[168:171], v30, s[28:31], s74 offen offset:1024
ka_kernel_pb58:
MF v[132:135], a[172:175], v[72:75], v[132:135]
TR a[170:171], v15, 14336
MF v[136:139], a[172:175], v[88:91], v[136:139]
TR a[172:173], v16, 12288
s_waitcnt lgkmcnt(7)
MF v[140:143], a[144:147], v[60:63], 0
TR a[174:175], v16, 14336
s_barrier
MF v[144:147], a[144:147], v[76:79], 0
TR a[144:145], v13, 16384
s_add_u32 s10, s10, 147456
s_addc_u32 s11, s11, 0
MF v[148:151], a[148:151], v[60:63], 0
TR a[146:147], v13, 18432
s_add_u32 m0, s38, 114688
MF v[152:155], a[148:151], v[76:79], 0
TR a[148:149], v14, 16384
global_load_lds_dwordx4 v9, s[10:11]
MF v[140:143], a[152:155], v[64:67], v[140:143]
TR a[150:151], v14, 18432
s_waitcnt vmcnt(3)
v_readfirstlane_b32 s68, v0
MF v[144:147], a[152:155], v[80:83], v[144:147]
TR a[152:153], v13, 20480
s_nop 0
s_add_u32 s68, s68, s69
s_cmp_ge_u32 s68, 4
s_cbranch_scc0 ka_kernel_spin103
ka_kernel_spb104:
MF v[148:151], a[156:159], v[64:67], v[148:151]
TR a[154:155], v13, 22528
buffer_load_dwordx4 v[188:191], v29, s[28:31], s75 offen sc1
MF v[152:155], a[156:159], v[80:83], v[152:155]
TR a[156:157], v14, 20480
s_waitcnt lgkmcnt(7)
MF v[140:143], a[160:163], v[68:71], v[140:143]
TR a[158:159], v14, 22528
buffer_load_dwordx4 v[192:195], v30, s[28:31], s75 offen sc1
MF v[144:147], a[160:163], v[84:87], v[144:147]
TR a[160:161], v13, 24576
MF v[148:151], a[164:167], v[68:71], v[148:151]
TR a[162:163], v13, 26624
buffer_load_dwordx4 v[196:199], v29, s[28:31], s75 offen offset:1024 sc1
MF v[152:155], a[164:167], v[84:87], v[152:155]
TR a[164:165], v14, 24576
global_load_lds_dwordx4 v10, s[10:11] offset:1024
MF v[140:143], a[168:171], v[72:75], v[140:143]
TR a[166:167], v14, 26624
buffer_load_dwordx4 v[200:203], v30, s[28:31], s75 offen offset:1024 sc1
MF v[144:147], a[168:171], v[88:91], v[144:147]
TR a[168:169], v13, 28672
global_load_lds_dwordx4 v11, s[10:11] offset:2048
MF v[148:151], a[172:175], v[72:75], v[148:151]
TR a[170:171], v13, 30720
global_load_lds_dwordx4 v12, s[10:11] offset:3072
MF v[152:155], a[172:175], v[88:91], v[152:155]
TR a[172:173], v14, 28672
s_waitcnt lgkmcnt(7)
MF v[124:127], a[144:147], v[92:95], v[124:127]
TR a[174:175], v14, 30720
s_add_u32 s70, s70, 128
MF v[128:131], a[144:147], v[108:111], v[128:131]
TR a[144:145], v15, 16384
s_cmp_eq_u32 s70, 1152
s_cselect_b32 s70, 0, s70
MF v[132:135], a[148:151], v[92:95], v[132:135]
TR a[146:147], v15, 18432
v_mov_b32 v255, 3
MF v[136:139], a[148:151], v[108:111], v[136:139]
TR a[148:149], v16, 16384
s_waitcnt vmcnt(8)
MF v[124:127], a[152:155], v[96:99], v[124:127]
TR a[150:151], v16, 18432
s_cbranch_vccnz ka_kernel_pa59
buffer_store_dword v255, v31, s[60:63], s64 offen offset:4
ka_kernel_pb60:
MF v[128:131], a[152:155], v[112:115], v[128:131]
TR a[152:153], v15, 20480
MF v[132:135], a[156:159], v[96:99], v[132:135]
TR a[154:155], v15, 22528
MF v[136:139], a[156:159], v[112:115], v[136:139]
TR a[156:157], v16, 20480
s_waitcnt lgkmcnt(7)
MF v[124:127], a[160:163], v[100:103], v[124:127]
TR a[158:159], v16, 22528
MF v[128:131], a[160:163], v[116:119], v[128:131]
TR a[160:161], v15, 24576
MF v[132:135], a[164:167], v[100:103], v[132:135]
TR a[162:163], v15, 26624
MF v[136:139], a[164:167], v[116:119], v[136:139]
TR a[164:165], v16, 24576
MF v[124:127], a[168:171], v[104:107], v[124:127]
TR a[166:167], v16, 26624
MF v[128:131], a[168:171], v[120:123], v[128:131]
TR a[168:169], v15, 28672
MF v[132:135], a[172:175], v[104:107], v[132:135]
TR a[170:171], v15, 30720
MF v[136:139], a[172:175], v[120:123], v[136:139]
TR a[172:173], v16, 28672
s_waitcnt vmcnt(6)
MF v[124:127], v[42:45], v[188:191], v[124:127]
TR a[174:175], v16, 30720
MF v[128:131], v[42:45], v[192:195], v[128:131]
MF v[132:135], v[40:43], v[188:191], v[132:135]
MF v[136:139], v[40:43], v[192:195], v[136:139]
s_barrier
s_waitcnt lgkmcnt(8)
MF v[140:143], a[144:147], v[92:95], v[140:143]
MF v[144:147], a[144:147], v[108:111], v[144:147]
TR a[144:145], v13, 32768
s_add_u32 s59, s35, s70
MF v[148:151], a[148:151], v[92:95], v[148:151]
TR a[146:147], v13, 34816
s_add_u32 s10, s20, s59
s_addc_u32 s11, s21, 0
MF v[152:155], a[148:151], v[108:111], v[152:155]
TR a[148:149], v14, 32768
s_add_u32 m0, s38, 0
MF v[140:143], a[152:155], v[96:99], v[140:143]
TR a[150:151], v14, 34816
global_load_lds_dwordx4 v9, s[10:11]
MF v[144:147], a[152:155], v[112:115], v[144:147]
TR a[152:153], v13, 36864
global_load_lds_dwordx4 v10, s[10:11] offset:1024
MF v[148:151], a[156:159], v[96:99], v[148:151]
TR a[154:155], v13, 38912
v_cvt_pk_bf16_f32 v156, v124, v125
MF v[152:155], a[156:159], v[112:115], v[152:155]
TR a[156:157], v14, 36864
s_waitcnt lgkmcnt(7)
MF v[140:143], a[160:163], v[100:103], v[140:143]
TR a[158:159], v14, 38912
v_cvt_pk_bf16_f32 v157, v126, v127
MF v[144:147], a[160:163], v[116:119], v[144:147]
TR a[160:161], v13, 40960
global_load_lds_dwordx4 v11, s[10:11] offset:2048
MF v[148:151], a[164:167], v[100:103], v[148:151]
TR a[162:163], v13, 43008
v_cvt_pk_bf16_f32 v158, v132, v133
MF v[152:155], a[164:167], v[116:119], v[152:155]
TR a[164:165], v14, 40960
v_cvt_pk_bf16_f32 v159, v134, v135
MF v[140:143], a[168:171], v[104:107], v[140:143]
TR a[166:167], v14, 43008
s_cbranch_vccnz ka_kernel_pa61
buffer_store_dwordx4 v[156:159], v29, s[28:31], s75 offen
ka_kernel_pb62:
MF v[144:147], a[168:171], v[120:123], v[144:147]
TR a[168:169], v13, 45056
global_load_lds_dwordx4 v12, s[10:11] offset:3072
MF v[148:151], a[172:175], v[104:107], v[148:151]
TR a[170:171], v13, 47104
v_cvt_pk_bf16_f32 v160, v128, v129
MF v[152:155], a[172:175], v[120:123], v[152:155]
TR a[172:173], v14, 45056
s_waitcnt vmcnt(8)
MF v[140:143], v[42:45], v[196:199], v[140:143]
TR a[174:175], v14, 47104
v_cvt_pk_bf16_f32 v161, v130, v131
MF v[144:147], v[42:45], v[200:203], v[144:147]
v_cvt_pk_bf16_f32 v162, v136, v137
v_cvt_pk_bf16_f32 v163, v138, v139
MF v[148:151], v[40:43], v[196:199], v[148:151]
s_cbranch_vccnz ka_kernel_pa63
buffer_store_dwordx4 v[160:163], v30, s[28:31], s75 offen
ka_kernel_pb64:
MF v[152:155], v[40:43], v[200:203], v[152:155]
buffer_load_dword v0, v31, s[60:63], s65 offen offset:4 sc1
s_waitcnt lgkmcnt(8)
MF v[124:127], a[144:147], v[60:63], 0
MF v[128:131], a[144:147], v[76:79], 0
TR a[144:145], v15, 32768
MF v[132:135], a[148:151], v[60:63], 0
TR a[146:147], v15, 34816
MF v[136:139], a[148:151], v[76:79], 0
TR a[148:149], v16, 32768
v_cvt_pk_bf16_f32 v164, v140, v141
MF v[124:127], a[152:155], v[64:67], v[124:127]
TR a[150:151], v16, 34816
v_cvt_pk_bf16_f32 v165, v142, v143
MF v[128:131], a[152:155], v[80:83], v[128:131]
TR a[152:153], v15, 36864
v_cvt_pk_bf16_f32 v166, v148, v149
MF v[132:135], a[156:159], v[64:67], v[132:135]
TR a[154:155], v15, 38912
v_cvt_pk_bf16_f32 v167, v150, v151
MF v[136:139], a[156:159], v[80:83], v[136:139]
TR a[156:157], v16, 36864
s_waitcnt lgkmcnt(7)
MF v[124:127], a[160:163], v[68:71], v[124:127]
TR a[158:159], v16, 38912
s_cbranch_vccnz ka_kernel_pa65
buffer_store_dwordx4 v[164:167], v29, s[28:31], s75 offen offset:1024
ka_kernel_pb66:
MF v[128:131], a[160:163], v[84:87], v[128:131]
TR a[160:161], v15, 40960
v_cvt_pk_bf16_f32 v168, v144, v145
MF v[132:135], a[164:167], v[68:71], v[132:135]
TR a[162:163], v15, 43008
v_cvt_pk_bf16_f32 v169, v146, v147
MF v[136:139], a[164:167], v[84:87], v[136:139]
TR a[164:165], v16, 40960
v_cvt_pk_bf16_f32 v170, v152, v153
MF v[124:127], a[168:171], v[72:75], v[124:127]
TR a[166:167], v16, 43008
v_cvt_pk_bf16_f32 v171, v154, v155
MF v[128:131], a[168:171], v[88:91], v[128:131]
TR a[168:169], v15, 45056
s_cbranch_vccnz ka_kernel_pa67
buffer_store_dwordx4 v[168:171], v30, s[28:31], s75 offen offset:1024
ka_kernel_pb68:
MF v[132:135], a[172:175], v[72:75], v[132:135]
TR a[170:171], v15, 47104
MF v[136:139], a[172:175], v[88:91], v[136:139]
TR a[172:173], v16, 45056
s_waitcnt lgkmcnt(7)
MF v[140:143], a[144:147], v[60:63], 0
TR a[174:175], v16, 47104
s_barrier
MF v[144:147], a[144:147], v[76:79], 0
TR a[144:145], v13, 49152
s_add_u32 s10, s10, 147456
s_addc_u32 s11, s11, 0
MF v[148:151], a[148:151], v[60:63], 0
TR a[146:147], v13, 51200
s_add_u32 m0, s38, 16384
MF v[152:155], a[148:151], v[76:79], 0
TR a[148:149], v14, 49152
global_load_lds_dwordx4 v9, s[10:11]
MF v[140:143], a[152:155], v[64:67], v[140:143]
TR a[150:151], v14, 51200
s_waitcnt vmcnt(3)
v_readfirstlane_b32 s68, v0
MF v[144:147], a[152:155], v[80:83], v[144:147]
TR a[152:153], v13, 53248
s_nop 0
s_add_u32 s68, s68, s69
s_cmp_ge_u32 s68, 5
s_cbranch_scc0 ka_kernel_spin105
ka_kernel_spb106:
MF v[148:151], a[156:159], v[64:67], v[148:151]
TR a[154:155], v13, 55296
buffer_load_dwordx4 v[172:175], v29, s[28:31], s76 offen sc1
MF v[152:155], a[156:159], v[80:83], v[152:155]
TR a[156:157], v14, 53248
s_waitcnt lgkmcnt(7)
MF v[140:143], a[160:163], v[68:71], v[140:143]
TR a[158:159], v14, 55296
buffer_load_dwordx4 v[176:179], v30, s[28:31], s76 offen sc1
MF v[144:147], a[160:163], v[84:87], v[144:147]
TR a[160:161], v13, 57344
MF v[148:151], a[164:167], v[68:71], v[148:151]
TR a[162:163], v13, 59392
buffer_load_dwordx4 v[180:183], v29, s[28:31], s76 offen offset:1024 sc1
MF v[152:155], a[164:167], v[84:87], v[152:155]
TR a[164:165], v14, 57344
global_load_lds_dwordx4 v10, s[10:11] offset:1024
MF v[140:143], a[168:171], v[72:75], v[140:143]
TR a[166:167], v14, 59392
buffer_load_dwordx4 v[184:187], v30, s[28:31], s76 offen offset:1024 sc1
MF v[144:147], a[168:171], v[88:91], v[144:147]
TR a[168:169], v13, 61440
global_load_lds_dwordx4 v11, s[10:11] offset:2048
MF v[148:151], a[172:175], v[72:75], v[148:151]
TR a[170:171], v13, 63488
global_load_lds_dwordx4 v12, s[10:11] offset:3072
MF v[152:155], a[172:175], v[88:91], v[152:155]
TR a[172:173], v14, 61440
s_waitcnt lgkmcnt(7)
MF v[124:127], a[144:147], v[92:95], v[124:127]
TR a[174:175], v14, 63488
s_add_u32 s70, s70, 128
MF v[128:131], a[144:147], v[108:111], v[128:131]
TR a[144:145], v15, 49152
s_cmp_eq_u32 s70, 1152
s_cselect_b32 s70, 0, s70
MF v[132:135], a[148:151], v[92:95], v[132:135]
TR a[146:147], v15, 51200
s_getpc_b64 s[4:5]
ka_kernel_pc30:
s_add_u32 s4, s4, kb_kernel-ka_kernel_pc30
s_addc_u32 s5, s5, (kb_kernel-ka_kernel_pc30)>>32
MF v[136:139], a[148:151], v[108:111], v[136:139]
TR a[148:149], v16, 49152
v_mov_b32 v255, 4
s_waitcnt vmcnt(8)
MF v[124:127], a[152:155], v[96:99], v[124:127]
TR a[150:151], v16, 51200
s_cbranch_vccnz ka_kernel_pa69
buffer_store_dword v255, v31, s[60:63], s64 offen offset:4
ka_kernel_pb70:
MF v[128:131], a[152:155], v[112:115], v[128:131]
TR a[152:153], v15, 53248
MF v[132:135], a[156:159], v[96:99], v[132:135]
TR a[154:155], v15, 55296
s_mov_b32 s6, code_end-kb_kernel
s_mov_b32 s7, 0x00020000
MF v[136:139], a[156:159], v[112:115], v[136:139]
TR a[156:157], v16, 53248
s_waitcnt lgkmcnt(7)
MF v[124:127], a[160:163], v[100:103], v[124:127]
TR a[158:159], v16, 55296
s_lshr_b32 s43, s2, 3
s_mul_i32 s43, s43, 2048
MF v[128:131], a[160:163], v[116:119], v[128:131]
TR a[160:161], v15, 57344
buffer_load_dwordx4 a[200:203], v29, s[4:7], s43 offen
MF v[132:135], a[164:167], v[100:103], v[132:135]
TR a[162:163], v15, 59392
buffer_load_dwordx4 a[200:203], v29, s[4:7], s43 offen offset:1024
MF v[136:139], a[164:167], v[116:119], v[136:139]
TR a[164:165], v16, 57344
MF v[124:127], a[168:171], v[104:107], v[124:127]
TR a[166:167], v16, 59392
MF v[128:131], a[168:171], v[120:123], v[128:131]
TR a[168:169], v15, 61440
MF v[132:135], a[172:175], v[104:107], v[132:135]
TR a[170:171], v15, 63488
MF v[136:139], a[172:175], v[120:123], v[136:139]
TR a[172:173], v16, 61440
s_waitcnt vmcnt(8)
MF v[124:127], v[42:45], v[172:175], v[124:127]
TR a[174:175], v16, 63488
MF v[128:131], v[42:45], v[176:179], v[128:131]
MF v[132:135], v[40:43], v[172:175], v[132:135]
MF v[136:139], v[40:43], v[176:179], v[136:139]
s_barrier
s_waitcnt lgkmcnt(8)
MF v[140:143], a[144:147], v[92:95], v[140:143]
MF v[144:147], a[144:147], v[108:111], v[144:147]
TR a[144:145], v17, 0
s_add_u32 s59, s35, s70
MF v[148:151], a[148:151], v[92:95], v[148:151]
TR a[146:147], v17, 2048
s_add_u32 s10, s20, s59
s_addc_u32 s11, s21, 0
MF v[152:155], a[148:151], v[108:111], v[152:155]
TR a[148:149], v18, 0
s_add_u32 m0, s38, 32768
MF v[140:143], a[152:155], v[96:99], v[140:143]
TR a[150:151], v18, 2048
global_load_lds_dwordx4 v9, s[10:11]
MF v[144:147], a[152:155], v[112:115], v[144:147]
TR a[152:153], v17, 4096
global_load_lds_dwordx4 v10, s[10:11] offset:1024
MF v[148:151], a[156:159], v[96:99], v[148:151]
TR a[154:155], v17, 6144
v_cvt_pk_bf16_f32 v156, v124, v125
MF v[152:155], a[156:159], v[112:115], v[152:155]
TR a[156:157], v18, 4096
s_waitcnt lgkmcnt(7)
MF v[140:143], a[160:163], v[100:103], v[140:143]
TR a[158:159], v18, 6144
v_cvt_pk_bf16_f32 v157, v126, v127
MF v[144:147], a[160:163], v[116:119], v[144:147]
TR a[160:161], v17, 8192
global_load_lds_dwordx4 v11, s[10:11] offset:2048
MF v[148:151], a[164:167], v[100:103], v[148:151]
TR a[162:163], v17, 10240
v_cvt_pk_bf16_f32 v158, v132, v133
MF v[152:155], a[164:167], v[116:119], v[152:155]
TR a[164:165], v18, 8192
v_cvt_pk_bf16_f32 v159, v134, v135
MF v[140:143], a[168:171], v[104:107], v[140:143]
TR a[166:167], v18, 10240
s_cbranch_vccnz ka_kernel_pa71
buffer_store_dwordx4 v[156:159], v29, s[28:31], s76 offen
ka_kernel_pb72:
MF v[144:147], a[168:171], v[120:123], v[144:147]
TR a[168:169], v17, 12288
global_load_lds_dwordx4 v12, s[10:11] offset:3072
MF v[148:151], a[172:175], v[104:107], v[148:151]
TR a[170:171], v17, 14336
v_cvt_pk_bf16_f32 v160, v128, v129
MF v[152:155], a[172:175], v[120:123], v[152:155]
TR a[172:173], v18, 12288
s_waitcnt vmcnt(10)
MF v[140:143], v[42:45], v[180:183], v[140:143]
TR a[174:175], v18, 14336
v_cvt_pk_bf16_f32 v161, v130, v131
MF v[144:147], v[42:45], v[184:187], v[144:147]
v_cvt_pk_bf16_f32 v162, v136, v137
v_cvt_pk_bf16_f32 v163, v138, v139
MF v[148:151], v[40:43], v[180:183], v[148:151]
s_cbranch_vccnz ka_kernel_pa73
buffer_store_dwordx4 v[160:163], v30, s[28:31], s76 offen
ka_kernel_pb74:
MF v[152:155], v[40:43], v[184:187], v[152:155]
buffer_load_dword v0, v31, s[60:63], s65 offen offset:4 sc1
s_waitcnt lgkmcnt(8)
MF v[124:127], a[144:147], v[60:63], 0
MF v[128:131], a[144:147], v[76:79], 0
TR a[144:145], v19, 0
MF v[132:135], a[148:151], v[60:63], 0
TR a[146:147], v19, 2048
MF v[136:139], a[148:151], v[76:79], 0
TR a[148:149], v20, 0
v_cvt_pk_bf16_f32 v164, v140, v141
MF v[124:127], a[152:155], v[64:67], v[124:127]
TR a[150:151], v20, 2048
v_cvt_pk_bf16_f32 v165, v142, v143
MF v[128:131], a[152:155], v[80:83], v[128:131]
TR a[152:153], v19, 4096
v_cvt_pk_bf16_f32 v166, v148, v149
MF v[132:135], a[156:159], v[64:67], v[132:135]
TR a[154:155], v19, 6144
v_cvt_pk_bf16_f32 v167, v150, v151
MF v[136:139], a[156:159], v[80:83], v[136:139]
TR a[156:157], v20, 4096
s_waitcnt lgkmcnt(7)
MF v[124:127], a[160:163], v[68:71], v[124:127]
TR a[158:159], v20, 6144
s_cbranch_vccnz ka_kernel_pa75
buffer_store_dwordx4 v[164:167], v29, s[28:31], s76 offen offset:1024
ka_kernel_pb76:
MF v[128:131], a[160:163], v[84:87], v[128:131]
TR a[160:161], v19, 8192
v_cvt_pk_bf16_f32 v168, v144, v145
MF v[132:135], a[164:167], v[68:71], v[132:135]
TR a[162:163], v19, 10240
v_cvt_pk_bf16_f32 v169, v146, v147
MF v[136:139], a[164:167], v[84:87], v[136:139]
TR a[164:165], v20, 8192
v_cvt_pk_bf16_f32 v170, v152, v153
MF v[124:127], a[168:171], v[72:75], v[124:127]
TR a[166:167], v20, 10240
v_cvt_pk_bf16_f32 v171, v154, v155
MF v[128:131], a[168:171], v[88:91], v[128:131]
TR a[168:169], v19, 12288
s_cbranch_vccnz ka_kernel_pa77
buffer_store_dwordx4 v[168:171], v30, s[28:31], s76 offen offset:1024
ka_kernel_pb78:
MF v[132:135], a[172:175], v[72:75], v[132:135]
TR a[170:171], v19, 14336
MF v[136:139], a[172:175], v[88:91], v[136:139]
TR a[172:173], v20, 12288
s_waitcnt lgkmcnt(7)
MF v[140:143], a[144:147], v[60:63], 0
TR a[174:175], v20, 14336
s_barrier
MF v[144:147], a[144:147], v[76:79], 0
TR a[144:145], v17, 16384
s_add_u32 s10, s10, 147456
s_addc_u32 s11, s11, 0
MF v[148:151], a[148:151], v[60:63], 0
TR a[146:147], v17, 18432
s_add_u32 m0, s38, 49152
MF v[152:155], a[148:151], v[76:79], 0
TR a[148:149], v18, 16384
global_load_lds_dwordx4 v9, s[10:11]
MF v[140:143], a[152:155], v[64:67], v[140:143]
TR a[150:151], v18, 18432
s_waitcnt vmcnt(3)
v_readfirstlane_b32 s68, v0
MF v[144:147], a[152:155], v[80:83], v[144:147]
TR a[152:153], v17, 20480
s_nop 0
s_add_u32 s68, s68, s69
s_cmp_ge_u32 s68, 6
s_cbranch_scc0 ka_kernel_spin107
ka_kernel_spb108:
MF v[148:151], a[156:159], v[64:67], v[148:151]
TR a[154:155], v17, 22528
buffer_load_dwordx4 v[188:191], v29, s[28:31], s77 offen sc1
MF v[152:155], a[156:159], v[80:83], v[152:155]
TR a[156:157], v18, 20480
s_waitcnt lgkmcnt(7)
MF v[140:143], a[160:163], v[68:71], v[140:143]
TR a[158:159], v18, 22528
buffer_load_dwordx4 v[192:195], v30, s[28:31], s77 offen sc1
MF v[144:147], a[160:163], v[84:87], v[144:147]
TR a[160:161], v17, 24576
MF v[148:151], a[164:167], v[68:71], v[148:151]
TR a[162:163], v17, 26624
buffer_load_dwordx4 v[196:199], v29, s[28:31], s77 offen offset:1024 sc1
MF v[152:155], a[164:167], v[84:87], v[152:155]
TR a[164:165], v18, 24576
global_load_lds_dwordx4 v10, s[10:11] offset:1024
MF v[140:143], a[168:171], v[72:75], v[140:143]
TR a[166:167], v18, 26624
buffer_load_dwordx4 v[200:203], v30, s[28:31], s77 offen offset:1024 sc1
MF v[144:147], a[168:171], v[88:91], v[144:147]
TR a[168:169], v17, 28672
global_load_lds_dwordx4 v11, s[10:11] offset:2048
MF v[148:151], a[172:175], v[72:75], v[148:151]
TR a[170:171], v17, 30720
global_load_lds_dwordx4 v12, s[10:11] offset:3072
MF v[152:155], a[172:175], v[88:91], v[152:155]
TR a[172:173], v18, 28672
s_waitcnt lgkmcnt(7)
MF v[124:127], a[144:147], v[92:95], v[124:127]
TR a[174:175], v18, 30720
v_mov_b32 v255, 5
MF v[128:131], a[144:147], v[108:111], v[128:131]
TR a[144:145], v19, 16384
MF v[132:135], a[148:151], v[92:95], v[132:135]
TR a[146:147], v19, 18432
MF v[136:139], a[148:151], v[108:111], v[136:139]
TR a[148:149], v20, 16384
s_waitcnt vmcnt(8)
MF v[124:127], a[152:155], v[96:99], v[124:127]
TR a[150:151], v20, 18432
s_cbranch_vccnz ka_kernel_pa79
buffer_store_dword v255, v31, s[60:63], s64 offen offset:4
ka_kernel_pb80:
MF v[128:131], a[152:155], v[112:115], v[128:131]
TR a[152:153], v19, 20480
MF v[132:135], a[156:159], v[96:99], v[132:135]
TR a[154:155], v19, 22528
MF v[136:139], a[156:159], v[112:115], v[136:139]
TR a[156:157], v20, 20480
s_waitcnt lgkmcnt(7)
MF v[124:127], a[160:163], v[100:103], v[124:127]
TR a[158:159], v20, 22528
MF v[128:131], a[160:163], v[116:119], v[128:131]
TR a[160:161], v19, 24576
MF v[132:135], a[164:167], v[100:103], v[132:135]
TR a[162:163], v19, 26624
MF v[136:139], a[164:167], v[116:119], v[136:139]
TR a[164:165], v20, 24576
MF v[124:127], a[168:171], v[104:107], v[124:127]
TR a[166:167], v20, 26624
MF v[128:131], a[168:171], v[120:123], v[128:131]
TR a[168:169], v19, 28672
MF v[132:135], a[172:175], v[104:107], v[132:135]
TR a[170:171], v19, 30720
MF v[136:139], a[172:175], v[120:123], v[136:139]
TR a[172:173], v20, 28672
s_waitcnt vmcnt(6)
MF v[124:127], v[42:45], v[188:191], v[124:127]
TR a[174:175], v20, 30720
MF v[128:131], v[42:45], v[192:195], v[128:131]
MF v[132:135], v[40:43], v[188:191], v[132:135]
MF v[136:139], v[40:43], v[192:195], v[136:139]
s_barrier
s_waitcnt lgkmcnt(8)
MF v[140:143], a[144:147], v[92:95], v[140:143]
MF v[144:147], a[144:147], v[108:111], v[144:147]
TR a[144:145], v17, 32768
MF v[148:151], a[148:151], v[92:95], v[148:151]
TR a[146:147], v17, 34816
MF v[152:155], a[148:151], v[108:111], v[152:155]
TR a[148:149], v18, 32768
v_cvt_pk_bf16_f32 v156, v124, v125
MF v[140:143], a[152:155], v[96:99], v[140:143]
TR a[150:151], v18, 34816
v_cvt_pk_bf16_f32 v157, v126, v127
MF v[144:147], a[152:155], v[112:115], v[144:147]
TR a[152:153], v17, 36864
v_cvt_pk_bf16_f32 v158, v132, v133
MF v[148:151], a[156:159], v[96:99], v[148:151]
TR a[154:155], v17, 38912
v_cvt_pk_bf16_f32 v159, v134, v135
MF v[152:155], a[156:159], v[112:115], v[152:155]
TR a[156:157], v18, 36864
s_waitcnt lgkmcnt(7)
MF v[140:143], a[160:163], v[100:103], v[140:143]
TR a[158:159], v18, 38912
s_cbranch_vccnz ka_kernel_pa81
buffer_store_dwordx4 v[156:159], v29, s[28:31], s77 offen
ka_kernel_pb82:
MF v[144:147], a[160:163], v[116:119], v[144:147]
TR a[160:161], v17, 40960
v_cvt_pk_bf16_f32 v160, v128, v129
MF v[148:151], a[164:167], v[100:103], v[148:151]
TR a[162:163], v17, 43008
v_cvt_pk_bf16_f32 v161, v130, v131
MF v[152:155], a[164:167], v[116:119], v[152:155]
TR a[164:165], v18, 40960
v_cvt_pk_bf16_f32 v162, v136, v137
MF v[140:143], a[168:171], v[104:107], v[140:143]
TR a[166:167], v18, 43008
v_cvt_pk_bf16_f32 v163, v138, v139
MF v[144:147], a[168:171], v[120:123], v[144:147]
TR a[168:169], v17, 45056
s_cbranch_vccnz ka_kernel_pa83
buffer_store_dwordx4 v[160:163], v30, s[28:31], s77 offen
ka_kernel_pb84:
MF v[148:151], a[172:175], v[104:107], v[148:151]
TR a[170:171], v17, 47104
MF v[152:155], a[172:175], v[120:123], v[152:155]
TR a[172:173], v18, 45056
s_waitcnt vmcnt(5)
MF v[140:143], v[42:45], v[196:199], v[140:143]
TR a[174:175], v18, 47104
MF v[144:147], v[42:45], v[200:203], v[144:147]
MF v[148:151], v[40:43], v[196:199], v[148:151]
MF v[152:155], v[40:43], v[200:203], v[152:155]
buffer_load_dword v0, v31, s[60:63], s65 offen offset:4 sc1
s_waitcnt lgkmcnt(8)
MF v[124:127], a[144:147], v[60:63], 0
MF v[128:131], a[144:147], v[76:79], 0
TR a[144:145], v19, 32768
MF v[132:135], a[148:151], v[60:63], 0
TR a[146:147], v19, 34816
MF v[136:139], a[148:151], v[76:79], 0
TR a[148:149], v20, 32768
v_cvt_pk_bf16_f32 v164, v140, v141
MF v[124:127], a[152:155], v[64:67], v[124:127]
TR a[150:151], v20, 34816
v_cvt_pk_bf16_f32 v165, v142, v143
MF v[128:131], a[152:155], v[80:83], v[128:131]
TR a[152:153], v19, 36864
v_cvt_pk_bf16_f32 v166, v148, v149
MF v[132:135], a[156:159], v[64:67], v[132:135]
TR a[154:155], v19, 38912
v_cvt_pk_bf16_f32 v167, v150, v151
MF v[136:139], a[156:159], v[80:83], v[136:139]
TR a[156:157], v20, 36864
s_waitcnt lgkmcnt(7)
MF v[124:127], a[160:163], v[68:71], v[124:127]
TR a[158:159], v20, 38912
s_cbranch_vccnz ka_kernel_pa85
buffer_store_dwordx4 v[164:167], v29, s[28:31], s77 offen offset:1024
ka_kernel_pb86:
MF v[128:131], a[160:163], v[84:87], v[128:131]
TR a[160:161], v19, 40960
v_cvt_pk_bf16_f32 v168, v144, v145
MF v[132:135], a[164:167], v[68:71], v[132:135]
TR a[162:163], v19, 43008
v_cvt_pk_bf16_f32 v169, v146, v147
MF v[136:139], a[164:167], v[84:87], v[136:139]
TR a[164:165], v20, 40960
v_cvt_pk_bf16_f32 v170, v152, v153
MF v[124:127], a[168:171], v[72:75], v[124:127]
TR a[166:167], v20, 43008
v_cvt_pk_bf16_f32 v171, v154, v155
MF v[128:131], a[168:171], v[88:91], v[128:131]
TR a[168:169], v19, 45056
s_cbranch_vccnz ka_kernel_pa87
buffer_store_dwordx4 v[168:171], v30, s[28:31], s77 offen offset:1024
ka_kernel_pb88:
MF v[132:135], a[172:175], v[72:75], v[132:135]
TR a[170:171], v19, 47104
MF v[136:139], a[172:175], v[88:91], v[136:139]
TR a[172:173], v20, 45056
s_waitcnt lgkmcnt(7)
MF v[140:143], a[144:147], v[60:63], 0
TR a[174:175], v20, 47104
s_barrier
MF v[144:147], a[144:147], v[76:79], 0
TR a[144:145], v17, 49152
MF v[148:151], a[148:151], v[60:63], 0
TR a[146:147], v17, 51200
MF v[152:155], a[148:151], v[76:79], 0
TR a[148:149], v18, 49152
MF v[140:143], a[152:155], v[64:67], v[140:143]
TR a[150:151], v18, 51200
s_waitcnt vmcnt(2)
v_readfirstlane_b32 s68, v0
MF v[144:147], a[152:155], v[80:83], v[144:147]
TR a[152:153], v17, 53248
s_nop 0
s_add_u32 s68, s68, s69
s_cmp_ge_u32 s68, 7
s_cbranch_scc0 ka_kernel_spin109
ka_kernel_spb110:
MF v[148:151], a[156:159], v[64:67], v[148:151]
TR a[154:155], v17, 55296
buffer_load_dwordx4 v[172:175], v29, s[28:31], s78 offen sc1
MF v[152:155], a[156:159], v[80:83], v[152:155]
TR a[156:157], v18, 53248
s_waitcnt lgkmcnt(7)
MF v[140:143], a[160:163], v[68:71], v[140:143]
TR a[158:159], v18, 55296
buffer_load_dwordx4 v[176:179], v30, s[28:31], s78 offen sc1
MF v[144:147], a[160:163], v[84:87], v[144:147]
TR a[160:161], v17, 57344
MF v[148:151], a[164:167], v[68:71], v[148:151]
TR a[162:163], v17, 59392
buffer_load_dwordx4 v[180:183], v29, s[28:31], s78 offen offset:1024 sc1
MF v[152:155], a[164:167], v[84:87], v[152:155]
TR a[164:165], v18, 57344
buffer_load_dwordx4 v[184:187], v30, s[28:31], s78 offen offset:1024 sc1
MF v[140:143], a[168:171], v[72:75], v[140:143]
TR a[166:167], v18, 59392
MF v[144:147], a[168:171], v[88:91], v[144:147]
TR a[168:169], v17, 61440
MF v[148:151], a[172:175], v[72:75], v[148:151]
TR a[170:171], v17, 63488
MF v[152:155], a[172:175], v[88:91], v[152:155]
TR a[172:173], v18, 61440
s_waitcnt lgkmcnt(7)
MF v[124:127], a[144:147], v[92:95], v[124:127]
TR a[174:175], v18, 63488
v_mov_b32 v255, 6
MF v[128:131], a[144:147], v[108:111], v[128:131]
TR a[144:145], v19, 49152
MF v[132:135], a[148:151], v[92:95], v[132:135]
TR a[146:147], v19, 51200
MF v[136:139], a[148:151], v[108:111], v[136:139]
TR a[148:149], v20, 49152
s_waitcnt vmcnt(4)
MF v[124:127], a[152:155], v[96:99], v[124:127]
TR a[150:151], v20, 51200
s_cbranch_vccnz ka_kernel_pa89
buffer_store_dword v255, v31, s[60:63], s64 offen offset:4
ka_kernel_pb90:
MF v[128:131], a[152:155], v[112:115], v[128:131]
TR a[152:153], v19, 53248
MF v[132:135], a[156:159], v[96:99], v[132:135]
TR a[154:155], v19, 55296
MF v[136:139], a[156:159], v[112:115], v[136:139]
TR a[156:157], v20, 53248
s_waitcnt lgkmcnt(7)
MF v[124:127], a[160:163], v[100:103], v[124:127]
TR a[158:159], v20, 55296
MF v[128:131], a[160:163], v[116:119], v[128:131]
TR a[160:161], v19, 57344
MF v[132:135], a[164:167], v[100:103], v[132:135]
TR a[162:163], v19, 59392
MF v[136:139], a[164:167], v[116:119], v[136:139]
TR a[164:165], v20, 57344
MF v[124:127], a[168:171], v[104:107], v[124:127]
TR a[166:167], v20, 59392
MF v[128:131], a[168:171], v[120:123], v[128:131]
TR a[168:169], v19, 61440
MF v[132:135], a[172:175], v[104:107], v[132:135]
TR a[170:171], v19, 63488
MF v[136:139], a[172:175], v[120:123], v[136:139]
TR a[172:173], v20, 61440
s_waitcnt vmcnt(3)
MF v[124:127], v[42:45], v[172:175], v[124:127]
TR a[174:175], v20, 63488
MF v[128:131], v[42:45], v[176:179], v[128:131]
MF v[132:135], v[40:43], v[172:175], v[132:135]
MF v[136:139], v[40:43], v[176:179], v[136:139]
s_barrier
s_waitcnt lgkmcnt(8)
MF v[140:143], a[144:147], v[92:95], v[140:143]
MF v[144:147], a[144:147], v[108:111], v[144:147]
TR a[144:145], v13, 0
MF v[148:151], a[148:151], v[92:95], v[148:151]
TR a[146:147], v13, 2048
MF v[152:155], a[148:151], v[108:111], v[152:155]
TR a[148:149], v14, 0
v_cvt_pk_bf16_f32 v156, v124, v125
MF v[140:143], a[152:155], v[96:99], v[140:143]
TR a[150:151], v14, 2048
v_cvt_pk_bf16_f32 v157, v126, v127
MF v[144:147], a[152:155], v[112:115], v[144:147]
TR a[152:153], v13, 4096
v_cvt_pk_bf16_f32 v158, v132, v133
MF v[148:151], a[156:159], v[96:99], v[148:151]
TR a[154:155], v13, 6144
v_cvt_pk_bf16_f32 v159, v134, v135
MF v[152:155], a[156:159], v[112:115], v[152:155]
TR a[156:157], v14, 4096
s_waitcnt lgkmcnt(7)
MF v[140:143], a[160:163], v[100:103], v[140:143]
TR a[158:159], v14, 6144
buffer_store_dwordx4 v[156:159], v29, s[28:31], s82 offen sc1
MF v[144:147], a[160:163], v[116:119], v[144:147]
TR a[160:161], v13, 8192
s_cbranch_vccnz ka_kernel_pa91
buffer_store_dwordx4 v[156:159], v29, s[28:31], s78 offen
ka_kernel_pb92:
MF v[148:151], a[164:167], v[100:103], v[148:151]
TR a[162:163], v13, 10240
v_cvt_pk_bf16_f32 v160, v128, v129
MF v[152:155], a[164:167], v[116:119], v[152:155]
TR a[164:165], v14, 8192
v_cvt_pk_bf16_f32 v161, v130, v131
MF v[140:143], a[168:171], v[104:107], v[140:143]
TR a[166:167], v14, 10240
v_cvt_pk_bf16_f32 v162, v136, v137
MF v[144:147], a[168:171], v[120:123], v[144:147]
TR a[168:169], v13, 12288
v_cvt_pk_bf16_f32 v163, v138, v139
MF v[148:151], a[172:175], v[104:107], v[148:151]
TR a[170:171], v13, 14336
buffer_store_dwordx4 v[160:163], v30, s[28:31], s82 offen sc1
MF v[152:155], a[172:175], v[120:123], v[152:155]
TR a[172:173], v14, 12288
s_waitcnt vmcnt(4)
MF v[140:143], v[42:45], v[180:183], v[140:143]
TR a[174:175], v14, 14336
s_cbranch_vccnz ka_kernel_pa93
buffer_store_dwordx4 v[160:163], v30, s[28:31], s78 offen
ka_kernel_pb94:
MF v[144:147], v[42:45], v[184:187], v[144:147]
MF v[148:151], v[40:43], v[180:183], v[148:151]
MF v[152:155], v[40:43], v[184:187], v[152:155]
buffer_load_dword v0, v31, s[60:63], s65 offen offset:4 sc1
s_waitcnt lgkmcnt(8)
MF v[124:127], a[144:147], v[60:63], 0
MF v[128:131], a[144:147], v[76:79], 0
TR a[144:145], v15, 0
MF v[132:135], a[148:151], v[60:63], 0
TR a[146:147], v15, 2048
MF v[136:139], a[148:151], v[76:79], 0
TR a[148:149], v16, 0
v_cvt_pk_bf16_f32 v164, v140, v141
MF v[124:127], a[152:155], v[64:67], v[124:127]
TR a[150:151], v16, 2048
v_cvt_pk_bf16_f32 v165, v142, v143
MF v[128:131], a[152:155], v[80:83], v[128:131]
TR a[152:153], v15, 4096
v_cvt_pk_bf16_f32 v166, v148, v149
MF v[132:135], a[156:159], v[64:67], v[132:135]
TR a[154:155], v15, 6144
v_cvt_pk_bf16_f32 v167, v150, v151
MF v[136:139], a[156:159], v[80:83], v[136:139]
TR a[156:157], v16, 4096
s_waitcnt lgkmcnt(7)
MF v[124:127], a[160:163], v[68:71], v[124:127]
TR a[158:159], v16, 6144
buffer_store_dwordx4 v[164:167], v29, s[28:31], s82 offen offset:1024 sc1
MF v[128:131], a[160:163], v[84:87], v[128:131]
TR a[160:161], v15, 8192
s_cbranch_vccnz ka_kernel_pa95
buffer_store_dwordx4 v[164:167], v29, s[28:31], s78 offen offset:1024
ka_kernel_pb96:
MF v[132:135], a[164:167], v[68:71], v[132:135]
TR a[162:163], v15, 10240
v_cvt_pk_bf16_f32 v168, v144, v145
MF v[136:139], a[164:167], v[84:87], v[136:139]
TR a[164:165], v16, 8192
v_cvt_pk_bf16_f32 v169, v146, v147
MF v[124:127], a[168:171], v[72:75], v[124:127]
TR a[166:167], v16, 10240
v_cvt_pk_bf16_f32 v170, v152, v153
MF v[128:131], a[168:171], v[88:91], v[128:131]
TR a[168:169], v15, 12288
v_cvt_pk_bf16_f32 v171, v154, v155
MF v[132:135], a[172:175], v[72:75], v[132:135]
TR a[170:171], v15, 14336
MF v[136:139], a[172:175], v[88:91], v[136:139]
TR a[172:173], v16, 12288
s_waitcnt lgkmcnt(7)
MF v[140:143], a[144:147], v[60:63], 0
TR a[174:175], v16, 14336
s_barrier
MF v[144:147], a[144:147], v[76:79], 0
TR a[144:145], v13, 16384
buffer_store_dwordx4 v[168:171], v30, s[28:31], s82 offen offset:1024 sc1
MF v[148:151], a[148:151], v[60:63], 0
TR a[146:147], v13, 18432
s_cbranch_vccnz ka_kernel_pa97
buffer_store_dwordx4 v[168:171], v30, s[28:31], s78 offen offset:1024
ka_kernel_pb98:
MF v[152:155], a[148:151], v[76:79], 0
TR a[148:149], v14, 16384
MF v[140:143], a[152:155], v[64:67], v[140:143]
TR a[150:151], v14, 18432
s_waitcnt vmcnt(4)
v_readfirstlane_b32 s68, v0
MF v[144:147], a[152:155], v[80:83], v[144:147]
TR a[152:153], v13, 20480
s_nop 0
s_add_u32 s68, s68, s69
s_cmp_ge_u32 s68, 8
s_cbranch_scc0 ka_kernel_spin111
ka_kernel_spb112:
MF v[148:151], a[156:159], v[64:67], v[148:151]
TR a[154:155], v13, 22528
buffer_load_dwordx4 v[188:191], v29, s[28:31], s79 offen sc1
MF v[152:155], a[156:159], v[80:83], v[152:155]
TR a[156:157], v14, 20480
s_waitcnt lgkmcnt(7)
MF v[140:143], a[160:163], v[68:71], v[140:143]
TR a[158:159], v14, 22528
buffer_load_dwordx4 v[192:195], v30, s[28:31], s79 offen sc1
MF v[144:147], a[160:163], v[84:87], v[144:147]
TR a[160:161], v13, 24576
MF v[148:151], a[164:167], v[68:71], v[148:151]
TR a[162:163], v13, 26624
buffer_load_dwordx4 v[196:199], v29, s[28:31], s79 offen offset:1024 sc1
MF v[152:155], a[164:167], v[84:87], v[152:155]
TR a[164:165], v14, 24576
buffer_load_dwordx4 v[200:203], v30, s[28:31], s79 offen offset:1024 sc1
MF v[140:143], a[168:171], v[72:75], v[140:143]
TR a[166:167], v14, 26624
MF v[144:147], a[168:171], v[88:91], v[144:147]
TR a[168:169], v13, 28672
MF v[148:151], a[172:175], v[72:75], v[148:151]
TR a[170:171], v13, 30720
MF v[152:155], a[172:175], v[88:91], v[152:155]
TR a[172:173], v14, 28672
s_waitcnt lgkmcnt(7)
MF v[124:127], a[144:147], v[92:95], v[124:127]
TR a[174:175], v14, 30720
v_mov_b32 v255, 7
MF v[128:131], a[144:147], v[108:111], v[128:131]
TR a[144:145], v15, 16384
MF v[132:135], a[148:151], v[92:95], v[132:135]
TR a[146:147], v15, 18432
MF v[136:139], a[148:151], v[108:111], v[136:139]
TR a[148:149], v16, 16384
s_waitcnt vmcnt(4)
MF v[124:127], a[152:155], v[96:99], v[124:127]
TR a[150:151], v16, 18432
s_cbranch_vccnz ka_kernel_pa99
buffer_store_dword v255, v31, s[60:63], s64 offen offset:4
ka_kernel_pb100:
MF v[128:131], a[152:155], v[112:115], v[128:131]
TR a[152:153], v15, 20480
MF v[132:135], a[156:159], v[96:99], v[132:135]
TR a[154:155], v15, 22528
MF v[136:139], a[156:159], v[112:115], v[136:139]
TR a[156:157], v16, 20480
s_waitcnt lgkmcnt(7)
MF v[124:127], a[160:163], v[100:103], v[124:127]
TR a[158:159], v16, 22528
MF v[128:131], a[160:163], v[116:119], v[128:131]
TR a[160:161], v15, 24576
MF v[132:135], a[164:167], v[100:103], v[132:135]
TR a[162:163], v15, 26624
MF v[136:139], a[164:167], v[116:119], v[136:139]
TR a[164:165], v16, 24576
MF v[124:127], a[168:171], v[104:107], v[124:127]
TR a[166:167], v16, 26624
MF v[128:131], a[168:171], v[120:123], v[128:131]
TR a[168:169], v15, 28672
MF v[132:135], a[172:175], v[104:107], v[132:135]
TR a[170:171], v15, 30720
MF v[136:139], a[172:175], v[120:123], v[136:139]
TR a[172:173], v16, 28672
s_waitcnt vmcnt(3)
MF v[124:127], v[42:45], v[188:191], v[124:127]
TR a[174:175], v16, 30720
MF v[128:131], v[42:45], v[192:195], v[128:131]
MF v[132:135], v[40:43], v[188:191], v[132:135]
MF v[136:139], v[40:43], v[192:195], v[136:139]
s_barrier
s_waitcnt lgkmcnt(8)
MF v[140:143], a[144:147], v[92:95], v[140:143]
MF v[144:147], a[144:147], v[108:111], v[144:147]
TR a[144:145], v13, 32768
MF v[148:151], a[148:151], v[92:95], v[148:151]
TR a[146:147], v13, 34816
MF v[152:155], a[148:151], v[108:111], v[152:155]
TR a[148:149], v14, 32768
v_cvt_pk_bf16_f32 v156, v124, v125
MF v[140:143], a[152:155], v[96:99], v[140:143]
TR a[150:151], v14, 34816
v_cvt_pk_bf16_f32 v157, v126, v127
MF v[144:147], a[152:155], v[112:115], v[144:147]
TR a[152:153], v13, 36864
v_cvt_pk_bf16_f32 v158, v132, v133
MF v[148:151], a[156:159], v[96:99], v[148:151]
TR a[154:155], v13, 38912
v_cvt_pk_bf16_f32 v159, v134, v135
MF v[152:155], a[156:159], v[112:115], v[152:155]
TR a[156:157], v14, 36864
s_waitcnt lgkmcnt(7)
MF v[140:143], a[160:163], v[100:103], v[140:143]
TR a[158:159], v14, 38912
s_add_u32 s83, s79, 18874368
MF v[144:147], a[160:163], v[116:119], v[144:147]
TR a[160:161], v13, 40960
buffer_store_dwordx4 v[156:159], v29, s[28:31], s83 offen sc1
MF v[148:151], a[164:167], v[100:103], v[148:151]
TR a[162:163], v13, 43008
v_cvt_pk_bf16_f32 v160, v128, v129
MF v[152:155], a[164:167], v[116:119], v[152:155]
TR a[164:165], v14, 40960
v_cvt_pk_bf16_f32 v161, v130, v131
MF v[140:143], a[168:171], v[104:107], v[140:143]
TR a[166:167], v14, 43008
v_cvt_pk_bf16_f32 v162, v136, v137
MF v[144:147], a[168:171], v[120:123], v[144:147]
TR a[168:169], v13, 45056
v_cvt_pk_bf16_f32 v163, v138, v139
MF v[148:151], a[172:175], v[104:107], v[148:151]
TR a[170:171], v13, 47104
buffer_store_dwordx4 v[160:163], v30, s[28:31], s83 offen sc1
MF v[152:155], a[172:175], v[120:123], v[152:155]
TR a[172:173], v14, 45056
s_waitcnt vmcnt(3)
MF v[140:143], v[42:45], v[196:199], v[140:143]
TR a[174:175], v14, 47104
MF v[144:147], v[42:45], v[200:203], v[144:147]
MF v[148:151], v[40:43], v[196:199], v[148:151]
MF v[152:155], v[40:43], v[200:203], v[152:155]
buffer_load_dword v0, v31, s[60:63], s65 offen offset:4 sc1
s_waitcnt lgkmcnt(8)
MF v[124:127], a[144:147], v[60:63], 0
MF v[128:131], a[144:147], v[76:79], 0
TR a[144:145], v15, 32768
MF v[132:135], a[148:151], v[60:63], 0
TR a[146:147], v15, 34816
MF v[136:139], a[148:151], v[76:79], 0
TR a[148:149], v16, 32768
v_cvt_pk_bf16_f32 v164, v140, v141
MF v[124:127], a[152:155], v[64:67], v[124:127]
TR a[150:151], v16, 34816
v_cvt_pk_bf16_f32 v165, v142, v143
MF v[128:131], a[152:155], v[80:83], v[128:131]
TR a[152:153], v15, 36864
v_cvt_pk_bf16_f32 v166, v148, v149
MF v[132:135], a[156:159], v[64:67], v[132:135]
TR a[154:155], v15, 38912
v_cvt_pk_bf16_f32 v167, v150, v151
MF v[136:139], a[156:159], v[80:83], v[136:139]
TR a[156:157], v16, 36864
s_waitcnt lgkmcnt(7)
MF v[124:127], a[160:163], v[68:71], v[124:127]
TR a[158:159], v16, 38912
buffer_store_dwordx4 v[164:167], v29, s[28:31], s83 offen offset:1024 sc1
MF v[128:131], a[160:163], v[84:87], v[128:131]
TR a[160:161], v15, 40960
v_cvt_pk_bf16_f32 v168, v144, v145
MF v[132:135], a[164:167], v[68:71], v[132:135]
TR a[162:163], v15, 43008
v_cvt_pk_bf16_f32 v169, v146, v147
MF v[136:139], a[164:167], v[84:87], v[136:139]
TR a[164:165], v16, 40960
v_cvt_pk_bf16_f32 v170, v152, v153
MF v[124:127], a[168:171], v[72:75], v[124:127]
TR a[166:167], v16, 43008
v_cvt_pk_bf16_f32 v171, v154, v155
MF v[128:131], a[168:171], v[88:91], v[128:131]
TR a[168:169], v15, 45056
buffer_store_dwordx4 v[168:171], v30, s[28:31], s83 offen offset:1024 sc1
MF v[132:135], a[172:175], v[72:75], v[132:135]
TR a[170:171], v15, 47104
MF v[136:139], a[172:175], v[88:91], v[136:139]
TR a[172:173], v16, 45056
s_waitcnt lgkmcnt(7)
MF v[140:143], a[144:147], v[60:63], 0
TR a[174:175], v16, 47104
s_barrier
MF v[144:147], a[144:147], v[76:79], 0
TR a[144:145], v13, 49152
MF v[148:151], a[148:151], v[60:63], 0
TR a[146:147], v13, 51200
MF v[152:155], a[148:151], v[76:79], 0
TR a[148:149], v14, 49152
MF v[140:143], a[152:155], v[64:67], v[140:143]
TR a[150:151], v14, 51200
s_waitcnt vmcnt(2)
v_readfirstlane_b32 s68, v0
MF v[144:147], a[152:155], v[80:83], v[144:147]
TR a[152:153], v13, 53248
s_nop 0
s_add_u32 s68, s68, s69
s_cmp_ge_u32 s68, 9
s_cbranch_scc0 ka_kernel_spin113
ka_kernel_spb114:
MF v[148:151], a[156:159], v[64:67], v[148:151]
TR a[154:155], v13, 55296
buffer_load_dwordx4 v[172:175], v29, s[28:31], s80 offen sc1
MF v[152:155], a[156:159], v[80:83], v[152:155]
TR a[156:157], v14, 53248
s_waitcnt lgkmcnt(7)
MF v[140:143], a[160:163], v[68:71], v[140:143]
TR a[158:159], v14, 55296
buffer_load_dwordx4 v[176:179], v30, s[28:31], s80 offen sc1
MF v[144:147], a[160:163], v[84:87], v[144:147]
TR a[160:161], v13, 57344
MF v[148:151], a[164:167], v[68:71], v[148:151]
TR a[162:163], v13, 59392
buffer_load_dwordx4 v[180:183], v29, s[28:31], s80 offen offset:1024 sc1
MF v[152:155], a[164:167], v[84:87], v[152:155]
TR a[164:165], v14, 57344
buffer_load_dwordx4 v[184:187], v30, s[28:31], s80 offen offset:1024 sc1
MF v[140:143], a[168:171], v[72:75], v[140:143]
TR a[166:167], v14, 59392
MF v[144:147], a[168:171], v[88:91], v[144:147]
TR a[168:169], v13, 61440
MF v[148:151], a[172:175], v[72:75], v[148:151]
TR a[170:171], v13, 63488
MF v[152:155], a[172:175], v[88:91], v[152:155]
TR a[172:173], v14, 61440
s_waitcnt lgkmcnt(7)
MF v[124:127], a[144:147], v[92:95], v[124:127]
TR a[174:175], v14, 63488
MF v[128:131], a[144:147], v[108:111], v[128:131]
TR a[144:145], v15, 49152
MF v[132:135], a[148:151], v[92:95], v[132:135]
TR a[146:147], v15, 51200
MF v[136:139], a[148:151], v[108:111], v[136:139]
TR a[148:149], v16, 49152
MF v[124:127], a[152:155], v[96:99], v[124:127]
TR a[150:151], v16, 51200
MF v[128:131], a[152:155], v[112:115], v[128:131]
TR a[152:153], v15, 53248
MF v[132:135], a[156:159], v[96:99], v[132:135]
TR a[154:155], v15, 55296
MF v[136:139], a[156:159], v[112:115], v[136:139]
TR a[156:157], v16, 53248
s_waitcnt lgkmcnt(7)
MF v[124:127], a[160:163], v[100:103], v[124:127]
TR a[158:159], v16, 55296
MF v[128:131], a[160:163], v[116:119], v[128:131]
TR a[160:161], v15, 57344
MF v[132:135], a[164:167], v[100:103], v[132:135]
TR a[162:163], v15, 59392
MF v[136:139], a[164:167], v[116:119], v[136:139]
TR a[164:165], v16, 57344
MF v[124:127], a[168:171], v[104:107], v[124:127]
TR a[166:167], v16, 59392
MF v[128:131], a[168:171], v[120:123], v[128:131]
TR a[168:169], v15, 61440
MF v[132:135], a[172:175], v[104:107], v[132:135]
TR a[170:171], v15, 63488
MF v[136:139], a[172:175], v[120:123], v[136:139]
TR a[172:173], v16, 61440
s_waitcnt vmcnt(2)
MF v[124:127], v[42:45], v[172:175], v[124:127]
TR a[174:175], v16, 63488
MF v[128:131], v[42:45], v[176:179], v[128:131]
MF v[132:135], v[40:43], v[172:175], v[132:135]
MF v[136:139], v[40:43], v[176:179], v[136:139]
s_waitcnt lgkmcnt(8)
MF v[140:143], a[144:147], v[92:95], v[140:143]
MF v[144:147], a[144:147], v[108:111], v[144:147]
MF v[148:151], a[148:151], v[92:95], v[148:151]
MF v[152:155], a[148:151], v[108:111], v[152:155]
v_cvt_pk_bf16_f32 v156, v124, v125
v_cvt_pk_bf16_f32 v157, v126, v127
MF v[140:143], a[152:155], v[96:99], v[140:143]
v_cvt_pk_bf16_f32 v158, v132, v133
v_cvt_pk_bf16_f32 v159, v134, v135
MF v[144:147], a[152:155], v[112:115], v[144:147]
s_add_u32 s83, s80, 18874368
buffer_store_dwordx4 v[156:159], v29, s[28:31], s83 offen sc1
MF v[148:151], a[156:159], v[96:99], v[148:151]
v_cvt_pk_bf16_f32 v160, v128, v129
v_cvt_pk_bf16_f32 v161, v130, v131
MF v[152:155], a[156:159], v[112:115], v[152:155]
v_cvt_pk_bf16_f32 v162, v136, v137
s_waitcnt lgkmcnt(0)
MF v[140:143], a[160:163], v[100:103], v[140:143]
v_cvt_pk_bf16_f32 v163, v138, v139
buffer_store_dwordx4 v[160:163], v30, s[28:31], s83 offen sc1
MF v[144:147], a[160:163], v[116:119], v[144:147]
MF v[148:151], a[164:167], v[100:103], v[148:151]
MF v[152:155], a[164:167], v[116:119], v[152:155]
MF v[140:143], a[168:171], v[104:107], v[140:143]
MF v[144:147], a[168:171], v[120:123], v[144:147]
MF v[148:151], a[172:175], v[104:107], v[148:151]
MF v[152:155], a[172:175], v[120:123], v[152:155]
s_waitcnt vmcnt(2)
MF v[140:143], v[42:45], v[180:183], v[140:143]
MF v[144:147], v[42:45], v[184:187], v[144:147]
MF v[148:151], v[40:43], v[180:183], v[148:151]
MF v[152:155], v[40:43], v[184:187], v[152:155]
s_nop 4
v_cvt_pk_bf16_f32 v164, v140, v141
v_cvt_pk_bf16_f32 v165, v142, v143
v_cvt_pk_bf16_f32 v166, v148, v149
v_cvt_pk_bf16_f32 v167, v150, v151
buffer_store_dwordx4 v[164:167], v29, s[28:31], s83 offen offset:1024 sc1
v_cvt_pk_bf16_f32 v168, v144, v145
v_cvt_pk_bf16_f32 v169, v146, v147
v_cvt_pk_bf16_f32 v170, v152, v153
v_cvt_pk_bf16_f32 v171, v154, v155
buffer_store_dwordx4 v[168:171], v30, s[28:31], s83 offen offset:1024 sc1
s_waitcnt vmcnt(0) lgkmcnt(0)
s_barrier
s_cmp_lg_u32 s39, 0
s_cbranch_scc1 ka_kernel_sk115
s_add_u32 s60, s52, 9568256
s_addc_u32 s61, s53, 0
s_mov_b32 s62, 0x4000
s_mov_b32 s63, 0x00020000
s_lshl_b32 s42, s41, 10
s_lshl_b32 s43, s40, 6
s_add_u32 s43, s43, s42
v_mov_b32 v1, 1
v_mov_b32 v2, 0
buffer_store_dword v1, v2, s[60:63], s43 offen offset:32 sc1
ka_kernel_sk115:
v_lshrrev_b32 v0, 4, v29
s_lshl_b32 s42, s39, 6
v_add_u32 v0, s42, v0
s_branch kb_kernel
ka_kernel_done1:
s_endpgm

.p2align 8
kb_kernel:
s_load_dwordx4 s[32:35], s[0:1], 48
s_mov_b32 s29, s39
s_mov_b32 s38, s52
s_mov_b32 s39, s53
s_mov_b32 s36, s54
s_mov_b32 s37, s55
s_lshl_b32 s100, s41, 4
s_add_u32 s100, s100, s40
s_add_u32 s4, s38, 9568256
s_addc_u32 s5, s39, 0
s_mov_b32 s6, 16384
s_mov_b32 s7, 0x00020000
s_add_u32 s20, s38, 16777216
s_addc_u32 s21, s39, 0
s_mov_b32 s22, 37748736
s_mov_b32 s23, 0x00020000
v_and_b32 v28, 63, v0
v_lshrrev_b32 v29, 4, v28
v_bfe_u32 v30, v28, 2, 2
v_and_b32 v31, 3, v28
s_lshl_b32 s101, s41, 10
v_and_b32 v246, 15, v0
v_lshlrev_b32 v246, 6, v246
s_cmp_lg_u32 s29, 0
s_cbranch_scc1 kb_kernel_skip2
buffer_load_dword v247, v246, s[4:7], s101 offen offset:32 sc1
kb_kernel_skip2:
v_and_b32 v49, 7, v28
v_bfe_u32 v50, v28, 3, 1
v_mul_u32_u24 v50, 9, v50
v_add_u32 v52, 8, v50
v_add_u32 v50, s29, v50
v_add_u32 v51, 4, v50
v_lshlrev_b32 v54, 8, v29
v_lshl_add_u32 v54, v49, 4, v54
v_cmp_eq_u32 s[44:45], s29, v29
v_mov_b32 v55, 1073741824
v_lshl_add_u32 v40, v50, 10, v54
v_lshl_add_u32 v41, v51, 10, v54
v_lshl_add_u32 v42, v52, 10, v54
v_cndmask_b32 v42, v55, v42, s[44:45]
s_lshr_b32 s82, s100, 1
s_mul_i32 s82, s82, 18432
s_and_b32 s42, s100, 1
s_lshl_b32 s42, s42, 7
s_add_u32 s82, s82, s42
v_mul_u32_u24 v53, 96, v29
v_add_u32 v53, 136448, v53
s_movk_i32 s42, 384
v_mad_u32_u24 v46, v50, s42, v53
v_mad_u32_u24 v47, v51, s42, v53
v_mad_u32_u24 v48, v52, s42, v53
v_mul_u32_u24 v53, 1152, v49
v_lshl_add_u32 v53, v29, 3, v53
v_add_u32 v53, 151808, v53
v_lshl_add_u32 v43, v50, 6, v53
v_lshl_add_u32 v44, v51, 6, v53
v_lshl_add_u32 v45, v52, 6, v53
ds_read_b64 v[152:153], v43
ds_read_b64 v[154:155], v43 offset:32
ds_read_b64 v[156:157], v44
ds_read_b64 v[158:159], v44 offset:32
ds_read_b64 v[160:161], v45
ds_read_b64 v[162:163], v45 offset:32
ds_read_b128 v[164:167], v46 offset:0
ds_read_b128 v[168:171], v46 offset:16
ds_read_b128 v[172:175], v46 offset:32
ds_read_b128 v[176:179], v46 offset:48
ds_read_b128 v[180:183], v46 offset:64
ds_read_b128 v[184:187], v46 offset:80
ds_read_b128 v[188:191], v47 offset:0
ds_read_b128 v[192:195], v47 offset:16
ds_read_b128 v[196:199], v47 offset:32
ds_read_b128 v[200:203], v47 offset:48
ds_read_b128 v[204:207], v47 offset:64
ds_read_b128 v[208:211], v47 offset:80
ds_read_b128 v[212:215], v48 offset:0
ds_read_b128 v[216:219], v48 offset:16
ds_read_b128 v[220:223], v48 offset:32
ds_read_b128 v[224:227], v48 offset:48
ds_read_b128 v[228:231], v48 offset:64
ds_read_b128 v[232:235], v48 offset:80
s_mul_i32 s28, s29, 9216
s_and_b32 s83, s29, 1
s_cmp_eq_u32 s83, 0
s_waitcnt lgkmcnt(0)
s_cselect_b32 s8, s32, s34
s_cselect_b32 s9, s33, s35
s_mov_b32 s10, 5308416
s_mov_b32 s11, 0x00020000
s_mov_b32 s12, s36
s_mov_b32 s13, s37
s_mov_b32 s14, 5308416
s_mov_b32 s15, 0x00020000
s_add_u32 s16, s38, 6291456
s_addc_u32 s17, s39, 0
s_mov_b32 s18, 2359296
s_mov_b32 s19, 0x00020000
s_mov_b32 s32, s100
s_mov_b32 s33, s82
s_movk_i32 s46, 1821
s_movk_i32 s47, 9216
v_lshlrev_b32 v25, 4, v28
v_add_u32 v26, 18432, v25
v_add_u32 v32, 0, v28
v_mul_u32_u24 v33, s46, v32
v_lshrrev_b32 v33, 16, v33
v_mul_u32_u24 v34, 36, v33
v_sub_u32 v32, v32, v34
v_bfe_u32 v34, v33, 2, 1
v_lshlrev_b32 v34, 1, v34
v_xor_b32 v32, v32, v34
v_lshlrev_b32 v32, 4, v32
v_mad_u32_u24 v1, v33, s47, v32
v_add_u32 v32, 64, v28
v_mul_u32_u24 v33, s46, v32
v_lshrrev_b32 v33, 16, v33
v_mul_u32_u24 v34, 36, v33
v_sub_u32 v32, v32, v34
v_bfe_u32 v34, v33, 2, 1
v_lshlrev_b32 v34, 1, v34
v_xor_b32 v32, v32, v34
v_lshlrev_b32 v32, 4, v32
v_mad_u32_u24 v2, v33, s47, v32
v_subrev_u32 v2, 1024, v2
v_add_u32 v32, 128, v28
v_mul_u32_u24 v33, s46, v32
v_lshrrev_b32 v33, 16, v33
v_mul_u32_u24 v34, 36, v33
v_sub_u32 v32, v32, v34
v_bfe_u32 v34, v33, 2, 1
v_lshlrev_b32 v34, 1, v34
v_xor_b32 v32, v32, v34
v_lshlrev_b32 v32, 4, v32
v_mad_u32_u24 v3, v33, s47, v32
v_subrev_u32 v3, 2048, v3
v_add_u32 v32, 192, v28
v_mul_u32_u24 v33, s46, v32
v_lshrrev_b32 v33, 16, v33
v_mul_u32_u24 v34, 36, v33
v_sub_u32 v32, v32, v34
v_bfe_u32 v34, v33, 2, 1
v_lshlrev_b32 v34, 1, v34
v_xor_b32 v32, v32, v34
v_lshlrev_b32 v32, 4, v32
v_mad_u32_u24 v4, v33, s47, v32
v_subrev_u32 v4, 3072, v4
v_add_u32 v32, 256, v28
v_mul_u32_u24 v33, s46, v32
v_lshrrev_b32 v33, 16, v33
v_mul_u32_u24 v34, 36, v33
v_sub_u32 v32, v32, v34
v_bfe_u32 v34, v33, 2, 1
v_lshlrev_b32 v34, 1, v34
v_xor_b32 v32, v32, v34
v_lshlrev_b32 v32, 4, v32
v_mad_u32_u24 v5, v33, s47, v32
v_add_u32 v32, 320, v28
v_mul_u32_u24 v33, s46, v32
v_lshrrev_b32 v33, 16, v33
v_mul_u32_u24 v34, 36, v33
v_sub_u32 v32, v32, v34
v_bfe_u32 v34, v33, 2, 1
v_lshlrev_b32 v34, 1, v34
v_xor_b32 v32, v32, v34
v_lshlrev_b32 v32, 4, v32
v_mad_u32_u24 v6, v33, s47, v32
v_subrev_u32 v6, 1024, v6
v_add_u32 v32, 384, v28
v_mul_u32_u24 v33, s46, v32
v_lshrrev_b32 v33, 16, v33
v_mul_u32_u24 v34, 36, v33
v_sub_u32 v32, v32, v34
v_bfe_u32 v34, v33, 2, 1
v_lshlrev_b32 v34, 1, v34
v_xor_b32 v32, v32, v34
v_lshlrev_b32 v32, 4, v32
v_mad_u32_u24 v7, v33, s47, v32
v_subrev_u32 v7, 2048, v7
v_add_u32 v32, 448, v28
v_mul_u32_u24 v33, s46, v32
v_lshrrev_b32 v33, 16, v33
v_mul_u32_u24 v34, 36, v33
v_sub_u32 v32, v32, v34
v_bfe_u32 v34, v33, 2, 1
v_lshlrev_b32 v34, 1, v34
v_xor_b32 v32, v32, v34
v_lshlrev_b32 v32, 4, v32
v_mad_u32_u24 v8, v33, s47, v32
v_subrev_u32 v8, 3072, v8
v_add_u32 v32, 512, v28
v_mul_u32_u24 v33, s46, v32
v_lshrrev_b32 v33, 16, v33
v_mul_u32_u24 v34, 36, v33
v_sub_u32 v32, v32, v34
v_bfe_u32 v34, v33, 2, 1
v_lshlrev_b32 v34, 1, v34
v_xor_b32 v32, v32, v34
v_lshlrev_b32 v32, 4, v32
v_mad_u32_u24 v9, v33, s47, v32
v_lshrrev_b32 v32, 4, v28
v_bfe_u32 v33, v28, 2, 2
v_cmp_eq_u32 vcc, v32, v33
v_and_b32 v32, 1, v28
v_lshlrev_b32 v32, 4, v32
v_mov_b32 v33, 0x3f80
v_lshlrev_b32 v32, v32, v33
v_cndmask_b32 v32, 0, v32, vcc
v_and_b32 v33, 2, v28
v_cmp_eq_u32 vcc, 0, v33
v_mov_b32 v248, 0
v_mov_b32 v249, 0
v_cndmask_b32 v250, 0, v32, vcc
v_cndmask_b32 v251, v32, 0, vcc
v_mov_b32 v252, 0
v_mov_b32 v253, 0
s_lshr_b32 s42, s29, 1
s_mul_i32 s24, s42, 147456
s_mul_i32 s43, s40, 576
s_add_u32 s24, s24, s43
s_mul_i32 s43, s40, 288
s_mul_i32 s42, s29, 72
s_add_u32 s43, s43, s42
s_mul_i32 s25, s43, 1152
s_lshl_b32 s43, s41, 3
s_lshl_b32 s42, s29, 1
s_add_u32 s43, s43, s42
s_mul_i32 s26, s43, 18432
s_lshr_b32 s42, s40, 2
s_add_u32 s42, s42, 4
s_mul_i32 s42, s42, 2359296
s_add_u32 s27, s26, s42
s_add_u32 s8, s8, s24
s_addc_u32 s9, s9, 0
s_add_u32 s34, s12, s25
s_addc_u32 s35, s13, 0
s_cmp_lg_u32 s29, 0
s_cbranch_scc1 kb_kernel_skip4
s_branch kb_kernel_chk5
kb_kernel_poll3:
buffer_load_dword v247, v246, s[4:7], s101 offen offset:32 sc1
s_add_u32 s3, s3, 1
s_cmp_gt_u32 s3, 0x80000
s_cbranch_scc1 kb_kernel_skip4
kb_kernel_chk5:
s_waitcnt vmcnt(0)
v_cmp_ne_u32 vcc, 1, v247
s_cbranch_vccnz kb_kernel_poll3
kb_kernel_skip4:
s_barrier
s_add_u32 s42, s82, 18874368
buffer_load_dwordx4 v[56:59], v40, s[20:23], s42 offen sc1
s_add_u32 s42, s42, 2359296
buffer_load_dwordx4 v[60:63], v40, s[20:23], s42 offen sc1
s_add_u32 s42, s42, 2359296
buffer_load_dwordx4 v[64:67], v40, s[20:23], s42 offen sc1
s_add_u32 s42, s42, 2359296
buffer_load_dwordx4 v[68:71], v40, s[20:23], s42 offen sc1
s_add_u32 s42, s82, 18874368
buffer_load_dwordx4 v[88:91], v41, s[20:23], s42 offen sc1
s_add_u32 s42, s42, 2359296
buffer_load_dwordx4 v[92:95], v41, s[20:23], s42 offen sc1
s_add_u32 s42, s42, 2359296
buffer_load_dwordx4 v[96:99], v41, s[20:23], s42 offen sc1
s_add_u32 s42, s42, 2359296
buffer_load_dwordx4 v[100:103], v41, s[20:23], s42 offen sc1
s_add_u32 s42, s82, 18874368
buffer_load_dwordx4 v[120:123], v42, s[20:23], s42 offen sc1
s_add_u32 s42, s42, 2359296
buffer_load_dwordx4 v[124:127], v42, s[20:23], s42 offen sc1
s_add_u32 s42, s42, 2359296
buffer_load_dwordx4 v[128:131], v42, s[20:23], s42 offen sc1
s_add_u32 s42, s42, 2359296
buffer_load_dwordx4 v[132:135], v42, s[20:23], s42 offen sc1
s_add_u32 m0, s28, 0
s_nop 0
global_load_lds_dwordx4 v1, s[8:9]
global_load_lds_dwordx4 v2, s[8:9] offset:1024
global_load_lds_dwordx4 v3, s[8:9] offset:2048
global_load_lds_dwordx4 v4, s[8:9] offset:3072
s_add_u32 m0, s28, 4096
s_nop 0
global_load_lds_dwordx4 v5, s[8:9]
global_load_lds_dwordx4 v6, s[8:9] offset:1024
global_load_lds_dwordx4 v7, s[8:9] offset:2048
global_load_lds_dwordx4 v8, s[8:9] offset:3072
s_add_u32 m0, s28, 8192
s_nop 0
global_load_lds_dwordx4 v9, s[8:9]
s_add_u32 s8, s8, 294912
s_addc_u32 s9, s9, 0
v_lshl_add_u32 v32, v29, 2, v30
v_mul_u32_u24 v32, 576, v32
v_lshl_add_u32 v32, v31, 3, v32
v_and_b32 v33, 1, v29
v_lshlrev_b32 v33, 5, v33
v_add_u32 v19, v32, v33
v_sub_u32 v20, v32, v33
v_lshl_add_u32 v32, v29, 2, v30
v_bfe_u32 v33, v32, 1, 2
v_lshlrev_b32 v33, 1, v33
v_lshrrev_b32 v34, 1, v29
v_or_b32 v33, v33, v34
v_lshrrev_b32 v34, 1, v31
v_xor_b32 v33, v33, v34
v_lshlrev_b32 v32, 7, v32
v_and_b32 v34, 1, v31
v_lshl_add_u32 v32, v34, 3, v32
v_xor_b32 v34, 0, v33
v_lshl_add_u32 v21, v34, 4, v32
v_xor_b32 v34, 2, v33
v_lshl_add_u32 v22, v34, 4, v32
v_xor_b32 v34, 4, v33
v_lshl_add_u32 v23, v34, 4, v32
v_xor_b32 v34, 6, v33
v_lshl_add_u32 v24, v34, 4, v32
v_add_u32 v21, 73728, v21
v_add_u32 v22, 73728, v22
v_add_u32 v23, 73728, v23
v_add_u32 v24, 73728, v24
v_lshrrev_b32 v32, 3, v28
v_mul_u32_u24 v32, 1152, v32
v_and_b32 v33, 7, v28
v_lshlrev_b32 v34, 1, v29
v_xor_b32 v33, v33, v34
v_xor_b32 v33, s83, v33
v_xor_b32 v34, 1, v33
v_lshl_add_u32 v33, v33, 4, v32
v_lshl_add_u32 v34, v34, 4, v32
v_add_u32 v10, 0, v33
v_add_u32 v11, 8192, v34
v_add_u32 v12, 16384, v33
v_add_u32 v13, 24576, v34
v_add_u32 v14, 36864, v33
v_add_u32 v15, 45056, v34
v_add_u32 v16, 53248, v33
v_add_u32 v17, 61440, v34
v_add_u32 v18, 73728, v33
s_nop 1
s_add_u32 s56, s38, 3145728
s_addc_u32 s57, s39, 0
s_mov_b32 s58, 2359296
s_mov_b32 s59, 0x00020000
v_mov_b32 v244, 0
v_mov_b32 v245, 0
v_lshrrev_b32 v53, 4, v0
v_lshlrev_b32 v54, 6, v49
v_add_u32 v54, 147456, v54
v_lshl_add_u32 v53, v53, 2, v54
v_and_b32 v55, 8, v0
v_cmp_eq_u32 s[30:31], 0, v55
s_waitcnt vmcnt(20)
MF v[72:75], v[250:253], v[56:59], 0
MF v[76:79], v[248:251], v[56:59], 0
s_waitcnt vmcnt(19)
MF v[72:75], v[250:253], v[60:63], v[72:75]
MF v[76:79], v[248:251], v[60:63], v[76:79]
s_waitcnt vmcnt(18)
MF v[72:75], v[250:253], v[64:67], v[72:75]
MF v[76:79], v[248:251], v[64:67], v[76:79]
s_waitcnt vmcnt(17)
MF v[72:75], v[250:253], v[68:71], v[72:75]
MF v[76:79], v[248:251], v[68:71], v[76:79]
s_waitcnt vmcnt(16)
MF v[104:107], v[250:253], v[88:91], 0
MF v[108:111], v[248:251], v[88:91], 0
s_waitcnt vmcnt(15)
MF v[104:107], v[250:253], v[92:95], v[104:107]
MF v[108:111], v[248:251], v[92:95], v[108:111]
s_waitcnt vmcnt(14)
MF v[104:107], v[250:253], v[96:99], v[104:107]
MF v[108:111], v[248:251], v[96:99], v[108:111]
s_waitcnt vmcnt(13)
MF v[104:107], v[250:253], v[100:103], v[104:107]
MF v[108:111], v[248:251], v[100:103], v[108:111]
s_waitcnt vmcnt(12)
MF v[136:139], v[250:253], v[120:123], 0
MF v[140:143], v[248:251], v[120:123], 0
s_waitcnt vmcnt(11)
MF v[136:139], v[250:253], v[124:127], v[136:139]
MF v[140:143], v[248:251], v[124:127], v[140:143]
s_waitcnt vmcnt(10)
MF v[136:139], v[250:253], v[128:131], v[136:139]
MF v[140:143], v[248:251], v[128:131], v[140:143]
s_waitcnt vmcnt(9)
MF v[136:139], v[250:253], v[132:135], v[136:139]
MF v[140:143], v[248:251], v[132:135], v[140:143]
s_waitcnt lgkmcnt(0)
v_lshlrev_b32 v56, 16, v152
v_and_b32 v57, 0xffff0000, v152
v_lshlrev_b32 v58, 16, v153
v_and_b32 v59, 0xffff0000, v153
v_lshlrev_b32 v60, 16, v154
v_and_b32 v61, 0xffff0000, v154
v_lshlrev_b32 v62, 16, v155
v_and_b32 v63, 0xffff0000, v155
v_fmac_f32 v56, v72, v164
v_fmac_f32 v57, v73, v165
v_fmac_f32 v58, v74, v166
v_fmac_f32 v59, v75, v167
v_fmac_f32 v60, v76, v168
v_fmac_f32 v61, v77, v169
v_fmac_f32 v62, v78, v170
v_fmac_f32 v63, v79, v171
v_cvt_pk_bf16_f32 v152, v56, v57
v_cvt_pk_bf16_f32 v153, v58, v59
v_cvt_pk_bf16_f32 v154, v60, v61
v_cvt_pk_bf16_f32 v155, v62, v63
v_lshlrev_b32 v56, 16, v152
v_and_b32 v57, 0xffff0000, v152
v_lshlrev_b32 v58, 16, v153
v_and_b32 v59, 0xffff0000, v153
v_lshlrev_b32 v60, 16, v154
v_and_b32 v61, 0xffff0000, v154
v_lshlrev_b32 v62, 16, v155
v_and_b32 v63, 0xffff0000, v155
v_add_f32 v244, v244, v56
v_add_f32 v244, v244, v57
v_add_f32 v244, v244, v58
v_add_f32 v244, v244, v59
v_add_f32 v244, v244, v60
v_add_f32 v244, v244, v61
v_add_f32 v244, v244, v62
v_add_f32 v244, v244, v63
v_lshlrev_b32 v88, 16, v156
v_and_b32 v89, 0xffff0000, v156
v_lshlrev_b32 v90, 16, v157
v_and_b32 v91, 0xffff0000, v157
v_lshlrev_b32 v92, 16, v158
v_and_b32 v93, 0xffff0000, v158
v_lshlrev_b32 v94, 16, v159
v_and_b32 v95, 0xffff0000, v159
v_fmac_f32 v88, v104, v188
v_fmac_f32 v89, v105, v189
v_fmac_f32 v90, v106, v190
v_fmac_f32 v91, v107, v191
v_fmac_f32 v92, v108, v192
v_fmac_f32 v93, v109, v193
v_fmac_f32 v94, v110, v194
v_fmac_f32 v95, v111, v195
v_cvt_pk_bf16_f32 v156, v88, v89
v_cvt_pk_bf16_f32 v157, v90, v91
v_cvt_pk_bf16_f32 v158, v92, v93
v_cvt_pk_bf16_f32 v159, v94, v95
v_lshlrev_b32 v88, 16, v156
v_and_b32 v89, 0xffff0000, v156
v_lshlrev_b32 v90, 16, v157
v_and_b32 v91, 0xffff0000, v157
v_lshlrev_b32 v92, 16, v158
v_and_b32 v93, 0xffff0000, v158
v_lshlrev_b32 v94, 16, v159
v_and_b32 v95, 0xffff0000, v159
v_add_f32 v244, v244, v88
v_add_f32 v244, v244, v89
v_add_f32 v244, v244, v90
v_add_f32 v244, v244, v91
v_add_f32 v244, v244, v92
v_add_f32 v244, v244, v93
v_add_f32 v244, v244, v94
v_add_f32 v244, v244, v95
v_lshlrev_b32 v120, 16, v160
v_and_b32 v121, 0xffff0000, v160
v_lshlrev_b32 v122, 16, v161
v_and_b32 v123, 0xffff0000, v161
v_lshlrev_b32 v124, 16, v162
v_and_b32 v125, 0xffff0000, v162
v_lshlrev_b32 v126, 16, v163
v_and_b32 v127, 0xffff0000, v163
s_nop 1
v_fmac_f32 v120, v136, v212
v_fmac_f32 v121, v137, v213
v_fmac_f32 v122, v138, v214
v_fmac_f32 v123, v139, v215
v_fmac_f32 v124, v140, v216
v_fmac_f32 v125, v141, v217
v_fmac_f32 v126, v142, v218
v_fmac_f32 v127, v143, v219
v_cvt_pk_bf16_f32 v160, v120, v121
v_cvt_pk_bf16_f32 v161, v122, v123
v_cvt_pk_bf16_f32 v162, v124, v125
v_cvt_pk_bf16_f32 v163, v126, v127
v_lshlrev_b32 v120, 16, v160
v_and_b32 v121, 0xffff0000, v160
v_lshlrev_b32 v122, 16, v161
v_and_b32 v123, 0xffff0000, v161
v_lshlrev_b32 v124, 16, v162
v_and_b32 v125, 0xffff0000, v162
v_lshlrev_b32 v126, 16, v163
v_and_b32 v127, 0xffff0000, v163
s_mov_b64 exec, s[44:45]
v_add_f32 v244, v244, v120
v_add_f32 v244, v244, v121
v_add_f32 v244, v244, v122
v_add_f32 v244, v244, v123
v_add_f32 v244, v244, v124
v_add_f32 v244, v244, v125
v_add_f32 v244, v244, v126
v_add_f32 v244, v244, v127
s_mov_b64 exec, -1
s_nop 1
v_add_f32_dpp v244, v244, v244 row_ror:8 row_mask:0xf bank_mask:0xf
s_and_saveexec_b64 s[46:47], s[30:31]
ds_write_b32 v53, v244 offset:0
s_mov_b64 exec, s[46:47]
buffer_store_dwordx4 v[152:155], v40, s[56:59], s33 offen
buffer_store_dwordx4 v[156:159], v41, s[56:59], s33 offen
buffer_store_dwordx4 v[160:163], v42, s[56:59], s33 offen
s_waitcnt lgkmcnt(0)
s_barrier
ds_read_b128 v[64:67], v54 offset:0
ds_read_b128 v[68:71], v54 offset:16
ds_read_b128 v[72:75], v54 offset:32
ds_read_b128 v[76:79], v54 offset:48
s_waitcnt lgkmcnt(0)
v_add_f32 v64, v64, v72
v_add_f32 v65, v65, v73
v_add_f32 v66, v66, v74
v_add_f32 v67, v67, v75
v_add_f32 v68, v68, v76
v_add_f32 v69, v69, v77
v_add_f32 v70, v70, v78
v_add_f32 v71, v71, v79
v_add_f32 v64, v64, v68
v_add_f32 v65, v65, v69
v_add_f32 v66, v66, v70
v_add_f32 v67, v67, v71
v_add_f32 v64, v64, v66
v_add_f32 v65, v65, v67
v_add_f32 v64, v64, v65
v_mul_f32 v244, 0x3ae38e39, v64
v_sub_f32 v236, v56, v244
v_sub_f32 v237, v57, v244
v_sub_f32 v238, v58, v244
v_sub_f32 v239, v59, v244
v_sub_f32 v240, v60, v244
v_sub_f32 v241, v61, v244
v_sub_f32 v242, v62, v244
v_sub_f32 v243, v63, v244
v_fmac_f32 v245, v236, v236
v_fmac_f32 v245, v237, v237
v_fmac_f32 v245, v238, v238
v_fmac_f32 v245, v239, v239
v_fmac_f32 v245, v240, v240
v_fmac_f32 v245, v241, v241
v_fmac_f32 v245, v242, v242
v_fmac_f32 v245, v243, v243
v_sub_f32 v236, v88, v244
v_sub_f32 v237, v89, v244
v_sub_f32 v238, v90, v244
v_sub_f32 v239, v91, v244
v_sub_f32 v240, v92, v244
v_sub_f32 v241, v93, v244
v_sub_f32 v242, v94, v244
v_sub_f32 v243, v95, v244
v_fmac_f32 v245, v236, v236
v_fmac_f32 v245, v237, v237
v_fmac_f32 v245, v238, v238
v_fmac_f32 v245, v239, v239
v_fmac_f32 v245, v240, v240
v_fmac_f32 v245, v241, v241
v_fmac_f32 v245, v242, v242
v_fmac_f32 v245, v243, v243
s_mov_b64 exec, s[44:45]
v_sub_f32 v236, v120, v244
v_sub_f32 v237, v121, v244
v_sub_f32 v238, v122, v244
v_sub_f32 v239, v123, v244
v_sub_f32 v240, v124, v244
v_sub_f32 v241, v125, v244
v_sub_f32 v242, v126, v244
v_sub_f32 v243, v127, v244
v_fmac_f32 v245, v236, v236
v_fmac_f32 v245, v237, v237
v_fmac_f32 v245, v238, v238
v_fmac_f32 v245, v239, v239
v_fmac_f32 v245, v240, v240
v_fmac_f32 v245, v241, v241
v_fmac_f32 v245, v242, v242
v_fmac_f32 v245, v243, v243
s_mov_b64 exec, -1
s_nop 1
v_add_f32_dpp v245, v245, v245 row_ror:8 row_mask:0xf bank_mask:0xf
s_and_saveexec_b64 s[46:47], s[30:31]
ds_write_b32 v53, v245 offset:512
s_mov_b64 exec, s[46:47]
s_waitcnt lgkmcnt(0)
s_barrier
ds_read_b128 v[64:67], v54 offset:512
ds_read_b128 v[68:71], v54 offset:528
ds_read_b128 v[72:75], v54 offset:544
ds_read_b128 v[76:79], v54 offset:560
s_waitcnt lgkmcnt(0)
v_add_f32 v64, v64, v72
v_add_f32 v65, v65, v73
v_add_f32 v66, v66, v74
v_add_f32 v67, v67, v75
v_add_f32 v68, v68, v76
v_add_f32 v69, v69, v77
v_add_f32 v70, v70, v78
v_add_f32 v71, v71, v79
v_add_f32 v64, v64, v68
v_add_f32 v65, v65, v69
v_add_f32 v66, v66, v70
v_add_f32 v67, v67, v71
v_add_f32 v64, v64, v66
v_add_f32 v65, v65, v67
v_add_f32 v64, v64, v65
v_mul_f32 v245, 0x3ae38e39, v64
v_cvt_pk_bf16_f32 v245, v244, v245
v_lshlrev_b32 v244, 16, v245
v_and_b32 v245, 0xffff0000, v245
v_add_f32 v245, 0x3727c5ac, v245
v_cvt_pk_bf16_f32 v245, v245, v245
v_and_b32 v245, 0xffff0000, v245
v_sqrt_f32 v245, v245
s_nop 0
v_cvt_pk_bf16_f32 v245, v245, v245
v_and_b32 v245, 0xffff0000, v245
v_rcp_f32 v245, v245
s_nop 0
v_mul_f32 v244, v244, v245
v_fma_f32 v56, v56, v245, -v244
v_fma_f32 v57, v57, v245, -v244
v_fma_f32 v58, v58, v245, -v244
v_fma_f32 v59, v59, v245, -v244
v_fma_f32 v60, v60, v245, -v244
v_fma_f32 v61, v61, v245, -v244
v_fma_f32 v62, v62, v245, -v244
v_fma_f32 v63, v63, v245, -v244
v_fmac_f32 v180, v56, v172
v_fmac_f32 v181, v57, v173
v_fmac_f32 v182, v58, v174
v_fmac_f32 v183, v59, v175
v_fmac_f32 v184, v60, v176
v_fmac_f32 v185, v61, v177
v_fmac_f32 v186, v62, v178
v_fmac_f32 v187, v63, v179
v_cvt_pk_bf16_f32 v64, v180, v181
v_cvt_pk_bf16_f32 v65, v182, v183
v_cvt_pk_bf16_f32 v66, v184, v185
v_cvt_pk_bf16_f32 v67, v186, v187
buffer_store_dwordx4 v[64:67], v40, s[16:19], s33 offen sc1
v_fma_f32 v88, v88, v245, -v244
v_fma_f32 v89, v89, v245, -v244
v_fma_f32 v90, v90, v245, -v244
v_fma_f32 v91, v91, v245, -v244
v_fma_f32 v92, v92, v245, -v244
v_fma_f32 v93, v93, v245, -v244
v_fma_f32 v94, v94, v245, -v244
v_fma_f32 v95, v95, v245, -v244
v_fmac_f32 v204, v88, v196
v_fmac_f32 v205, v89, v197
v_fmac_f32 v206, v90, v198
v_fmac_f32 v207, v91, v199
v_fmac_f32 v208, v92, v200
v_fmac_f32 v209, v93, v201
v_fmac_f32 v210, v94, v202
v_fmac_f32 v211, v95, v203
v_cvt_pk_bf16_f32 v68, v204, v205
v_cvt_pk_bf16_f32 v69, v206, v207
v_cvt_pk_bf16_f32 v70, v208, v209
v_cvt_pk_bf16_f32 v71, v210, v211
buffer_store_dwordx4 v[68:71], v41, s[16:19], s33 offen sc1
v_fma_f32 v120, v120, v245, -v244
v_fma_f32 v121, v121, v245, -v244
v_fma_f32 v122, v122, v245, -v244
v_fma_f32 v123, v123, v245, -v244
v_fma_f32 v124, v124, v245, -v244
v_fma_f32 v125, v125, v245, -v244
v_fma_f32 v126, v126, v245, -v244
v_fma_f32 v127, v127, v245, -v244
v_fmac_f32 v228, v120, v220
v_fmac_f32 v229, v121, v221
v_fmac_f32 v230, v122, v222
v_fmac_f32 v231, v123, v223
v_fmac_f32 v232, v124, v224
v_fmac_f32 v233, v125, v225
v_fmac_f32 v234, v126, v226
v_fmac_f32 v235, v127, v227
v_cvt_pk_bf16_f32 v72, v228, v229
v_cvt_pk_bf16_f32 v73, v230, v231
v_cvt_pk_bf16_f32 v74, v232, v233
v_cvt_pk_bf16_f32 v75, v234, v235
buffer_store_dwordx4 v[72:75], v42, s[16:19], s33 offen sc1
s_add_u32 s60, s38, 9502720
s_addc_u32 s61, s39, 0
s_mov_b32 s62, 0x10000
s_mov_b32 s63, 0x00020000
s_bfe_u32 s68, s2, 131075
s_mov_b32 s3, 0
s_andn2_b32 s64, s2, 24
s_add_u32 s65, s68, 1
s_and_b32 s65, s65, 3
s_lshl_b32 s65, s65, 3
s_or_b32 s65, s65, s64
s_add_u32 s66, s68, 3
s_and_b32 s66, s66, 3
s_lshl_b32 s66, s66, 3
s_or_b32 s66, s66, s64
s_lshl_b32 s67, s29, 6
s_lshl_b32 s64, s2, 8
s_add_u32 s64, s64, s67
s_lshl_b32 s65, s65, 8
s_add_u32 s65, s65, s67
s_lshl_b32 s66, s66, 8
s_add_u32 s66, s66, s67
s_mul_i32 s70, s68, 5
s_lshr_b32 s70, s70, 1
s_cmp_eq_u32 s68, 1
s_cselect_b32 s69, 3, 2
s_getreg_b32 s67, hwreg(HW_REG_XCC_ID, 0, 4)
s_add_u32 s67, s67, 1
v_mov_b32 v27, 0
v_mov_b32 v255, s67
s_lshl_b32 s68, s70, 11
s_add_u32 s72, s27, s68
s_add_u32 s68, s68, 2048
s_cmp_eq_u32 s68, 18432
s_cselect_b32 s68, 0, s68
s_add_u32 s73, s27, s68
s_add_u32 s68, s68, 2048
s_cmp_eq_u32 s68, 18432
s_cselect_b32 s68, 0, s68
s_add_u32 s74, s27, s68
s_add_u32 s68, s68, 2048
s_cmp_eq_u32 s68, 18432
s_cselect_b32 s68, 0, s68
s_add_u32 s75, s27, s68
s_add_u32 s68, s68, 2048
s_cmp_eq_u32 s68, 18432
s_cselect_b32 s68, 0, s68
s_add_u32 s76, s27, s68
s_add_u32 s68, s68, 2048
s_cmp_eq_u32 s68, 18432
s_cselect_b32 s68, 0, s68
s_add_u32 s77, s27, s68
s_add_u32 s68, s68, 2048
s_cmp_eq_u32 s68, 18432
s_cselect_b32 s68, 0, s68
s_add_u32 s78, s27, s68
s_add_u32 s68, s68, 2048
s_cmp_eq_u32 s68, 18432
s_cselect_b32 s68, 0, s68
s_add_u32 s79, s27, s68
s_add_u32 s68, s68, 2048
s_cmp_eq_u32 s68, 18432
s_cselect_b32 s68, 0, s68
s_add_u32 s80, s27, s68
s_cmp_eq_u32 s69, 3
s_cselect_b32 s71, 1073741824, s74
s_cselect_b32 s81, s74, 1073741824
s_lshl_b32 s70, s70, 7
buffer_store_dword v255, v27, s[60:63], s64 offen sc1
s_waitcnt vmcnt(1)
s_barrier
s_cmp_lg_u32 s29, 0
s_cbranch_scc1 kb_kernel_skip8
s_lshl_b32 s43, s32, 6
v_mov_b32 v53, 1
v_mov_b32 v54, 0
buffer_store_dword v53, v54, s[4:7], s43 offen sc1
kb_kernel_skip8:
s_add_u32 m0, s28, 36864
s_nop 0
global_load_lds_dwordx4 v1, s[8:9]
global_load_lds_dwordx4 v2, s[8:9] offset:1024
global_load_lds_dwordx4 v3, s[8:9] offset:2048
global_load_lds_dwordx4 v4, s[8:9] offset:3072
s_add_u32 m0, s28, 40960
s_nop 0
global_load_lds_dwordx4 v5, s[8:9]
global_load_lds_dwordx4 v6, s[8:9] offset:1024
global_load_lds_dwordx4 v7, s[8:9] offset:2048
global_load_lds_dwordx4 v8, s[8:9] offset:3072
s_add_u32 m0, s28, 45056
s_nop 0
global_load_lds_dwordx4 v9, s[8:9]
s_add_u32 s8, s8, 294912
s_addc_u32 s9, s9, 0
s_cmp_lg_u32 s29, 0
s_cbranch_scc1 kb_kernel_skip7
s_lshl_b32 s42, s41, 10
v_and_b32 v54, 15, v0
v_lshlrev_b32 v54, 6, v54
kb_kernel_poll6:
buffer_load_dword v55, v54, s[4:7], s42 offen sc1
s_add_u32 s3, s3, 1
s_cmp_gt_u32 s3, 0x80000
s_cbranch_scc1 kb_kernel_skip7
s_waitcnt vmcnt(0)
v_cmp_ne_u32 vcc, 1, v55
s_cbranch_vccnz kb_kernel_poll6
kb_kernel_skip7:
s_barrier
s_add_u32 s30, s16, s26
s_addc_u32 s31, s17, 0
global_load_dwordx4 a[112:115], v25, s[30:31] sc1
global_load_dwordx4 a[116:119], v26, s[30:31] sc1
s_add_u32 s30, s30, 1024
s_addc_u32 s31, s31, 0
global_load_dwordx4 a[120:123], v25, s[30:31] sc1
global_load_dwordx4 a[124:127], v26, s[30:31] sc1
s_add_u32 s30, s30, 1024
s_addc_u32 s31, s31, 0
global_load_dwordx4 a[128:131], v25, s[30:31] sc1
global_load_dwordx4 a[132:135], v26, s[30:31] sc1
s_add_u32 s30, s30, 1024
s_addc_u32 s31, s31, 0
s_waitcnt vmcnt(4)
s_barrier
TR a[80:81], v19, 0
TR a[82:83], v19, 18432
TR a[84:85], v19, 9216
TR a[86:87], v19, 27648
TR a[88:89], v20, 32
TR a[90:91], v20, 18464
TR a[92:93], v20, 9248
TR a[94:95], v20, 27680
TR a[96:97], v19, 64
TR a[98:99], v19, 18496
TR a[100:101], v19, 9280
TR a[102:103], v19, 27712
TR a[104:105], v20, 96
TR a[106:107], v20, 18528
s_waitcnt lgkmcnt(6)
MF v[40:43], a[80:83], a[112:115], 0
TR a[108:109], v20, 9312
s_add_u32 m0, s28, 73728
MF v[44:47], a[80:83], a[116:119], 0
TR a[110:111], v20, 27744
global_load_lds_dwordx4 v1, s[8:9]
MF v[184:187], a[84:87], a[112:115], 0
TR a[80:81], v19, 128
global_load_lds_dwordx4 v2, s[8:9] offset:1024
MF v[188:191], a[84:87], a[116:119], 0
TR a[82:83], v19, 18560
global_load_lds_dwordx4 v3, s[8:9] offset:2048
MF v[48:51], a[88:91], a[112:115], 0
TR a[84:85], v19, 9344
MF v[52:55], a[88:91], a[116:119], 0
TR a[86:87], v19, 27776
global_load_lds_dwordx4 v4, s[8:9] offset:3072
MF v[192:195], a[92:95], a[112:115], 0
TR a[88:89], v20, 160
MF v[196:199], a[92:95], a[116:119], 0
TR a[90:91], v20, 18592
s_waitcnt lgkmcnt(6)
MF v[56:59], a[96:99], a[112:115], 0
TR a[92:93], v20, 9376
s_add_u32 m0, s28, 77824
MF v[60:63], a[96:99], a[116:119], 0
TR a[94:95], v20, 27808
global_load_lds_dwordx4 v5, s[8:9]
MF v[200:203], a[100:103], a[112:115], 0
TR a[96:97], v19, 192
global_load_lds_dwordx4 v6, s[8:9] offset:1024
MF v[204:207], a[100:103], a[116:119], 0
TR a[98:99], v19, 18624
global_load_lds_dwordx4 v7, s[8:9] offset:2048
MF v[64:67], a[104:107], a[112:115], 0
TR a[100:101], v19, 9408
v_add_u32 v248, 0x9000, v19
MF v[68:71], a[104:107], a[116:119], 0
TR a[102:103], v19, 27840
global_load_lds_dwordx4 v8, s[8:9] offset:3072
MF v[208:211], a[108:111], a[112:115], 0
TR a[104:105], v20, 224
v_add_u32 v249, 0x9000, v20
MF v[212:215], a[108:111], a[116:119], 0
TR a[106:107], v20, 18656
s_waitcnt lgkmcnt(6)
MF v[72:75], a[80:83], a[112:115], 0
TR a[108:109], v20, 9440
s_add_u32 m0, s28, 81920
MF v[76:79], a[80:83], a[116:119], 0
TR a[110:111], v20, 27872
global_load_lds_dwordx4 v9, s[8:9]
MF v[216:219], a[84:87], a[112:115], 0
TR a[80:81], v19, 256
s_add_u32 s8, s8, 294912
s_addc_u32 s9, s9, 0
MF v[220:223], a[84:87], a[116:119], 0
TR a[82:83], v19, 18688
MF v[80:83], a[88:91], a[112:115], 0
TR a[84:85], v19, 9472
MF v[84:87], a[88:91], a[116:119], 0
TR a[86:87], v19, 27904
MF v[224:227], a[92:95], a[112:115], 0
TR a[88:89], v20, 288
MF v[228:231], a[92:95], a[116:119], 0
TR a[90:91], v20, 18720
s_waitcnt lgkmcnt(6)
MF v[88:91], a[96:99], a[112:115], 0
TR a[92:93], v20, 9504
MF v[92:95], a[96:99], a[116:119], 0
TR a[94:95], v20, 27936
MF v[232:235], a[100:103], a[112:115], 0
TR a[96:97], v19, 320
MF v[236:239], a[100:103], a[116:119], 0
TR a[98:99], v19, 18752
MF v[96:99], a[104:107], a[112:115], 0
TR a[100:101], v19, 9536
MF v[100:103], a[104:107], a[116:119], 0
TR a[102:103], v19, 27968
MF v[240:243], a[108:111], a[112:115], 0
TR a[104:105], v20, 352
MF v[244:247], a[108:111], a[116:119], 0
TR a[106:107], v20, 18784
s_waitcnt lgkmcnt(6)
MF v[104:107], a[80:83], a[112:115], 0
TR a[108:109], v20, 9568
MF v[108:111], a[80:83], a[116:119], 0
TR a[110:111], v20, 28000
MF a[0:3], a[84:87], a[112:115], 0
TR a[80:81], v19, 384
MF a[4:7], a[84:87], a[116:119], 0
TR a[82:83], v19, 18816
MF v[112:115], a[88:91], a[112:115], 0
TR a[84:85], v19, 9600
MF v[116:119], a[88:91], a[116:119], 0
TR a[86:87], v19, 28032
MF a[8:11], a[92:95], a[112:115], 0
TR a[88:89], v20, 416
MF a[12:15], a[92:95], a[116:119], 0
TR a[90:91], v20, 18848
s_waitcnt lgkmcnt(6)
MF v[120:123], a[96:99], a[112:115], 0
TR a[92:93], v20, 9632
MF v[124:127], a[96:99], a[116:119], 0
TR a[94:95], v20, 28064
MF a[16:19], a[100:103], a[112:115], 0
TR a[96:97], v19, 448
MF a[20:23], a[100:103], a[116:119], 0
TR a[98:99], v19, 18880
MF v[128:131], a[104:107], a[112:115], 0
TR a[100:101], v19, 9664
MF v[132:135], a[104:107], a[116:119], 0
TR a[102:103], v19, 28096
MF a[24:27], a[108:111], a[112:115], 0
TR a[104:105], v20, 480
MF a[28:31], a[108:111], a[116:119], 0
TR a[106:107], v20, 18912
s_waitcnt lgkmcnt(6)
MF v[136:139], a[80:83], a[112:115], 0
TR a[108:109], v20, 9696
MF v[140:143], a[80:83], a[116:119], 0
TR a[110:111], v20, 28128
MF a[32:35], a[84:87], a[112:115], 0
TR a[80:81], v19, 512
MF a[36:39], a[84:87], a[116:119], 0
TR a[82:83], v19, 18944
MF v[144:147], a[88:91], a[112:115], 0
TR a[84:85], v19, 9728
MF v[148:151], a[88:91], a[116:119], 0
TR a[86:87], v19, 28160
MF a[40:43], a[92:95], a[112:115], 0
TR a[88:89], v20, 544
s_waitcnt vmcnt(11)
MF a[44:47], a[92:95], a[116:119], 0
TR a[90:91], v20, 18976
s_waitcnt lgkmcnt(6)
MF v[152:155], a[96:99], a[112:115], 0
TR a[92:93], v20, 9760
s_barrier
MF v[156:159], a[96:99], a[116:119], 0
TR a[94:95], v20, 28192
s_add_u32 m0, s28, 110592
MF a[48:51], a[100:103], a[112:115], 0
TR a[96:97], v248, 0
global_load_lds_dwordx4 v1, s[8:9]
MF a[52:55], a[100:103], a[116:119], 0
TR a[98:99], v248, 18432
MF v[160:163], a[104:107], a[112:115], 0
TR a[100:101], v248, 9216
MF v[164:167], a[104:107], a[116:119], 0
TR a[102:103], v248, 27648
MF a[56:59], a[108:111], a[112:115], 0
TR a[104:105], v249, 32
global_load_lds_dwordx4 v2, s[8:9] offset:1024
MF a[60:63], a[108:111], a[116:119], 0
TR a[106:107], v249, 18464
s_waitcnt lgkmcnt(6)
MF v[168:171], a[80:83], a[112:115], 0
TR a[108:109], v249, 9248
MF v[172:175], a[80:83], a[116:119], 0
TR a[110:111], v249, 27680
MF a[64:67], a[84:87], a[112:115], 0
TR a[80:81], v248, 64
MF a[68:71], a[84:87], a[116:119], 0
TR a[82:83], v248, 18496
global_load_lds_dwordx4 v3, s[8:9] offset:2048
MF v[176:179], a[88:91], a[112:115], 0
TR a[84:85], v248, 9280
MF v[180:183], a[88:91], a[116:119], 0
TR a[86:87], v248, 27712
v_add_u32 v19, 0x9000, v248
MF a[72:75], a[92:95], a[112:115], 0
TR a[88:89], v249, 96
v_add_u32 v20, 0x9000, v249
MF a[76:79], a[92:95], a[116:119], 0
TR a[90:91], v249, 18528
s_waitcnt lgkmcnt(6)
MF v[40:43], a[96:99], a[120:123], v[40:43]
TR a[92:93], v249, 9312
global_load_lds_dwordx4 v4, s[8:9] offset:3072
MF v[44:47], a[96:99], a[124:127], v[44:47]
TR a[94:95], v249, 27744
s_add_u32 m0, s28, 114688
MF v[184:187], a[100:103], a[120:123], v[184:187]
TR a[96:97], v248, 128
MF v[188:191], a[100:103], a[124:127], v[188:191]
TR a[98:99], v248, 18560
MF v[48:51], a[104:107], a[120:123], v[48:51]
TR a[100:101], v248, 9344
MF v[52:55], a[104:107], a[124:127], v[52:55]
TR a[102:103], v248, 27776
global_load_lds_dwordx4 v5, s[8:9]
MF v[192:195], a[108:111], a[120:123], v[192:195]
TR a[104:105], v249, 160
MF v[196:199], a[108:111], a[124:127], v[196:199]
TR a[106:107], v249, 18592
s_waitcnt lgkmcnt(6)
MF v[56:59], a[80:83], a[120:123], v[56:59]
TR a[108:109], v249, 9376
MF v[60:63], a[80:83], a[124:127], v[60:63]
TR a[110:111], v249, 27808
MF v[200:203], a[84:87], a[120:123], v[200:203]
TR a[80:81], v248, 192
global_load_lds_dwordx4 v6, s[8:9] offset:1024
MF v[204:207], a[84:87], a[124:127], v[204:207]
TR a[82:83], v248, 18624
MF v[64:67], a[88:91], a[120:123], v[64:67]
TR a[84:85], v248, 9408
MF v[68:71], a[88:91], a[124:127], v[68:71]
TR a[86:87], v248, 27840
MF v[208:211], a[92:95], a[120:123], v[208:211]
TR a[88:89], v249, 224
MF v[212:215], a[92:95], a[124:127], v[212:215]
TR a[90:91], v249, 18656
s_waitcnt lgkmcnt(6)
MF v[72:75], a[96:99], a[120:123], v[72:75]
TR a[92:93], v249, 9440
global_load_lds_dwordx4 v7, s[8:9] offset:2048
MF v[76:79], a[96:99], a[124:127], v[76:79]
TR a[94:95], v249, 27872
MF v[216:219], a[100:103], a[120:123], v[216:219]
TR a[96:97], v248, 256
MF v[220:223], a[100:103], a[124:127], v[220:223]
TR a[98:99], v248, 18688
MF v[80:83], a[104:107], a[120:123], v[80:83]
TR a[100:101], v248, 9472
global_load_lds_dwordx4 v8, s[8:9] offset:3072
MF v[84:87], a[104:107], a[124:127], v[84:87]
TR a[102:103], v248, 27904
s_add_u32 m0, s28, 118784
MF v[224:227], a[108:111], a[120:123], v[224:227]
TR a[104:105], v249, 288
MF v[228:231], a[108:111], a[124:127], v[228:231]
TR a[106:107], v249, 18720
s_waitcnt lgkmcnt(6)
MF v[88:91], a[80:83], a[120:123], v[88:91]
TR a[108:109], v249, 9504
MF v[92:95], a[80:83], a[124:127], v[92:95]
TR a[110:111], v249, 27936
global_load_lds_dwordx4 v9, s[8:9]
MF v[232:235], a[84:87], a[120:123], v[232:235]
TR a[80:81], v248, 320
s_add_u32 s8, s8, 294912
s_addc_u32 s9, s9, 0
MF v[236:239], a[84:87], a[124:127], v[236:239]
TR a[82:83], v248, 18752
MF v[96:99], a[88:91], a[120:123], v[96:99]
TR a[84:85], v248, 9536
MF v[100:103], a[88:91], a[124:127], v[100:103]
TR a[86:87], v248, 27968
MF v[240:243], a[92:95], a[120:123], v[240:243]
TR a[88:89], v249, 352
global_load_dwordx4 a[136:139], v25, s[30:31] sc1
MF v[244:247], a[92:95], a[124:127], v[244:247]
TR a[90:91], v249, 18784
s_waitcnt lgkmcnt(6)
MF v[104:107], a[96:99], a[120:123], v[104:107]
TR a[92:93], v249, 9568
MF v[108:111], a[96:99], a[124:127], v[108:111]
TR a[94:95], v249, 28000
MF a[0:3], a[100:103], a[120:123], a[0:3]
TR a[96:97], v248, 384
MF a[4:7], a[100:103], a[124:127], a[4:7]
TR a[98:99], v248, 18816
global_load_dwordx4 a[140:143], v26, s[30:31] sc1
MF v[112:115], a[104:107], a[120:123], v[112:115]
TR a[100:101], v248, 9600
s_add_u32 s30, s30, 1024
s_addc_u32 s31, s31, 0
MF v[116:119], a[104:107], a[124:127], v[116:119]
TR a[102:103], v248, 28032
MF a[8:11], a[108:111], a[120:123], a[8:11]
TR a[104:105], v249, 416
MF a[12:15], a[108:111], a[124:127], a[12:15]
TR a[106:107], v249, 18848
s_waitcnt lgkmcnt(6)
MF v[120:123], a[80:83], a[120:123], v[120:123]
TR a[108:109], v249, 9632
MF v[124:127], a[80:83], a[124:127], v[124:127]
TR a[110:111], v249, 28064
MF a[16:19], a[84:87], a[120:123], a[16:19]
TR a[80:81], v248, 448
MF a[20:23], a[84:87], a[124:127], a[20:23]
TR a[82:83], v248, 18880
MF v[128:131], a[88:91], a[120:123], v[128:131]
TR a[84:85], v248, 9664
MF v[132:135], a[88:91], a[124:127], v[132:135]
TR a[86:87], v248, 28096
MF a[24:27], a[92:95], a[120:123], a[24:27]
TR a[88:89], v249, 480
MF a[28:31], a[92:95], a[124:127], a[28:31]
TR a[90:91], v249, 18912
s_waitcnt lgkmcnt(6)
MF v[136:139], a[96:99], a[120:123], v[136:139]
TR a[92:93], v249, 9696
MF v[140:143], a[96:99], a[124:127], v[140:143]
TR a[94:95], v249, 28128
MF a[32:35], a[100:103], a[120:123], a[32:35]
TR a[96:97], v248, 512
MF a[36:39], a[100:103], a[124:127], a[36:39]
TR a[98:99], v248, 18944
MF v[144:147], a[104:107], a[120:123], v[144:147]
TR a[100:101], v248, 9728
MF v[148:151], a[104:107], a[124:127], v[148:151]
TR a[102:103], v248, 28160
MF a[40:43], a[108:111], a[120:123], a[40:43]
TR a[104:105], v249, 544
s_waitcnt vmcnt(11)
MF a[44:47], a[108:111], a[124:127], a[44:47]
TR a[106:107], v249, 18976
s_waitcnt lgkmcnt(6)
MF v[152:155], a[80:83], a[120:123], v[152:155]
TR a[108:109], v249, 9760
s_barrier
MF v[156:159], a[80:83], a[124:127], v[156:159]
TR a[110:111], v249, 28192
s_add_u32 m0, s28, 0
MF a[48:51], a[84:87], a[120:123], a[48:51]
TR a[80:81], v19, 0
global_load_lds_dwordx4 v1, s[8:9]
MF a[52:55], a[84:87], a[124:127], a[52:55]
TR a[82:83], v19, 18432
MF v[160:163], a[88:91], a[120:123], v[160:163]
TR a[84:85], v19, 9216
MF v[164:167], a[88:91], a[124:127], v[164:167]
TR a[86:87], v19, 27648
MF a[56:59], a[92:95], a[120:123], a[56:59]
TR a[88:89], v20, 32
global_load_lds_dwordx4 v2, s[8:9] offset:1024
MF a[60:63], a[92:95], a[124:127], a[60:63]
TR a[90:91], v20, 18464
s_waitcnt lgkmcnt(6)
MF v[168:171], a[96:99], a[120:123], v[168:171]
TR a[92:93], v20, 9248
MF v[172:175], a[96:99], a[124:127], v[172:175]
TR a[94:95], v20, 27680
MF a[64:67], a[100:103], a[120:123], a[64:67]
TR a[96:97], v19, 64
MF a[68:71], a[100:103], a[124:127], a[68:71]
TR a[98:99], v19, 18496
global_load_lds_dwordx4 v3, s[8:9] offset:2048
MF v[176:179], a[104:107], a[120:123], v[176:179]
TR a[100:101], v19, 9280
MF v[180:183], a[104:107], a[124:127], v[180:183]
TR a[102:103], v19, 27712
v_add_u32 v248, 0x9000, v19
MF a[72:75], a[108:111], a[120:123], a[72:75]
TR a[104:105], v20, 96
v_add_u32 v249, 0x9000, v20
MF a[76:79], a[108:111], a[124:127], a[76:79]
TR a[106:107], v20, 18528
s_waitcnt lgkmcnt(6)
MF v[40:43], a[80:83], a[128:131], v[40:43]
TR a[108:109], v20, 9312
global_load_lds_dwordx4 v4, s[8:9] offset:3072
MF v[44:47], a[80:83], a[132:135], v[44:47]
TR a[110:111], v20, 27744
s_add_u32 m0, s28, 4096
MF v[184:187], a[84:87], a[128:131], v[184:187]
TR a[80:81], v19, 128
MF v[188:191], a[84:87], a[132:135], v[188:191]
TR a[82:83], v19, 18560
MF v[48:51], a[88:91], a[128:131], v[48:51]
TR a[84:85], v19, 9344
MF v[52:55], a[88:91], a[132:135], v[52:55]
TR a[86:87], v19, 27776
global_load_lds_dwordx4 v5, s[8:9]
MF v[192:195], a[92:95], a[128:131], v[192:195]
TR a[88:89], v20, 160
MF v[196:199], a[92:95], a[132:135], v[196:199]
TR a[90:91], v20, 18592
s_waitcnt lgkmcnt(6)
MF v[56:59], a[96:99], a[128:131], v[56:59]
TR a[92:93], v20, 9376
MF v[60:63], a[96:99], a[132:135], v[60:63]
TR a[94:95], v20, 27808
MF v[200:203], a[100:103], a[128:131], v[200:203]
TR a[96:97], v19, 192
global_load_lds_dwordx4 v6, s[8:9] offset:1024
MF v[204:207], a[100:103], a[132:135], v[204:207]
TR a[98:99], v19, 18624
MF v[64:67], a[104:107], a[128:131], v[64:67]
TR a[100:101], v19, 9408
MF v[68:71], a[104:107], a[132:135], v[68:71]
TR a[102:103], v19, 27840
MF v[208:211], a[108:111], a[128:131], v[208:211]
TR a[104:105], v20, 224
MF v[212:215], a[108:111], a[132:135], v[212:215]
TR a[106:107], v20, 18656
s_waitcnt lgkmcnt(6)
MF v[72:75], a[80:83], a[128:131], v[72:75]
TR a[108:109], v20, 9440
global_load_lds_dwordx4 v7, s[8:9] offset:2048
MF v[76:79], a[80:83], a[132:135], v[76:79]
TR a[110:111], v20, 27872
MF v[216:219], a[84:87], a[128:131], v[216:219]
TR a[80:81], v19, 256
MF v[220:223], a[84:87], a[132:135], v[220:223]
TR a[82:83], v19, 18688
MF v[80:83], a[88:91], a[128:131], v[80:83]
TR a[84:85], v19, 9472
global_load_lds_dwordx4 v8, s[8:9] offset:3072
MF v[84:87], a[88:91], a[132:135], v[84:87]
TR a[86:87], v19, 27904
s_add_u32 m0, s28, 8192
MF v[224:227], a[92:95], a[128:131], v[224:227]
TR a[88:89], v20, 288
MF v[228:231], a[92:95], a[132:135], v[228:231]
TR a[90:91], v20, 18720
s_waitcnt lgkmcnt(6)
MF v[88:91], a[96:99], a[128:131], v[88:91]
TR a[92:93], v20, 9504
MF v[92:95], a[96:99], a[132:135], v[92:95]
TR a[94:95], v20, 27936
global_load_lds_dwordx4 v9, s[8:9]
MF v[232:235], a[100:103], a[128:131], v[232:235]
TR a[96:97], v19, 320
s_add_u32 s8, s8, 294912
s_addc_u32 s9, s9, 0
MF v[236:239], a[100:103], a[132:135], v[236:239]
TR a[98:99], v19, 18752
MF v[96:99], a[104:107], a[128:131], v[96:99]
TR a[100:101], v19, 9536
MF v[100:103], a[104:107], a[132:135], v[100:103]
TR a[102:103], v19, 27968
MF v[240:243], a[108:111], a[128:131], v[240:243]
TR a[104:105], v20, 352
global_load_dwordx4 a[144:147], v25, s[30:31] sc1
MF v[244:247], a[108:111], a[132:135], v[244:247]
TR a[106:107], v20, 18784
s_waitcnt lgkmcnt(6)
MF v[104:107], a[80:83], a[128:131], v[104:107]
TR a[108:109], v20, 9568
MF v[108:111], a[80:83], a[132:135], v[108:111]
TR a[110:111], v20, 28000
MF a[0:3], a[84:87], a[128:131], a[0:3]
TR a[80:81], v19, 384
MF a[4:7], a[84:87], a[132:135], a[4:7]
TR a[82:83], v19, 18816
global_load_dwordx4 a[148:151], v26, s[30:31] sc1
MF v[112:115], a[88:91], a[128:131], v[112:115]
TR a[84:85], v19, 9600
s_add_u32 s30, s30, 1024
s_addc_u32 s31, s31, 0
MF v[116:119], a[88:91], a[132:135], v[116:119]
TR a[86:87], v19, 28032
MF a[8:11], a[92:95], a[128:131], a[8:11]
TR a[88:89], v20, 416
MF a[12:15], a[92:95], a[132:135], a[12:15]
TR a[90:91], v20, 18848
s_waitcnt lgkmcnt(6)
MF v[120:123], a[96:99], a[128:131], v[120:123]
TR a[92:93], v20, 9632
MF v[124:127], a[96:99], a[132:135], v[124:127]
TR a[94:95], v20, 28064
MF a[16:19], a[100:103], a[128:131], a[16:19]
TR a[96:97], v19, 448
MF a[20:23], a[100:103], a[132:135], a[20:23]
TR a[98:99], v19, 18880
MF v[128:131], a[104:107], a[128:131], v[128:131]
TR a[100:101], v19, 9664
MF v[132:135], a[104:107], a[132:135], v[132:135]
TR a[102:103], v19, 28096
MF a[24:27], a[108:111], a[128:131], a[24:27]
TR a[104:105], v20, 480
MF a[28:31], a[108:111], a[132:135], a[28:31]
TR a[106:107], v20, 18912
s_waitcnt lgkmcnt(6)
MF v[136:139], a[80:83], a[128:131], v[136:139]
TR a[108:109], v20, 9696
MF v[140:143], a[80:83], a[132:135], v[140:143]
TR a[110:111], v20, 28128
MF a[32:35], a[84:87], a[128:131], a[32:35]
TR a[80:81], v19, 512
MF a[36:39], a[84:87], a[132:135], a[36:39]
TR a[82:83], v19, 18944
MF v[144:147], a[88:91], a[128:131], v[144:147]
TR a[84:85], v19, 9728
MF v[148:151], a[88:91], a[132:135], v[148:151]
TR a[86:87], v19, 28160
MF a[40:43], a[92:95], a[128:131], a[40:43]
TR a[88:89], v20, 544
s_waitcnt vmcnt(11)
MF a[44:47], a[92:95], a[132:135], a[44:47]
TR a[90:91], v20, 18976
s_waitcnt lgkmcnt(6)
MF v[152:155], a[96:99], a[128:131], v[152:155]
TR a[92:93], v20, 9760
s_barrier
MF v[156:159], a[96:99], a[132:135], v[156:159]
TR a[94:95], v20, 28192
s_add_u32 m0, s28, 36864
MF a[48:51], a[100:103], a[128:131], a[48:51]
TR a[96:97], v248, 0
global_load_lds_dwordx4 v1, s[8:9]
MF a[52:55], a[100:103], a[132:135], a[52:55]
TR a[98:99], v248, 18432
MF v[160:163], a[104:107], a[128:131], v[160:163]
TR a[100:101], v248, 9216
MF v[164:167], a[104:107], a[132:135], v[164:167]
TR a[102:103], v248, 27648
MF a[56:59], a[108:111], a[128:131], a[56:59]
TR a[104:105], v249, 32
global_load_lds_dwordx4 v2, s[8:9] offset:1024
MF a[60:63], a[108:111], a[132:135], a[60:63]
TR a[106:107], v249, 18464
s_waitcnt lgkmcnt(6)
MF v[168:171], a[80:83], a[128:131], v[168:171]
TR a[108:109], v249, 9248
MF v[172:175], a[80:83], a[132:135], v[172:175]
TR a[110:111], v249, 27680
MF a[64:67], a[84:87], a[128:131], a[64:67]
TR a[80:81], v248, 64
MF a[68:71], a[84:87], a[132:135], a[68:71]
TR a[82:83], v248, 18496
global_load_lds_dwordx4 v3, s[8:9] offset:2048
MF v[176:179], a[88:91], a[128:131], v[176:179]
TR a[84:85], v248, 9280
MF v[180:183], a[88:91], a[132:135], v[180:183]
TR a[86:87], v248, 27712
v_add_u32 v19, 0xfffe5000, v248
MF a[72:75], a[92:95], a[128:131], a[72:75]
TR a[88:89], v249, 96
v_add_u32 v20, 0xfffe5000, v249
MF a[76:79], a[92:95], a[132:135], a[76:79]
TR a[90:91], v249, 18528
s_waitcnt lgkmcnt(6)
MF v[40:43], a[96:99], a[136:139], v[40:43]
TR a[92:93], v249, 9312
global_load_lds_dwordx4 v4, s[8:9] offset:3072
MF v[44:47], a[96:99], a[140:143], v[44:47]
TR a[94:95], v249, 27744
s_add_u32 m0, s28, 40960
MF v[184:187], a[100:103], a[136:139], v[184:187]
TR a[96:97], v248, 128
MF v[188:191], a[100:103], a[140:143], v[188:191]
TR a[98:99], v248, 18560
MF v[48:51], a[104:107], a[136:139], v[48:51]
TR a[100:101], v248, 9344
MF v[52:55], a[104:107], a[140:143], v[52:55]
TR a[102:103], v248, 27776
global_load_lds_dwordx4 v5, s[8:9]
MF v[192:195], a[108:111], a[136:139], v[192:195]
TR a[104:105], v249, 160
MF v[196:199], a[108:111], a[140:143], v[196:199]
TR a[106:107], v249, 18592
s_waitcnt lgkmcnt(6)
MF v[56:59], a[80:83], a[136:139], v[56:59]
TR a[108:109], v249, 9376
MF v[60:63], a[80:83], a[140:143], v[60:63]
TR a[110:111], v249, 27808
MF v[200:203], a[84:87], a[136:139], v[200:203]
TR a[80:81], v248, 192
global_load_lds_dwordx4 v6, s[8:9] offset:1024
MF v[204:207], a[84:87], a[140:143], v[204:207]
TR a[82:83], v248, 18624
MF v[64:67], a[88:91], a[136:139], v[64:67]
TR a[84:85], v248, 9408
MF v[68:71], a[88:91], a[140:143], v[68:71]
TR a[86:87], v248, 27840
MF v[208:211], a[92:95], a[136:139], v[208:211]
TR a[88:89], v249, 224
MF v[212:215], a[92:95], a[140:143], v[212:215]
TR a[90:91], v249, 18656
s_waitcnt lgkmcnt(6)
MF v[72:75], a[96:99], a[136:139], v[72:75]
TR a[92:93], v249, 9440
global_load_lds_dwordx4 v7, s[8:9] offset:2048
MF v[76:79], a[96:99], a[140:143], v[76:79]
TR a[94:95], v249, 27872
MF v[216:219], a[100:103], a[136:139], v[216:219]
TR a[96:97], v248, 256
MF v[220:223], a[100:103], a[140:143], v[220:223]
TR a[98:99], v248, 18688
MF v[80:83], a[104:107], a[136:139], v[80:83]
TR a[100:101], v248, 9472
global_load_lds_dwordx4 v8, s[8:9] offset:3072
MF v[84:87], a[104:107], a[140:143], v[84:87]
TR a[102:103], v248, 27904
s_add_u32 m0, s28, 45056
MF v[224:227], a[108:111], a[136:139], v[224:227]
TR a[104:105], v249, 288
MF v[228:231], a[108:111], a[140:143], v[228:231]
TR a[106:107], v249, 18720
s_waitcnt lgkmcnt(6)
MF v[88:91], a[80:83], a[136:139], v[88:91]
TR a[108:109], v249, 9504
MF v[92:95], a[80:83], a[140:143], v[92:95]
TR a[110:111], v249, 27936
global_load_lds_dwordx4 v9, s[8:9]
MF v[232:235], a[84:87], a[136:139], v[232:235]
TR a[80:81], v248, 320
s_add_u32 s8, s8, 294912
s_addc_u32 s9, s9, 0
MF v[236:239], a[84:87], a[140:143], v[236:239]
TR a[82:83], v248, 18752
MF v[96:99], a[88:91], a[136:139], v[96:99]
TR a[84:85], v248, 9536
MF v[100:103], a[88:91], a[140:143], v[100:103]
TR a[86:87], v248, 27968
MF v[240:243], a[92:95], a[136:139], v[240:243]
TR a[88:89], v249, 352
global_load_dwordx4 a[152:155], v25, s[30:31] sc1
MF v[244:247], a[92:95], a[140:143], v[244:247]
TR a[90:91], v249, 18784
s_waitcnt lgkmcnt(6)
MF v[104:107], a[96:99], a[136:139], v[104:107]
TR a[92:93], v249, 9568
MF v[108:111], a[96:99], a[140:143], v[108:111]
TR a[94:95], v249, 28000
MF a[0:3], a[100:103], a[136:139], a[0:3]
TR a[96:97], v248, 384
MF a[4:7], a[100:103], a[140:143], a[4:7]
TR a[98:99], v248, 18816
global_load_dwordx4 a[156:159], v26, s[30:31] sc1
MF v[112:115], a[104:107], a[136:139], v[112:115]
TR a[100:101], v248, 9600
s_add_u32 s30, s30, 1024
s_addc_u32 s31, s31, 0
MF v[116:119], a[104:107], a[140:143], v[116:119]
TR a[102:103], v248, 28032
MF a[8:11], a[108:111], a[136:139], a[8:11]
TR a[104:105], v249, 416
MF a[12:15], a[108:111], a[140:143], a[12:15]
TR a[106:107], v249, 18848
s_waitcnt lgkmcnt(6)
MF v[120:123], a[80:83], a[136:139], v[120:123]
TR a[108:109], v249, 9632
MF v[124:127], a[80:83], a[140:143], v[124:127]
TR a[110:111], v249, 28064
MF a[16:19], a[84:87], a[136:139], a[16:19]
TR a[80:81], v248, 448
MF a[20:23], a[84:87], a[140:143], a[20:23]
TR a[82:83], v248, 18880
MF v[128:131], a[88:91], a[136:139], v[128:131]
TR a[84:85], v248, 9664
MF v[132:135], a[88:91], a[140:143], v[132:135]
TR a[86:87], v248, 28096
MF a[24:27], a[92:95], a[136:139], a[24:27]
TR a[88:89], v249, 480
MF a[28:31], a[92:95], a[140:143], a[28:31]
TR a[90:91], v249, 18912
s_waitcnt lgkmcnt(6)
MF v[136:139], a[96:99], a[136:139], v[136:139]
TR a[92:93], v249, 9696
MF v[140:143], a[96:99], a[140:143], v[140:143]
TR a[94:95], v249, 28128
MF a[32:35], a[100:103], a[136:139], a[32:35]
TR a[96:97], v248, 512
MF a[36:39], a[100:103], a[140:143], a[36:39]
TR a[98:99], v248, 18944
MF v[144:147], a[104:107], a[136:139], v[144:147]
TR a[100:101], v248, 9728
MF v[148:151], a[104:107], a[140:143], v[148:151]
TR a[102:103], v248, 28160
MF a[40:43], a[108:111], a[136:139], a[40:43]
TR a[104:105], v249, 544
s_waitcnt vmcnt(11)
MF a[44:47], a[108:111], a[140:143], a[44:47]
TR a[106:107], v249, 18976
s_waitcnt lgkmcnt(6)
MF v[152:155], a[80:83], a[136:139], v[152:155]
TR a[108:109], v249, 9760
s_barrier
MF v[156:159], a[80:83], a[140:143], v[156:159]
TR a[110:111], v249, 28192
s_add_u32 m0, s28, 73728
MF a[48:51], a[84:87], a[136:139], a[48:51]
TR a[80:81], v19, 0
global_load_lds_dwordx4 v1, s[8:9]
MF a[52:55], a[84:87], a[140:143], a[52:55]
TR a[82:83], v19, 18432
MF v[160:163], a[88:91], a[136:139], v[160:163]
TR a[84:85], v19, 9216
MF v[164:167], a[88:91], a[140:143], v[164:167]
TR a[86:87], v19, 27648
MF a[56:59], a[92:95], a[136:139], a[56:59]
TR a[88:89], v20, 32
global_load_lds_dwordx4 v2, s[8:9] offset:1024
MF a[60:63], a[92:95], a[140:143], a[60:63]
TR a[90:91], v20, 18464
s_waitcnt lgkmcnt(6)
MF v[168:171], a[96:99], a[136:139], v[168:171]
TR a[92:93], v20, 9248
MF v[172:175], a[96:99], a[140:143], v[172:175]
TR a[94:95], v20, 27680
MF a[64:67], a[100:103], a[136:139], a[64:67]
TR a[96:97], v19, 64
MF a[68:71], a[100:103], a[140:143], a[68:71]
TR a[98:99], v19, 18496
global_load_lds_dwordx4 v3, s[8:9] offset:2048
MF v[176:179], a[104:107], a[136:139], v[176:179]
TR a[100:101], v19, 9280
MF v[180:183], a[104:107], a[140:143], v[180:183]
TR a[102:103], v19, 27712
v_add_u32 v248, 0x9000, v19
MF a[72:75], a[108:111], a[136:139], a[72:75]
TR a[104:105], v20, 96
v_add_u32 v249, 0x9000, v20
MF a[76:79], a[108:111], a[140:143], a[76:79]
TR a[106:107], v20, 18528
s_waitcnt lgkmcnt(6)
MF v[40:43], a[80:83], a[144:147], v[40:43]
TR a[108:109], v20, 9312
global_load_lds_dwordx4 v4, s[8:9] offset:3072
MF v[44:47], a[80:83], a[148:151], v[44:47]
TR a[110:111], v20, 27744
s_add_u32 m0, s28, 77824
MF v[184:187], a[84:87], a[144:147], v[184:187]
TR a[80:81], v19, 128
MF v[188:191], a[84:87], a[148:151], v[188:191]
TR a[82:83], v19, 18560
MF v[48:51], a[88:91], a[144:147], v[48:51]
TR a[84:85], v19, 9344
MF v[52:55], a[88:91], a[148:151], v[52:55]
TR a[86:87], v19, 27776
global_load_lds_dwordx4 v5, s[8:9]
MF v[192:195], a[92:95], a[144:147], v[192:195]
TR a[88:89], v20, 160
MF v[196:199], a[92:95], a[148:151], v[196:199]
TR a[90:91], v20, 18592
s_waitcnt lgkmcnt(6)
MF v[56:59], a[96:99], a[144:147], v[56:59]
TR a[92:93], v20, 9376
MF v[60:63], a[96:99], a[148:151], v[60:63]
TR a[94:95], v20, 27808
MF v[200:203], a[100:103], a[144:147], v[200:203]
TR a[96:97], v19, 192
global_load_lds_dwordx4 v6, s[8:9] offset:1024
MF v[204:207], a[100:103], a[148:151], v[204:207]
TR a[98:99], v19, 18624
MF v[64:67], a[104:107], a[144:147], v[64:67]
TR a[100:101], v19, 9408
MF v[68:71], a[104:107], a[148:151], v[68:71]
TR a[102:103], v19, 27840
MF v[208:211], a[108:111], a[144:147], v[208:211]
TR a[104:105], v20, 224
MF v[212:215], a[108:111], a[148:151], v[212:215]
TR a[106:107], v20, 18656
s_waitcnt lgkmcnt(6)
MF v[72:75], a[80:83], a[144:147], v[72:75]
TR a[108:109], v20, 9440
global_load_lds_dwordx4 v7, s[8:9] offset:2048
MF v[76:79], a[80:83], a[148:151], v[76:79]
TR a[110:111], v20, 27872
MF v[216:219], a[84:87], a[144:147], v[216:219]
TR a[80:81], v19, 256
MF v[220:223], a[84:87], a[148:151], v[220:223]
TR a[82:83], v19, 18688
MF v[80:83], a[88:91], a[144:147], v[80:83]
TR a[84:85], v19, 9472
global_load_lds_dwordx4 v8, s[8:9] offset:3072
MF v[84:87], a[88:91], a[148:151], v[84:87]
TR a[86:87], v19, 27904
s_add_u32 m0, s28, 81920
MF v[224:227], a[92:95], a[144:147], v[224:227]
TR a[88:89], v20, 288
MF v[228:231], a[92:95], a[148:151], v[228:231]
TR a[90:91], v20, 18720
s_waitcnt lgkmcnt(6)
MF v[88:91], a[96:99], a[144:147], v[88:91]
TR a[92:93], v20, 9504
MF v[92:95], a[96:99], a[148:151], v[92:95]
TR a[94:95], v20, 27936
global_load_lds_dwordx4 v9, s[8:9]
MF v[232:235], a[100:103], a[144:147], v[232:235]
TR a[96:97], v19, 320
s_add_u32 s8, s8, 294912
s_addc_u32 s9, s9, 0
MF v[236:239], a[100:103], a[148:151], v[236:239]
TR a[98:99], v19, 18752
MF v[96:99], a[104:107], a[144:147], v[96:99]
TR a[100:101], v19, 9536
MF v[100:103], a[104:107], a[148:151], v[100:103]
TR a[102:103], v19, 27968
MF v[240:243], a[108:111], a[144:147], v[240:243]
TR a[104:105], v20, 352
global_load_dwordx4 a[160:163], v25, s[30:31] sc1
MF v[244:247], a[108:111], a[148:151], v[244:247]
TR a[106:107], v20, 18784
s_waitcnt lgkmcnt(6)
MF v[104:107], a[80:83], a[144:147], v[104:107]
TR a[108:109], v20, 9568
MF v[108:111], a[80:83], a[148:151], v[108:111]
TR a[110:111], v20, 28000
MF a[0:3], a[84:87], a[144:147], a[0:3]
TR a[80:81], v19, 384
MF a[4:7], a[84:87], a[148:151], a[4:7]
TR a[82:83], v19, 18816
global_load_dwordx4 a[164:167], v26, s[30:31] sc1
MF v[112:115], a[88:91], a[144:147], v[112:115]
TR a[84:85], v19, 9600
s_add_u32 s30, s30, 1024
s_addc_u32 s31, s31, 0
MF v[116:119], a[88:91], a[148:151], v[116:119]
TR a[86:87], v19, 28032
MF a[8:11], a[92:95], a[144:147], a[8:11]
TR a[88:89], v20, 416
MF a[12:15], a[92:95], a[148:151], a[12:15]
TR a[90:91], v20, 18848
s_waitcnt lgkmcnt(6)
MF v[120:123], a[96:99], a[144:147], v[120:123]
TR a[92:93], v20, 9632
MF v[124:127], a[96:99], a[148:151], v[124:127]
TR a[94:95], v20, 28064
MF a[16:19], a[100:103], a[144:147], a[16:19]
TR a[96:97], v19, 448
MF a[20:23], a[100:103], a[148:151], a[20:23]
TR a[98:99], v19, 18880
MF v[128:131], a[104:107], a[144:147], v[128:131]
TR a[100:101], v19, 9664
MF v[132:135], a[104:107], a[148:151], v[132:135]
TR a[102:103], v19, 28096
MF a[24:27], a[108:111], a[144:147], a[24:27]
TR a[104:105], v20, 480
MF a[28:31], a[108:111], a[148:151], a[28:31]
TR a[106:107], v20, 18912
s_waitcnt lgkmcnt(6)
MF v[136:139], a[80:83], a[144:147], v[136:139]
TR a[108:109], v20, 9696
MF v[140:143], a[80:83], a[148:151], v[140:143]
TR a[110:111], v20, 28128
MF a[32:35], a[84:87], a[144:147], a[32:35]
TR a[80:81], v19, 512
MF a[36:39], a[84:87], a[148:151], a[36:39]
TR a[82:83], v19, 18944
MF v[144:147], a[88:91], a[144:147], v[144:147]
TR a[84:85], v19, 9728
MF v[148:151], a[88:91], a[148:151], v[148:151]
TR a[86:87], v19, 28160
MF a[40:43], a[92:95], a[144:147], a[40:43]
TR a[88:89], v20, 544
s_waitcnt vmcnt(11)
MF a[44:47], a[92:95], a[148:151], a[44:47]
TR a[90:91], v20, 18976
s_waitcnt lgkmcnt(6)
MF v[152:155], a[96:99], a[144:147], v[152:155]
TR a[92:93], v20, 9760
s_barrier
MF v[156:159], a[96:99], a[148:151], v[156:159]
TR a[94:95], v20, 28192
s_add_u32 m0, s28, 110592
MF a[48:51], a[100:103], a[144:147], a[48:51]
TR a[96:97], v248, 0
global_load_lds_dwordx4 v1, s[8:9]
MF a[52:55], a[100:103], a[148:151], a[52:55]
TR a[98:99], v248, 18432
MF v[160:163], a[104:107], a[144:147], v[160:163]
TR a[100:101], v248, 9216
MF v[164:167], a[104:107], a[148:151], v[164:167]
TR a[102:103], v248, 27648
MF a[56:59], a[108:111], a[144:147], a[56:59]
TR a[104:105], v249, 32
global_load_lds_dwordx4 v2, s[8:9] offset:1024
MF a[60:63], a[108:111], a[148:151], a[60:63]
TR a[106:107], v249, 18464
s_waitcnt lgkmcnt(6)
MF v[168:171], a[80:83], a[144:147], v[168:171]
TR a[108:109], v249, 9248
MF v[172:175], a[80:83], a[148:151], v[172:175]
TR a[110:111], v249, 27680
MF a[64:67], a[84:87], a[144:147], a[64:67]
TR a[80:81], v248, 64
MF a[68:71], a[84:87], a[148:151], a[68:71]
TR a[82:83], v248, 18496
global_load_lds_dwordx4 v3, s[8:9] offset:2048
MF v[176:179], a[88:91], a[144:147], v[176:179]
TR a[84:85], v248, 9280
MF v[180:183], a[88:91], a[148:151], v[180:183]
TR a[86:87], v248, 27712
v_add_u32 v19, 0x9000, v248
MF a[72:75], a[92:95], a[144:147], a[72:75]
TR a[88:89], v249, 96
v_add_u32 v20, 0x9000, v249
MF a[76:79], a[92:95], a[148:151], a[76:79]
TR a[90:91], v249, 18528
s_waitcnt lgkmcnt(6)
MF v[40:43], a[96:99], a[152:155], v[40:43]
TR a[92:93], v249, 9312
global_load_lds_dwordx4 v4, s[8:9] offset:3072
MF v[44:47], a[96:99], a[156:159], v[44:47]
TR a[94:95], v249, 27744
s_add_u32 m0, s28, 114688
MF v[184:187], a[100:103], a[152:155], v[184:187]
TR a[96:97], v248, 128
MF v[188:191], a[100:103], a[156:159], v[188:191]
TR a[98:99], v248, 18560
MF v[48:51], a[104:107], a[152:155], v[48:51]
TR a[100:101], v248, 9344
MF v[52:55], a[104:107], a[156:159], v[52:55]
TR a[102:103], v248, 27776
global_load_lds_dwordx4 v5, s[8:9]
MF v[192:195], a[108:111], a[152:155], v[192:195]
TR a[104:105], v249, 160
MF v[196:199], a[108:111], a[156:159], v[196:199]
TR a[106:107], v249, 18592
s_waitcnt lgkmcnt(6)
MF v[56:59], a[80:83], a[152:155], v[56:59]
TR a[108:109], v249, 9376
MF v[60:63], a[80:83], a[156:159], v[60:63]
TR a[110:111], v249, 27808
MF v[200:203], a[84:87], a[152:155], v[200:203]
TR a[80:81], v248, 192
global_load_lds_dwordx4 v6, s[8:9] offset:1024
MF v[204:207], a[84:87], a[156:159], v[204:207]
TR a[82:83], v248, 18624
MF v[64:67], a[88:91], a[152:155], v[64:67]
TR a[84:85], v248, 9408
MF v[68:71], a[88:91], a[156:159], v[68:71]
TR a[86:87], v248, 27840
MF v[208:211], a[92:95], a[152:155], v[208:211]
TR a[88:89], v249, 224
MF v[212:215], a[92:95], a[156:159], v[212:215]
TR a[90:91], v249, 18656
s_waitcnt lgkmcnt(6)
MF v[72:75], a[96:99], a[152:155], v[72:75]
TR a[92:93], v249, 9440
global_load_lds_dwordx4 v7, s[8:9] offset:2048
MF v[76:79], a[96:99], a[156:159], v[76:79]
TR a[94:95], v249, 27872
MF v[216:219], a[100:103], a[152:155], v[216:219]
TR a[96:97], v248, 256
MF v[220:223], a[100:103], a[156:159], v[220:223]
TR a[98:99], v248, 18688
MF v[80:83], a[104:107], a[152:155], v[80:83]
TR a[100:101], v248, 9472
global_load_lds_dwordx4 v8, s[8:9] offset:3072
MF v[84:87], a[104:107], a[156:159], v[84:87]
TR a[102:103], v248, 27904
s_add_u32 m0, s28, 118784
MF v[224:227], a[108:111], a[152:155], v[224:227]
TR a[104:105], v249, 288
MF v[228:231], a[108:111], a[156:159], v[228:231]
TR a[106:107], v249, 18720
s_waitcnt lgkmcnt(6)
MF v[88:91], a[80:83], a[152:155], v[88:91]
TR a[108:109], v249, 9504
MF v[92:95], a[80:83], a[156:159], v[92:95]
TR a[110:111], v249, 27936
global_load_lds_dwordx4 v9, s[8:9]
MF v[232:235], a[84:87], a[152:155], v[232:235]
TR a[80:81], v248, 320
s_add_u32 s8, s8, 294912
s_addc_u32 s9, s9, 0
MF v[236:239], a[84:87], a[156:159], v[236:239]
TR a[82:83], v248, 18752
MF v[96:99], a[88:91], a[152:155], v[96:99]
TR a[84:85], v248, 9536
MF v[100:103], a[88:91], a[156:159], v[100:103]
TR a[86:87], v248, 27968
MF v[240:243], a[92:95], a[152:155], v[240:243]
TR a[88:89], v249, 352
global_load_dwordx4 a[168:171], v25, s[30:31] sc1
MF v[244:247], a[92:95], a[156:159], v[244:247]
TR a[90:91], v249, 18784
s_waitcnt lgkmcnt(6)
MF v[104:107], a[96:99], a[152:155], v[104:107]
TR a[92:93], v249, 9568
MF v[108:111], a[96:99], a[156:159], v[108:111]
TR a[94:95], v249, 28000
MF a[0:3], a[100:103], a[152:155], a[0:3]
TR a[96:97], v248, 384
MF a[4:7], a[100:103], a[156:159], a[4:7]
TR a[98:99], v248, 18816
global_load_dwordx4 a[172:175], v26, s[30:31] sc1
MF v[112:115], a[104:107], a[152:155], v[112:115]
TR a[100:101], v248, 9600
s_add_u32 s30, s30, 1024
s_addc_u32 s31, s31, 0
MF v[116:119], a[104:107], a[156:159], v[116:119]
TR a[102:103], v248, 28032
MF a[8:11], a[108:111], a[152:155], a[8:11]
TR a[104:105], v249, 416
MF a[12:15], a[108:111], a[156:159], a[12:15]
TR a[106:107], v249, 18848
s_waitcnt lgkmcnt(6)
MF v[120:123], a[80:83], a[152:155], v[120:123]
TR a[108:109], v249, 9632
s_getpc_b64 s[48:49]
kb_kernel_pc9:
s_add_u32 s48, s48, kb_kernel-kb_kernel_pc9
s_addc_u32 s49, s49, (kb_kernel-kb_kernel_pc9)>>32
MF v[124:127], a[80:83], a[156:159], v[124:127]
TR a[110:111], v249, 28064
s_mov_b32 s50, kb_kernel_done1-kb_kernel
s_mov_b32 s51, 0x00020000
MF a[16:19], a[84:87], a[152:155], a[16:19]
TR a[80:81], v248, 448
s_lshr_b32 s52, s2, 3
s_mul_i32 s52, s52, 2048
MF a[20:23], a[84:87], a[156:159], a[20:23]
TR a[82:83], v248, 18880
buffer_load_dwordx4 v[36:39], v25, s[48:51], s52 offen
MF v[128:131], a[88:91], a[152:155], v[128:131]
TR a[84:85], v248, 9664
buffer_load_dwordx4 v[36:39], v25, s[48:51], s52 offen offset:1024
MF v[132:135], a[88:91], a[156:159], v[132:135]
TR a[86:87], v248, 28096
MF a[24:27], a[92:95], a[152:155], a[24:27]
TR a[88:89], v249, 480
MF a[28:31], a[92:95], a[156:159], a[28:31]
TR a[90:91], v249, 18912
s_waitcnt lgkmcnt(6)
MF v[136:139], a[96:99], a[152:155], v[136:139]
TR a[92:93], v249, 9696
MF v[140:143], a[96:99], a[156:159], v[140:143]
TR a[94:95], v249, 28128
MF a[32:35], a[100:103], a[152:155], a[32:35]
TR a[96:97], v248, 512
MF a[36:39], a[100:103], a[156:159], a[36:39]
TR a[98:99], v248, 18944
MF v[144:147], a[104:107], a[152:155], v[144:147]
TR a[100:101], v248, 9728
MF v[148:151], a[104:107], a[156:159], v[148:151]
TR a[102:103], v248, 28160
MF a[40:43], a[108:111], a[152:155], a[40:43]
TR a[104:105], v249, 544
s_waitcnt vmcnt(13)
MF a[44:47], a[108:111], a[156:159], a[44:47]
TR a[106:107], v249, 18976
s_waitcnt lgkmcnt(6)
MF v[152:155], a[80:83], a[152:155], v[152:155]
TR a[108:109], v249, 9760
s_barrier
MF v[156:159], a[80:83], a[156:159], v[156:159]
TR a[110:111], v249, 28192
s_add_u32 m0, s28, 0
MF a[48:51], a[84:87], a[152:155], a[48:51]
TR a[80:81], v19, 0
global_load_lds_dwordx4 v1, s[8:9]
MF a[52:55], a[84:87], a[156:159], a[52:55]
TR a[82:83], v19, 18432
MF v[160:163], a[88:91], a[152:155], v[160:163]
TR a[84:85], v19, 9216
MF v[164:167], a[88:91], a[156:159], v[164:167]
TR a[86:87], v19, 27648
MF a[56:59], a[92:95], a[152:155], a[56:59]
TR a[88:89], v20, 32
global_load_lds_dwordx4 v2, s[8:9] offset:1024
MF a[60:63], a[92:95], a[156:159], a[60:63]
TR a[90:91], v20, 18464
s_waitcnt lgkmcnt(6)
MF v[168:171], a[96:99], a[152:155], v[168:171]
TR a[92:93], v20, 9248
MF v[172:175], a[96:99], a[156:159], v[172:175]
TR a[94:95], v20, 27680
MF a[64:67], a[100:103], a[152:155], a[64:67]
TR a[96:97], v19, 64
MF a[68:71], a[100:103], a[156:159], a[68:71]
TR a[98:99], v19, 18496
global_load_lds_dwordx4 v3, s[8:9] offset:2048
MF v[176:179], a[104:107], a[152:155], v[176:179]
TR a[100:101], v19, 9280
MF v[180:183], a[104:107], a[156:159], v[180:183]
TR a[102:103], v19, 27712
v_add_u32 v248, 0x9000, v19
MF a[72:75], a[108:111], a[152:155], a[72:75]
TR a[104:105], v20, 96
v_add_u32 v249, 0x9000, v20
MF a[76:79], a[108:111], a[156:159], a[76:79]
TR a[106:107], v20, 18528
s_waitcnt lgkmcnt(6)
MF v[40:43], a[80:83], a[160:163], v[40:43]
TR a[108:109], v20, 9312
global_load_lds_dwordx4 v4, s[8:9] offset:3072
MF v[44:47], a[80:83], a[164:167], v[44:47]
TR a[110:111], v20, 27744
s_add_u32 m0, s28, 4096
MF v[184:187], a[84:87], a[160:163], v[184:187]
TR a[80:81], v19, 128
MF v[188:191], a[84:87], a[164:167], v[188:191]
TR a[82:83], v19, 18560
MF v[48:51], a[88:91], a[160:163], v[48:51]
TR a[84:85], v19, 9344
MF v[52:55], a[88:91], a[164:167], v[52:55]
TR a[86:87], v19, 27776
global_load_lds_dwordx4 v5, s[8:9]
MF v[192:195], a[92:95], a[160:163], v[192:195]
TR a[88:89], v20, 160
MF v[196:199], a[92:95], a[164:167], v[196:199]
TR a[90:91], v20, 18592
s_waitcnt lgkmcnt(6)
MF v[56:59], a[96:99], a[160:163], v[56:59]
TR a[92:93], v20, 9376
MF v[60:63], a[96:99], a[164:167], v[60:63]
TR a[94:95], v20, 27808
MF v[200:203], a[100:103], a[160:163], v[200:203]
TR a[96:97], v19, 192
global_load_lds_dwordx4 v6, s[8:9] offset:1024
MF v[204:207], a[100:103], a[164:167], v[204:207]
TR a[98:99], v19, 18624
MF v[64:67], a[104:107], a[160:163], v[64:67]
TR a[100:101], v19, 9408
MF v[68:71], a[104:107], a[164:167], v[68:71]
TR a[102:103], v19, 27840
MF v[208:211], a[108:111], a[160:163], v[208:211]
TR a[104:105], v20, 224
MF v[212:215], a[108:111], a[164:167], v[212:215]
TR a[106:107], v20, 18656
s_waitcnt lgkmcnt(6)
MF v[72:75], a[80:83], a[160:163], v[72:75]
TR a[108:109], v20, 9440
global_load_lds_dwordx4 v7, s[8:9] offset:2048
MF v[76:79], a[80:83], a[164:167], v[76:79]
TR a[110:111], v20, 27872
MF v[216:219], a[84:87], a[160:163], v[216:219]
TR a[80:81], v19, 256
MF v[220:223], a[84:87], a[164:167], v[220:223]
TR a[82:83], v19, 18688
MF v[80:83], a[88:91], a[160:163], v[80:83]
TR a[84:85], v19, 9472
global_load_lds_dwordx4 v8, s[8:9] offset:3072
MF v[84:87], a[88:91], a[164:167], v[84:87]
TR a[86:87], v19, 27904
s_add_u32 m0, s28, 8192
MF v[224:227], a[92:95], a[160:163], v[224:227]
TR a[88:89], v20, 288
MF v[228:231], a[92:95], a[164:167], v[228:231]
TR a[90:91], v20, 18720
s_waitcnt lgkmcnt(6)
MF v[88:91], a[96:99], a[160:163], v[88:91]
TR a[92:93], v20, 9504
MF v[92:95], a[96:99], a[164:167], v[92:95]
TR a[94:95], v20, 27936
global_load_lds_dwordx4 v9, s[8:9]
MF v[232:235], a[100:103], a[160:163], v[232:235]
TR a[96:97], v19, 320
s_add_u32 s8, s8, 294912
s_addc_u32 s9, s9, 0
MF v[236:239], a[100:103], a[164:167], v[236:239]
TR a[98:99], v19, 18752
MF v[96:99], a[104:107], a[160:163], v[96:99]
TR a[100:101], v19, 9536
MF v[100:103], a[104:107], a[164:167], v[100:103]
TR a[102:103], v19, 27968
MF v[240:243], a[108:111], a[160:163], v[240:243]
TR a[104:105], v20, 352
global_load_dwordx4 a[176:179], v25, s[30:31] sc1
MF v[244:247], a[108:111], a[164:167], v[244:247]
TR a[106:107], v20, 18784
s_waitcnt lgkmcnt(6)
MF v[104:107], a[80:83], a[160:163], v[104:107]
TR a[108:109], v20, 9568
MF v[108:111], a[80:83], a[164:167], v[108:111]
TR a[110:111], v20, 28000
MF a[0:3], a[84:87], a[160:163], a[0:3]
TR a[80:81], v19, 384
MF a[4:7], a[84:87], a[164:167], a[4:7]
TR a[82:83], v19, 18816
global_load_dwordx4 a[180:183], v26, s[30:31] sc1
MF v[112:115], a[88:91], a[160:163], v[112:115]
TR a[84:85], v19, 9600
s_add_u32 s30, s30, 1024
s_addc_u32 s31, s31, 0
MF v[116:119], a[88:91], a[164:167], v[116:119]
TR a[86:87], v19, 28032
MF a[8:11], a[92:95], a[160:163], a[8:11]
TR a[88:89], v20, 416
MF a[12:15], a[92:95], a[164:167], a[12:15]
TR a[90:91], v20, 18848
s_waitcnt lgkmcnt(6)
MF v[120:123], a[96:99], a[160:163], v[120:123]
TR a[92:93], v20, 9632
MF v[124:127], a[96:99], a[164:167], v[124:127]
TR a[94:95], v20, 28064
MF a[16:19], a[100:103], a[160:163], a[16:19]
TR a[96:97], v19, 448
MF a[20:23], a[100:103], a[164:167], a[20:23]
TR a[98:99], v19, 18880
MF v[128:131], a[104:107], a[160:163], v[128:131]
TR a[100:101], v19, 9664
MF v[132:135], a[104:107], a[164:167], v[132:135]
TR a[102:103], v19, 28096
MF a[24:27], a[108:111], a[160:163], a[24:27]
TR a[104:105], v20, 480
MF a[28:31], a[108:111], a[164:167], a[28:31]
TR a[106:107], v20, 18912
s_waitcnt lgkmcnt(6)
MF v[136:139], a[80:83], a[160:163], v[136:139]
TR a[108:109], v20, 9696
MF v[140:143], a[80:83], a[164:167], v[140:143]
TR a[110:111], v20, 28128
MF a[32:35], a[84:87], a[160:163], a[32:35]
TR a[80:81], v19, 512
MF a[36:39], a[84:87], a[164:167], a[36:39]
TR a[82:83], v19, 18944
MF v[144:147], a[88:91], a[160:163], v[144:147]
TR a[84:85], v19, 9728
MF v[148:151], a[88:91], a[164:167], v[148:151]
TR a[86:87], v19, 28160
MF a[40:43], a[92:95], a[160:163], a[40:43]
TR a[88:89], v20, 544
s_waitcnt vmcnt(13)
MF a[44:47], a[92:95], a[164:167], a[44:47]
TR a[90:91], v20, 18976
s_waitcnt lgkmcnt(6)
MF v[152:155], a[96:99], a[160:163], v[152:155]
TR a[92:93], v20, 9760
s_barrier
MF v[156:159], a[96:99], a[164:167], v[156:159]
TR a[94:95], v20, 28192
s_add_u32 m0, s28, 36864
MF a[48:51], a[100:103], a[160:163], a[48:51]
TR a[96:97], v248, 0
global_load_lds_dwordx4 v1, s[8:9]
MF a[52:55], a[100:103], a[164:167], a[52:55]
TR a[98:99], v248, 18432
MF v[160:163], a[104:107], a[160:163], v[160:163]
TR a[100:101], v248, 9216
MF v[164:167], a[104:107], a[164:167], v[164:167]
TR a[102:103], v248, 27648
MF a[56:59], a[108:111], a[160:163], a[56:59]
TR a[104:105], v249, 32
global_load_lds_dwordx4 v2, s[8:9] offset:1024
MF a[60:63], a[108:111], a[164:167], a[60:63]
TR a[106:107], v249, 18464
s_waitcnt lgkmcnt(6)
MF v[168:171], a[80:83], a[160:163], v[168:171]
TR a[108:109], v249, 9248
MF v[172:175], a[80:83], a[164:167], v[172:175]
TR a[110:111], v249, 27680
MF a[64:67], a[84:87], a[160:163], a[64:67]
TR a[80:81], v248, 64
MF a[68:71], a[84:87], a[164:167], a[68:71]
TR a[82:83], v248, 18496
global_load_lds_dwordx4 v3, s[8:9] offset:2048
MF v[176:179], a[88:91], a[160:163], v[176:179]
TR a[84:85], v248, 9280
s_and_b32 s42, s41, 7
MF v[180:183], a[88:91], a[164:167], v[180:183]
TR a[86:87], v248, 27712
s_mul_i32 s56, s40, 331776
MF a[72:75], a[92:95], a[160:163], a[72:75]
TR a[88:89], v249, 96
s_mul_i32 s57, s42, 41472
MF a[76:79], a[92:95], a[164:167], a[76:79]
TR a[90:91], v249, 18528
s_waitcnt lgkmcnt(6)
MF v[40:43], a[96:99], a[168:171], v[40:43]
TR a[92:93], v249, 9312
global_load_lds_dwordx4 v4, s[8:9] offset:3072
MF v[44:47], a[96:99], a[172:175], v[44:47]
TR a[94:95], v249, 27744
s_add_u32 m0, s28, 40960
MF v[184:187], a[100:103], a[168:171], v[184:187]
TR a[96:97], v248, 128
s_add_u32 s56, s56, s57
MF v[188:191], a[100:103], a[172:175], v[188:191]
TR a[98:99], v248, 18560
s_lshl_b32 s57, s29, 10
MF v[48:51], a[104:107], a[168:171], v[48:51]
TR a[100:101], v248, 9344
s_add_u32 s56, s56, s57
MF v[52:55], a[104:107], a[172:175], v[52:55]
TR a[102:103], v248, 27776
global_load_lds_dwordx4 v5, s[8:9]
MF v[192:195], a[108:111], a[168:171], v[192:195]
TR a[104:105], v249, 160
buffer_load_dwordx4 v[36:39], v25, s[12:15], s56 offen
MF v[196:199], a[108:111], a[172:175], v[196:199]
TR a[106:107], v249, 18592
s_waitcnt lgkmcnt(6)
MF v[56:59], a[80:83], a[168:171], v[56:59]
TR a[108:109], v249, 9376
v_add_u32 v19, 0xfffe5000, v248
MF v[60:63], a[80:83], a[172:175], v[60:63]
TR a[110:111], v249, 27808
v_add_u32 v20, 0xfffe5000, v249
MF v[200:203], a[84:87], a[168:171], v[200:203]
TR a[80:81], v248, 192
global_load_lds_dwordx4 v6, s[8:9] offset:1024
MF v[204:207], a[84:87], a[172:175], v[204:207]
TR a[82:83], v248, 18624
MF v[64:67], a[88:91], a[168:171], v[64:67]
TR a[84:85], v248, 9408
MF v[68:71], a[88:91], a[172:175], v[68:71]
TR a[86:87], v248, 27840
MF v[208:211], a[92:95], a[168:171], v[208:211]
TR a[88:89], v249, 224
MF v[212:215], a[92:95], a[172:175], v[212:215]
TR a[90:91], v249, 18656
s_waitcnt lgkmcnt(6)
MF v[72:75], a[96:99], a[168:171], v[72:75]
TR a[92:93], v249, 9440
global_load_lds_dwordx4 v7, s[8:9] offset:2048
MF v[76:79], a[96:99], a[172:175], v[76:79]
TR a[94:95], v249, 27872
MF v[216:219], a[100:103], a[168:171], v[216:219]
TR a[96:97], v248, 256
MF v[220:223], a[100:103], a[172:175], v[220:223]
TR a[98:99], v248, 18688
MF v[80:83], a[104:107], a[168:171], v[80:83]
TR a[100:101], v248, 9472
global_load_lds_dwordx4 v8, s[8:9] offset:3072
MF v[84:87], a[104:107], a[172:175], v[84:87]
TR a[102:103], v248, 27904
s_add_u32 m0, s28, 45056
MF v[224:227], a[108:111], a[168:171], v[224:227]
TR a[104:105], v249, 288
MF v[228:231], a[108:111], a[172:175], v[228:231]
TR a[106:107], v249, 18720
s_waitcnt lgkmcnt(6)
MF v[88:91], a[80:83], a[168:171], v[88:91]
TR a[108:109], v249, 9504
MF v[92:95], a[80:83], a[172:175], v[92:95]
TR a[110:111], v249, 27936
global_load_lds_dwordx4 v9, s[8:9]
MF v[232:235], a[84:87], a[168:171], v[232:235]
TR a[80:81], v248, 320
s_add_u32 s8, s8, 294912
s_addc_u32 s9, s9, 0
MF v[236:239], a[84:87], a[172:175], v[236:239]
TR a[82:83], v248, 18752
MF v[96:99], a[88:91], a[168:171], v[96:99]
TR a[84:85], v248, 9536
MF v[100:103], a[88:91], a[172:175], v[100:103]
TR a[86:87], v248, 27968
MF v[240:243], a[92:95], a[168:171], v[240:243]
TR a[88:89], v249, 352
global_load_dwordx4 a[184:187], v25, s[30:31] sc1
MF v[244:247], a[92:95], a[172:175], v[244:247]
TR a[90:91], v249, 18784
s_waitcnt lgkmcnt(6)
MF v[104:107], a[96:99], a[168:171], v[104:107]
TR a[92:93], v249, 9568
MF v[108:111], a[96:99], a[172:175], v[108:111]
TR a[94:95], v249, 28000
MF a[0:3], a[100:103], a[168:171], a[0:3]
TR a[96:97], v248, 384
MF a[4:7], a[100:103], a[172:175], a[4:7]
TR a[98:99], v248, 18816
global_load_dwordx4 a[188:191], v26, s[30:31] sc1
MF v[112:115], a[104:107], a[168:171], v[112:115]
TR a[100:101], v248, 9600
s_add_u32 s30, s30, 1024
s_addc_u32 s31, s31, 0
MF v[116:119], a[104:107], a[172:175], v[116:119]
TR a[102:103], v248, 28032
MF a[8:11], a[108:111], a[168:171], a[8:11]
TR a[104:105], v249, 416
MF a[12:15], a[108:111], a[172:175], a[12:15]
TR a[106:107], v249, 18848
s_waitcnt lgkmcnt(6)
MF v[120:123], a[80:83], a[168:171], v[120:123]
TR a[108:109], v249, 9632
MF v[124:127], a[80:83], a[172:175], v[124:127]
TR a[110:111], v249, 28064
MF a[16:19], a[84:87], a[168:171], a[16:19]
TR a[80:81], v248, 448
MF a[20:23], a[84:87], a[172:175], a[20:23]
TR a[82:83], v248, 18880
MF v[128:131], a[88:91], a[168:171], v[128:131]
TR a[84:85], v248, 9664
MF v[132:135], a[88:91], a[172:175], v[132:135]
TR a[86:87], v248, 28096
MF a[24:27], a[92:95], a[168:171], a[24:27]
TR a[88:89], v249, 480
MF a[28:31], a[92:95], a[172:175], a[28:31]
TR a[90:91], v249, 18912
s_waitcnt lgkmcnt(6)
MF v[136:139], a[96:99], a[168:171], v[136:139]
TR a[92:93], v249, 9696
MF v[140:143], a[96:99], a[172:175], v[140:143]
TR a[94:95], v249, 28128
MF a[32:35], a[100:103], a[168:171], a[32:35]
TR a[96:97], v248, 512
MF a[36:39], a[100:103], a[172:175], a[36:39]
TR a[98:99], v248, 18944
MF v[144:147], a[104:107], a[168:171], v[144:147]
TR a[100:101], v248, 9728
MF v[148:151], a[104:107], a[172:175], v[148:151]
TR a[102:103], v248, 28160
MF a[40:43], a[108:111], a[168:171], a[40:43]
TR a[104:105], v249, 544
s_waitcnt vmcnt(12)
MF a[44:47], a[108:111], a[172:175], a[44:47]
TR a[106:107], v249, 18976
s_waitcnt lgkmcnt(6)
MF v[152:155], a[80:83], a[168:171], v[152:155]
TR a[108:109], v249, 9760
s_barrier
MF v[156:159], a[80:83], a[172:175], v[156:159]
TR a[110:111], v249, 28192
s_add_u32 m0, s28, 73728
MF a[48:51], a[84:87], a[168:171], a[48:51]
TR a[80:81], v19, 0
global_load_lds_dwordx4 v1, s[8:9]
MF a[52:55], a[84:87], a[172:175], a[52:55]
TR a[82:83], v19, 18432
s_add_u32 s56, s56, 4096
MF v[160:163], a[88:91], a[168:171], v[160:163]
TR a[84:85], v19, 9216
buffer_load_dwordx4 v[36:39], v25, s[12:15], s56 offen
MF v[164:167], a[88:91], a[172:175], v[164:167]
TR a[86:87], v19, 27648
MF a[56:59], a[92:95], a[168:171], a[56:59]
TR a[88:89], v20, 32
global_load_lds_dwordx4 v2, s[8:9] offset:1024
MF a[60:63], a[92:95], a[172:175], a[60:63]
TR a[90:91], v20, 18464
s_waitcnt lgkmcnt(6)
MF v[168:171], a[96:99], a[168:171], v[168:171]
TR a[92:93], v20, 9248
MF v[172:175], a[96:99], a[172:175], v[172:175]
TR a[94:95], v20, 27680
MF a[64:67], a[100:103], a[168:171], a[64:67]
TR a[96:97], v19, 64
MF a[68:71], a[100:103], a[172:175], a[68:71]
TR a[98:99], v19, 18496
global_load_lds_dwordx4 v3, s[8:9] offset:2048
MF v[176:179], a[104:107], a[168:171], v[176:179]
TR a[100:101], v19, 9280
MF v[180:183], a[104:107], a[172:175], v[180:183]
TR a[102:103], v19, 27712
v_add_u32 v248, 0x9000, v19
MF a[72:75], a[108:111], a[168:171], a[72:75]
TR a[104:105], v20, 96
v_add_u32 v249, 0x9000, v20
MF a[76:79], a[108:111], a[172:175], a[76:79]
TR a[106:107], v20, 18528
s_waitcnt lgkmcnt(6)
MF v[40:43], a[80:83], a[176:179], v[40:43]
TR a[108:109], v20, 9312
global_load_lds_dwordx4 v4, s[8:9] offset:3072
MF v[44:47], a[80:83], a[180:183], v[44:47]
TR a[110:111], v20, 27744
s_add_u32 m0, s28, 77824
MF v[184:187], a[84:87], a[176:179], v[184:187]
TR a[80:81], v19, 128
MF v[188:191], a[84:87], a[180:183], v[188:191]
TR a[82:83], v19, 18560
MF v[48:51], a[88:91], a[176:179], v[48:51]
TR a[84:85], v19, 9344
MF v[52:55], a[88:91], a[180:183], v[52:55]
TR a[86:87], v19, 27776
global_load_lds_dwordx4 v5, s[8:9]
MF v[192:195], a[92:95], a[176:179], v[192:195]
TR a[88:89], v20, 160
MF v[196:199], a[92:95], a[180:183], v[196:199]
TR a[90:91], v20, 18592
s_waitcnt lgkmcnt(6)
MF v[56:59], a[96:99], a[176:179], v[56:59]
TR a[92:93], v20, 9376
MF v[60:63], a[96:99], a[180:183], v[60:63]
TR a[94:95], v20, 27808
MF v[200:203], a[100:103], a[176:179], v[200:203]
TR a[96:97], v19, 192
global_load_lds_dwordx4 v6, s[8:9] offset:1024
MF v[204:207], a[100:103], a[180:183], v[204:207]
TR a[98:99], v19, 18624
MF v[64:67], a[104:107], a[176:179], v[64:67]
TR a[100:101], v19, 9408
MF v[68:71], a[104:107], a[180:183], v[68:71]
TR a[102:103], v19, 27840
MF v[208:211], a[108:111], a[176:179], v[208:211]
TR a[104:105], v20, 224
MF v[212:215], a[108:111], a[180:183], v[212:215]
TR a[106:107], v20, 18656
s_waitcnt lgkmcnt(6)
MF v[72:75], a[80:83], a[176:179], v[72:75]
TR a[108:109], v20, 9440
global_load_lds_dwordx4 v7, s[8:9] offset:2048
MF v[76:79], a[80:83], a[180:183], v[76:79]
TR a[110:111], v20, 27872
MF v[216:219], a[84:87], a[176:179], v[216:219]
TR a[80:81], v19, 256
MF v[220:223], a[84:87], a[180:183], v[220:223]
TR a[82:83], v19, 18688
MF v[80:83], a[88:91], a[176:179], v[80:83]
TR a[84:85], v19, 9472
global_load_lds_dwordx4 v8, s[8:9] offset:3072
MF v[84:87], a[88:91], a[180:183], v[84:87]
TR a[86:87], v19, 27904
s_add_u32 m0, s28, 81920
MF v[224:227], a[92:95], a[176:179], v[224:227]
TR a[88:89], v20, 288
buffer_load_dwordx4 v[36:39], v25, s[20:23], s72 offen
MF v[228:231], a[92:95], a[180:183], v[228:231]
TR a[90:91], v20, 18720
s_waitcnt lgkmcnt(6)
MF v[88:91], a[96:99], a[176:179], v[88:91]
TR a[92:93], v20, 9504
MF v[92:95], a[96:99], a[180:183], v[92:95]
TR a[94:95], v20, 27936
global_load_lds_dwordx4 v9, s[8:9]
MF v[232:235], a[100:103], a[176:179], v[232:235]
TR a[96:97], v19, 320
s_add_u32 s8, s8, 294912
s_addc_u32 s9, s9, 0
MF v[236:239], a[100:103], a[180:183], v[236:239]
TR a[98:99], v19, 18752
MF v[96:99], a[104:107], a[176:179], v[96:99]
TR a[100:101], v19, 9536
MF v[100:103], a[104:107], a[180:183], v[100:103]
TR a[102:103], v19, 27968
MF v[240:243], a[108:111], a[176:179], v[240:243]
TR a[104:105], v20, 352
global_load_dwordx4 a[192:195], v25, s[30:31] sc1
MF v[244:247], a[108:111], a[180:183], v[244:247]
TR a[106:107], v20, 18784
s_waitcnt lgkmcnt(6)
MF v[104:107], a[80:83], a[176:179], v[104:107]
TR a[108:109], v20, 9568
MF v[108:111], a[80:83], a[180:183], v[108:111]
TR a[110:111], v20, 28000
MF a[0:3], a[84:87], a[176:179], a[0:3]
TR a[80:81], v19, 384
MF a[4:7], a[84:87], a[180:183], a[4:7]
TR a[82:83], v19, 18816
global_load_dwordx4 a[196:199], v26, s[30:31] sc1
MF v[112:115], a[88:91], a[176:179], v[112:115]
TR a[84:85], v19, 9600
s_add_u32 s30, s30, 1024
s_addc_u32 s31, s31, 0
MF v[116:119], a[88:91], a[180:183], v[116:119]
TR a[86:87], v19, 28032
MF a[8:11], a[92:95], a[176:179], a[8:11]
TR a[88:89], v20, 416
MF a[12:15], a[92:95], a[180:183], a[12:15]
TR a[90:91], v20, 18848
s_waitcnt lgkmcnt(6)
MF v[120:123], a[96:99], a[176:179], v[120:123]
TR a[92:93], v20, 9632
MF v[124:127], a[96:99], a[180:183], v[124:127]
TR a[94:95], v20, 28064
MF a[16:19], a[100:103], a[176:179], a[16:19]
TR a[96:97], v19, 448
MF a[20:23], a[100:103], a[180:183], a[20:23]
TR a[98:99], v19, 18880
MF v[128:131], a[104:107], a[176:179], v[128:131]
TR a[100:101], v19, 9664
s_add_u32 s56, s56, 4096
MF v[132:135], a[104:107], a[180:183], v[132:135]
TR a[102:103], v19, 28096
buffer_load_dwordx4 v[36:39], v25, s[12:15], s56 offen
MF a[24:27], a[108:111], a[176:179], a[24:27]
TR a[104:105], v20, 480
MF a[28:31], a[108:111], a[180:183], a[28:31]
TR a[106:107], v20, 18912
s_waitcnt lgkmcnt(6)
MF v[136:139], a[80:83], a[176:179], v[136:139]
TR a[108:109], v20, 9696
MF v[140:143], a[80:83], a[180:183], v[140:143]
TR a[110:111], v20, 28128
MF a[32:35], a[84:87], a[176:179], a[32:35]
TR a[80:81], v19, 512
MF a[36:39], a[84:87], a[180:183], a[36:39]
TR a[82:83], v19, 18944
MF v[144:147], a[88:91], a[176:179], v[144:147]
TR a[84:85], v19, 9728
MF v[148:151], a[88:91], a[180:183], v[148:151]
TR a[86:87], v19, 28160
MF a[40:43], a[92:95], a[176:179], a[40:43]
TR a[88:89], v20, 544
s_waitcnt vmcnt(14)
MF a[44:47], a[92:95], a[180:183], a[44:47]
TR a[90:91], v20, 18976
s_waitcnt lgkmcnt(6)
MF v[152:155], a[96:99], a[176:179], v[152:155]
TR a[92:93], v20, 9760
s_barrier
MF v[156:159], a[96:99], a[180:183], v[156:159]
TR a[94:95], v20, 28192
s_add_u32 m0, s28, 110592
MF a[48:51], a[100:103], a[176:179], a[48:51]
TR a[96:97], v248, 0
global_load_lds_dwordx4 v1, s[8:9]
MF a[52:55], a[100:103], a[180:183], a[52:55]
TR a[98:99], v248, 18432
MF v[160:163], a[104:107], a[176:179], v[160:163]
TR a[100:101], v248, 9216
MF v[164:167], a[104:107], a[180:183], v[164:167]
TR a[102:103], v248, 27648
MF a[56:59], a[108:111], a[176:179], a[56:59]
TR a[104:105], v249, 32
global_load_lds_dwordx4 v2, s[8:9] offset:1024
MF a[60:63], a[108:111], a[180:183], a[60:63]
TR a[106:107], v249, 18464
s_waitcnt lgkmcnt(6)
MF v[168:171], a[80:83], a[176:179], v[168:171]
TR a[108:109], v249, 9248
MF v[172:175], a[80:83], a[180:183], v[172:175]
TR a[110:111], v249, 27680
MF a[64:67], a[84:87], a[176:179], a[64:67]
TR a[80:81], v248, 64
MF a[68:71], a[84:87], a[180:183], a[68:71]
TR a[82:83], v248, 18496
global_load_lds_dwordx4 v3, s[8:9] offset:2048
MF v[176:179], a[88:91], a[176:179], v[176:179]
TR a[84:85], v248, 9280
MF v[180:183], a[88:91], a[180:183], v[180:183]
TR a[86:87], v248, 27712
v_add_u32 v19, 0x9000, v248
MF a[72:75], a[92:95], a[176:179], a[72:75]
TR a[88:89], v249, 96
buffer_load_dwordx4 v[36:39], v26, s[20:23], s72 offen
MF a[76:79], a[92:95], a[180:183], a[76:79]
TR a[90:91], v249, 18528
s_waitcnt lgkmcnt(6)
MF v[40:43], a[96:99], a[184:187], v[40:43]
TR a[92:93], v249, 9312
global_load_lds_dwordx4 v4, s[8:9] offset:3072
MF v[44:47], a[96:99], a[188:191], v[44:47]
TR a[94:95], v249, 27744
s_add_u32 m0, s28, 114688
MF v[184:187], a[100:103], a[184:187], v[184:187]
TR a[96:97], v248, 128
v_add_u32 v20, 0x9000, v249
MF v[188:191], a[100:103], a[188:191], v[188:191]
TR a[98:99], v248, 18560
MF v[48:51], a[104:107], a[184:187], v[48:51]
TR a[100:101], v248, 9344
MF v[52:55], a[104:107], a[188:191], v[52:55]
TR a[102:103], v248, 27776
global_load_lds_dwordx4 v5, s[8:9]
MF v[192:195], a[108:111], a[184:187], v[192:195]
TR a[104:105], v249, 160
MF v[196:199], a[108:111], a[188:191], v[196:199]
TR a[106:107], v249, 18592
s_waitcnt lgkmcnt(6)
MF v[56:59], a[80:83], a[184:187], v[56:59]
TR a[108:109], v249, 9376
MF v[60:63], a[80:83], a[188:191], v[60:63]
TR a[110:111], v249, 27808
MF v[200:203], a[84:87], a[184:187], v[200:203]
TR a[80:81], v248, 192
global_load_lds_dwordx4 v6, s[8:9] offset:1024
MF v[204:207], a[84:87], a[188:191], v[204:207]
TR a[82:83], v248, 18624
MF v[64:67], a[88:91], a[184:187], v[64:67]
TR a[84:85], v248, 9408
MF v[68:71], a[88:91], a[188:191], v[68:71]
TR a[86:87], v248, 27840
MF v[208:211], a[92:95], a[184:187], v[208:211]
TR a[88:89], v249, 224
MF v[212:215], a[92:95], a[188:191], v[212:215]
TR a[90:91], v249, 18656
s_waitcnt lgkmcnt(6)
MF v[72:75], a[96:99], a[184:187], v[72:75]
TR a[92:93], v249, 9440
global_load_lds_dwordx4 v7, s[8:9] offset:2048
MF v[76:79], a[96:99], a[188:191], v[76:79]
TR a[94:95], v249, 27872
MF v[216:219], a[100:103], a[184:187], v[216:219]
TR a[96:97], v248, 256
MF v[220:223], a[100:103], a[188:191], v[220:223]
TR a[98:99], v248, 18688
MF v[80:83], a[104:107], a[184:187], v[80:83]
TR a[100:101], v248, 9472
global_load_lds_dwordx4 v8, s[8:9] offset:3072
MF v[84:87], a[104:107], a[188:191], v[84:87]
TR a[102:103], v248, 27904
s_add_u32 m0, s28, 118784
MF v[224:227], a[108:111], a[184:187], v[224:227]
TR a[104:105], v249, 288
MF v[228:231], a[108:111], a[188:191], v[228:231]
TR a[106:107], v249, 18720
s_waitcnt lgkmcnt(6)
MF v[88:91], a[80:83], a[184:187], v[88:91]
TR a[108:109], v249, 9504
MF v[92:95], a[80:83], a[188:191], v[92:95]
TR a[110:111], v249, 27936
global_load_lds_dwordx4 v9, s[8:9]
MF v[232:235], a[84:87], a[184:187], v[232:235]
TR a[80:81], v248, 320
s_add_u32 s8, s8, 294912
s_addc_u32 s9, s9, 0
MF v[236:239], a[84:87], a[188:191], v[236:239]
TR a[82:83], v248, 18752
MF v[96:99], a[88:91], a[184:187], v[96:99]
TR a[84:85], v248, 9536
MF v[100:103], a[88:91], a[188:191], v[100:103]
TR a[86:87], v248, 27968
MF v[240:243], a[92:95], a[184:187], v[240:243]
TR a[88:89], v249, 352
global_load_dwordx4 a[200:203], v25, s[30:31] sc1
MF v[244:247], a[92:95], a[188:191], v[244:247]
TR a[90:91], v249, 18784
s_waitcnt lgkmcnt(6)
MF v[104:107], a[96:99], a[184:187], v[104:107]
TR a[92:93], v249, 9568
s_add_u32 s56, s56, 4096
MF v[108:111], a[96:99], a[188:191], v[108:111]
TR a[94:95], v249, 28000
buffer_load_dwordx4 v[36:39], v25, s[12:15], s56 offen
MF a[0:3], a[100:103], a[184:187], a[0:3]
TR a[96:97], v248, 384
MF a[4:7], a[100:103], a[188:191], a[4:7]
TR a[98:99], v248, 18816
global_load_dwordx4 a[204:207], v26, s[30:31] sc1
MF v[112:115], a[104:107], a[184:187], v[112:115]
TR a[100:101], v248, 9600
s_add_u32 s30, s30, 1024
s_addc_u32 s31, s31, 0
MF v[116:119], a[104:107], a[188:191], v[116:119]
TR a[102:103], v248, 28032
MF a[8:11], a[108:111], a[184:187], a[8:11]
TR a[104:105], v249, 416
MF a[12:15], a[108:111], a[188:191], a[12:15]
TR a[106:107], v249, 18848
s_waitcnt lgkmcnt(6)
MF v[120:123], a[80:83], a[184:187], v[120:123]
TR a[108:109], v249, 9632
MF v[124:127], a[80:83], a[188:191], v[124:127]
TR a[110:111], v249, 28064
MF a[16:19], a[84:87], a[184:187], a[16:19]
TR a[80:81], v248, 448
MF a[20:23], a[84:87], a[188:191], a[20:23]
TR a[82:83], v248, 18880
MF v[128:131], a[88:91], a[184:187], v[128:131]
TR a[84:85], v248, 9664
MF v[132:135], a[88:91], a[188:191], v[132:135]
TR a[86:87], v248, 28096
MF a[24:27], a[92:95], a[184:187], a[24:27]
TR a[88:89], v249, 480
MF a[28:31], a[92:95], a[188:191], a[28:31]
TR a[90:91], v249, 18912
s_waitcnt lgkmcnt(6)
MF v[136:139], a[96:99], a[184:187], v[136:139]
TR a[92:93], v249, 9696
buffer_load_dwordx4 v[36:39], v25, s[20:23], s72 offen offset:1024
MF v[140:143], a[96:99], a[188:191], v[140:143]
TR a[94:95], v249, 28128
MF a[32:35], a[100:103], a[184:187], a[32:35]
TR a[96:97], v248, 512
MF a[36:39], a[100:103], a[188:191], a[36:39]
TR a[98:99], v248, 18944
MF v[144:147], a[104:107], a[184:187], v[144:147]
TR a[100:101], v248, 9728
MF v[148:151], a[104:107], a[188:191], v[148:151]
TR a[102:103], v248, 28160
MF a[40:43], a[108:111], a[184:187], a[40:43]
TR a[104:105], v249, 544
s_waitcnt vmcnt(15)
MF a[44:47], a[108:111], a[188:191], a[44:47]
TR a[106:107], v249, 18976
s_waitcnt lgkmcnt(6)
MF v[152:155], a[80:83], a[184:187], v[152:155]
TR a[108:109], v249, 9760
s_barrier
MF v[156:159], a[80:83], a[188:191], v[156:159]
TR a[110:111], v249, 28192
s_add_u32 m0, s28, 0
MF a[48:51], a[84:87], a[184:187], a[48:51]
TR a[80:81], v19, 0
global_load_lds_dwordx4 v1, s[8:9]
MF a[52:55], a[84:87], a[188:191], a[52:55]
TR a[82:83], v19, 18432
MF v[160:163], a[88:91], a[184:187], v[160:163]
TR a[84:85], v19, 9216
MF v[164:167], a[88:91], a[188:191], v[164:167]
TR a[86:87], v19, 27648
MF a[56:59], a[92:95], a[184:187], a[56:59]
TR a[88:89], v20, 32
global_load_lds_dwordx4 v2, s[8:9] offset:1024
MF a[60:63], a[92:95], a[188:191], a[60:63]
TR a[90:91], v20, 18464
s_waitcnt lgkmcnt(6)
MF v[168:171], a[96:99], a[184:187], v[168:171]
TR a[92:93], v20, 9248
MF v[172:175], a[96:99], a[188:191], v[172:175]
TR a[94:95], v20, 27680
MF a[64:67], a[100:103], a[184:187], a[64:67]
TR a[96:97], v19, 64
MF a[68:71], a[100:103], a[188:191], a[68:71]
TR a[98:99], v19, 18496
global_load_lds_dwordx4 v3, s[8:9] offset:2048
MF v[176:179], a[104:107], a[184:187], v[176:179]
TR a[100:101], v19, 9280
MF v[180:183], a[104:107], a[188:191], v[180:183]
TR a[102:103], v19, 27712
v_add_u32 v248, 0x9000, v19
MF a[72:75], a[108:111], a[184:187], a[72:75]
TR a[104:105], v20, 96
v_add_u32 v249, 0x9000, v20
MF a[76:79], a[108:111], a[188:191], a[76:79]
TR a[106:107], v20, 18528
s_waitcnt lgkmcnt(6)
MF v[40:43], a[80:83], a[192:195], v[40:43]
TR a[108:109], v20, 9312
global_load_lds_dwordx4 v4, s[8:9] offset:3072
MF v[44:47], a[80:83], a[196:199], v[44:47]
TR a[110:111], v20, 27744
s_add_u32 m0, s28, 4096
MF v[184:187], a[84:87], a[192:195], v[184:187]
TR a[80:81], v19, 128
MF v[188:191], a[84:87], a[196:199], v[188:191]
TR a[82:83], v19, 18560
MF v[48:51], a[88:91], a[192:195], v[48:51]
TR a[84:85], v19, 9344
MF v[52:55], a[88:91], a[196:199], v[52:55]
TR a[86:87], v19, 27776
global_load_lds_dwordx4 v5, s[8:9]
MF v[192:195], a[92:95], a[192:195], v[192:195]
TR a[88:89], v20, 160
MF v[196:199], a[92:95], a[196:199], v[196:199]
TR a[90:91], v20, 18592
s_waitcnt lgkmcnt(6)
MF v[56:59], a[96:99], a[192:195], v[56:59]
TR a[92:93], v20, 9376
MF v[60:63], a[96:99], a[196:199], v[60:63]
TR a[94:95], v20, 27808
MF v[200:203], a[100:103], a[192:195], v[200:203]
TR a[96:97], v19, 192
global_load_lds_dwordx4 v6, s[8:9] offset:1024
MF v[204:207], a[100:103], a[196:199], v[204:207]
TR a[98:99], v19, 18624
MF v[64:67], a[104:107], a[192:195], v[64:67]
TR a[100:101], v19, 9408
MF v[68:71], a[104:107], a[196:199], v[68:71]
TR a[102:103], v19, 27840
MF v[208:211], a[108:111], a[192:195], v[208:211]
TR a[104:105], v20, 224
MF v[212:215], a[108:111], a[196:199], v[212:215]
TR a[106:107], v20, 18656
s_waitcnt lgkmcnt(6)
MF v[72:75], a[80:83], a[192:195], v[72:75]
TR a[108:109], v20, 9440
global_load_lds_dwordx4 v7, s[8:9] offset:2048
MF v[76:79], a[80:83], a[196:199], v[76:79]
TR a[110:111], v20, 27872
MF v[216:219], a[84:87], a[192:195], v[216:219]
TR a[80:81], v19, 256
MF v[220:223], a[84:87], a[196:199], v[220:223]
TR a[82:83], v19, 18688
MF v[80:83], a[88:91], a[192:195], v[80:83]
TR a[84:85], v19, 9472
global_load_lds_dwordx4 v8, s[8:9] offset:3072
MF v[84:87], a[88:91], a[196:199], v[84:87]
TR a[86:87], v19, 27904
s_add_u32 m0, s28, 8192
MF v[224:227], a[92:95], a[192:195], v[224:227]
TR a[88:89], v20, 288
s_add_u32 s56, s56, 4096
MF v[228:231], a[92:95], a[196:199], v[228:231]
TR a[90:91], v20, 18720
s_waitcnt lgkmcnt(6)
MF v[88:91], a[96:99], a[192:195], v[88:91]
TR a[92:93], v20, 9504
buffer_load_dwordx4 v[36:39], v25, s[12:15], s56 offen
MF v[92:95], a[96:99], a[196:199], v[92:95]
TR a[94:95], v20, 27936
global_load_lds_dwordx4 v9, s[8:9]
MF v[232:235], a[100:103], a[192:195], v[232:235]
TR a[96:97], v19, 320
s_add_u32 s8, s8, 294912
s_addc_u32 s9, s9, 0
MF v[236:239], a[100:103], a[196:199], v[236:239]
TR a[98:99], v19, 18752
buffer_load_dwordx4 v[36:39], v26, s[20:23], s72 offen offset:1024
MF v[96:99], a[104:107], a[192:195], v[96:99]
TR a[100:101], v19, 9536
MF v[100:103], a[104:107], a[196:199], v[100:103]
TR a[102:103], v19, 27968
MF v[240:243], a[108:111], a[192:195], v[240:243]
TR a[104:105], v20, 352
global_load_dwordx4 a[208:211], v25, s[30:31] sc1
MF v[244:247], a[108:111], a[196:199], v[244:247]
TR a[106:107], v20, 18784
s_waitcnt lgkmcnt(6)
MF v[104:107], a[80:83], a[192:195], v[104:107]
TR a[108:109], v20, 9568
MF v[108:111], a[80:83], a[196:199], v[108:111]
TR a[110:111], v20, 28000
MF a[0:3], a[84:87], a[192:195], a[0:3]
TR a[80:81], v19, 384
MF a[4:7], a[84:87], a[196:199], a[4:7]
TR a[82:83], v19, 18816
global_load_dwordx4 a[212:215], v26, s[30:31] sc1
MF v[112:115], a[88:91], a[192:195], v[112:115]
TR a[84:85], v19, 9600
s_add_u32 s30, s30, 1024
s_addc_u32 s31, s31, 0
MF v[116:119], a[88:91], a[196:199], v[116:119]
TR a[86:87], v19, 28032
MF a[8:11], a[92:95], a[192:195], a[8:11]
TR a[88:89], v20, 416
MF a[12:15], a[92:95], a[196:199], a[12:15]
TR a[90:91], v20, 18848
s_waitcnt lgkmcnt(6)
MF v[120:123], a[96:99], a[192:195], v[120:123]
TR a[92:93], v20, 9632
MF v[124:127], a[96:99], a[196:199], v[124:127]
TR a[94:95], v20, 28064
MF a[16:19], a[100:103], a[192:195], a[16:19]
TR a[96:97], v19, 448
MF a[20:23], a[100:103], a[196:199], a[20:23]
TR a[98:99], v19, 18880
MF v[128:131], a[104:107], a[192:195], v[128:131]
TR a[100:101], v19, 9664
MF v[132:135], a[104:107], a[196:199], v[132:135]
TR a[102:103], v19, 28096
MF a[24:27], a[108:111], a[192:195], a[24:27]
TR a[104:105], v20, 480
MF a[28:31], a[108:111], a[196:199], a[28:31]
TR a[106:107], v20, 18912
s_waitcnt lgkmcnt(6)
MF v[136:139], a[80:83], a[192:195], v[136:139]
TR a[108:109], v20, 9696
MF v[140:143], a[80:83], a[196:199], v[140:143]
TR a[110:111], v20, 28128
MF a[32:35], a[84:87], a[192:195], a[32:35]
TR a[80:81], v19, 512
MF a[36:39], a[84:87], a[196:199], a[36:39]
TR a[82:83], v19, 18944
MF v[144:147], a[88:91], a[192:195], v[144:147]
TR a[84:85], v19, 9728
MF v[148:151], a[88:91], a[196:199], v[148:151]
TR a[86:87], v19, 28160
MF a[40:43], a[92:95], a[192:195], a[40:43]
TR a[88:89], v20, 544
s_waitcnt vmcnt(14)
MF a[44:47], a[92:95], a[196:199], a[44:47]
TR a[90:91], v20, 18976
s_waitcnt lgkmcnt(6)
MF v[152:155], a[96:99], a[192:195], v[152:155]
TR a[92:93], v20, 9760
s_barrier
MF v[156:159], a[96:99], a[196:199], v[156:159]
TR a[94:95], v20, 28192
s_add_u32 m0, s28, 36864
MF a[48:51], a[100:103], a[192:195], a[48:51]
TR a[96:97], v248, 0
global_load_lds_dwordx4 v1, s[8:9]
MF a[52:55], a[100:103], a[196:199], a[52:55]
TR a[98:99], v248, 18432
MF v[160:163], a[104:107], a[192:195], v[160:163]
TR a[100:101], v248, 9216
MF v[164:167], a[104:107], a[196:199], v[164:167]
TR a[102:103], v248, 27648
MF a[56:59], a[108:111], a[192:195], a[56:59]
TR a[104:105], v249, 32
global_load_lds_dwordx4 v2, s[8:9] offset:1024
MF a[60:63], a[108:111], a[196:199], a[60:63]
TR a[106:107], v249, 18464
s_waitcnt lgkmcnt(6)
MF v[168:171], a[80:83], a[192:195], v[168:171]
TR a[108:109], v249, 9248
MF v[172:175], a[80:83], a[196:199], v[172:175]
TR a[110:111], v249, 27680
MF a[64:67], a[84:87], a[192:195], a[64:67]
TR a[80:81], v248, 64
MF a[68:71], a[84:87], a[196:199], a[68:71]
TR a[82:83], v248, 18496
global_load_lds_dwordx4 v3, s[8:9] offset:2048
MF v[176:179], a[88:91], a[192:195], v[176:179]
TR a[84:85], v248, 9280
MF v[180:183], a[88:91], a[196:199], v[180:183]
TR a[86:87], v248, 27712
v_add_u32 v19, 0xfffe5000, v248
MF a[72:75], a[92:95], a[192:195], a[72:75]
TR a[88:89], v249, 96
v_add_u32 v20, 0xfffe5000, v249
MF a[76:79], a[92:95], a[196:199], a[76:79]
TR a[90:91], v249, 18528
s_waitcnt lgkmcnt(6)
MF v[40:43], a[96:99], a[200:203], v[40:43]
TR a[92:93], v249, 9312
global_load_lds_dwordx4 v4, s[8:9] offset:3072
MF v[44:47], a[96:99], a[204:207], v[44:47]
TR a[94:95], v249, 27744
s_add_u32 m0, s28, 40960
MF v[184:187], a[100:103], a[200:203], v[184:187]
TR a[96:97], v248, 128
MF v[188:191], a[100:103], a[204:207], v[188:191]
TR a[98:99], v248, 18560
MF v[48:51], a[104:107], a[200:203], v[48:51]
TR a[100:101], v248, 9344
buffer_load_dwordx4 v[36:39], v25, s[20:23], s73 offen
MF v[52:55], a[104:107], a[204:207], v[52:55]
TR a[102:103], v248, 27776
global_load_lds_dwordx4 v5, s[8:9]
MF v[192:195], a[108:111], a[200:203], v[192:195]
TR a[104:105], v249, 160
MF v[196:199], a[108:111], a[204:207], v[196:199]
TR a[106:107], v249, 18592
s_waitcnt lgkmcnt(6)
MF v[56:59], a[80:83], a[200:203], v[56:59]
TR a[108:109], v249, 9376
s_add_u32 s56, s56, 4096
MF v[60:63], a[80:83], a[204:207], v[60:63]
TR a[110:111], v249, 27808
buffer_load_dwordx4 v[36:39], v25, s[12:15], s56 offen
MF v[200:203], a[84:87], a[200:203], v[200:203]
TR a[80:81], v248, 192
global_load_lds_dwordx4 v6, s[8:9] offset:1024
MF v[204:207], a[84:87], a[204:207], v[204:207]
TR a[82:83], v248, 18624
MF v[64:67], a[88:91], a[200:203], v[64:67]
TR a[84:85], v248, 9408
MF v[68:71], a[88:91], a[204:207], v[68:71]
TR a[86:87], v248, 27840
MF v[208:211], a[92:95], a[200:203], v[208:211]
TR a[88:89], v249, 224
MF v[212:215], a[92:95], a[204:207], v[212:215]
TR a[90:91], v249, 18656
s_waitcnt lgkmcnt(6)
MF v[72:75], a[96:99], a[200:203], v[72:75]
TR a[92:93], v249, 9440
global_load_lds_dwordx4 v7, s[8:9] offset:2048
MF v[76:79], a[96:99], a[204:207], v[76:79]
TR a[94:95], v249, 27872
MF v[216:219], a[100:103], a[200:203], v[216:219]
TR a[96:97], v248, 256
MF v[220:223], a[100:103], a[204:207], v[220:223]
TR a[98:99], v248, 18688
MF v[80:83], a[104:107], a[200:203], v[80:83]
TR a[100:101], v248, 9472
global_load_lds_dwordx4 v8, s[8:9] offset:3072
MF v[84:87], a[104:107], a[204:207], v[84:87]
TR a[102:103], v248, 27904
s_add_u32 m0, s28, 45056
MF v[224:227], a[108:111], a[200:203], v[224:227]
TR a[104:105], v249, 288
MF v[228:231], a[108:111], a[204:207], v[228:231]
TR a[106:107], v249, 18720
s_waitcnt lgkmcnt(6)
MF v[88:91], a[80:83], a[200:203], v[88:91]
TR a[108:109], v249, 9504
MF v[92:95], a[80:83], a[204:207], v[92:95]
TR a[110:111], v249, 27936
global_load_lds_dwordx4 v9, s[8:9]
MF v[232:235], a[84:87], a[200:203], v[232:235]
TR a[80:81], v248, 320
s_add_u32 s8, s8, 294912
s_addc_u32 s9, s9, 0
MF v[236:239], a[84:87], a[204:207], v[236:239]
TR a[82:83], v248, 18752
MF v[96:99], a[88:91], a[200:203], v[96:99]
TR a[84:85], v248, 9536
MF v[100:103], a[88:91], a[204:207], v[100:103]
TR a[86:87], v248, 27968
MF v[240:243], a[92:95], a[200:203], v[240:243]
TR a[88:89], v249, 352
global_load_dwordx4 a[216:219], v25, s[30:31] sc1
MF v[244:247], a[92:95], a[204:207], v[244:247]
TR a[90:91], v249, 18784
s_waitcnt lgkmcnt(6)
MF v[104:107], a[96:99], a[200:203], v[104:107]
TR a[92:93], v249, 9568
MF v[108:111], a[96:99], a[204:207], v[108:111]
TR a[94:95], v249, 28000
MF a[0:3], a[100:103], a[200:203], a[0:3]
TR a[96:97], v248, 384
MF a[4:7], a[100:103], a[204:207], a[4:7]
TR a[98:99], v248, 18816
global_load_dwordx4 a[220:223], v26, s[30:31] sc1
MF v[112:115], a[104:107], a[200:203], v[112:115]
TR a[100:101], v248, 9600
s_add_u32 s30, s30, 1024
s_addc_u32 s31, s31, 0
MF v[116:119], a[104:107], a[204:207], v[116:119]
TR a[102:103], v248, 28032
MF a[8:11], a[108:111], a[200:203], a[8:11]
TR a[104:105], v249, 416
MF a[12:15], a[108:111], a[204:207], a[12:15]
TR a[106:107], v249, 18848
s_waitcnt lgkmcnt(6)
MF v[120:123], a[80:83], a[200:203], v[120:123]
TR a[108:109], v249, 9632
MF v[124:127], a[80:83], a[204:207], v[124:127]
TR a[110:111], v249, 28064
MF a[16:19], a[84:87], a[200:203], a[16:19]
TR a[80:81], v248, 448
MF a[20:23], a[84:87], a[204:207], a[20:23]
TR a[82:83], v248, 18880
MF v[128:131], a[88:91], a[200:203], v[128:131]
TR a[84:85], v248, 9664
MF v[132:135], a[88:91], a[204:207], v[132:135]
TR a[86:87], v248, 28096
MF a[24:27], a[92:95], a[200:203], a[24:27]
TR a[88:89], v249, 480
MF a[28:31], a[92:95], a[204:207], a[28:31]
TR a[90:91], v249, 18912
s_waitcnt lgkmcnt(6)
MF v[136:139], a[96:99], a[200:203], v[136:139]
TR a[92:93], v249, 9696
MF v[140:143], a[96:99], a[204:207], v[140:143]
TR a[94:95], v249, 28128
MF a[32:35], a[100:103], a[200:203], a[32:35]
TR a[96:97], v248, 512
MF a[36:39], a[100:103], a[204:207], a[36:39]
TR a[98:99], v248, 18944
MF v[144:147], a[104:107], a[200:203], v[144:147]
TR a[100:101], v248, 9728
MF v[148:151], a[104:107], a[204:207], v[148:151]
TR a[102:103], v248, 28160
MF a[40:43], a[108:111], a[200:203], a[40:43]
TR a[104:105], v249, 544
s_waitcnt vmcnt(13)
MF a[44:47], a[108:111], a[204:207], a[44:47]
TR a[106:107], v249, 18976
s_waitcnt lgkmcnt(6)
MF v[152:155], a[80:83], a[200:203], v[152:155]
TR a[108:109], v249, 9760
s_barrier
MF v[156:159], a[80:83], a[204:207], v[156:159]
TR a[110:111], v249, 28192
s_add_u32 m0, s28, 73728
MF a[48:51], a[84:87], a[200:203], a[48:51]
TR a[80:81], v19, 0
global_load_lds_dwordx4 v1, s[8:9]
MF a[52:55], a[84:87], a[204:207], a[52:55]
TR a[82:83], v19, 18432
buffer_load_dwordx4 v[36:39], v26, s[20:23], s73 offen
MF v[160:163], a[88:91], a[200:203], v[160:163]
TR a[84:85], v19, 9216
MF v[164:167], a[88:91], a[204:207], v[164:167]
TR a[86:87], v19, 27648
MF a[56:59], a[92:95], a[200:203], a[56:59]
TR a[88:89], v20, 32
global_load_lds_dwordx4 v2, s[8:9] offset:1024
MF a[60:63], a[92:95], a[204:207], a[60:63]
TR a[90:91], v20, 18464
s_waitcnt lgkmcnt(6)
MF v[168:171], a[96:99], a[200:203], v[168:171]
TR a[92:93], v20, 9248
MF v[172:175], a[96:99], a[204:207], v[172:175]
TR a[94:95], v20, 27680
MF a[64:67], a[100:103], a[200:203], a[64:67]
TR a[96:97], v19, 64
MF a[68:71], a[100:103], a[204:207], a[68:71]
TR a[98:99], v19, 18496
global_load_lds_dwordx4 v3, s[8:9] offset:2048
MF v[176:179], a[104:107], a[200:203], v[176:179]
TR a[100:101], v19, 9280
s_add_u32 s56, s56, 4096
MF v[180:183], a[104:107], a[204:207], v[180:183]
TR a[102:103], v19, 27712
buffer_load_dwordx4 v[36:39], v25, s[12:15], s56 offen
MF a[72:75], a[108:111], a[200:203], a[72:75]
TR a[104:105], v20, 96
v_add_u32 v248, 0x9000, v19
MF a[76:79], a[108:111], a[204:207], a[76:79]
TR a[106:107], v20, 18528
s_waitcnt lgkmcnt(6)
MF v[40:43], a[80:83], a[208:211], v[40:43]
TR a[108:109], v20, 9312
global_load_lds_dwordx4 v4, s[8:9] offset:3072
MF v[44:47], a[80:83], a[212:215], v[44:47]
TR a[110:111], v20, 27744
s_add_u32 m0, s28, 77824
MF v[184:187], a[84:87], a[208:211], v[184:187]
TR a[80:81], v19, 128
v_add_u32 v249, 0x9000, v20
MF v[188:191], a[84:87], a[212:215], v[188:191]
TR a[82:83], v19, 18560
MF v[48:51], a[88:91], a[208:211], v[48:51]
TR a[84:85], v19, 9344
MF v[52:55], a[88:91], a[212:215], v[52:55]
TR a[86:87], v19, 27776
global_load_lds_dwordx4 v5, s[8:9]
MF v[192:195], a[92:95], a[208:211], v[192:195]
TR a[88:89], v20, 160
MF v[196:199], a[92:95], a[212:215], v[196:199]
TR a[90:91], v20, 18592
s_waitcnt lgkmcnt(6)
MF v[56:59], a[96:99], a[208:211], v[56:59]
TR a[92:93], v20, 9376
MF v[60:63], a[96:99], a[212:215], v[60:63]
TR a[94:95], v20, 27808
MF v[200:203], a[100:103], a[208:211], v[200:203]
TR a[96:97], v19, 192
global_load_lds_dwordx4 v6, s[8:9] offset:1024
MF v[204:207], a[100:103], a[212:215], v[204:207]
TR a[98:99], v19, 18624
MF v[64:67], a[104:107], a[208:211], v[64:67]
TR a[100:101], v19, 9408
MF v[68:71], a[104:107], a[212:215], v[68:71]
TR a[102:103], v19, 27840
MF v[208:211], a[108:111], a[208:211], v[208:211]
TR a[104:105], v20, 224
MF v[212:215], a[108:111], a[212:215], v[212:215]
TR a[106:107], v20, 18656
s_waitcnt lgkmcnt(6)
MF v[72:75], a[80:83], a[208:211], v[72:75]
TR a[108:109], v20, 9440
global_load_lds_dwordx4 v7, s[8:9] offset:2048
MF v[76:79], a[80:83], a[212:215], v[76:79]
TR a[110:111], v20, 27872
MF v[216:219], a[84:87], a[208:211], v[216:219]
TR a[80:81], v19, 256
MF v[220:223], a[84:87], a[212:215], v[220:223]
TR a[82:83], v19, 18688
MF v[80:83], a[88:91], a[208:211], v[80:83]
TR a[84:85], v19, 9472
global_load_lds_dwordx4 v8, s[8:9] offset:3072
MF v[84:87], a[88:91], a[212:215], v[84:87]
TR a[86:87], v19, 27904
s_add_u32 m0, s28, 81920
MF v[224:227], a[92:95], a[208:211], v[224:227]
TR a[88:89], v20, 288
MF v[228:231], a[92:95], a[212:215], v[228:231]
TR a[90:91], v20, 18720
s_waitcnt lgkmcnt(6)
MF v[88:91], a[96:99], a[208:211], v[88:91]
TR a[92:93], v20, 9504
MF v[92:95], a[96:99], a[212:215], v[92:95]
TR a[94:95], v20, 27936
global_load_lds_dwordx4 v9, s[8:9]
MF v[232:235], a[100:103], a[208:211], v[232:235]
TR a[96:97], v19, 320
s_add_u32 s8, s8, 294912
s_addc_u32 s9, s9, 0
MF v[236:239], a[100:103], a[212:215], v[236:239]
TR a[98:99], v19, 18752
MF v[96:99], a[104:107], a[208:211], v[96:99]
TR a[100:101], v19, 9536
MF v[100:103], a[104:107], a[212:215], v[100:103]
TR a[102:103], v19, 27968
MF v[240:243], a[108:111], a[208:211], v[240:243]
TR a[104:105], v20, 352
global_load_dwordx4 a[224:227], v25, s[30:31] sc1
MF v[244:247], a[108:111], a[212:215], v[244:247]
TR a[106:107], v20, 18784
s_waitcnt lgkmcnt(6)
MF v[104:107], a[80:83], a[208:211], v[104:107]
TR a[108:109], v20, 9568
buffer_load_dwordx4 v[36:39], v25, s[20:23], s73 offen offset:1024
MF v[108:111], a[80:83], a[212:215], v[108:111]
TR a[110:111], v20, 28000
MF a[0:3], a[84:87], a[208:211], a[0:3]
TR a[80:81], v19, 384
MF a[4:7], a[84:87], a[212:215], a[4:7]
TR a[82:83], v19, 18816
global_load_dwordx4 a[228:231], v26, s[30:31] sc1
MF v[112:115], a[88:91], a[208:211], v[112:115]
TR a[84:85], v19, 9600
s_add_u32 s30, s30, 1024
s_addc_u32 s31, s31, 0
MF v[116:119], a[88:91], a[212:215], v[116:119]
TR a[86:87], v19, 28032
s_getpc_b64 s[48:49]
kb_kernel_pc10:
s_add_u32 s48, s48, kb_kernel-kb_kernel_pc10
s_addc_u32 s49, s49, (kb_kernel-kb_kernel_pc10)>>32
MF a[8:11], a[92:95], a[208:211], a[8:11]
TR a[88:89], v20, 416
s_mov_b32 s50, kb_kernel_done1-kb_kernel
s_mov_b32 s51, 0x00020000
MF a[12:15], a[92:95], a[212:215], a[12:15]
TR a[90:91], v20, 18848
s_waitcnt lgkmcnt(6)
MF v[120:123], a[96:99], a[208:211], v[120:123]
TR a[92:93], v20, 9632
s_lshr_b32 s52, s2, 3
s_mul_i32 s52, s52, 2048
MF v[124:127], a[96:99], a[212:215], v[124:127]
TR a[94:95], v20, 28064
buffer_load_dwordx4 v[36:39], v25, s[48:51], s52 offen
MF a[16:19], a[100:103], a[208:211], a[16:19]
TR a[96:97], v19, 448
buffer_load_dwordx4 v[36:39], v25, s[48:51], s52 offen offset:1024
MF a[20:23], a[100:103], a[212:215], a[20:23]
TR a[98:99], v19, 18880
MF v[128:131], a[104:107], a[208:211], v[128:131]
TR a[100:101], v19, 9664
MF v[132:135], a[104:107], a[212:215], v[132:135]
TR a[102:103], v19, 28096
MF a[24:27], a[108:111], a[208:211], a[24:27]
TR a[104:105], v20, 480
MF a[28:31], a[108:111], a[212:215], a[28:31]
TR a[106:107], v20, 18912
s_waitcnt lgkmcnt(6)
MF v[136:139], a[80:83], a[208:211], v[136:139]
TR a[108:109], v20, 9696
MF v[140:143], a[80:83], a[212:215], v[140:143]
TR a[110:111], v20, 28128
MF a[32:35], a[84:87], a[208:211], a[32:35]
TR a[80:81], v19, 512
MF a[36:39], a[84:87], a[212:215], a[36:39]
TR a[82:83], v19, 18944
MF v[144:147], a[88:91], a[208:211], v[144:147]
TR a[84:85], v19, 9728
MF v[148:151], a[88:91], a[212:215], v[148:151]
TR a[86:87], v19, 28160
MF a[40:43], a[92:95], a[208:211], a[40:43]
TR a[88:89], v20, 544
s_waitcnt vmcnt(16)
MF a[44:47], a[92:95], a[212:215], a[44:47]
TR a[90:91], v20, 18976
s_waitcnt lgkmcnt(6)
MF v[152:155], a[96:99], a[208:211], v[152:155]
TR a[92:93], v20, 9760
s_barrier
MF v[156:159], a[96:99], a[212:215], v[156:159]
TR a[94:95], v20, 28192
s_add_u32 m0, s28, 110592
MF a[48:51], a[100:103], a[208:211], a[48:51]
TR a[96:97], v248, 0
global_load_lds_dwordx4 v1, s[8:9]
MF a[52:55], a[100:103], a[212:215], a[52:55]
TR a[98:99], v248, 18432
s_add_u32 s56, s56, 4096
MF v[160:163], a[104:107], a[208:211], v[160:163]
TR a[100:101], v248, 9216
buffer_load_dwordx4 v[36:39], v25, s[12:15], s56 offen
MF v[164:167], a[104:107], a[212:215], v[164:167]
TR a[102:103], v248, 27648
MF a[56:59], a[108:111], a[208:211], a[56:59]
TR a[104:105], v249, 32
global_load_lds_dwordx4 v2, s[8:9] offset:1024
MF a[60:63], a[108:111], a[212:215], a[60:63]
TR a[106:107], v249, 18464
s_waitcnt lgkmcnt(6)
MF v[168:171], a[80:83], a[208:211], v[168:171]
TR a[108:109], v249, 9248
MF v[172:175], a[80:83], a[212:215], v[172:175]
TR a[110:111], v249, 27680
MF a[64:67], a[84:87], a[208:211], a[64:67]
TR a[80:81], v248, 64
MF a[68:71], a[84:87], a[212:215], a[68:71]
TR a[82:83], v248, 18496
global_load_lds_dwordx4 v3, s[8:9] offset:2048
MF v[176:179], a[88:91], a[208:211], v[176:179]
TR a[84:85], v248, 9280
MF v[180:183], a[88:91], a[212:215], v[180:183]
TR a[86:87], v248, 27712
v_add_u32 v19, 0x9000, v248
MF a[72:75], a[92:95], a[208:211], a[72:75]
TR a[88:89], v249, 96
v_add_u32 v20, 0x9000, v249
MF a[76:79], a[92:95], a[212:215], a[76:79]
TR a[90:91], v249, 18528
s_waitcnt lgkmcnt(6)
MF v[40:43], a[96:99], a[216:219], v[40:43]
TR a[92:93], v249, 9312
global_load_lds_dwordx4 v4, s[8:9] offset:3072
MF v[44:47], a[96:99], a[220:223], v[44:47]
TR a[94:95], v249, 27744
s_add_u32 m0, s28, 114688
MF v[184:187], a[100:103], a[216:219], v[184:187]
TR a[96:97], v248, 128
MF v[188:191], a[100:103], a[220:223], v[188:191]
TR a[98:99], v248, 18560
MF v[48:51], a[104:107], a[216:219], v[48:51]
TR a[100:101], v248, 9344
MF v[52:55], a[104:107], a[220:223], v[52:55]
TR a[102:103], v248, 27776
global_load_lds_dwordx4 v5, s[8:9]
MF v[192:195], a[108:111], a[216:219], v[192:195]
TR a[104:105], v249, 160
MF v[196:199], a[108:111], a[220:223], v[196:199]
TR a[106:107], v249, 18592
s_waitcnt lgkmcnt(6)
MF v[56:59], a[80:83], a[216:219], v[56:59]
TR a[108:109], v249, 9376
MF v[60:63], a[80:83], a[220:223], v[60:63]
TR a[110:111], v249, 27808
MF v[200:203], a[84:87], a[216:219], v[200:203]
TR a[80:81], v248, 192
global_load_lds_dwordx4 v6, s[8:9] offset:1024
MF v[204:207], a[84:87], a[220:223], v[204:207]
TR a[82:83], v248, 18624
buffer_load_dwordx4 v[36:39], v26, s[20:23], s73 offen offset:1024
MF v[64:67], a[88:91], a[216:219], v[64:67]
TR a[84:85], v248, 9408
MF v[68:71], a[88:91], a[220:223], v[68:71]
TR a[86:87], v248, 27840
MF v[208:211], a[92:95], a[216:219], v[208:211]
TR a[88:89], v249, 224
MF v[212:215], a[92:95], a[220:223], v[212:215]
TR a[90:91], v249, 18656
s_waitcnt lgkmcnt(6)
MF v[72:75], a[96:99], a[216:219], v[72:75]
TR a[92:93], v249, 9440
global_load_lds_dwordx4 v7, s[8:9] offset:2048
MF v[76:79], a[96:99], a[220:223], v[76:79]
TR a[94:95], v249, 27872
MF v[216:219], a[100:103], a[216:219], v[216:219]
TR a[96:97], v248, 256
MF v[220:223], a[100:103], a[220:223], v[220:223]
TR a[98:99], v248, 18688
MF v[80:83], a[104:107], a[216:219], v[80:83]
TR a[100:101], v248, 9472
global_load_lds_dwordx4 v8, s[8:9] offset:3072
MF v[84:87], a[104:107], a[220:223], v[84:87]
TR a[102:103], v248, 27904
s_add_u32 m0, s28, 118784
MF v[224:227], a[108:111], a[216:219], v[224:227]
TR a[104:105], v249, 288
MF v[228:231], a[108:111], a[220:223], v[228:231]
TR a[106:107], v249, 18720
s_waitcnt lgkmcnt(6)
MF v[88:91], a[80:83], a[216:219], v[88:91]
TR a[108:109], v249, 9504
MF v[92:95], a[80:83], a[220:223], v[92:95]
TR a[110:111], v249, 27936
global_load_lds_dwordx4 v9, s[8:9]
MF v[232:235], a[84:87], a[216:219], v[232:235]
TR a[80:81], v248, 320
s_add_u32 s8, s8, 294912
s_addc_u32 s9, s9, 0
MF v[236:239], a[84:87], a[220:223], v[236:239]
TR a[82:83], v248, 18752
MF v[96:99], a[88:91], a[216:219], v[96:99]
TR a[84:85], v248, 9536
MF v[100:103], a[88:91], a[220:223], v[100:103]
TR a[86:87], v248, 27968
MF v[240:243], a[92:95], a[216:219], v[240:243]
TR a[88:89], v249, 352
global_load_dwordx4 a[232:235], v25, s[30:31] sc1
MF v[244:247], a[92:95], a[220:223], v[244:247]
TR a[90:91], v249, 18784
s_waitcnt lgkmcnt(6)
MF v[104:107], a[96:99], a[216:219], v[104:107]
TR a[92:93], v249, 9568
MF v[108:111], a[96:99], a[220:223], v[108:111]
TR a[94:95], v249, 28000
MF a[0:3], a[100:103], a[216:219], a[0:3]
TR a[96:97], v248, 384
MF a[4:7], a[100:103], a[220:223], a[4:7]
TR a[98:99], v248, 18816
global_load_dwordx4 a[236:239], v26, s[30:31] sc1
MF v[112:115], a[104:107], a[216:219], v[112:115]
TR a[100:101], v248, 9600
s_add_u32 s30, s30, 1024
s_addc_u32 s31, s31, 0
MF v[116:119], a[104:107], a[220:223], v[116:119]
TR a[102:103], v248, 28032
MF a[8:11], a[108:111], a[216:219], a[8:11]
TR a[104:105], v249, 416
MF a[12:15], a[108:111], a[220:223], a[12:15]
TR a[106:107], v249, 18848
s_waitcnt lgkmcnt(6)
MF v[120:123], a[80:83], a[216:219], v[120:123]
TR a[108:109], v249, 9632
MF v[124:127], a[80:83], a[220:223], v[124:127]
TR a[110:111], v249, 28064
MF a[16:19], a[84:87], a[216:219], a[16:19]
TR a[80:81], v248, 448
MF a[20:23], a[84:87], a[220:223], a[20:23]
TR a[82:83], v248, 18880
MF v[128:131], a[88:91], a[216:219], v[128:131]
TR a[84:85], v248, 9664
s_add_u32 s56, s56, 4096
MF v[132:135], a[88:91], a[220:223], v[132:135]
TR a[86:87], v248, 28096
buffer_load_dwordx4 v[36:39], v25, s[12:15], s56 offen
MF a[24:27], a[92:95], a[216:219], a[24:27]
TR a[88:89], v249, 480
MF a[28:31], a[92:95], a[220:223], a[28:31]
TR a[90:91], v249, 18912
s_waitcnt lgkmcnt(6)
MF v[136:139], a[96:99], a[216:219], v[136:139]
TR a[92:93], v249, 9696
MF v[140:143], a[96:99], a[220:223], v[140:143]
TR a[94:95], v249, 28128
MF a[32:35], a[100:103], a[216:219], a[32:35]
TR a[96:97], v248, 512
MF a[36:39], a[100:103], a[220:223], a[36:39]
TR a[98:99], v248, 18944
MF v[144:147], a[104:107], a[216:219], v[144:147]
TR a[100:101], v248, 9728
MF v[148:151], a[104:107], a[220:223], v[148:151]
TR a[102:103], v248, 28160
MF a[40:43], a[108:111], a[216:219], a[40:43]
TR a[104:105], v249, 544
s_waitcnt vmcnt(16)
MF a[44:47], a[108:111], a[220:223], a[44:47]
TR a[106:107], v249, 18976
s_waitcnt lgkmcnt(6)
MF v[152:155], a[80:83], a[216:219], v[152:155]
TR a[108:109], v249, 9760
s_barrier
MF v[156:159], a[80:83], a[220:223], v[156:159]
TR a[110:111], v249, 28192
s_add_u32 m0, s28, 0
MF a[48:51], a[84:87], a[216:219], a[48:51]
TR a[80:81], v19, 0
global_load_lds_dwordx4 v1, s[8:9]
MF a[52:55], a[84:87], a[220:223], a[52:55]
TR a[82:83], v19, 18432
MF v[160:163], a[88:91], a[216:219], v[160:163]
TR a[84:85], v19, 9216
buffer_load_dwordx4 v[36:39], v25, s[20:23], s81 offen
MF v[164:167], a[88:91], a[220:223], v[164:167]
TR a[86:87], v19, 27648
MF a[56:59], a[92:95], a[216:219], a[56:59]
TR a[88:89], v20, 32
global_load_lds_dwordx4 v2, s[8:9] offset:1024
MF a[60:63], a[92:95], a[220:223], a[60:63]
TR a[90:91], v20, 18464
s_waitcnt lgkmcnt(6)
MF v[168:171], a[96:99], a[216:219], v[168:171]
TR a[92:93], v20, 9248
MF v[172:175], a[96:99], a[220:223], v[172:175]
TR a[94:95], v20, 27680
MF a[64:67], a[100:103], a[216:219], a[64:67]
TR a[96:97], v19, 64
MF a[68:71], a[100:103], a[220:223], a[68:71]
TR a[98:99], v19, 18496
global_load_lds_dwordx4 v3, s[8:9] offset:2048
MF v[176:179], a[104:107], a[216:219], v[176:179]
TR a[100:101], v19, 9280
MF v[180:183], a[104:107], a[220:223], v[180:183]
TR a[102:103], v19, 27712
v_add_u32 v248, 0x9000, v19
MF a[72:75], a[108:111], a[216:219], a[72:75]
TR a[104:105], v20, 96
v_add_u32 v249, 0x9000, v20
MF a[76:79], a[108:111], a[220:223], a[76:79]
TR a[106:107], v20, 18528
s_waitcnt lgkmcnt(6)
MF v[40:43], a[80:83], a[224:227], v[40:43]
TR a[108:109], v20, 9312
global_load_lds_dwordx4 v4, s[8:9] offset:3072
MF v[44:47], a[80:83], a[228:231], v[44:47]
TR a[110:111], v20, 27744
s_add_u32 m0, s28, 4096
MF v[184:187], a[84:87], a[224:227], v[184:187]
TR a[80:81], v19, 128
MF v[188:191], a[84:87], a[228:231], v[188:191]
TR a[82:83], v19, 18560
MF v[48:51], a[88:91], a[224:227], v[48:51]
TR a[84:85], v19, 9344
MF v[52:55], a[88:91], a[228:231], v[52:55]
TR a[86:87], v19, 27776
global_load_lds_dwordx4 v5, s[8:9]
MF v[192:195], a[92:95], a[224:227], v[192:195]
TR a[88:89], v20, 160
MF v[196:199], a[92:95], a[228:231], v[196:199]
TR a[90:91], v20, 18592
s_waitcnt lgkmcnt(6)
MF v[56:59], a[96:99], a[224:227], v[56:59]
TR a[92:93], v20, 9376
MF v[60:63], a[96:99], a[228:231], v[60:63]
TR a[94:95], v20, 27808
MF v[200:203], a[100:103], a[224:227], v[200:203]
TR a[96:97], v19, 192
global_load_lds_dwordx4 v6, s[8:9] offset:1024
MF v[204:207], a[100:103], a[228:231], v[204:207]
TR a[98:99], v19, 18624
MF v[64:67], a[104:107], a[224:227], v[64:67]
TR a[100:101], v19, 9408
MF v[68:71], a[104:107], a[228:231], v[68:71]
TR a[102:103], v19, 27840
MF v[208:211], a[108:111], a[224:227], v[208:211]
TR a[104:105], v20, 224
MF v[212:215], a[108:111], a[228:231], v[212:215]
TR a[106:107], v20, 18656
s_waitcnt lgkmcnt(6)
MF v[72:75], a[80:83], a[224:227], v[72:75]
TR a[108:109], v20, 9440
global_load_lds_dwordx4 v7, s[8:9] offset:2048
MF v[76:79], a[80:83], a[228:231], v[76:79]
TR a[110:111], v20, 27872
MF v[216:219], a[84:87], a[224:227], v[216:219]
TR a[80:81], v19, 256
MF v[220:223], a[84:87], a[228:231], v[220:223]
TR a[82:83], v19, 18688
MF v[80:83], a[88:91], a[224:227], v[80:83]
TR a[84:85], v19, 9472
global_load_lds_dwordx4 v8, s[8:9] offset:3072
MF v[84:87], a[88:91], a[228:231], v[84:87]
TR a[86:87], v19, 27904
s_add_u32 m0, s28, 8192
MF v[224:227], a[92:95], a[224:227], v[224:227]
TR a[88:89], v20, 288
MF v[228:231], a[92:95], a[228:231], v[228:231]
TR a[90:91], v20, 18720
s_waitcnt lgkmcnt(6)
MF v[88:91], a[96:99], a[224:227], v[88:91]
TR a[92:93], v20, 9504
MF v[92:95], a[96:99], a[228:231], v[92:95]
TR a[94:95], v20, 27936
global_load_lds_dwordx4 v9, s[8:9]
MF v[232:235], a[100:103], a[224:227], v[232:235]
TR a[96:97], v19, 320
s_add_u32 s8, s8, 294912
s_addc_u32 s9, s9, 0
MF v[236:239], a[100:103], a[228:231], v[236:239]
TR a[98:99], v19, 18752
MF v[96:99], a[104:107], a[224:227], v[96:99]
TR a[100:101], v19, 9536
MF v[100:103], a[104:107], a[228:231], v[100:103]
TR a[102:103], v19, 27968
MF v[240:243], a[108:111], a[224:227], v[240:243]
TR a[104:105], v20, 352
global_load_dwordx4 a[240:243], v25, s[30:31] sc1
MF v[244:247], a[108:111], a[228:231], v[244:247]
TR a[106:107], v20, 18784
s_waitcnt lgkmcnt(6)
MF v[104:107], a[80:83], a[224:227], v[104:107]
TR a[108:109], v20, 9568
s_add_u32 s56, s56, 4096
MF v[108:111], a[80:83], a[228:231], v[108:111]
TR a[110:111], v20, 28000
buffer_load_dwordx4 v[36:39], v25, s[12:15], s56 offen
MF a[0:3], a[84:87], a[224:227], a[0:3]
TR a[80:81], v19, 384
MF a[4:7], a[84:87], a[228:231], a[4:7]
TR a[82:83], v19, 18816
global_load_dwordx4 a[244:247], v26, s[30:31] sc1
MF v[112:115], a[88:91], a[224:227], v[112:115]
TR a[84:85], v19, 9600
s_add_u32 s30, s30, 1024
s_addc_u32 s31, s31, 0
MF v[116:119], a[88:91], a[228:231], v[116:119]
TR a[86:87], v19, 28032
MF a[8:11], a[92:95], a[224:227], a[8:11]
TR a[88:89], v20, 416
buffer_load_dwordx4 v[36:39], v26, s[20:23], s81 offen
MF a[12:15], a[92:95], a[228:231], a[12:15]
TR a[90:91], v20, 18848
s_waitcnt lgkmcnt(6)
MF v[120:123], a[96:99], a[224:227], v[120:123]
TR a[92:93], v20, 9632
MF v[124:127], a[96:99], a[228:231], v[124:127]
TR a[94:95], v20, 28064
MF a[16:19], a[100:103], a[224:227], a[16:19]
TR a[96:97], v19, 448
MF a[20:23], a[100:103], a[228:231], a[20:23]
TR a[98:99], v19, 18880
MF v[128:131], a[104:107], a[224:227], v[128:131]
TR a[100:101], v19, 9664
MF v[132:135], a[104:107], a[228:231], v[132:135]
TR a[102:103], v19, 28096
MF a[24:27], a[108:111], a[224:227], a[24:27]
TR a[104:105], v20, 480
MF a[28:31], a[108:111], a[228:231], a[28:31]
TR a[106:107], v20, 18912
s_waitcnt lgkmcnt(6)
MF v[136:139], a[80:83], a[224:227], v[136:139]
TR a[108:109], v20, 9696
MF v[140:143], a[80:83], a[228:231], v[140:143]
TR a[110:111], v20, 28128
MF a[32:35], a[84:87], a[224:227], a[32:35]
TR a[80:81], v19, 512
MF a[36:39], a[84:87], a[228:231], a[36:39]
TR a[82:83], v19, 18944
MF v[144:147], a[88:91], a[224:227], v[144:147]
TR a[84:85], v19, 9728
MF v[148:151], a[88:91], a[228:231], v[148:151]
TR a[86:87], v19, 28160
MF a[40:43], a[92:95], a[224:227], a[40:43]
TR a[88:89], v20, 544
s_waitcnt vmcnt(15)
MF a[44:47], a[92:95], a[228:231], a[44:47]
TR a[90:91], v20, 18976
s_waitcnt lgkmcnt(6)
MF v[152:155], a[96:99], a[224:227], v[152:155]
TR a[92:93], v20, 9760
s_barrier
MF v[156:159], a[96:99], a[228:231], v[156:159]
TR a[94:95], v20, 28192
s_add_u32 m0, s28, 36864
MF a[48:51], a[100:103], a[224:227], a[48:51]
TR a[96:97], v248, 0
global_load_lds_dwordx4 v1, s[8:9]
MF a[52:55], a[100:103], a[228:231], a[52:55]
TR a[98:99], v248, 18432
MF v[160:163], a[104:107], a[224:227], v[160:163]
TR a[100:101], v248, 9216
MF v[164:167], a[104:107], a[228:231], v[164:167]
TR a[102:103], v248, 27648
MF a[56:59], a[108:111], a[224:227], a[56:59]
TR a[104:105], v249, 32
global_load_lds_dwordx4 v2, s[8:9] offset:1024
MF a[60:63], a[108:111], a[228:231], a[60:63]
TR a[106:107], v249, 18464
s_waitcnt lgkmcnt(6)
MF v[168:171], a[80:83], a[224:227], v[168:171]
TR a[108:109], v249, 9248
MF v[172:175], a[80:83], a[228:231], v[172:175]
TR a[110:111], v249, 27680
MF a[64:67], a[84:87], a[224:227], a[64:67]
TR a[80:81], v248, 64
MF a[68:71], a[84:87], a[228:231], a[68:71]
TR a[82:83], v248, 18496
global_load_lds_dwordx4 v3, s[8:9] offset:2048
MF v[176:179], a[88:91], a[224:227], v[176:179]
TR a[84:85], v248, 9280
MF v[180:183], a[88:91], a[228:231], v[180:183]
TR a[86:87], v248, 27712
v_add_u32 v19, 0xfffe5000, v248
MF a[72:75], a[92:95], a[224:227], a[72:75]
TR a[88:89], v249, 96
v_add_u32 v20, 0xfffe5000, v249
MF a[76:79], a[92:95], a[228:231], a[76:79]
TR a[90:91], v249, 18528
s_waitcnt lgkmcnt(6)
MF v[40:43], a[96:99], a[232:235], v[40:43]
TR a[92:93], v249, 9312
global_load_lds_dwordx4 v4, s[8:9] offset:3072
MF v[44:47], a[96:99], a[236:239], v[44:47]
TR a[94:95], v249, 27744
s_add_u32 m0, s28, 40960
MF v[184:187], a[100:103], a[232:235], v[184:187]
TR a[96:97], v248, 128
MF v[188:191], a[100:103], a[236:239], v[188:191]
TR a[98:99], v248, 18560
MF v[48:51], a[104:107], a[232:235], v[48:51]
TR a[100:101], v248, 9344
MF v[52:55], a[104:107], a[236:239], v[52:55]
TR a[102:103], v248, 27776
global_load_lds_dwordx4 v5, s[8:9]
MF v[192:195], a[108:111], a[232:235], v[192:195]
TR a[104:105], v249, 160
MF v[196:199], a[108:111], a[236:239], v[196:199]
TR a[106:107], v249, 18592
s_waitcnt lgkmcnt(6)
MF v[56:59], a[80:83], a[232:235], v[56:59]
TR a[108:109], v249, 9376
MF v[60:63], a[80:83], a[236:239], v[60:63]
TR a[110:111], v249, 27808
MF v[200:203], a[84:87], a[232:235], v[200:203]
TR a[80:81], v248, 192
global_load_lds_dwordx4 v6, s[8:9] offset:1024
MF v[204:207], a[84:87], a[236:239], v[204:207]
TR a[82:83], v248, 18624
MF v[64:67], a[88:91], a[232:235], v[64:67]
TR a[84:85], v248, 9408
MF v[68:71], a[88:91], a[236:239], v[68:71]
TR a[86:87], v248, 27840
MF v[208:211], a[92:95], a[232:235], v[208:211]
TR a[88:89], v249, 224
MF v[212:215], a[92:95], a[236:239], v[212:215]
TR a[90:91], v249, 18656
s_waitcnt lgkmcnt(6)
MF v[72:75], a[96:99], a[232:235], v[72:75]
TR a[92:93], v249, 9440
global_load_lds_dwordx4 v7, s[8:9] offset:2048
MF v[76:79], a[96:99], a[236:239], v[76:79]
TR a[94:95], v249, 27872
buffer_load_dwordx4 v[36:39], v25, s[20:23], s81 offen offset:1024
MF v[216:219], a[100:103], a[232:235], v[216:219]
TR a[96:97], v248, 256
MF v[220:223], a[100:103], a[236:239], v[220:223]
TR a[98:99], v248, 18688
MF v[80:83], a[104:107], a[232:235], v[80:83]
TR a[100:101], v248, 9472
global_load_lds_dwordx4 v8, s[8:9] offset:3072
MF v[84:87], a[104:107], a[236:239], v[84:87]
TR a[102:103], v248, 27904
s_add_u32 m0, s28, 45056
MF v[224:227], a[108:111], a[232:235], v[224:227]
TR a[104:105], v249, 288
s_add_u32 s56, s56, 4096
MF v[228:231], a[108:111], a[236:239], v[228:231]
TR a[106:107], v249, 18720
s_waitcnt lgkmcnt(6)
MF v[88:91], a[80:83], a[232:235], v[88:91]
TR a[108:109], v249, 9504
buffer_load_dwordx4 v[36:39], v25, s[12:15], s56 offen
MF v[92:95], a[80:83], a[236:239], v[92:95]
TR a[110:111], v249, 27936
global_load_lds_dwordx4 v9, s[8:9]
MF v[232:235], a[84:87], a[232:235], v[232:235]
TR a[80:81], v248, 320
s_add_u32 s8, s8, 294912
s_addc_u32 s9, s9, 0
MF v[236:239], a[84:87], a[236:239], v[236:239]
TR a[82:83], v248, 18752
MF v[96:99], a[88:91], a[232:235], v[96:99]
TR a[84:85], v248, 9536
MF v[100:103], a[88:91], a[236:239], v[100:103]
TR a[86:87], v248, 27968
MF v[240:243], a[92:95], a[232:235], v[240:243]
TR a[88:89], v249, 352
global_load_dwordx4 a[248:251], v25, s[30:31] sc1
MF v[244:247], a[92:95], a[236:239], v[244:247]
TR a[90:91], v249, 18784
s_waitcnt lgkmcnt(6)
MF v[104:107], a[96:99], a[232:235], v[104:107]
TR a[92:93], v249, 9568
MF v[108:111], a[96:99], a[236:239], v[108:111]
TR a[94:95], v249, 28000
MF a[0:3], a[100:103], a[232:235], a[0:3]
TR a[96:97], v248, 384
MF a[4:7], a[100:103], a[236:239], a[4:7]
TR a[98:99], v248, 18816
global_load_dwordx4 a[252:255], v26, s[30:31] sc1
MF v[112:115], a[104:107], a[232:235], v[112:115]
TR a[100:101], v248, 9600
s_add_u32 s30, s30, 1024
s_addc_u32 s31, s31, 0
MF v[116:119], a[104:107], a[236:239], v[116:119]
TR a[102:103], v248, 28032
MF a[8:11], a[108:111], a[232:235], a[8:11]
TR a[104:105], v249, 416
MF a[12:15], a[108:111], a[236:239], a[12:15]
TR a[106:107], v249, 18848
s_waitcnt lgkmcnt(6)
MF v[120:123], a[80:83], a[232:235], v[120:123]
TR a[108:109], v249, 9632
MF v[124:127], a[80:83], a[236:239], v[124:127]
TR a[110:111], v249, 28064
MF a[16:19], a[84:87], a[232:235], a[16:19]
TR a[80:81], v248, 448
MF a[20:23], a[84:87], a[236:239], a[20:23]
TR a[82:83], v248, 18880
MF v[128:131], a[88:91], a[232:235], v[128:131]
TR a[84:85], v248, 9664
MF v[132:135], a[88:91], a[236:239], v[132:135]
TR a[86:87], v248, 28096
MF a[24:27], a[92:95], a[232:235], a[24:27]
TR a[88:89], v249, 480
MF a[28:31], a[92:95], a[236:239], a[28:31]
TR a[90:91], v249, 18912
s_waitcnt lgkmcnt(6)
MF v[136:139], a[96:99], a[232:235], v[136:139]
TR a[92:93], v249, 9696
MF v[140:143], a[96:99], a[236:239], v[140:143]
TR a[94:95], v249, 28128
MF a[32:35], a[100:103], a[232:235], a[32:35]
TR a[96:97], v248, 512
MF a[36:39], a[100:103], a[236:239], a[36:39]
TR a[98:99], v248, 18944
MF v[144:147], a[104:107], a[232:235], v[144:147]
TR a[100:101], v248, 9728
MF v[148:151], a[104:107], a[236:239], v[148:151]
TR a[102:103], v248, 28160
MF a[40:43], a[108:111], a[232:235], a[40:43]
TR a[104:105], v249, 544
s_waitcnt vmcnt(14)
MF a[44:47], a[108:111], a[236:239], a[44:47]
TR a[106:107], v249, 18976
s_waitcnt lgkmcnt(6)
MF v[152:155], a[80:83], a[232:235], v[152:155]
TR a[108:109], v249, 9760
s_barrier
MF v[156:159], a[80:83], a[236:239], v[156:159]
TR a[110:111], v249, 28192
s_add_u32 s58, s34, s70
s_addc_u32 s59, s35, 0
MF a[48:51], a[84:87], a[232:235], a[48:51]
TR a[80:81], v19, 0
s_add_u32 m0, s28, 73728
MF a[52:55], a[84:87], a[236:239], a[52:55]
TR a[82:83], v19, 18432
global_load_lds_dwordx4 v10, s[58:59]
MF v[160:163], a[88:91], a[232:235], v[160:163]
TR a[84:85], v19, 9216
MF v[164:167], a[88:91], a[236:239], v[164:167]
TR a[86:87], v19, 27648
MF a[56:59], a[92:95], a[232:235], a[56:59]
TR a[88:89], v20, 32
global_load_lds_dwordx4 v11, s[58:59] offset:1024
MF a[60:63], a[92:95], a[236:239], a[60:63]
TR a[90:91], v20, 18464
s_waitcnt lgkmcnt(6)
MF v[168:171], a[96:99], a[232:235], v[168:171]
TR a[92:93], v20, 9248
MF v[172:175], a[96:99], a[236:239], v[172:175]
TR a[94:95], v20, 27680
MF a[64:67], a[100:103], a[232:235], a[64:67]
TR a[96:97], v19, 64
buffer_load_dwordx4 v[36:39], v26, s[20:23], s81 offen offset:1024
MF a[68:71], a[100:103], a[236:239], a[68:71]
TR a[98:99], v19, 18496
global_load_lds_dwordx4 v12, s[58:59] offset:2048
MF v[176:179], a[104:107], a[232:235], v[176:179]
TR a[100:101], v19, 9280
buffer_load_dword v254, v27, s[60:63], s66 offen sc1
MF v[180:183], a[104:107], a[236:239], v[180:183]
TR a[102:103], v19, 27712
v_add_u32 v248, 0x9000, v19
MF a[72:75], a[108:111], a[232:235], a[72:75]
TR a[104:105], v20, 96
v_add_u32 v249, 0x9000, v20
MF a[76:79], a[108:111], a[236:239], a[76:79]
TR a[106:107], v20, 18528
s_waitcnt lgkmcnt(6)
MF v[40:43], a[80:83], a[240:243], v[40:43]
TR a[108:109], v20, 9312
global_load_lds_dwordx4 v13, s[58:59] offset:3072
MF v[44:47], a[80:83], a[244:247], v[44:47]
TR a[110:111], v20, 27744
s_add_u32 m0, s28, 77824
MF v[184:187], a[84:87], a[240:243], v[184:187]
TR a[80:81], v19, 128
MF v[188:191], a[84:87], a[244:247], v[188:191]
TR a[82:83], v19, 18560
MF v[48:51], a[88:91], a[240:243], v[48:51]
TR a[84:85], v19, 9344
MF v[52:55], a[88:91], a[244:247], v[52:55]
TR a[86:87], v19, 27776
global_load_lds_dwordx4 v14, s[58:59]
MF v[192:195], a[92:95], a[240:243], v[192:195]
TR a[88:89], v20, 160
MF v[196:199], a[92:95], a[244:247], v[196:199]
TR a[90:91], v20, 18592
s_waitcnt lgkmcnt(6)
MF v[56:59], a[96:99], a[240:243], v[56:59]
TR a[92:93], v20, 9376
MF v[60:63], a[96:99], a[244:247], v[60:63]
TR a[94:95], v20, 27808
MF v[200:203], a[100:103], a[240:243], v[200:203]
TR a[96:97], v19, 192
global_load_lds_dwordx4 v15, s[58:59] offset:1024
MF v[204:207], a[100:103], a[244:247], v[204:207]
TR a[98:99], v19, 18624
MF v[64:67], a[104:107], a[240:243], v[64:67]
TR a[100:101], v19, 9408
MF v[68:71], a[104:107], a[244:247], v[68:71]
TR a[102:103], v19, 27840
MF v[208:211], a[108:111], a[240:243], v[208:211]
TR a[104:105], v20, 224
MF v[212:215], a[108:111], a[244:247], v[212:215]
TR a[106:107], v20, 18656
s_waitcnt lgkmcnt(6)
MF v[72:75], a[80:83], a[240:243], v[72:75]
TR a[108:109], v20, 9440
global_load_lds_dwordx4 v16, s[58:59] offset:2048
MF v[76:79], a[80:83], a[244:247], v[76:79]
TR a[110:111], v20, 27872
MF v[216:219], a[84:87], a[240:243], v[216:219]
TR a[80:81], v19, 256
MF v[220:223], a[84:87], a[244:247], v[220:223]
TR a[82:83], v19, 18688
MF v[80:83], a[88:91], a[240:243], v[80:83]
TR a[84:85], v19, 9472
global_load_lds_dwordx4 v17, s[58:59] offset:3072
MF v[84:87], a[88:91], a[244:247], v[84:87]
TR a[86:87], v19, 27904
s_add_u32 m0, s28, 81920
MF v[224:227], a[92:95], a[240:243], v[224:227]
TR a[88:89], v20, 288
MF v[228:231], a[92:95], a[244:247], v[228:231]
TR a[90:91], v20, 18720
s_waitcnt lgkmcnt(6)
MF v[88:91], a[96:99], a[240:243], v[88:91]
TR a[92:93], v20, 9504
MF v[92:95], a[96:99], a[244:247], v[92:95]
TR a[94:95], v20, 27936
global_load_lds_dwordx4 v18, s[58:59]
MF v[232:235], a[100:103], a[240:243], v[232:235]
TR a[96:97], v19, 320
s_add_u32 s70, s70, 128
MF v[236:239], a[100:103], a[244:247], v[236:239]
TR a[98:99], v19, 18752
s_cmp_eq_u32 s70, 1152
s_cselect_b32 s70, 0, s70
MF v[96:99], a[104:107], a[240:243], v[96:99]
TR a[100:101], v19, 9536
MF v[100:103], a[104:107], a[244:247], v[100:103]
TR a[102:103], v19, 27968
MF v[240:243], a[108:111], a[240:243], v[240:243]
TR a[104:105], v20, 352
MF v[244:247], a[108:111], a[244:247], v[244:247]
TR a[106:107], v20, 18784
s_waitcnt lgkmcnt(6)
MF v[104:107], a[80:83], a[240:243], v[104:107]
TR a[108:109], v20, 9568
MF v[108:111], a[80:83], a[244:247], v[108:111]
TR a[110:111], v20, 28000
MF a[0:3], a[84:87], a[240:243], a[0:3]
TR a[80:81], v19, 384
MF a[4:7], a[84:87], a[244:247], a[4:7]
TR a[82:83], v19, 18816
MF v[112:115], a[88:91], a[240:243], v[112:115]
TR a[84:85], v19, 9600
MF v[116:119], a[88:91], a[244:247], v[116:119]
TR a[86:87], v19, 28032
MF a[8:11], a[92:95], a[240:243], a[8:11]
TR a[88:89], v20, 416
MF a[12:15], a[92:95], a[244:247], a[12:15]
TR a[90:91], v20, 18848
s_waitcnt lgkmcnt(6)
MF v[120:123], a[96:99], a[240:243], v[120:123]
TR a[92:93], v20, 9632
MF v[124:127], a[96:99], a[244:247], v[124:127]
TR a[94:95], v20, 28064
MF a[16:19], a[100:103], a[240:243], a[16:19]
TR a[96:97], v19, 448
MF a[20:23], a[100:103], a[244:247], a[20:23]
TR a[98:99], v19, 18880
MF v[128:131], a[104:107], a[240:243], v[128:131]
TR a[100:101], v19, 9664
MF v[132:135], a[104:107], a[244:247], v[132:135]
TR a[102:103], v19, 28096
MF a[24:27], a[108:111], a[240:243], a[24:27]
TR a[104:105], v20, 480
MF a[28:31], a[108:111], a[244:247], a[28:31]
TR a[106:107], v20, 18912
s_waitcnt lgkmcnt(6)
MF v[136:139], a[80:83], a[240:243], v[136:139]
TR a[108:109], v20, 9696
MF v[140:143], a[80:83], a[244:247], v[140:143]
TR a[110:111], v20, 28128
MF a[32:35], a[84:87], a[240:243], a[32:35]
TR a[80:81], v19, 512
MF a[36:39], a[84:87], a[244:247], a[36:39]
TR a[82:83], v19, 18944
MF v[144:147], a[88:91], a[240:243], v[144:147]
TR a[84:85], v19, 9728
MF v[148:151], a[88:91], a[244:247], v[148:151]
TR a[86:87], v19, 28160
MF a[40:43], a[92:95], a[240:243], a[40:43]
TR a[88:89], v20, 544
s_waitcnt vmcnt(11)
MF a[44:47], a[92:95], a[244:247], a[44:47]
TR a[90:91], v20, 18976
s_waitcnt lgkmcnt(6)
MF v[152:155], a[96:99], a[240:243], v[152:155]
TR a[92:93], v20, 9760
s_barrier
MF v[156:159], a[96:99], a[244:247], v[156:159]
TR a[94:95], v20, 28192
s_add_u32 s58, s34, s70
s_addc_u32 s59, s35, 0
MF a[48:51], a[100:103], a[240:243], a[48:51]
TR a[96:97], v248, 0
s_add_u32 m0, s28, 110592
MF a[52:55], a[100:103], a[244:247], a[52:55]
TR a[98:99], v248, 18432
global_load_lds_dwordx4 v10, s[58:59]
MF v[160:163], a[104:107], a[240:243], v[160:163]
TR a[100:101], v248, 9216
MF v[164:167], a[104:107], a[244:247], v[164:167]
TR a[102:103], v248, 27648
MF a[56:59], a[108:111], a[240:243], a[56:59]
TR a[104:105], v249, 32
global_load_lds_dwordx4 v11, s[58:59] offset:1024
MF a[60:63], a[108:111], a[244:247], a[60:63]
TR a[106:107], v249, 18464
s_waitcnt lgkmcnt(6)
MF v[168:171], a[80:83], a[240:243], v[168:171]
TR a[108:109], v249, 9248
MF v[172:175], a[80:83], a[244:247], v[172:175]
TR a[110:111], v249, 27680
MF a[64:67], a[84:87], a[240:243], a[64:67]
TR a[80:81], v248, 64
MF a[68:71], a[84:87], a[244:247], a[68:71]
TR a[82:83], v248, 18496
global_load_lds_dwordx4 v12, s[58:59] offset:2048
MF v[176:179], a[88:91], a[240:243], v[176:179]
TR a[84:85], v248, 9280
MF v[180:183], a[88:91], a[244:247], v[180:183]
TR a[86:87], v248, 27712
MF a[72:75], a[92:95], a[240:243], a[72:75]
TR a[88:89], v249, 96
MF a[76:79], a[92:95], a[244:247], a[76:79]
TR a[90:91], v249, 18528
s_waitcnt lgkmcnt(6)
MF v[40:43], a[96:99], a[248:251], v[40:43]
TR a[92:93], v249, 9312
global_load_lds_dwordx4 v13, s[58:59] offset:3072
MF v[44:47], a[96:99], a[252:255], v[44:47]
TR a[94:95], v249, 27744
s_add_u32 m0, s28, 114688
MF v[184:187], a[100:103], a[248:251], v[184:187]
TR a[96:97], v248, 128
MF v[188:191], a[100:103], a[252:255], v[188:191]
TR a[98:99], v248, 18560
MF v[48:51], a[104:107], a[248:251], v[48:51]
TR a[100:101], v248, 9344
MF v[52:55], a[104:107], a[252:255], v[52:55]
TR a[102:103], v248, 27776
global_load_lds_dwordx4 v14, s[58:59]
MF v[192:195], a[108:111], a[248:251], v[192:195]
TR a[104:105], v249, 160
MF v[196:199], a[108:111], a[252:255], v[196:199]
TR a[106:107], v249, 18592
s_waitcnt lgkmcnt(6)
MF v[56:59], a[80:83], a[248:251], v[56:59]
TR a[108:109], v249, 9376
MF v[60:63], a[80:83], a[252:255], v[60:63]
TR a[110:111], v249, 27808
MF v[200:203], a[84:87], a[248:251], v[200:203]
TR a[80:81], v248, 192
global_load_lds_dwordx4 v15, s[58:59] offset:1024
MF v[204:207], a[84:87], a[252:255], v[204:207]
TR a[82:83], v248, 18624
MF v[64:67], a[88:91], a[248:251], v[64:67]
TR a[84:85], v248, 9408
MF v[68:71], a[88:91], a[252:255], v[68:71]
TR a[86:87], v248, 27840
MF v[208:211], a[92:95], a[248:251], v[208:211]
TR a[88:89], v249, 224
MF v[212:215], a[92:95], a[252:255], v[212:215]
TR a[90:91], v249, 18656
s_waitcnt lgkmcnt(6)
MF v[72:75], a[96:99], a[248:251], v[72:75]
TR a[92:93], v249, 9440
global_load_lds_dwordx4 v16, s[58:59] offset:2048
MF v[76:79], a[96:99], a[252:255], v[76:79]
TR a[94:95], v249, 27872
MF v[216:219], a[100:103], a[248:251], v[216:219]
TR a[96:97], v248, 256
MF v[220:223], a[100:103], a[252:255], v[220:223]
TR a[98:99], v248, 18688
MF v[80:83], a[104:107], a[248:251], v[80:83]
TR a[100:101], v248, 9472
global_load_lds_dwordx4 v17, s[58:59] offset:3072
MF v[84:87], a[104:107], a[252:255], v[84:87]
TR a[102:103], v248, 27904
s_add_u32 m0, s28, 118784
MF v[224:227], a[108:111], a[248:251], v[224:227]
TR a[104:105], v249, 288
MF v[228:231], a[108:111], a[252:255], v[228:231]
TR a[106:107], v249, 18720
s_waitcnt lgkmcnt(6)
MF v[88:91], a[80:83], a[248:251], v[88:91]
TR a[108:109], v249, 9504
MF v[92:95], a[80:83], a[252:255], v[92:95]
TR a[110:111], v249, 27936
global_load_lds_dwordx4 v18, s[58:59]
MF v[232:235], a[84:87], a[248:251], v[232:235]
TR a[80:81], v248, 320
s_add_u32 s70, s70, 128
MF v[236:239], a[84:87], a[252:255], v[236:239]
TR a[82:83], v248, 18752
s_cmp_eq_u32 s70, 1152
s_cselect_b32 s70, 0, s70
MF v[96:99], a[88:91], a[248:251], v[96:99]
TR a[84:85], v248, 9536
MF v[100:103], a[88:91], a[252:255], v[100:103]
TR a[86:87], v248, 27968
MF v[240:243], a[92:95], a[248:251], v[240:243]
TR a[88:89], v249, 352
MF v[244:247], a[92:95], a[252:255], v[244:247]
TR a[90:91], v249, 18784
s_waitcnt lgkmcnt(6)
MF v[104:107], a[96:99], a[248:251], v[104:107]
TR a[92:93], v249, 9568
MF v[108:111], a[96:99], a[252:255], v[108:111]
TR a[94:95], v249, 28000
MF a[0:3], a[100:103], a[248:251], a[0:3]
TR a[96:97], v248, 384
MF a[4:7], a[100:103], a[252:255], a[4:7]
TR a[98:99], v248, 18816
MF v[112:115], a[104:107], a[248:251], v[112:115]
TR a[100:101], v248, 9600
MF v[116:119], a[104:107], a[252:255], v[116:119]
TR a[102:103], v248, 28032
MF a[8:11], a[108:111], a[248:251], a[8:11]
TR a[104:105], v249, 416
MF a[12:15], a[108:111], a[252:255], a[12:15]
TR a[106:107], v249, 18848
s_waitcnt lgkmcnt(6)
MF v[120:123], a[80:83], a[248:251], v[120:123]
TR a[108:109], v249, 9632
MF v[124:127], a[80:83], a[252:255], v[124:127]
TR a[110:111], v249, 28064
MF a[16:19], a[84:87], a[248:251], a[16:19]
TR a[80:81], v248, 448
MF a[20:23], a[84:87], a[252:255], a[20:23]
TR a[82:83], v248, 18880
MF v[128:131], a[88:91], a[248:251], v[128:131]
TR a[84:85], v248, 9664
MF v[132:135], a[88:91], a[252:255], v[132:135]
TR a[86:87], v248, 28096
MF a[24:27], a[92:95], a[248:251], a[24:27]
TR a[88:89], v249, 480
MF a[28:31], a[92:95], a[252:255], a[28:31]
TR a[90:91], v249, 18912
s_waitcnt lgkmcnt(6)
MF v[136:139], a[96:99], a[248:251], v[136:139]
TR a[92:93], v249, 9696
MF v[140:143], a[96:99], a[252:255], v[140:143]
TR a[94:95], v249, 28128
MF a[32:35], a[100:103], a[248:251], a[32:35]
TR a[96:97], v248, 512
MF a[36:39], a[100:103], a[252:255], a[36:39]
TR a[98:99], v248, 18944
MF v[144:147], a[104:107], a[248:251], v[144:147]
TR a[100:101], v248, 9728
MF v[148:151], a[104:107], a[252:255], v[148:151]
TR a[102:103], v248, 28160
MF a[40:43], a[108:111], a[248:251], a[40:43]
TR a[104:105], v249, 544
s_waitcnt vmcnt(9)
MF a[44:47], a[108:111], a[252:255], a[44:47]
TR a[106:107], v249, 18976
s_waitcnt lgkmcnt(6)
MF v[152:155], a[80:83], a[248:251], v[152:155]
TR a[108:109], v249, 9760
s_barrier
MF v[156:159], a[80:83], a[252:255], v[156:159]
TR a[110:111], v249, 28192
s_add_u32 s58, s34, s70
s_addc_u32 s59, s35, 0
MF a[48:51], a[84:87], a[248:251], a[48:51]
TR a[80:81], v21, 0
s_add_u32 m0, s28, 0
MF a[52:55], a[84:87], a[252:255], a[52:55]
TR a[82:83], v21, 2048
global_load_lds_dwordx4 v10, s[58:59]
MF v[160:163], a[88:91], a[248:251], v[160:163]
TR a[84:85], v22, 0
MF v[164:167], a[88:91], a[252:255], v[164:167]
TR a[86:87], v22, 2048
MF a[56:59], a[92:95], a[248:251], a[56:59]
TR a[88:89], v21, 4096
global_load_lds_dwordx4 v11, s[58:59] offset:1024
MF a[60:63], a[92:95], a[252:255], a[60:63]
TR a[90:91], v21, 6144
s_waitcnt lgkmcnt(6)
MF v[168:171], a[96:99], a[248:251], v[168:171]
TR a[92:93], v22, 4096
MF v[172:175], a[96:99], a[252:255], v[172:175]
TR a[94:95], v22, 6144
MF a[64:67], a[100:103], a[248:251], a[64:67]
TR a[96:97], v21, 8192
MF a[68:71], a[100:103], a[252:255], a[68:71]
TR a[98:99], v21, 10240
global_load_lds_dwordx4 v12, s[58:59] offset:2048
MF v[176:179], a[104:107], a[248:251], v[176:179]
TR a[100:101], v22, 8192
MF v[180:183], a[104:107], a[252:255], v[180:183]
TR a[102:103], v22, 10240
v_add_u32 v250, 0x9000, v21
MF a[72:75], a[108:111], a[248:251], a[72:75]
TR a[104:105], v21, 12288
v_add_u32 v251, 0x9000, v22
MF a[76:79], a[108:111], a[252:255], a[76:79]
TR a[106:107], v21, 14336
v_max_f32 v40, 0, v40
v_max_f32 v41, 0, v41
v_max_f32 v42, 0, v42
v_max_f32 v43, 0, v43
v_pk_mul_f32 v[40:41], v[40:41], v[184:185]
v_pk_mul_f32 v[42:43], v[42:43], v[186:187]
v_cvt_pk_bf16_f32 v40, v40, v41
v_cvt_pk_bf16_f32 v41, v42, v43
v_max_f32 v48, 0, v48
v_max_f32 v49, 0, v49
v_max_f32 v50, 0, v50
v_max_f32 v51, 0, v51
v_pk_mul_f32 v[48:49], v[48:49], v[192:193]
v_pk_mul_f32 v[50:51], v[50:51], v[194:195]
v_cvt_pk_bf16_f32 v42, v48, v49
v_cvt_pk_bf16_f32 v43, v50, v51
v_max_f32 v44, 0, v44
v_max_f32 v45, 0, v45
v_max_f32 v46, 0, v46
v_max_f32 v47, 0, v47
v_pk_mul_f32 v[44:45], v[44:45], v[188:189]
v_pk_mul_f32 v[46:47], v[46:47], v[190:191]
v_cvt_pk_bf16_f32 v44, v44, v45
v_cvt_pk_bf16_f32 v45, v46, v47
v_max_f32 v52, 0, v52
v_max_f32 v53, 0, v53
v_max_f32 v54, 0, v54
v_max_f32 v55, 0, v55
v_pk_mul_f32 v[52:53], v[52:53], v[196:197]
v_pk_mul_f32 v[54:55], v[54:55], v[198:199]
v_cvt_pk_bf16_f32 v46, v52, v53
v_cvt_pk_bf16_f32 v47, v54, v55
v_max_f32 v56, 0, v56
v_max_f32 v57, 0, v57
v_max_f32 v58, 0, v58
v_max_f32 v59, 0, v59
v_pk_mul_f32 v[56:57], v[56:57], v[200:201]
v_pk_mul_f32 v[58:59], v[58:59], v[202:203]
v_cvt_pk_bf16_f32 v48, v56, v57
v_cvt_pk_bf16_f32 v49, v58, v59
v_max_f32 v64, 0, v64
v_max_f32 v65, 0, v65
v_max_f32 v66, 0, v66
v_max_f32 v67, 0, v67
v_pk_mul_f32 v[64:65], v[64:65], v[208:209]
v_pk_mul_f32 v[66:67], v[66:67], v[210:211]
v_cvt_pk_bf16_f32 v50, v64, v65
v_cvt_pk_bf16_f32 v51, v66, v67
v_max_f32 v60, 0, v60
v_max_f32 v61, 0, v61
v_max_f32 v62, 0, v62
v_max_f32 v63, 0, v63
v_pk_mul_f32 v[60:61], v[60:61], v[204:205]
v_pk_mul_f32 v[62:63], v[62:63], v[206:207]
v_cvt_pk_bf16_f32 v52, v60, v61
v_cvt_pk_bf16_f32 v53, v62, v63
v_max_f32 v68, 0, v68
v_max_f32 v69, 0, v69
v_max_f32 v70, 0, v70
v_max_f32 v71, 0, v71
v_pk_mul_f32 v[68:69], v[68:69], v[212:213]
v_pk_mul_f32 v[70:71], v[70:71], v[214:215]
v_cvt_pk_bf16_f32 v54, v68, v69
v_cvt_pk_bf16_f32 v55, v70, v71
v_max_f32 v72, 0, v72
v_max_f32 v73, 0, v73
v_max_f32 v74, 0, v74
v_max_f32 v75, 0, v75
v_pk_mul_f32 v[72:73], v[72:73], v[216:217]
v_pk_mul_f32 v[74:75], v[74:75], v[218:219]
v_cvt_pk_bf16_f32 v56, v72, v73
v_cvt_pk_bf16_f32 v57, v74, v75
v_max_f32 v80, 0, v80
v_max_f32 v81, 0, v81
v_max_f32 v82, 0, v82
v_max_f32 v83, 0, v83
v_pk_mul_f32 v[80:81], v[80:81], v[224:225]
v_pk_mul_f32 v[82:83], v[82:83], v[226:227]
v_cvt_pk_bf16_f32 v58, v80, v81
v_cvt_pk_bf16_f32 v59, v82, v83
v_max_f32 v76, 0, v76
v_max_f32 v77, 0, v77
v_max_f32 v78, 0, v78
v_max_f32 v79, 0, v79
v_pk_mul_f32 v[76:77], v[76:77], v[220:221]
v_pk_mul_f32 v[78:79], v[78:79], v[222:223]
v_cvt_pk_bf16_f32 v60, v76, v77
v_cvt_pk_bf16_f32 v61, v78, v79
v_max_f32 v84, 0, v84
v_max_f32 v85, 0, v85
v_max_f32 v86, 0, v86
v_max_f32 v87, 0, v87
v_pk_mul_f32 v[84:85], v[84:85], v[228:229]
v_pk_mul_f32 v[86:87], v[86:87], v[230:231]
v_cvt_pk_bf16_f32 v62, v84, v85
v_cvt_pk_bf16_f32 v63, v86, v87
v_max_f32 v88, 0, v88
v_max_f32 v89, 0, v89
v_max_f32 v90, 0, v90
v_max_f32 v91, 0, v91
v_pk_mul_f32 v[88:89], v[88:89], v[232:233]
v_pk_mul_f32 v[90:91], v[90:91], v[234:235]
v_cvt_pk_bf16_f32 v64, v88, v89
v_cvt_pk_bf16_f32 v65, v90, v91
v_max_f32 v96, 0, v96
v_max_f32 v97, 0, v97
v_max_f32 v98, 0, v98
v_max_f32 v99, 0, v99
v_pk_mul_f32 v[96:97], v[96:97], v[240:241]
v_pk_mul_f32 v[98:99], v[98:99], v[242:243]
v_cvt_pk_bf16_f32 v66, v96, v97
v_cvt_pk_bf16_f32 v67, v98, v99
v_max_f32 v92, 0, v92
v_max_f32 v93, 0, v93
v_max_f32 v94, 0, v94
v_max_f32 v95, 0, v95
v_pk_mul_f32 v[92:93], v[92:93], v[236:237]
v_pk_mul_f32 v[94:95], v[94:95], v[238:239]
v_cvt_pk_bf16_f32 v68, v92, v93
v_cvt_pk_bf16_f32 v69, v94, v95
v_max_f32 v100, 0, v100
v_max_f32 v101, 0, v101
v_max_f32 v102, 0, v102
v_max_f32 v103, 0, v103
v_pk_mul_f32 v[100:101], v[100:101], v[244:245]
v_pk_mul_f32 v[102:103], v[102:103], v[246:247]
v_cvt_pk_bf16_f32 v70, v100, v101
v_cvt_pk_bf16_f32 v71, v102, v103
v_accvgpr_read_b32 v32, a0
v_accvgpr_read_b32 v33, a1
v_accvgpr_read_b32 v34, a2
v_accvgpr_read_b32 v35, a3
v_max_f32 v104, 0, v104
v_max_f32 v105, 0, v105
v_max_f32 v106, 0, v106
v_max_f32 v107, 0, v107
v_pk_mul_f32 v[104:105], v[104:105], v[32:33]
v_pk_mul_f32 v[106:107], v[106:107], v[34:35]
v_cvt_pk_bf16_f32 v72, v104, v105
v_cvt_pk_bf16_f32 v73, v106, v107
v_accvgpr_read_b32 v32, a8
v_accvgpr_read_b32 v33, a9
v_accvgpr_read_b32 v34, a10
v_accvgpr_read_b32 v35, a11
v_max_f32 v112, 0, v112
v_max_f32 v113, 0, v113
v_max_f32 v114, 0, v114
v_max_f32 v115, 0, v115
v_pk_mul_f32 v[112:113], v[112:113], v[32:33]
v_pk_mul_f32 v[114:115], v[114:115], v[34:35]
v_cvt_pk_bf16_f32 v74, v112, v113
v_cvt_pk_bf16_f32 v75, v114, v115
v_accvgpr_read_b32 v32, a4
v_accvgpr_read_b32 v33, a5
v_accvgpr_read_b32 v34, a6
v_accvgpr_read_b32 v35, a7
v_max_f32 v108, 0, v108
v_max_f32 v109, 0, v109
v_max_f32 v110, 0, v110
v_max_f32 v111, 0, v111
v_pk_mul_f32 v[108:109], v[108:109], v[32:33]
v_pk_mul_f32 v[110:111], v[110:111], v[34:35]
v_cvt_pk_bf16_f32 v76, v108, v109
v_cvt_pk_bf16_f32 v77, v110, v111
v_accvgpr_read_b32 v32, a12
v_accvgpr_read_b32 v33, a13
v_accvgpr_read_b32 v34, a14
v_accvgpr_read_b32 v35, a15
v_max_f32 v116, 0, v116
v_max_f32 v117, 0, v117
v_max_f32 v118, 0, v118
v_max_f32 v119, 0, v119
v_pk_mul_f32 v[116:117], v[116:117], v[32:33]
v_pk_mul_f32 v[118:119], v[118:119], v[34:35]
v_cvt_pk_bf16_f32 v78, v116, v117
v_cvt_pk_bf16_f32 v79, v118, v119
v_accvgpr_read_b32 v32, a16
v_accvgpr_read_b32 v33, a17
v_accvgpr_read_b32 v34, a18
v_accvgpr_read_b32 v35, a19
v_max_f32 v120, 0, v120
v_max_f32 v121, 0, v121
v_max_f32 v122, 0, v122
v_max_f32 v123, 0, v123
v_pk_mul_f32 v[120:121], v[120:121], v[32:33]
v_pk_mul_f32 v[122:123], v[122:123], v[34:35]
v_cvt_pk_bf16_f32 v80, v120, v121
v_cvt_pk_bf16_f32 v81, v122, v123
v_accvgpr_read_b32 v32, a24
v_accvgpr_read_b32 v33, a25
v_accvgpr_read_b32 v34, a26
v_accvgpr_read_b32 v35, a27
v_max_f32 v128, 0, v128
v_max_f32 v129, 0, v129
v_max_f32 v130, 0, v130
v_max_f32 v131, 0, v131
v_pk_mul_f32 v[128:129], v[128:129], v[32:33]
v_pk_mul_f32 v[130:131], v[130:131], v[34:35]
v_cvt_pk_bf16_f32 v82, v128, v129
v_cvt_pk_bf16_f32 v83, v130, v131
v_accvgpr_read_b32 v32, a20
v_accvgpr_read_b32 v33, a21
v_accvgpr_read_b32 v34, a22
v_accvgpr_read_b32 v35, a23
v_max_f32 v124, 0, v124
v_max_f32 v125, 0, v125
v_max_f32 v126, 0, v126
v_max_f32 v127, 0, v127
v_pk_mul_f32 v[124:125], v[124:125], v[32:33]
v_pk_mul_f32 v[126:127], v[126:127], v[34:35]
v_cvt_pk_bf16_f32 v84, v124, v125
v_cvt_pk_bf16_f32 v85, v126, v127
v_accvgpr_read_b32 v32, a28
v_accvgpr_read_b32 v33, a29
v_accvgpr_read_b32 v34, a30
v_accvgpr_read_b32 v35, a31
v_max_f32 v132, 0, v132
v_max_f32 v133, 0, v133
v_max_f32 v134, 0, v134
v_max_f32 v135, 0, v135
v_pk_mul_f32 v[132:133], v[132:133], v[32:33]
v_pk_mul_f32 v[134:135], v[134:135], v[34:35]
v_cvt_pk_bf16_f32 v86, v132, v133
v_cvt_pk_bf16_f32 v87, v134, v135
v_accvgpr_read_b32 v32, a32
v_accvgpr_read_b32 v33, a33
v_accvgpr_read_b32 v34, a34
v_accvgpr_read_b32 v35, a35
v_max_f32 v136, 0, v136
v_max_f32 v137, 0, v137
v_max_f32 v138, 0, v138
v_max_f32 v139, 0, v139
v_pk_mul_f32 v[136:137], v[136:137], v[32:33]
v_pk_mul_f32 v[138:139], v[138:139], v[34:35]
v_cvt_pk_bf16_f32 v88, v136, v137
v_cvt_pk_bf16_f32 v89, v138, v139
v_accvgpr_read_b32 v32, a40
v_accvgpr_read_b32 v33, a41
v_accvgpr_read_b32 v34, a42
v_accvgpr_read_b32 v35, a43
v_max_f32 v144, 0, v144
v_max_f32 v145, 0, v145
v_max_f32 v146, 0, v146
v_max_f32 v147, 0, v147
v_pk_mul_f32 v[144:145], v[144:145], v[32:33]
v_pk_mul_f32 v[146:147], v[146:147], v[34:35]
v_cvt_pk_bf16_f32 v90, v144, v145
v_cvt_pk_bf16_f32 v91, v146, v147
v_accvgpr_read_b32 v32, a36
v_accvgpr_read_b32 v33, a37
v_accvgpr_read_b32 v34, a38
v_accvgpr_read_b32 v35, a39
v_max_f32 v140, 0, v140
v_max_f32 v141, 0, v141
v_max_f32 v142, 0, v142
v_max_f32 v143, 0, v143
v_pk_mul_f32 v[140:141], v[140:141], v[32:33]
v_pk_mul_f32 v[142:143], v[142:143], v[34:35]
v_cvt_pk_bf16_f32 v92, v140, v141
v_cvt_pk_bf16_f32 v93, v142, v143
v_accvgpr_read_b32 v32, a44
v_accvgpr_read_b32 v33, a45
v_accvgpr_read_b32 v34, a46
v_accvgpr_read_b32 v35, a47
v_max_f32 v148, 0, v148
v_max_f32 v149, 0, v149
v_max_f32 v150, 0, v150
v_max_f32 v151, 0, v151
v_pk_mul_f32 v[148:149], v[148:149], v[32:33]
v_pk_mul_f32 v[150:151], v[150:151], v[34:35]
v_cvt_pk_bf16_f32 v94, v148, v149
v_cvt_pk_bf16_f32 v95, v150, v151
v_accvgpr_read_b32 v32, a48
v_accvgpr_read_b32 v33, a49
v_accvgpr_read_b32 v34, a50
v_accvgpr_read_b32 v35, a51
v_max_f32 v152, 0, v152
v_max_f32 v153, 0, v153
v_max_f32 v154, 0, v154
v_max_f32 v155, 0, v155
v_pk_mul_f32 v[152:153], v[152:153], v[32:33]
v_pk_mul_f32 v[154:155], v[154:155], v[34:35]
v_cvt_pk_bf16_f32 v96, v152, v153
v_cvt_pk_bf16_f32 v97, v154, v155
v_accvgpr_read_b32 v32, a56
v_accvgpr_read_b32 v33, a57
v_accvgpr_read_b32 v34, a58
v_accvgpr_read_b32 v35, a59
v_max_f32 v160, 0, v160
v_max_f32 v161, 0, v161
v_max_f32 v162, 0, v162
v_max_f32 v163, 0, v163
v_pk_mul_f32 v[160:161], v[160:161], v[32:33]
v_pk_mul_f32 v[162:163], v[162:163], v[34:35]
v_cvt_pk_bf16_f32 v98, v160, v161
v_cvt_pk_bf16_f32 v99, v162, v163
v_accvgpr_read_b32 v32, a52
v_accvgpr_read_b32 v33, a53
v_accvgpr_read_b32 v34, a54
v_accvgpr_read_b32 v35, a55
v_max_f32 v156, 0, v156
v_max_f32 v157, 0, v157
v_max_f32 v158, 0, v158
v_max_f32 v159, 0, v159
v_pk_mul_f32 v[156:157], v[156:157], v[32:33]
v_pk_mul_f32 v[158:159], v[158:159], v[34:35]
v_cvt_pk_bf16_f32 v100, v156, v157
v_cvt_pk_bf16_f32 v101, v158, v159
v_accvgpr_read_b32 v32, a60
v_accvgpr_read_b32 v33, a61
v_accvgpr_read_b32 v34, a62
v_accvgpr_read_b32 v35, a63
v_max_f32 v164, 0, v164
v_max_f32 v165, 0, v165
v_max_f32 v166, 0, v166
v_max_f32 v167, 0, v167
v_pk_mul_f32 v[164:165], v[164:165], v[32:33]
v_pk_mul_f32 v[166:167], v[166:167], v[34:35]
v_cvt_pk_bf16_f32 v102, v164, v165
v_cvt_pk_bf16_f32 v103, v166, v167
v_accvgpr_read_b32 v32, a64
v_accvgpr_read_b32 v33, a65
v_accvgpr_read_b32 v34, a66
v_accvgpr_read_b32 v35, a67
v_max_f32 v168, 0, v168
v_max_f32 v169, 0, v169
v_max_f32 v170, 0, v170
v_max_f32 v171, 0, v171
v_pk_mul_f32 v[168:169], v[168:169], v[32:33]
v_pk_mul_f32 v[170:171], v[170:171], v[34:35]
v_cvt_pk_bf16_f32 v104, v168, v169
v_cvt_pk_bf16_f32 v105, v170, v171
v_accvgpr_read_b32 v32, a72
v_accvgpr_read_b32 v33, a73
v_accvgpr_read_b32 v34, a74
v_accvgpr_read_b32 v35, a75
v_max_f32 v176, 0, v176
v_max_f32 v177, 0, v177
v_max_f32 v178, 0, v178
v_max_f32 v179, 0, v179
v_pk_mul_f32 v[176:177], v[176:177], v[32:33]
v_pk_mul_f32 v[178:179], v[178:179], v[34:35]
v_cvt_pk_bf16_f32 v106, v176, v177
v_cvt_pk_bf16_f32 v107, v178, v179
v_accvgpr_read_b32 v32, a68
v_accvgpr_read_b32 v33, a69
v_accvgpr_read_b32 v34, a70
v_accvgpr_read_b32 v35, a71
v_max_f32 v172, 0, v172
v_max_f32 v173, 0, v173
v_max_f32 v174, 0, v174
v_max_f32 v175, 0, v175
v_pk_mul_f32 v[172:173], v[172:173], v[32:33]
v_pk_mul_f32 v[174:175], v[174:175], v[34:35]
v_cvt_pk_bf16_f32 v108, v172, v173
v_cvt_pk_bf16_f32 v109, v174, v175
v_accvgpr_read_b32 v32, a76
v_accvgpr_read_b32 v33, a77
v_accvgpr_read_b32 v34, a78
v_accvgpr_read_b32 v35, a79
v_max_f32 v180, 0, v180
v_max_f32 v181, 0, v181
v_max_f32 v182, 0, v182
v_max_f32 v183, 0, v183
v_pk_mul_f32 v[180:181], v[180:181], v[32:33]
v_pk_mul_f32 v[182:183], v[182:183], v[34:35]
v_cvt_pk_bf16_f32 v110, v180, v181
v_cvt_pk_bf16_f32 v111, v182, v183
v_lshrrev_b32 v32, 4, v28
v_bfe_u32 v33, v28, 2, 2
v_cmp_eq_u32 vcc, v32, v33
v_and_b32 v32, 1, v28
v_lshlrev_b32 v32, 4, v32
v_mov_b32 v33, 0x3f80
v_lshlrev_b32 v32, v32, v33
v_cndmask_b32 v32, 0, v32, vcc
v_and_b32 v33, 2, v28
v_cmp_eq_u32 vcc, 0, v33
v_mov_b32 v152, 0
v_mov_b32 v153, 0
v_cndmask_b32 v154, 0, v32, vcc
v_cndmask_b32 v155, v32, 0, vcc
v_mov_b32 v156, 0
v_mov_b32 v157, 0
s_waitcnt lgkmcnt(6)
MF v[184:187], a[80:83], v[40:43], 0
TR a[108:109], v22, 12288
global_load_lds_dwordx4 v13, s[58:59] offset:3072
MF v[188:191], a[80:83], v[44:47], 0
TR a[110:111], v22, 14336
s_add_u32 m0, s28, 4096
MF v[192:195], a[84:87], v[40:43], 0
TR a[80:81], v21, 16384
v_add_u32 v252, 0x9000, v23
MF v[196:199], a[84:87], v[44:47], 0
TR a[82:83], v21, 18432
v_add_u32 v253, 0x9000, v24
MF v[184:187], a[88:91], v[48:51], v[184:187]
TR a[84:85], v22, 16384
MF v[188:191], a[88:91], v[52:55], v[188:191]
TR a[86:87], v22, 18432
global_load_lds_dwordx4 v14, s[58:59]
MF v[192:195], a[92:95], v[48:51], v[192:195]
TR a[88:89], v23, 0
MF v[196:199], a[92:95], v[52:55], v[196:199]
TR a[90:91], v23, 2048
s_waitcnt lgkmcnt(6)
MF v[184:187], a[96:99], v[56:59], v[184:187]
TR a[92:93], v24, 0
MF v[188:191], a[96:99], v[60:63], v[188:191]
TR a[94:95], v24, 2048
MF v[192:195], a[100:103], v[56:59], v[192:195]
TR a[96:97], v23, 4096
global_load_lds_dwordx4 v15, s[58:59] offset:1024
MF v[196:199], a[100:103], v[60:63], v[196:199]
TR a[98:99], v23, 6144
MF v[184:187], a[104:107], v[64:67], v[184:187]
TR a[100:101], v24, 4096
MF v[188:191], a[104:107], v[68:71], v[188:191]
TR a[102:103], v24, 6144
MF v[192:195], a[108:111], v[64:67], v[192:195]
TR a[104:105], v23, 8192
MF v[196:199], a[108:111], v[68:71], v[196:199]
TR a[106:107], v23, 10240
s_waitcnt lgkmcnt(6)
MF v[184:187], a[80:83], v[72:75], v[184:187]
TR a[108:109], v24, 8192
global_load_lds_dwordx4 v16, s[58:59] offset:2048
MF v[188:191], a[80:83], v[76:79], v[188:191]
TR a[110:111], v24, 10240
MF v[192:195], a[84:87], v[72:75], v[192:195]
TR a[80:81], v23, 12288
v_readfirstlane_b32 s68, v254
MF v[196:199], a[84:87], v[76:79], v[196:199]
TR a[82:83], v23, 14336
s_nop 0
s_cmp_eq_u32 s68, s67
s_cselect_b64 vcc, 0, -1
MF v[200:203], a[88:91], v[40:43], 0
TR a[84:85], v24, 12288
global_load_lds_dwordx4 v17, s[58:59] offset:3072
MF v[204:207], a[88:91], v[44:47], 0
TR a[86:87], v24, 14336
s_add_u32 m0, s28, 8192
MF v[208:211], a[92:95], v[40:43], 0
TR a[88:89], v23, 16384
MF v[212:215], a[92:95], v[44:47], 0
TR a[90:91], v23, 18432
s_waitcnt lgkmcnt(6)
MF v[200:203], a[96:99], v[48:51], v[200:203]
TR a[92:93], v24, 16384
MF v[204:207], a[96:99], v[52:55], v[204:207]
TR a[94:95], v24, 18432
global_load_lds_dwordx4 v18, s[58:59]
MF v[208:211], a[100:103], v[48:51], v[208:211]
TR a[96:97], v21, 20480
s_add_u32 s70, s70, 128
MF v[212:215], a[100:103], v[52:55], v[212:215]
TR a[98:99], v21, 22528
s_cmp_eq_u32 s70, 1152
s_cselect_b32 s70, 0, s70
MF v[200:203], a[104:107], v[56:59], v[200:203]
TR a[100:101], v22, 20480
MF v[204:207], a[104:107], v[60:63], v[204:207]
TR a[102:103], v22, 22528
MF v[208:211], a[108:111], v[56:59], v[208:211]
TR a[104:105], v21, 24576
MF v[212:215], a[108:111], v[60:63], v[212:215]
TR a[106:107], v21, 26624
s_waitcnt lgkmcnt(6)
MF v[200:203], a[80:83], v[64:67], v[200:203]
TR a[108:109], v22, 24576
MF v[204:207], a[80:83], v[68:71], v[204:207]
TR a[110:111], v22, 26624
MF v[208:211], a[84:87], v[64:67], v[208:211]
TR a[80:81], v21, 28672
MF v[212:215], a[84:87], v[68:71], v[212:215]
TR a[82:83], v21, 30720
MF v[200:203], a[88:91], v[72:75], v[200:203]
TR a[84:85], v22, 28672
MF v[204:207], a[88:91], v[76:79], v[204:207]
TR a[86:87], v22, 30720
MF v[208:211], a[92:95], v[72:75], v[208:211]
TR a[88:89], v21, 32768
MF v[212:215], a[92:95], v[76:79], v[212:215]
TR a[90:91], v21, 34816
s_waitcnt lgkmcnt(6)
MF v[184:187], a[96:99], v[80:83], v[184:187]
TR a[92:93], v22, 32768
MF v[188:191], a[96:99], v[84:87], v[188:191]
TR a[94:95], v22, 34816
MF v[192:195], a[100:103], v[80:83], v[192:195]
TR a[96:97], v23, 20480
MF v[196:199], a[100:103], v[84:87], v[196:199]
TR a[98:99], v23, 22528
MF v[184:187], a[104:107], v[88:91], v[184:187]
TR a[100:101], v24, 20480
MF v[188:191], a[104:107], v[92:95], v[188:191]
TR a[102:103], v24, 22528
MF v[192:195], a[108:111], v[88:91], v[192:195]
TR a[104:105], v23, 24576
MF v[196:199], a[108:111], v[92:95], v[196:199]
TR a[106:107], v23, 26624
s_waitcnt lgkmcnt(6)
MF v[184:187], a[80:83], v[96:99], v[184:187]
TR a[108:109], v24, 24576
MF v[188:191], a[80:83], v[100:103], v[188:191]
TR a[110:111], v24, 26624
MF v[192:195], a[84:87], v[96:99], v[192:195]
TR a[80:81], v23, 28672
MF v[196:199], a[84:87], v[100:103], v[196:199]
TR a[82:83], v23, 30720
MF v[184:187], a[88:91], v[104:107], v[184:187]
TR a[84:85], v24, 28672
MF v[188:191], a[88:91], v[108:111], v[188:191]
TR a[86:87], v24, 30720
MF v[192:195], a[92:95], v[104:107], v[192:195]
TR a[88:89], v23, 32768
s_waitcnt vmcnt(9)
MF v[196:199], a[92:95], v[108:111], v[196:199]
TR a[90:91], v23, 34816
s_waitcnt lgkmcnt(6)
MF v[200:203], a[96:99], v[80:83], v[200:203]
TR a[92:93], v24, 32768
s_barrier
MF v[204:207], a[96:99], v[84:87], v[204:207]
TR a[94:95], v24, 34816
s_add_u32 s58, s34, s70
s_addc_u32 s59, s35, 0
MF v[208:211], a[100:103], v[80:83], v[208:211]
TR a[96:97], v250, 0
s_add_u32 m0, s28, 36864
MF v[212:215], a[100:103], v[84:87], v[212:215]
TR a[98:99], v250, 2048
global_load_lds_dwordx4 v10, s[58:59]
MF v[200:203], a[104:107], v[88:91], v[200:203]
TR a[100:101], v251, 0
v_cvt_pk_bf16_f32 v216, v184, v185
MF v[204:207], a[104:107], v[92:95], v[204:207]
TR a[102:103], v251, 2048
v_cvt_pk_bf16_f32 v217, v186, v187
MF v[208:211], a[108:111], v[88:91], v[208:211]
TR a[104:105], v250, 4096
global_load_lds_dwordx4 v11, s[58:59] offset:1024
MF v[212:215], a[108:111], v[92:95], v[212:215]
TR a[106:107], v250, 6144
s_waitcnt lgkmcnt(6)
MF v[200:203], a[80:83], v[96:99], v[200:203]
TR a[108:109], v251, 4096
v_cvt_pk_bf16_f32 v218, v192, v193
MF v[204:207], a[80:83], v[100:103], v[204:207]
TR a[110:111], v251, 6144
v_cvt_pk_bf16_f32 v219, v194, v195
MF v[208:211], a[84:87], v[96:99], v[208:211]
TR a[80:81], v250, 8192
s_cbranch_vccnz kb_kernel_pa11
buffer_store_dwordx4 v[216:219], v25, s[20:23], s72 offen
kb_kernel_pb12:
MF v[212:215], a[84:87], v[100:103], v[212:215]
TR a[82:83], v250, 10240
global_load_lds_dwordx4 v12, s[58:59] offset:2048
MF v[200:203], a[88:91], v[104:107], v[200:203]
TR a[84:85], v251, 8192
v_cvt_pk_bf16_f32 v220, v188, v189
MF v[204:207], a[88:91], v[108:111], v[204:207]
TR a[86:87], v251, 10240
v_cvt_pk_bf16_f32 v221, v190, v191
MF v[208:211], a[92:95], v[104:107], v[208:211]
TR a[88:89], v250, 12288
v_cvt_pk_bf16_f32 v222, v196, v197
MF v[212:215], a[92:95], v[108:111], v[212:215]
TR a[90:91], v250, 14336
v_cvt_pk_bf16_f32 v223, v198, v199
s_waitcnt lgkmcnt(6)
MF v[184:187], a[96:99], v[40:43], 0
TR a[92:93], v251, 12288
MF v[188:191], a[96:99], v[44:47], 0
TR a[94:95], v251, 14336
global_load_lds_dwordx4 v13, s[58:59] offset:3072
MF v[192:195], a[100:103], v[40:43], 0
TR a[96:97], v250, 16384
s_add_u32 m0, s28, 40960
MF v[196:199], a[100:103], v[44:47], 0
TR a[98:99], v250, 18432
s_cbranch_vccnz kb_kernel_pa13
buffer_store_dwordx4 v[220:223], v26, s[20:23], s72 offen
kb_kernel_pb14:
MF v[184:187], a[104:107], v[48:51], v[184:187]
TR a[100:101], v251, 16384
v_cvt_pk_bf16_f32 v224, v200, v201
MF v[188:191], a[104:107], v[52:55], v[188:191]
TR a[102:103], v251, 18432
global_load_lds_dwordx4 v14, s[58:59]
MF v[192:195], a[108:111], v[48:51], v[192:195]
TR a[104:105], v252, 0
v_cvt_pk_bf16_f32 v225, v202, v203
MF v[196:199], a[108:111], v[52:55], v[196:199]
TR a[106:107], v252, 2048
s_waitcnt lgkmcnt(6)
MF v[184:187], a[80:83], v[56:59], v[184:187]
TR a[108:109], v253, 0
v_cvt_pk_bf16_f32 v226, v208, v209
MF v[188:191], a[80:83], v[60:63], v[188:191]
TR a[110:111], v253, 2048
v_cvt_pk_bf16_f32 v227, v210, v211
MF v[192:195], a[84:87], v[56:59], v[192:195]
TR a[80:81], v252, 4096
global_load_lds_dwordx4 v15, s[58:59] offset:1024
MF v[196:199], a[84:87], v[60:63], v[196:199]
TR a[82:83], v252, 6144
s_cbranch_vccnz kb_kernel_pa15
buffer_store_dwordx4 v[224:227], v25, s[20:23], s72 offen offset:1024
kb_kernel_pb16:
MF v[184:187], a[88:91], v[64:67], v[184:187]
TR a[84:85], v253, 4096
v_cvt_pk_bf16_f32 v228, v204, v205
MF v[188:191], a[88:91], v[68:71], v[188:191]
TR a[86:87], v253, 6144
v_cvt_pk_bf16_f32 v229, v206, v207
MF v[192:195], a[92:95], v[64:67], v[192:195]
TR a[88:89], v252, 8192
v_cvt_pk_bf16_f32 v230, v212, v213
MF v[196:199], a[92:95], v[68:71], v[196:199]
TR a[90:91], v252, 10240
s_waitcnt lgkmcnt(6)
MF v[184:187], a[96:99], v[72:75], v[184:187]
TR a[92:93], v253, 8192
global_load_lds_dwordx4 v16, s[58:59] offset:2048
MF v[188:191], a[96:99], v[76:79], v[188:191]
TR a[94:95], v253, 10240
v_cvt_pk_bf16_f32 v231, v214, v215
MF v[192:195], a[100:103], v[72:75], v[192:195]
TR a[96:97], v252, 12288
s_cbranch_vccnz kb_kernel_pa17
buffer_store_dwordx4 v[228:231], v26, s[20:23], s72 offen offset:1024
kb_kernel_pb18:
MF v[196:199], a[100:103], v[76:79], v[196:199]
TR a[98:99], v252, 14336
v_add_u32 v21, 0xfffe5000, v250
MF v[200:203], a[104:107], v[40:43], 0
TR a[100:101], v253, 12288
global_load_lds_dwordx4 v17, s[58:59] offset:3072
MF v[204:207], a[104:107], v[44:47], 0
TR a[102:103], v253, 14336
s_add_u32 m0, s28, 45056
MF v[208:211], a[108:111], v[40:43], 0
TR a[104:105], v252, 16384
v_add_u32 v22, 0xfffe5000, v251
MF v[212:215], a[108:111], v[44:47], 0
TR a[106:107], v252, 18432
s_waitcnt lgkmcnt(6)
MF v[200:203], a[80:83], v[48:51], v[200:203]
TR a[108:109], v253, 16384
v_add_u32 v23, 0xfffe5000, v252
MF v[204:207], a[80:83], v[52:55], v[204:207]
TR a[110:111], v253, 18432
global_load_lds_dwordx4 v18, s[58:59]
MF v[208:211], a[84:87], v[48:51], v[208:211]
TR a[80:81], v250, 20480
s_add_u32 s70, s70, 128
MF v[212:215], a[84:87], v[52:55], v[212:215]
TR a[82:83], v250, 22528
s_cmp_eq_u32 s70, 1152
s_cselect_b32 s70, 0, s70
MF v[200:203], a[88:91], v[56:59], v[200:203]
TR a[84:85], v251, 20480
v_add_u32 v24, 0xfffe5000, v253
MF v[204:207], a[88:91], v[60:63], v[204:207]
TR a[86:87], v251, 22528
MF v[208:211], a[92:95], v[56:59], v[208:211]
TR a[88:89], v250, 24576
MF v[212:215], a[92:95], v[60:63], v[212:215]
TR a[90:91], v250, 26624
s_waitcnt lgkmcnt(6)
MF v[200:203], a[96:99], v[64:67], v[200:203]
TR a[92:93], v251, 24576
MF v[204:207], a[96:99], v[68:71], v[204:207]
TR a[94:95], v251, 26624
MF v[208:211], a[100:103], v[64:67], v[208:211]
TR a[96:97], v250, 28672
MF v[212:215], a[100:103], v[68:71], v[212:215]
TR a[98:99], v250, 30720
MF v[200:203], a[104:107], v[72:75], v[200:203]
TR a[100:101], v251, 28672
v_mov_b32 v255, 1
MF v[204:207], a[104:107], v[76:79], v[204:207]
TR a[102:103], v251, 30720
MF v[208:211], a[108:111], v[72:75], v[208:211]
TR a[104:105], v250, 32768
MF v[212:215], a[108:111], v[76:79], v[212:215]
TR a[106:107], v250, 34816
s_waitcnt vmcnt(2)
s_waitcnt lgkmcnt(6)
MF v[184:187], a[80:83], v[80:83], v[184:187]
TR a[108:109], v251, 32768
s_cbranch_vccnz kb_kernel_pa19
buffer_store_dword v255, v27, s[60:63], s64 offen offset:4
kb_kernel_pb20:
MF v[188:191], a[80:83], v[84:87], v[188:191]
TR a[110:111], v251, 34816
MF v[192:195], a[84:87], v[80:83], v[192:195]
TR a[80:81], v252, 20480
MF v[196:199], a[84:87], v[84:87], v[196:199]
TR a[82:83], v252, 22528
MF v[184:187], a[88:91], v[88:91], v[184:187]
TR a[84:85], v253, 20480
MF v[188:191], a[88:91], v[92:95], v[188:191]
TR a[86:87], v253, 22528
MF v[192:195], a[92:95], v[88:91], v[192:195]
TR a[88:89], v252, 24576
MF v[196:199], a[92:95], v[92:95], v[196:199]
TR a[90:91], v252, 26624
s_waitcnt lgkmcnt(6)
MF v[184:187], a[96:99], v[96:99], v[184:187]
TR a[92:93], v253, 24576
MF v[188:191], a[96:99], v[100:103], v[188:191]
TR a[94:95], v253, 26624
MF v[192:195], a[100:103], v[96:99], v[192:195]
TR a[96:97], v252, 28672
MF v[196:199], a[100:103], v[100:103], v[196:199]
TR a[98:99], v252, 30720
MF v[184:187], a[104:107], v[104:107], v[184:187]
TR a[100:101], v253, 28672
MF v[188:191], a[104:107], v[108:111], v[188:191]
TR a[102:103], v253, 30720
MF v[192:195], a[108:111], v[104:107], v[192:195]
TR a[104:105], v252, 32768
MF v[196:199], a[108:111], v[108:111], v[196:199]
TR a[106:107], v252, 34816
s_waitcnt lgkmcnt(6)
MF v[200:203], a[80:83], v[80:83], v[200:203]
TR a[108:109], v253, 32768
s_barrier
MF v[204:207], a[80:83], v[84:87], v[204:207]
TR a[110:111], v253, 34816
s_add_u32 s58, s34, s70
s_addc_u32 s59, s35, 0
MF v[208:211], a[84:87], v[80:83], v[208:211]
TR a[80:81], v21, 0
s_add_u32 m0, s28, 73728
MF v[212:215], a[84:87], v[84:87], v[212:215]
TR a[82:83], v21, 2048
global_load_lds_dwordx4 v10, s[58:59]
MF v[200:203], a[88:91], v[88:91], v[200:203]
TR a[84:85], v22, 0
v_cvt_pk_bf16_f32 v216, v184, v185
MF v[204:207], a[88:91], v[92:95], v[204:207]
TR a[86:87], v22, 2048
v_cvt_pk_bf16_f32 v217, v186, v187
MF v[208:211], a[92:95], v[88:91], v[208:211]
TR a[88:89], v21, 4096
global_load_lds_dwordx4 v11, s[58:59] offset:1024
MF v[212:215], a[92:95], v[92:95], v[212:215]
TR a[90:91], v21, 6144
s_waitcnt lgkmcnt(6)
MF v[200:203], a[96:99], v[96:99], v[200:203]
TR a[92:93], v22, 4096
v_cvt_pk_bf16_f32 v218, v192, v193
MF v[204:207], a[96:99], v[100:103], v[204:207]
TR a[94:95], v22, 6144
v_cvt_pk_bf16_f32 v219, v194, v195
MF v[208:211], a[100:103], v[96:99], v[208:211]
TR a[96:97], v21, 8192
s_cbranch_vccnz kb_kernel_pa21
buffer_store_dwordx4 v[216:219], v25, s[20:23], s73 offen
kb_kernel_pb22:
MF v[212:215], a[100:103], v[100:103], v[212:215]
TR a[98:99], v21, 10240
global_load_lds_dwordx4 v12, s[58:59] offset:2048
MF v[200:203], a[104:107], v[104:107], v[200:203]
TR a[100:101], v22, 8192
v_cvt_pk_bf16_f32 v220, v188, v189
MF v[204:207], a[104:107], v[108:111], v[204:207]
TR a[102:103], v22, 10240
v_cvt_pk_bf16_f32 v221, v190, v191
MF v[208:211], a[108:111], v[104:107], v[208:211]
TR a[104:105], v21, 12288
v_cvt_pk_bf16_f32 v222, v196, v197
MF v[212:215], a[108:111], v[108:111], v[212:215]
TR a[106:107], v21, 14336
v_cvt_pk_bf16_f32 v223, v198, v199
s_waitcnt lgkmcnt(6)
MF v[184:187], a[80:83], v[40:43], 0
TR a[108:109], v22, 12288
MF v[188:191], a[80:83], v[44:47], 0
TR a[110:111], v22, 14336
global_load_lds_dwordx4 v13, s[58:59] offset:3072
MF v[192:195], a[84:87], v[40:43], 0
TR a[80:81], v21, 16384
s_add_u32 m0, s28, 77824
MF v[196:199], a[84:87], v[44:47], 0
TR a[82:83], v21, 18432
s_cbranch_vccnz kb_kernel_pa23
buffer_store_dwordx4 v[220:223], v26, s[20:23], s73 offen
kb_kernel_pb24:
MF v[184:187], a[88:91], v[48:51], v[184:187]
TR a[84:85], v22, 16384
v_cvt_pk_bf16_f32 v224, v200, v201
MF v[188:191], a[88:91], v[52:55], v[188:191]
TR a[86:87], v22, 18432
global_load_lds_dwordx4 v14, s[58:59]
MF v[192:195], a[92:95], v[48:51], v[192:195]
TR a[88:89], v23, 0
v_cvt_pk_bf16_f32 v225, v202, v203
MF v[196:199], a[92:95], v[52:55], v[196:199]
TR a[90:91], v23, 2048
s_waitcnt lgkmcnt(6)
MF v[184:187], a[96:99], v[56:59], v[184:187]
TR a[92:93], v24, 0
buffer_load_dword v254, v27, s[60:63], s65 offen offset:4 sc1
MF v[188:191], a[96:99], v[60:63], v[188:191]
TR a[94:95], v24, 2048
v_cvt_pk_bf16_f32 v226, v208, v209
MF v[192:195], a[100:103], v[56:59], v[192:195]
TR a[96:97], v23, 4096
global_load_lds_dwordx4 v15, s[58:59] offset:1024
MF v[196:199], a[100:103], v[60:63], v[196:199]
TR a[98:99], v23, 6144
v_cvt_pk_bf16_f32 v227, v210, v211
MF v[184:187], a[104:107], v[64:67], v[184:187]
TR a[100:101], v24, 4096
s_cbranch_vccnz kb_kernel_pa25
buffer_store_dwordx4 v[224:227], v25, s[20:23], s73 offen offset:1024
kb_kernel_pb26:
MF v[188:191], a[104:107], v[68:71], v[188:191]
TR a[102:103], v24, 6144
v_cvt_pk_bf16_f32 v228, v204, v205
MF v[192:195], a[108:111], v[64:67], v[192:195]
TR a[104:105], v23, 8192
v_cvt_pk_bf16_f32 v229, v206, v207
MF v[196:199], a[108:111], v[68:71], v[196:199]
TR a[106:107], v23, 10240
s_waitcnt lgkmcnt(6)
MF v[184:187], a[80:83], v[72:75], v[184:187]
TR a[108:109], v24, 8192
global_load_lds_dwordx4 v16, s[58:59] offset:2048
MF v[188:191], a[80:83], v[76:79], v[188:191]
TR a[110:111], v24, 10240
v_cvt_pk_bf16_f32 v230, v212, v213
MF v[192:195], a[84:87], v[72:75], v[192:195]
TR a[80:81], v23, 12288
v_cvt_pk_bf16_f32 v231, v214, v215
MF v[196:199], a[84:87], v[76:79], v[196:199]
TR a[82:83], v23, 14336
s_cbranch_vccnz kb_kernel_pa27
buffer_store_dwordx4 v[228:231], v26, s[20:23], s73 offen offset:1024
kb_kernel_pb28:
MF v[200:203], a[88:91], v[40:43], 0
TR a[84:85], v24, 12288
global_load_lds_dwordx4 v17, s[58:59] offset:3072
MF v[204:207], a[88:91], v[44:47], 0
TR a[86:87], v24, 14336
s_add_u32 m0, s28, 81920
MF v[208:211], a[92:95], v[40:43], 0
TR a[88:89], v23, 16384
v_add_u32 v250, 0x9000, v21
MF v[212:215], a[92:95], v[44:47], 0
TR a[90:91], v23, 18432
s_waitcnt lgkmcnt(6)
MF v[200:203], a[96:99], v[48:51], v[200:203]
TR a[92:93], v24, 16384
v_add_u32 v251, 0x9000, v22
MF v[204:207], a[96:99], v[52:55], v[204:207]
TR a[94:95], v24, 18432
global_load_lds_dwordx4 v18, s[58:59]
MF v[208:211], a[100:103], v[48:51], v[208:211]
TR a[96:97], v21, 20480
s_add_u32 s70, s70, 128
MF v[212:215], a[100:103], v[52:55], v[212:215]
TR a[98:99], v21, 22528
s_cmp_eq_u32 s70, 1152
s_cselect_b32 s70, 0, s70
MF v[200:203], a[104:107], v[56:59], v[200:203]
TR a[100:101], v22, 20480
v_add_u32 v252, 0x9000, v23
MF v[204:207], a[104:107], v[60:63], v[204:207]
TR a[102:103], v22, 22528
v_add_u32 v253, 0x9000, v24
MF v[208:211], a[108:111], v[56:59], v[208:211]
TR a[104:105], v21, 24576
MF v[212:215], a[108:111], v[60:63], v[212:215]
TR a[106:107], v21, 26624
s_waitcnt vmcnt(6)
v_readfirstlane_b32 s68, v254
s_waitcnt lgkmcnt(6)
MF v[200:203], a[80:83], v[64:67], v[200:203]
TR a[108:109], v22, 24576
s_nop 0
s_add_u32 s68, s68, s69
s_cmp_ge_u32 s68, 3
s_cbranch_scc0 kb_kernel_spin81
kb_kernel_spb82:
MF v[204:207], a[80:83], v[68:71], v[204:207]
TR a[110:111], v22, 26624
buffer_load_dwordx4 v[112:115], v25, s[20:23], s71 offen sc1
MF v[208:211], a[84:87], v[64:67], v[208:211]
TR a[80:81], v21, 28672
MF v[212:215], a[84:87], v[68:71], v[212:215]
TR a[82:83], v21, 30720
buffer_load_dwordx4 v[116:119], v26, s[20:23], s71 offen sc1
MF v[200:203], a[88:91], v[72:75], v[200:203]
TR a[84:85], v22, 28672
MF v[204:207], a[88:91], v[76:79], v[204:207]
TR a[86:87], v22, 30720
buffer_load_dwordx4 v[120:123], v25, s[20:23], s71 offen offset:1024 sc1
MF v[208:211], a[92:95], v[72:75], v[208:211]
TR a[88:89], v21, 32768
v_mov_b32 v255, 2
MF v[212:215], a[92:95], v[76:79], v[212:215]
TR a[90:91], v21, 34816
s_waitcnt vmcnt(5)
buffer_load_dwordx4 v[124:127], v26, s[20:23], s71 offen offset:1024 sc1
s_waitcnt lgkmcnt(6)
MF v[184:187], a[96:99], v[80:83], v[184:187]
TR a[92:93], v22, 32768
s_cbranch_vccnz kb_kernel_pa29
buffer_store_dword v255, v27, s[60:63], s64 offen offset:4
kb_kernel_pb30:
MF v[188:191], a[96:99], v[84:87], v[188:191]
TR a[94:95], v22, 34816
MF v[192:195], a[100:103], v[80:83], v[192:195]
TR a[96:97], v23, 20480
MF v[196:199], a[100:103], v[84:87], v[196:199]
TR a[98:99], v23, 22528
MF v[184:187], a[104:107], v[88:91], v[184:187]
TR a[100:101], v24, 20480
MF v[188:191], a[104:107], v[92:95], v[188:191]
TR a[102:103], v24, 22528
MF v[192:195], a[108:111], v[88:91], v[192:195]
TR a[104:105], v23, 24576
MF v[196:199], a[108:111], v[92:95], v[196:199]
TR a[106:107], v23, 26624
s_waitcnt lgkmcnt(6)
MF v[184:187], a[80:83], v[96:99], v[184:187]
TR a[108:109], v24, 24576
MF v[188:191], a[80:83], v[100:103], v[188:191]
TR a[110:111], v24, 26624
MF v[192:195], a[84:87], v[96:99], v[192:195]
TR a[80:81], v23, 28672
MF v[196:199], a[84:87], v[100:103], v[196:199]
TR a[82:83], v23, 30720
MF v[184:187], a[88:91], v[104:107], v[184:187]
TR a[84:85], v24, 28672
MF v[188:191], a[88:91], v[108:111], v[188:191]
TR a[86:87], v24, 30720
MF v[192:195], a[92:95], v[104:107], v[192:195]
TR a[88:89], v23, 32768
MF v[196:199], a[92:95], v[108:111], v[196:199]
TR a[90:91], v23, 34816
s_waitcnt vmcnt(3)
MF v[184:187], v[154:157], v[112:115], v[184:187]
TR a[92:93], v24, 32768
MF v[188:191], v[154:157], v[116:119], v[188:191]
TR a[94:95], v24, 34816
MF v[192:195], v[152:155], v[112:115], v[192:195]
MF v[196:199], v[152:155], v[116:119], v[196:199]
s_barrier
s_waitcnt lgkmcnt(8)
MF v[200:203], a[96:99], v[80:83], v[200:203]
MF v[204:207], a[96:99], v[84:87], v[204:207]
TR a[96:97], v250, 0
s_add_u32 s58, s34, s70
s_addc_u32 s59, s35, 0
MF v[208:211], a[100:103], v[80:83], v[208:211]
TR a[98:99], v250, 2048
s_add_u32 m0, s28, 110592
MF v[212:215], a[100:103], v[84:87], v[212:215]
TR a[100:101], v251, 0
global_load_lds_dwordx4 v10, s[58:59]
MF v[200:203], a[104:107], v[88:91], v[200:203]
TR a[102:103], v251, 2048
v_cvt_pk_bf16_f32 v216, v184, v185
MF v[204:207], a[104:107], v[92:95], v[204:207]
TR a[104:105], v250, 4096
v_cvt_pk_bf16_f32 v217, v186, v187
MF v[208:211], a[108:111], v[88:91], v[208:211]
TR a[106:107], v250, 6144
global_load_lds_dwordx4 v11, s[58:59] offset:1024
MF v[212:215], a[108:111], v[92:95], v[212:215]
TR a[108:109], v251, 4096
s_waitcnt lgkmcnt(7)
MF v[200:203], a[80:83], v[96:99], v[200:203]
TR a[110:111], v251, 6144
v_cvt_pk_bf16_f32 v218, v192, v193
MF v[204:207], a[80:83], v[100:103], v[204:207]
TR a[80:81], v250, 8192
v_cvt_pk_bf16_f32 v219, v194, v195
MF v[208:211], a[84:87], v[96:99], v[208:211]
TR a[82:83], v250, 10240
s_cbranch_vccnz kb_kernel_pa31
buffer_store_dwordx4 v[216:219], v25, s[20:23], s74 offen
kb_kernel_pb32:
MF v[212:215], a[84:87], v[100:103], v[212:215]
TR a[84:85], v251, 8192
global_load_lds_dwordx4 v12, s[58:59] offset:2048
MF v[200:203], a[88:91], v[104:107], v[200:203]
TR a[86:87], v251, 10240
v_cvt_pk_bf16_f32 v220, v188, v189
MF v[204:207], a[88:91], v[108:111], v[204:207]
TR a[88:89], v250, 12288
v_cvt_pk_bf16_f32 v221, v190, v191
MF v[208:211], a[92:95], v[104:107], v[208:211]
TR a[90:91], v250, 14336
v_cvt_pk_bf16_f32 v222, v196, v197
MF v[212:215], a[92:95], v[108:111], v[212:215]
TR a[92:93], v251, 12288
s_waitcnt vmcnt(5)
MF v[200:203], v[154:157], v[120:123], v[200:203]
TR a[94:95], v251, 14336
global_load_lds_dwordx4 v13, s[58:59] offset:3072
MF v[204:207], v[154:157], v[124:127], v[204:207]
s_add_u32 m0, s28, 114688
v_cvt_pk_bf16_f32 v223, v198, v199
MF v[208:211], v[152:155], v[120:123], v[208:211]
s_cbranch_vccnz kb_kernel_pa33
buffer_store_dwordx4 v[220:223], v26, s[20:23], s74 offen
kb_kernel_pb34:
v_add_u32 v21, 0x9000, v250
MF v[212:215], v[152:155], v[124:127], v[212:215]
buffer_load_dword v254, v27, s[60:63], s65 offen offset:4 sc1
s_waitcnt lgkmcnt(8)
MF v[184:187], a[96:99], v[40:43], 0
v_add_u32 v22, 0x9000, v251
v_add_u32 v23, 0x9000, v252
MF v[188:191], a[96:99], v[44:47], 0
TR a[96:97], v250, 16384
global_load_lds_dwordx4 v14, s[58:59]
MF v[192:195], a[100:103], v[40:43], 0
TR a[98:99], v250, 18432
v_add_u32 v24, 0x9000, v253
MF v[196:199], a[100:103], v[44:47], 0
TR a[100:101], v251, 16384
v_cvt_pk_bf16_f32 v224, v200, v201
MF v[184:187], a[104:107], v[48:51], v[184:187]
TR a[102:103], v251, 18432
v_cvt_pk_bf16_f32 v225, v202, v203
MF v[188:191], a[104:107], v[52:55], v[188:191]
TR a[104:105], v252, 0
v_cvt_pk_bf16_f32 v226, v208, v209
MF v[192:195], a[108:111], v[48:51], v[192:195]
TR a[106:107], v252, 2048
global_load_lds_dwordx4 v15, s[58:59] offset:1024
MF v[196:199], a[108:111], v[52:55], v[196:199]
TR a[108:109], v253, 0
s_waitcnt lgkmcnt(7)
MF v[184:187], a[80:83], v[56:59], v[184:187]
TR a[110:111], v253, 2048
v_cvt_pk_bf16_f32 v227, v210, v211
MF v[188:191], a[80:83], v[60:63], v[188:191]
TR a[80:81], v252, 4096
s_cbranch_vccnz kb_kernel_pa35
buffer_store_dwordx4 v[224:227], v25, s[20:23], s74 offen offset:1024
kb_kernel_pb36:
MF v[192:195], a[84:87], v[56:59], v[192:195]
TR a[82:83], v252, 6144
v_cvt_pk_bf16_f32 v228, v204, v205
MF v[196:199], a[84:87], v[60:63], v[196:199]
TR a[84:85], v253, 4096
global_load_lds_dwordx4 v16, s[58:59] offset:2048
MF v[184:187], a[88:91], v[64:67], v[184:187]
TR a[86:87], v253, 6144
v_cvt_pk_bf16_f32 v229, v206, v207
MF v[188:191], a[88:91], v[68:71], v[188:191]
TR a[88:89], v252, 8192
v_cvt_pk_bf16_f32 v230, v212, v213
MF v[192:195], a[92:95], v[64:67], v[192:195]
TR a[90:91], v252, 10240
v_cvt_pk_bf16_f32 v231, v214, v215
MF v[196:199], a[92:95], v[68:71], v[196:199]
TR a[92:93], v253, 8192
s_waitcnt lgkmcnt(7)
MF v[184:187], a[96:99], v[72:75], v[184:187]
TR a[94:95], v253, 10240
global_load_lds_dwordx4 v17, s[58:59] offset:3072
MF v[188:191], a[96:99], v[76:79], v[188:191]
TR a[96:97], v252, 12288
s_add_u32 m0, s28, 118784
MF v[192:195], a[100:103], v[72:75], v[192:195]
TR a[98:99], v252, 14336
s_cbranch_vccnz kb_kernel_pa37
buffer_store_dwordx4 v[228:231], v26, s[20:23], s74 offen offset:1024
kb_kernel_pb38:
MF v[196:199], a[100:103], v[76:79], v[196:199]
TR a[100:101], v253, 12288
MF v[200:203], a[104:107], v[40:43], 0
TR a[102:103], v253, 14336
MF v[204:207], a[104:107], v[44:47], 0
TR a[104:105], v252, 16384
global_load_lds_dwordx4 v18, s[58:59]
MF v[208:211], a[108:111], v[40:43], 0
TR a[106:107], v252, 18432
s_add_u32 s70, s70, 128
MF v[212:215], a[108:111], v[44:47], 0
TR a[108:109], v253, 16384
s_waitcnt vmcnt(7)
v_readfirstlane_b32 s68, v254
s_waitcnt lgkmcnt(7)
MF v[200:203], a[80:83], v[48:51], v[200:203]
TR a[110:111], v253, 18432
s_nop 0
s_add_u32 s68, s68, s69
s_cmp_ge_u32 s68, 4
s_cbranch_scc0 kb_kernel_spin83
kb_kernel_spb84:
MF v[204:207], a[80:83], v[52:55], v[204:207]
TR a[80:81], v250, 20480
buffer_load_dwordx4 v[128:131], v25, s[20:23], s75 offen sc1
MF v[208:211], a[84:87], v[48:51], v[208:211]
TR a[82:83], v250, 22528
MF v[212:215], a[84:87], v[52:55], v[212:215]
TR a[84:85], v251, 20480
buffer_load_dwordx4 v[132:135], v26, s[20:23], s75 offen sc1
MF v[200:203], a[88:91], v[56:59], v[200:203]
TR a[86:87], v251, 22528
MF v[204:207], a[88:91], v[60:63], v[204:207]
TR a[88:89], v250, 24576
s_cmp_eq_u32 s70, 1152
s_cselect_b32 s70, 0, s70
buffer_load_dwordx4 v[136:139], v25, s[20:23], s75 offen offset:1024 sc1
MF v[208:211], a[92:95], v[56:59], v[208:211]
TR a[90:91], v250, 26624
MF v[212:215], a[92:95], v[60:63], v[212:215]
TR a[92:93], v251, 24576
buffer_load_dwordx4 v[140:143], v26, s[20:23], s75 offen offset:1024 sc1
s_waitcnt lgkmcnt(7)
MF v[200:203], a[96:99], v[64:67], v[200:203]
TR a[94:95], v251, 26624
MF v[204:207], a[96:99], v[68:71], v[204:207]
TR a[96:97], v250, 28672
MF v[208:211], a[100:103], v[64:67], v[208:211]
TR a[98:99], v250, 30720
MF v[212:215], a[100:103], v[68:71], v[212:215]
TR a[100:101], v251, 28672
MF v[200:203], a[104:107], v[72:75], v[200:203]
TR a[102:103], v251, 30720
v_mov_b32 v255, 3
MF v[204:207], a[104:107], v[76:79], v[204:207]
TR a[104:105], v250, 32768
MF v[208:211], a[108:111], v[72:75], v[208:211]
TR a[106:107], v250, 34816
MF v[212:215], a[108:111], v[76:79], v[212:215]
TR a[108:109], v251, 32768
s_waitcnt vmcnt(5)
s_waitcnt lgkmcnt(7)
MF v[184:187], a[80:83], v[80:83], v[184:187]
TR a[110:111], v251, 34816
s_cbranch_vccnz kb_kernel_pa39
buffer_store_dword v255, v27, s[60:63], s64 offen offset:4
kb_kernel_pb40:
MF v[188:191], a[80:83], v[84:87], v[188:191]
TR a[80:81], v252, 20480
MF v[192:195], a[84:87], v[80:83], v[192:195]
TR a[82:83], v252, 22528
MF v[196:199], a[84:87], v[84:87], v[196:199]
TR a[84:85], v253, 20480
MF v[184:187], a[88:91], v[88:91], v[184:187]
TR a[86:87], v253, 22528
MF v[188:191], a[88:91], v[92:95], v[188:191]
TR a[88:89], v252, 24576
MF v[192:195], a[92:95], v[88:91], v[192:195]
TR a[90:91], v252, 26624
MF v[196:199], a[92:95], v[92:95], v[196:199]
TR a[92:93], v253, 24576
s_waitcnt lgkmcnt(7)
MF v[184:187], a[96:99], v[96:99], v[184:187]
TR a[94:95], v253, 26624
MF v[188:191], a[96:99], v[100:103], v[188:191]
TR a[96:97], v252, 28672
MF v[192:195], a[100:103], v[96:99], v[192:195]
TR a[98:99], v252, 30720
MF v[196:199], a[100:103], v[100:103], v[196:199]
TR a[100:101], v253, 28672
MF v[184:187], a[104:107], v[104:107], v[184:187]
TR a[102:103], v253, 30720
MF v[188:191], a[104:107], v[108:111], v[188:191]
TR a[104:105], v252, 32768
MF v[192:195], a[108:111], v[104:107], v[192:195]
TR a[106:107], v252, 34816
MF v[196:199], a[108:111], v[108:111], v[196:199]
TR a[108:109], v253, 32768
s_waitcnt vmcnt(3)
MF v[184:187], v[154:157], v[128:131], v[184:187]
TR a[110:111], v253, 34816
MF v[188:191], v[154:157], v[132:135], v[188:191]
MF v[192:195], v[152:155], v[128:131], v[192:195]
MF v[196:199], v[152:155], v[132:135], v[196:199]
s_barrier
s_waitcnt lgkmcnt(8)
MF v[200:203], a[80:83], v[80:83], v[200:203]
MF v[204:207], a[80:83], v[84:87], v[204:207]
TR a[80:81], v21, 0
s_add_u32 s58, s34, s70
s_addc_u32 s59, s35, 0
MF v[208:211], a[84:87], v[80:83], v[208:211]
TR a[82:83], v21, 2048
s_add_u32 m0, s28, 0
MF v[212:215], a[84:87], v[84:87], v[212:215]
TR a[84:85], v22, 0
global_load_lds_dwordx4 v10, s[58:59]
MF v[200:203], a[88:91], v[88:91], v[200:203]
TR a[86:87], v22, 2048
v_cvt_pk_bf16_f32 v216, v184, v185
MF v[204:207], a[88:91], v[92:95], v[204:207]
TR a[88:89], v21, 4096
v_cvt_pk_bf16_f32 v217, v186, v187
MF v[208:211], a[92:95], v[88:91], v[208:211]
TR a[90:91], v21, 6144
global_load_lds_dwordx4 v11, s[58:59] offset:1024
MF v[212:215], a[92:95], v[92:95], v[212:215]
TR a[92:93], v22, 4096
s_waitcnt lgkmcnt(7)
MF v[200:203], a[96:99], v[96:99], v[200:203]
TR a[94:95], v22, 6144
v_cvt_pk_bf16_f32 v218, v192, v193
MF v[204:207], a[96:99], v[100:103], v[204:207]
TR a[96:97], v21, 8192
v_cvt_pk_bf16_f32 v219, v194, v195
MF v[208:211], a[100:103], v[96:99], v[208:211]
TR a[98:99], v21, 10240
s_cbranch_vccnz kb_kernel_pa41
buffer_store_dwordx4 v[216:219], v25, s[20:23], s75 offen
kb_kernel_pb42:
MF v[212:215], a[100:103], v[100:103], v[212:215]
TR a[100:101], v22, 8192
global_load_lds_dwordx4 v12, s[58:59] offset:2048
MF v[200:203], a[104:107], v[104:107], v[200:203]
TR a[102:103], v22, 10240
v_cvt_pk_bf16_f32 v220, v188, v189
MF v[204:207], a[104:107], v[108:111], v[204:207]
TR a[104:105], v21, 12288
v_cvt_pk_bf16_f32 v221, v190, v191
MF v[208:211], a[108:111], v[104:107], v[208:211]
TR a[106:107], v21, 14336
v_cvt_pk_bf16_f32 v222, v196, v197
MF v[212:215], a[108:111], v[108:111], v[212:215]
TR a[108:109], v22, 12288
s_waitcnt vmcnt(5)
MF v[200:203], v[154:157], v[136:139], v[200:203]
TR a[110:111], v22, 14336
global_load_lds_dwordx4 v13, s[58:59] offset:3072
MF v[204:207], v[154:157], v[140:143], v[204:207]
s_add_u32 m0, s28, 4096
v_cvt_pk_bf16_f32 v223, v198, v199
MF v[208:211], v[152:155], v[136:139], v[208:211]
s_cbranch_vccnz kb_kernel_pa43
buffer_store_dwordx4 v[220:223], v26, s[20:23], s75 offen
kb_kernel_pb44:
v_add_u32 v250, 0x9000, v21
MF v[212:215], v[152:155], v[140:143], v[212:215]
buffer_load_dword v254, v27, s[60:63], s65 offen offset:4 sc1
s_waitcnt lgkmcnt(8)
MF v[184:187], a[80:83], v[40:43], 0
v_add_u32 v251, 0x9000, v22
v_add_u32 v252, 0x9000, v23
MF v[188:191], a[80:83], v[44:47], 0
TR a[80:81], v21, 16384
global_load_lds_dwordx4 v14, s[58:59]
MF v[192:195], a[84:87], v[40:43], 0
TR a[82:83], v21, 18432
v_add_u32 v253, 0x9000, v24
MF v[196:199], a[84:87], v[44:47], 0
TR a[84:85], v22, 16384
v_cvt_pk_bf16_f32 v224, v200, v201
MF v[184:187], a[88:91], v[48:51], v[184:187]
TR a[86:87], v22, 18432
v_cvt_pk_bf16_f32 v225, v202, v203
MF v[188:191], a[88:91], v[52:55], v[188:191]
TR a[88:89], v23, 0
v_cvt_pk_bf16_f32 v226, v208, v209
MF v[192:195], a[92:95], v[48:51], v[192:195]
TR a[90:91], v23, 2048
global_load_lds_dwordx4 v15, s[58:59] offset:1024
MF v[196:199], a[92:95], v[52:55], v[196:199]
TR a[92:93], v24, 0
s_waitcnt lgkmcnt(7)
MF v[184:187], a[96:99], v[56:59], v[184:187]
TR a[94:95], v24, 2048
v_cvt_pk_bf16_f32 v227, v210, v211
MF v[188:191], a[96:99], v[60:63], v[188:191]
TR a[96:97], v23, 4096
s_cbranch_vccnz kb_kernel_pa45
buffer_store_dwordx4 v[224:227], v25, s[20:23], s75 offen offset:1024
kb_kernel_pb46:
MF v[192:195], a[100:103], v[56:59], v[192:195]
TR a[98:99], v23, 6144
v_cvt_pk_bf16_f32 v228, v204, v205
MF v[196:199], a[100:103], v[60:63], v[196:199]
TR a[100:101], v24, 4096
global_load_lds_dwordx4 v16, s[58:59] offset:2048
MF v[184:187], a[104:107], v[64:67], v[184:187]
TR a[102:103], v24, 6144
v_cvt_pk_bf16_f32 v229, v206, v207
MF v[188:191], a[104:107], v[68:71], v[188:191]
TR a[104:105], v23, 8192
v_cvt_pk_bf16_f32 v230, v212, v213
MF v[192:195], a[108:111], v[64:67], v[192:195]
TR a[106:107], v23, 10240
v_cvt_pk_bf16_f32 v231, v214, v215
MF v[196:199], a[108:111], v[68:71], v[196:199]
TR a[108:109], v24, 8192
s_waitcnt lgkmcnt(7)
MF v[184:187], a[80:83], v[72:75], v[184:187]
TR a[110:111], v24, 10240
global_load_lds_dwordx4 v17, s[58:59] offset:3072
MF v[188:191], a[80:83], v[76:79], v[188:191]
TR a[80:81], v23, 12288
s_add_u32 m0, s28, 8192
MF v[192:195], a[84:87], v[72:75], v[192:195]
TR a[82:83], v23, 14336
s_cbranch_vccnz kb_kernel_pa47
buffer_store_dwordx4 v[228:231], v26, s[20:23], s75 offen offset:1024
kb_kernel_pb48:
MF v[196:199], a[84:87], v[76:79], v[196:199]
TR a[84:85], v24, 12288
MF v[200:203], a[88:91], v[40:43], 0
TR a[86:87], v24, 14336
MF v[204:207], a[88:91], v[44:47], 0
TR a[88:89], v23, 16384
global_load_lds_dwordx4 v18, s[58:59]
MF v[208:211], a[92:95], v[40:43], 0
TR a[90:91], v23, 18432
s_add_u32 s70, s70, 128
MF v[212:215], a[92:95], v[44:47], 0
TR a[92:93], v24, 16384
s_waitcnt vmcnt(7)
v_readfirstlane_b32 s68, v254
s_waitcnt lgkmcnt(7)
MF v[200:203], a[96:99], v[48:51], v[200:203]
TR a[94:95], v24, 18432
s_nop 0
s_add_u32 s68, s68, s69
s_cmp_ge_u32 s68, 5
s_cbranch_scc0 kb_kernel_spin85
kb_kernel_spb86:
MF v[204:207], a[96:99], v[52:55], v[204:207]
TR a[96:97], v21, 20480
buffer_load_dwordx4 v[112:115], v25, s[20:23], s76 offen sc1
MF v[208:211], a[100:103], v[48:51], v[208:211]
TR a[98:99], v21, 22528
MF v[212:215], a[100:103], v[52:55], v[212:215]
TR a[100:101], v22, 20480
buffer_load_dwordx4 v[116:119], v26, s[20:23], s76 offen sc1
MF v[200:203], a[104:107], v[56:59], v[200:203]
TR a[102:103], v22, 22528
MF v[204:207], a[104:107], v[60:63], v[204:207]
TR a[104:105], v21, 24576
s_cmp_eq_u32 s70, 1152
s_cselect_b32 s70, 0, s70
buffer_load_dwordx4 v[120:123], v25, s[20:23], s76 offen offset:1024 sc1
MF v[208:211], a[108:111], v[56:59], v[208:211]
TR a[106:107], v21, 26624
MF v[212:215], a[108:111], v[60:63], v[212:215]
TR a[108:109], v22, 24576
buffer_load_dwordx4 v[124:127], v26, s[20:23], s76 offen offset:1024 sc1
s_waitcnt lgkmcnt(7)
MF v[200:203], a[80:83], v[64:67], v[200:203]
TR a[110:111], v22, 26624
MF v[204:207], a[80:83], v[68:71], v[204:207]
TR a[80:81], v21, 28672
MF v[208:211], a[84:87], v[64:67], v[208:211]
TR a[82:83], v21, 30720
MF v[212:215], a[84:87], v[68:71], v[212:215]
TR a[84:85], v22, 28672
MF v[200:203], a[88:91], v[72:75], v[200:203]
TR a[86:87], v22, 30720
v_mov_b32 v255, 4
MF v[204:207], a[88:91], v[76:79], v[204:207]
TR a[88:89], v21, 32768
MF v[208:211], a[92:95], v[72:75], v[208:211]
TR a[90:91], v21, 34816
MF v[212:215], a[92:95], v[76:79], v[212:215]
TR a[92:93], v22, 32768
s_waitcnt vmcnt(5)
s_waitcnt lgkmcnt(7)
MF v[184:187], a[96:99], v[80:83], v[184:187]
TR a[94:95], v22, 34816
s_cbranch_vccnz kb_kernel_pa49
buffer_store_dword v255, v27, s[60:63], s64 offen offset:4
kb_kernel_pb50:
MF v[188:191], a[96:99], v[84:87], v[188:191]
TR a[96:97], v23, 20480
MF v[192:195], a[100:103], v[80:83], v[192:195]
TR a[98:99], v23, 22528
MF v[196:199], a[100:103], v[84:87], v[196:199]
TR a[100:101], v24, 20480
MF v[184:187], a[104:107], v[88:91], v[184:187]
TR a[102:103], v24, 22528
MF v[188:191], a[104:107], v[92:95], v[188:191]
TR a[104:105], v23, 24576
MF v[192:195], a[108:111], v[88:91], v[192:195]
TR a[106:107], v23, 26624
MF v[196:199], a[108:111], v[92:95], v[196:199]
TR a[108:109], v24, 24576
s_waitcnt lgkmcnt(7)
MF v[184:187], a[80:83], v[96:99], v[184:187]
TR a[110:111], v24, 26624
MF v[188:191], a[80:83], v[100:103], v[188:191]
TR a[80:81], v23, 28672
MF v[192:195], a[84:87], v[96:99], v[192:195]
TR a[82:83], v23, 30720
MF v[196:199], a[84:87], v[100:103], v[196:199]
TR a[84:85], v24, 28672
MF v[184:187], a[88:91], v[104:107], v[184:187]
TR a[86:87], v24, 30720
MF v[188:191], a[88:91], v[108:111], v[188:191]
TR a[88:89], v23, 32768
MF v[192:195], a[92:95], v[104:107], v[192:195]
TR a[90:91], v23, 34816
MF v[196:199], a[92:95], v[108:111], v[196:199]
TR a[92:93], v24, 32768
s_waitcnt vmcnt(3)
MF v[184:187], v[154:157], v[112:115], v[184:187]
TR a[94:95], v24, 34816
MF v[188:191], v[154:157], v[116:119], v[188:191]
MF v[192:195], v[152:155], v[112:115], v[192:195]
MF v[196:199], v[152:155], v[116:119], v[196:199]
s_barrier
s_waitcnt lgkmcnt(8)
MF v[200:203], a[96:99], v[80:83], v[200:203]
MF v[204:207], a[96:99], v[84:87], v[204:207]
TR a[96:97], v250, 0
s_add_u32 s58, s34, s70
s_addc_u32 s59, s35, 0
MF v[208:211], a[100:103], v[80:83], v[208:211]
TR a[98:99], v250, 2048
s_add_u32 m0, s28, 36864
MF v[212:215], a[100:103], v[84:87], v[212:215]
TR a[100:101], v251, 0
global_load_lds_dwordx4 v10, s[58:59]
MF v[200:203], a[104:107], v[88:91], v[200:203]
TR a[102:103], v251, 2048
v_cvt_pk_bf16_f32 v216, v184, v185
MF v[204:207], a[104:107], v[92:95], v[204:207]
TR a[104:105], v250, 4096
v_cvt_pk_bf16_f32 v217, v186, v187
MF v[208:211], a[108:111], v[88:91], v[208:211]
TR a[106:107], v250, 6144
global_load_lds_dwordx4 v11, s[58:59] offset:1024
MF v[212:215], a[108:111], v[92:95], v[212:215]
TR a[108:109], v251, 4096
s_waitcnt lgkmcnt(7)
MF v[200:203], a[80:83], v[96:99], v[200:203]
TR a[110:111], v251, 6144
v_cvt_pk_bf16_f32 v218, v192, v193
MF v[204:207], a[80:83], v[100:103], v[204:207]
TR a[80:81], v250, 8192
v_cvt_pk_bf16_f32 v219, v194, v195
MF v[208:211], a[84:87], v[96:99], v[208:211]
TR a[82:83], v250, 10240
s_cbranch_vccnz kb_kernel_pa51
buffer_store_dwordx4 v[216:219], v25, s[20:23], s76 offen
kb_kernel_pb52:
MF v[212:215], a[84:87], v[100:103], v[212:215]
TR a[84:85], v251, 8192
global_load_lds_dwordx4 v12, s[58:59] offset:2048
MF v[200:203], a[88:91], v[104:107], v[200:203]
TR a[86:87], v251, 10240
v_cvt_pk_bf16_f32 v220, v188, v189
MF v[204:207], a[88:91], v[108:111], v[204:207]
TR a[88:89], v250, 12288
v_cvt_pk_bf16_f32 v221, v190, v191
MF v[208:211], a[92:95], v[104:107], v[208:211]
TR a[90:91], v250, 14336
v_cvt_pk_bf16_f32 v222, v196, v197
MF v[212:215], a[92:95], v[108:111], v[212:215]
TR a[92:93], v251, 12288
s_waitcnt vmcnt(5)
MF v[200:203], v[154:157], v[120:123], v[200:203]
TR a[94:95], v251, 14336
global_load_lds_dwordx4 v13, s[58:59] offset:3072
MF v[204:207], v[154:157], v[124:127], v[204:207]
s_add_u32 m0, s28, 40960
v_cvt_pk_bf16_f32 v223, v198, v199
MF v[208:211], v[152:155], v[120:123], v[208:211]
s_cbranch_vccnz kb_kernel_pa53
buffer_store_dwordx4 v[220:223], v26, s[20:23], s76 offen
kb_kernel_pb54:
v_add_u32 v21, 0xfffe5000, v250
MF v[212:215], v[152:155], v[124:127], v[212:215]
buffer_load_dword v254, v27, s[60:63], s65 offen offset:4 sc1
s_waitcnt lgkmcnt(8)
MF v[184:187], a[96:99], v[40:43], 0
v_add_u32 v22, 0xfffe5000, v251
v_add_u32 v23, 0xfffe5000, v252
MF v[188:191], a[96:99], v[44:47], 0
TR a[96:97], v250, 16384
global_load_lds_dwordx4 v14, s[58:59]
MF v[192:195], a[100:103], v[40:43], 0
TR a[98:99], v250, 18432
v_add_u32 v24, 0xfffe5000, v253
MF v[196:199], a[100:103], v[44:47], 0
TR a[100:101], v251, 16384
v_cvt_pk_bf16_f32 v224, v200, v201
MF v[184:187], a[104:107], v[48:51], v[184:187]
TR a[102:103], v251, 18432
v_cvt_pk_bf16_f32 v225, v202, v203
MF v[188:191], a[104:107], v[52:55], v[188:191]
TR a[104:105], v252, 0
v_cvt_pk_bf16_f32 v226, v208, v209
MF v[192:195], a[108:111], v[48:51], v[192:195]
TR a[106:107], v252, 2048
global_load_lds_dwordx4 v15, s[58:59] offset:1024
MF v[196:199], a[108:111], v[52:55], v[196:199]
TR a[108:109], v253, 0
s_waitcnt lgkmcnt(7)
MF v[184:187], a[80:83], v[56:59], v[184:187]
TR a[110:111], v253, 2048
v_cvt_pk_bf16_f32 v227, v210, v211
MF v[188:191], a[80:83], v[60:63], v[188:191]
TR a[80:81], v252, 4096
s_cbranch_vccnz kb_kernel_pa55
buffer_store_dwordx4 v[224:227], v25, s[20:23], s76 offen offset:1024
kb_kernel_pb56:
MF v[192:195], a[84:87], v[56:59], v[192:195]
TR a[82:83], v252, 6144
v_cvt_pk_bf16_f32 v228, v204, v205
MF v[196:199], a[84:87], v[60:63], v[196:199]
TR a[84:85], v253, 4096
global_load_lds_dwordx4 v16, s[58:59] offset:2048
MF v[184:187], a[88:91], v[64:67], v[184:187]
TR a[86:87], v253, 6144
v_cvt_pk_bf16_f32 v229, v206, v207
MF v[188:191], a[88:91], v[68:71], v[188:191]
TR a[88:89], v252, 8192
v_cvt_pk_bf16_f32 v230, v212, v213
MF v[192:195], a[92:95], v[64:67], v[192:195]
TR a[90:91], v252, 10240
v_cvt_pk_bf16_f32 v231, v214, v215
MF v[196:199], a[92:95], v[68:71], v[196:199]
TR a[92:93], v253, 8192
s_waitcnt lgkmcnt(7)
MF v[184:187], a[96:99], v[72:75], v[184:187]
TR a[94:95], v253, 10240
global_load_lds_dwordx4 v17, s[58:59] offset:3072
MF v[188:191], a[96:99], v[76:79], v[188:191]
TR a[96:97], v252, 12288
s_add_u32 m0, s28, 45056
MF v[192:195], a[100:103], v[72:75], v[192:195]
TR a[98:99], v252, 14336
s_cbranch_vccnz kb_kernel_pa57
buffer_store_dwordx4 v[228:231], v26, s[20:23], s76 offen offset:1024
kb_kernel_pb58:
MF v[196:199], a[100:103], v[76:79], v[196:199]
TR a[100:101], v253, 12288
MF v[200:203], a[104:107], v[40:43], 0
TR a[102:103], v253, 14336
MF v[204:207], a[104:107], v[44:47], 0
TR a[104:105], v252, 16384
global_load_lds_dwordx4 v18, s[58:59]
MF v[208:211], a[108:111], v[40:43], 0
TR a[106:107], v252, 18432
s_add_u32 s70, s70, 128
MF v[212:215], a[108:111], v[44:47], 0
TR a[108:109], v253, 16384
s_waitcnt vmcnt(7)
v_readfirstlane_b32 s68, v254
s_waitcnt lgkmcnt(7)
MF v[200:203], a[80:83], v[48:51], v[200:203]
TR a[110:111], v253, 18432
s_nop 0
s_add_u32 s68, s68, s69
s_cmp_ge_u32 s68, 6
s_cbranch_scc0 kb_kernel_spin87
kb_kernel_spb88:
MF v[204:207], a[80:83], v[52:55], v[204:207]
TR a[80:81], v250, 20480
buffer_load_dwordx4 v[128:131], v25, s[20:23], s77 offen sc1
MF v[208:211], a[84:87], v[48:51], v[208:211]
TR a[82:83], v250, 22528
MF v[212:215], a[84:87], v[52:55], v[212:215]
TR a[84:85], v251, 20480
buffer_load_dwordx4 v[132:135], v26, s[20:23], s77 offen sc1
MF v[200:203], a[88:91], v[56:59], v[200:203]
TR a[86:87], v251, 22528
MF v[204:207], a[88:91], v[60:63], v[204:207]
TR a[88:89], v250, 24576
s_cmp_eq_u32 s70, 1152
s_cselect_b32 s70, 0, s70
buffer_load_dwordx4 v[136:139], v25, s[20:23], s77 offen offset:1024 sc1
MF v[208:211], a[92:95], v[56:59], v[208:211]
TR a[90:91], v250, 26624
MF v[212:215], a[92:95], v[60:63], v[212:215]
TR a[92:93], v251, 24576
buffer_load_dwordx4 v[140:143], v26, s[20:23], s77 offen offset:1024 sc1
s_waitcnt lgkmcnt(7)
MF v[200:203], a[96:99], v[64:67], v[200:203]
TR a[94:95], v251, 26624
MF v[204:207], a[96:99], v[68:71], v[204:207]
TR a[96:97], v250, 28672
MF v[208:211], a[100:103], v[64:67], v[208:211]
TR a[98:99], v250, 30720
MF v[212:215], a[100:103], v[68:71], v[212:215]
TR a[100:101], v251, 28672
MF v[200:203], a[104:107], v[72:75], v[200:203]
TR a[102:103], v251, 30720
v_mov_b32 v255, 5
MF v[204:207], a[104:107], v[76:79], v[204:207]
TR a[104:105], v250, 32768
MF v[208:211], a[108:111], v[72:75], v[208:211]
TR a[106:107], v250, 34816
MF v[212:215], a[108:111], v[76:79], v[212:215]
TR a[108:109], v251, 32768
s_waitcnt vmcnt(5)
s_waitcnt lgkmcnt(7)
MF v[184:187], a[80:83], v[80:83], v[184:187]
TR a[110:111], v251, 34816
s_cbranch_vccnz kb_kernel_pa59
buffer_store_dword v255, v27, s[60:63], s64 offen offset:4
kb_kernel_pb60:
MF v[188:191], a[80:83], v[84:87], v[188:191]
TR a[80:81], v252, 20480
MF v[192:195], a[84:87], v[80:83], v[192:195]
TR a[82:83], v252, 22528
MF v[196:199], a[84:87], v[84:87], v[196:199]
TR a[84:85], v253, 20480
MF v[184:187], a[88:91], v[88:91], v[184:187]
TR a[86:87], v253, 22528
MF v[188:191], a[88:91], v[92:95], v[188:191]
TR a[88:89], v252, 24576
MF v[192:195], a[92:95], v[88:91], v[192:195]
TR a[90:91], v252, 26624
MF v[196:199], a[92:95], v[92:95], v[196:199]
TR a[92:93], v253, 24576
s_waitcnt lgkmcnt(7)
MF v[184:187], a[96:99], v[96:99], v[184:187]
TR a[94:95], v253, 26624
MF v[188:191], a[96:99], v[100:103], v[188:191]
TR a[96:97], v252, 28672
MF v[192:195], a[100:103], v[96:99], v[192:195]
TR a[98:99], v252, 30720
MF v[196:199], a[100:103], v[100:103], v[196:199]
TR a[100:101], v253, 28672
MF v[184:187], a[104:107], v[104:107], v[184:187]
TR a[102:103], v253, 30720
MF v[188:191], a[104:107], v[108:111], v[188:191]
TR a[104:105], v252, 32768
MF v[192:195], a[108:111], v[104:107], v[192:195]
TR a[106:107], v252, 34816
MF v[196:199], a[108:111], v[108:111], v[196:199]
TR a[108:109], v253, 32768
s_waitcnt vmcnt(3)
MF v[184:187], v[154:157], v[128:131], v[184:187]
TR a[110:111], v253, 34816
MF v[188:191], v[154:157], v[132:135], v[188:191]
MF v[192:195], v[152:155], v[128:131], v[192:195]
MF v[196:199], v[152:155], v[132:135], v[196:199]
s_barrier
s_waitcnt lgkmcnt(8)
MF v[200:203], a[80:83], v[80:83], v[200:203]
MF v[204:207], a[80:83], v[84:87], v[204:207]
TR a[80:81], v21, 0
s_add_u32 s58, s34, s70
s_addc_u32 s59, s35, 0
MF v[208:211], a[84:87], v[80:83], v[208:211]
TR a[82:83], v21, 2048
s_add_u32 m0, s28, 73728
MF v[212:215], a[84:87], v[84:87], v[212:215]
TR a[84:85], v22, 0
global_load_lds_dwordx4 v10, s[58:59]
MF v[200:203], a[88:91], v[88:91], v[200:203]
TR a[86:87], v22, 2048
v_cvt_pk_bf16_f32 v216, v184, v185
MF v[204:207], a[88:91], v[92:95], v[204:207]
TR a[88:89], v21, 4096
v_cvt_pk_bf16_f32 v217, v186, v187
MF v[208:211], a[92:95], v[88:91], v[208:211]
TR a[90:91], v21, 6144
global_load_lds_dwordx4 v11, s[58:59] offset:1024
MF v[212:215], a[92:95], v[92:95], v[212:215]
TR a[92:93], v22, 4096
s_waitcnt lgkmcnt(7)
MF v[200:203], a[96:99], v[96:99], v[200:203]
TR a[94:95], v22, 6144
v_cvt_pk_bf16_f32 v218, v192, v193
MF v[204:207], a[96:99], v[100:103], v[204:207]
TR a[96:97], v21, 8192
v_cvt_pk_bf16_f32 v219, v194, v195
MF v[208:211], a[100:103], v[96:99], v[208:211]
TR a[98:99], v21, 10240
s_cbranch_vccnz kb_kernel_pa61
buffer_store_dwordx4 v[216:219], v25, s[20:23], s77 offen
kb_kernel_pb62:
MF v[212:215], a[100:103], v[100:103], v[212:215]
TR a[100:101], v22, 8192
global_load_lds_dwordx4 v12, s[58:59] offset:2048
MF v[200:203], a[104:107], v[104:107], v[200:203]
TR a[102:103], v22, 10240
v_cvt_pk_bf16_f32 v220, v188, v189
MF v[204:207], a[104:107], v[108:111], v[204:207]
TR a[104:105], v21, 12288
v_cvt_pk_bf16_f32 v221, v190, v191
MF v[208:211], a[108:111], v[104:107], v[208:211]
TR a[106:107], v21, 14336
v_cvt_pk_bf16_f32 v222, v196, v197
MF v[212:215], a[108:111], v[108:111], v[212:215]
TR a[108:109], v22, 12288
s_waitcnt vmcnt(5)
MF v[200:203], v[154:157], v[136:139], v[200:203]
TR a[110:111], v22, 14336
global_load_lds_dwordx4 v13, s[58:59] offset:3072
MF v[204:207], v[154:157], v[140:143], v[204:207]
s_add_u32 m0, s28, 77824
v_cvt_pk_bf16_f32 v223, v198, v199
MF v[208:211], v[152:155], v[136:139], v[208:211]
s_cbranch_vccnz kb_kernel_pa63
buffer_store_dwordx4 v[220:223], v26, s[20:23], s77 offen
kb_kernel_pb64:
v_add_u32 v250, 0x9000, v21
MF v[212:215], v[152:155], v[140:143], v[212:215]
buffer_load_dword v254, v27, s[60:63], s65 offen offset:4 sc1
s_waitcnt lgkmcnt(8)
MF v[184:187], a[80:83], v[40:43], 0
v_add_u32 v251, 0x9000, v22
v_add_u32 v252, 0x9000, v23
MF v[188:191], a[80:83], v[44:47], 0
TR a[80:81], v21, 16384
global_load_lds_dwordx4 v14, s[58:59]
MF v[192:195], a[84:87], v[40:43], 0
TR a[82:83], v21, 18432
v_add_u32 v253, 0x9000, v24
MF v[196:199], a[84:87], v[44:47], 0
TR a[84:85], v22, 16384
v_cvt_pk_bf16_f32 v224, v200, v201
MF v[184:187], a[88:91], v[48:51], v[184:187]
TR a[86:87], v22, 18432
v_cvt_pk_bf16_f32 v225, v202, v203
MF v[188:191], a[88:91], v[52:55], v[188:191]
TR a[88:89], v23, 0
v_cvt_pk_bf16_f32 v226, v208, v209
MF v[192:195], a[92:95], v[48:51], v[192:195]
TR a[90:91], v23, 2048
global_load_lds_dwordx4 v15, s[58:59] offset:1024
MF v[196:199], a[92:95], v[52:55], v[196:199]
TR a[92:93], v24, 0
s_waitcnt lgkmcnt(7)
MF v[184:187], a[96:99], v[56:59], v[184:187]
TR a[94:95], v24, 2048
v_cvt_pk_bf16_f32 v227, v210, v211
MF v[188:191], a[96:99], v[60:63], v[188:191]
TR a[96:97], v23, 4096
s_cbranch_vccnz kb_kernel_pa65
buffer_store_dwordx4 v[224:227], v25, s[20:23], s77 offen offset:1024
kb_kernel_pb66:
MF v[192:195], a[100:103], v[56:59], v[192:195]
TR a[98:99], v23, 6144
v_cvt_pk_bf16_f32 v228, v204, v205
MF v[196:199], a[100:103], v[60:63], v[196:199]
TR a[100:101], v24, 4096
global_load_lds_dwordx4 v16, s[58:59] offset:2048
MF v[184:187], a[104:107], v[64:67], v[184:187]
TR a[102:103], v24, 6144
v_cvt_pk_bf16_f32 v229, v206, v207
MF v[188:191], a[104:107], v[68:71], v[188:191]
TR a[104:105], v23, 8192
v_cvt_pk_bf16_f32 v230, v212, v213
MF v[192:195], a[108:111], v[64:67], v[192:195]
TR a[106:107], v23, 10240
v_cvt_pk_bf16_f32 v231, v214, v215
MF v[196:199], a[108:111], v[68:71], v[196:199]
TR a[108:109], v24, 8192
s_waitcnt lgkmcnt(7)
MF v[184:187], a[80:83], v[72:75], v[184:187]
TR a[110:111], v24, 10240
global_load_lds_dwordx4 v17, s[58:59] offset:3072
MF v[188:191], a[80:83], v[76:79], v[188:191]
TR a[80:81], v23, 12288
s_add_u32 m0, s28, 81920
MF v[192:195], a[84:87], v[72:75], v[192:195]
TR a[82:83], v23, 14336
s_cbranch_vccnz kb_kernel_pa67
buffer_store_dwordx4 v[228:231], v26, s[20:23], s77 offen offset:1024
kb_kernel_pb68:
MF v[196:199], a[84:87], v[76:79], v[196:199]
TR a[84:85], v24, 12288
MF v[200:203], a[88:91], v[40:43], 0
TR a[86:87], v24, 14336
MF v[204:207], a[88:91], v[44:47], 0
TR a[88:89], v23, 16384
global_load_lds_dwordx4 v18, s[58:59]
MF v[208:211], a[92:95], v[40:43], 0
TR a[90:91], v23, 18432
MF v[212:215], a[92:95], v[44:47], 0
TR a[92:93], v24, 16384
s_waitcnt vmcnt(7)
v_readfirstlane_b32 s68, v254
s_waitcnt lgkmcnt(7)
MF v[200:203], a[96:99], v[48:51], v[200:203]
TR a[94:95], v24, 18432
s_nop 0
s_add_u32 s68, s68, s69
s_cmp_ge_u32 s68, 7
s_cbranch_scc0 kb_kernel_spin89
kb_kernel_spb90:
MF v[204:207], a[96:99], v[52:55], v[204:207]
TR a[96:97], v21, 20480
buffer_load_dwordx4 v[112:115], v25, s[20:23], s78 offen sc1
MF v[208:211], a[100:103], v[48:51], v[208:211]
TR a[98:99], v21, 22528
MF v[212:215], a[100:103], v[52:55], v[212:215]
TR a[100:101], v22, 20480
buffer_load_dwordx4 v[116:119], v26, s[20:23], s78 offen sc1
MF v[200:203], a[104:107], v[56:59], v[200:203]
TR a[102:103], v22, 22528
MF v[204:207], a[104:107], v[60:63], v[204:207]
TR a[104:105], v21, 24576
buffer_load_dwordx4 v[120:123], v25, s[20:23], s78 offen offset:1024 sc1
MF v[208:211], a[108:111], v[56:59], v[208:211]
TR a[106:107], v21, 26624
buffer_load_dwordx4 v[124:127], v26, s[20:23], s78 offen offset:1024 sc1
MF v[212:215], a[108:111], v[60:63], v[212:215]
TR a[108:109], v22, 24576
s_waitcnt lgkmcnt(7)
MF v[200:203], a[80:83], v[64:67], v[200:203]
TR a[110:111], v22, 26624
MF v[204:207], a[80:83], v[68:71], v[204:207]
TR a[80:81], v21, 28672
MF v[208:211], a[84:87], v[64:67], v[208:211]
TR a[82:83], v21, 30720
MF v[212:215], a[84:87], v[68:71], v[212:215]
TR a[84:85], v22, 28672
MF v[200:203], a[88:91], v[72:75], v[200:203]
TR a[86:87], v22, 30720
v_mov_b32 v255, 6
MF v[204:207], a[88:91], v[76:79], v[204:207]
TR a[88:89], v21, 32768
MF v[208:211], a[92:95], v[72:75], v[208:211]
TR a[90:91], v21, 34816
MF v[212:215], a[92:95], v[76:79], v[212:215]
TR a[92:93], v22, 32768
s_waitcnt vmcnt(5)
s_waitcnt lgkmcnt(7)
MF v[184:187], a[96:99], v[80:83], v[184:187]
TR a[94:95], v22, 34816
s_cbranch_vccnz kb_kernel_pa69
buffer_store_dword v255, v27, s[60:63], s64 offen offset:4
kb_kernel_pb70:
MF v[188:191], a[96:99], v[84:87], v[188:191]
TR a[96:97], v23, 20480
MF v[192:195], a[100:103], v[80:83], v[192:195]
TR a[98:99], v23, 22528
MF v[196:199], a[100:103], v[84:87], v[196:199]
TR a[100:101], v24, 20480
MF v[184:187], a[104:107], v[88:91], v[184:187]
TR a[102:103], v24, 22528
MF v[188:191], a[104:107], v[92:95], v[188:191]
TR a[104:105], v23, 24576
MF v[192:195], a[108:111], v[88:91], v[192:195]
TR a[106:107], v23, 26624
MF v[196:199], a[108:111], v[92:95], v[196:199]
TR a[108:109], v24, 24576
s_waitcnt lgkmcnt(7)
MF v[184:187], a[80:83], v[96:99], v[184:187]
TR a[110:111], v24, 26624
MF v[188:191], a[80:83], v[100:103], v[188:191]
TR a[80:81], v23, 28672
MF v[192:195], a[84:87], v[96:99], v[192:195]
TR a[82:83], v23, 30720
MF v[196:199], a[84:87], v[100:103], v[196:199]
TR a[84:85], v24, 28672
MF v[184:187], a[88:91], v[104:107], v[184:187]
TR a[86:87], v24, 30720
MF v[188:191], a[88:91], v[108:111], v[188:191]
TR a[88:89], v23, 32768
MF v[192:195], a[92:95], v[104:107], v[192:195]
TR a[90:91], v23, 34816
MF v[196:199], a[92:95], v[108:111], v[196:199]
TR a[92:93], v24, 32768
s_waitcnt vmcnt(3)
MF v[184:187], v[154:157], v[112:115], v[184:187]
TR a[94:95], v24, 34816
MF v[188:191], v[154:157], v[116:119], v[188:191]
MF v[192:195], v[152:155], v[112:115], v[192:195]
MF v[196:199], v[152:155], v[116:119], v[196:199]
s_barrier
s_waitcnt lgkmcnt(8)
MF v[200:203], a[96:99], v[80:83], v[200:203]
MF v[204:207], a[96:99], v[84:87], v[204:207]
TR a[96:97], v250, 0
MF v[208:211], a[100:103], v[80:83], v[208:211]
TR a[98:99], v250, 2048
MF v[212:215], a[100:103], v[84:87], v[212:215]
TR a[100:101], v251, 0
v_cvt_pk_bf16_f32 v216, v184, v185
MF v[200:203], a[104:107], v[88:91], v[200:203]
TR a[102:103], v251, 2048
v_cvt_pk_bf16_f32 v217, v186, v187
MF v[204:207], a[104:107], v[92:95], v[204:207]
TR a[104:105], v250, 4096
v_cvt_pk_bf16_f32 v218, v192, v193
MF v[208:211], a[108:111], v[88:91], v[208:211]
TR a[106:107], v250, 6144
v_cvt_pk_bf16_f32 v219, v194, v195
MF v[212:215], a[108:111], v[92:95], v[212:215]
TR a[108:109], v251, 4096
s_waitcnt lgkmcnt(7)
MF v[200:203], a[80:83], v[96:99], v[200:203]
TR a[110:111], v251, 6144
s_cbranch_vccnz kb_kernel_pa71
buffer_store_dwordx4 v[216:219], v25, s[20:23], s78 offen
kb_kernel_pb72:
MF v[204:207], a[80:83], v[100:103], v[204:207]
TR a[80:81], v250, 8192
v_cvt_pk_bf16_f32 v220, v188, v189
MF v[208:211], a[84:87], v[96:99], v[208:211]
TR a[82:83], v250, 10240
v_cvt_pk_bf16_f32 v221, v190, v191
MF v[212:215], a[84:87], v[100:103], v[212:215]
TR a[84:85], v251, 8192
v_cvt_pk_bf16_f32 v222, v196, v197
MF v[200:203], a[88:91], v[104:107], v[200:203]
TR a[86:87], v251, 10240
v_cvt_pk_bf16_f32 v223, v198, v199
MF v[204:207], a[88:91], v[108:111], v[204:207]
TR a[88:89], v250, 12288
s_cbranch_vccnz kb_kernel_pa73
buffer_store_dwordx4 v[220:223], v26, s[20:23], s78 offen
kb_kernel_pb74:
MF v[208:211], a[92:95], v[104:107], v[208:211]
TR a[90:91], v250, 14336
v_add_u32 v21, 0x9000, v250
MF v[212:215], a[92:95], v[108:111], v[212:215]
TR a[92:93], v251, 12288
s_waitcnt vmcnt(3)
MF v[200:203], v[154:157], v[120:123], v[200:203]
TR a[94:95], v251, 14336
v_add_u32 v22, 0x9000, v251
MF v[204:207], v[154:157], v[124:127], v[204:207]
v_add_u32 v23, 0x9000, v252
v_add_u32 v24, 0x9000, v253
MF v[208:211], v[152:155], v[120:123], v[208:211]
MF v[212:215], v[152:155], v[124:127], v[212:215]
buffer_load_dword v254, v27, s[60:63], s65 offen offset:4 sc1
s_waitcnt lgkmcnt(8)
MF v[184:187], a[96:99], v[40:43], 0
MF v[188:191], a[96:99], v[44:47], 0
TR a[96:97], v250, 16384
MF v[192:195], a[100:103], v[40:43], 0
TR a[98:99], v250, 18432
MF v[196:199], a[100:103], v[44:47], 0
TR a[100:101], v251, 16384
v_cvt_pk_bf16_f32 v224, v200, v201
MF v[184:187], a[104:107], v[48:51], v[184:187]
TR a[102:103], v251, 18432
v_cvt_pk_bf16_f32 v225, v202, v203
MF v[188:191], a[104:107], v[52:55], v[188:191]
TR a[104:105], v252, 0
v_cvt_pk_bf16_f32 v226, v208, v209
MF v[192:195], a[108:111], v[48:51], v[192:195]
TR a[106:107], v252, 2048
v_cvt_pk_bf16_f32 v227, v210, v211
MF v[196:199], a[108:111], v[52:55], v[196:199]
TR a[108:109], v253, 0
s_waitcnt lgkmcnt(7)
MF v[184:187], a[80:83], v[56:59], v[184:187]
TR a[110:111], v253, 2048
s_cbranch_vccnz kb_kernel_pa75
buffer_store_dwordx4 v[224:227], v25, s[20:23], s78 offen offset:1024
kb_kernel_pb76:
MF v[188:191], a[80:83], v[60:63], v[188:191]
TR a[80:81], v252, 4096
v_cvt_pk_bf16_f32 v228, v204, v205
MF v[192:195], a[84:87], v[56:59], v[192:195]
TR a[82:83], v252, 6144
v_cvt_pk_bf16_f32 v229, v206, v207
MF v[196:199], a[84:87], v[60:63], v[196:199]
TR a[84:85], v253, 4096
v_cvt_pk_bf16_f32 v230, v212, v213
MF v[184:187], a[88:91], v[64:67], v[184:187]
TR a[86:87], v253, 6144
v_cvt_pk_bf16_f32 v231, v214, v215
MF v[188:191], a[88:91], v[68:71], v[188:191]
TR a[88:89], v252, 8192
s_cbranch_vccnz kb_kernel_pa77
buffer_store_dwordx4 v[228:231], v26, s[20:23], s78 offen offset:1024
kb_kernel_pb78:
MF v[192:195], a[92:95], v[64:67], v[192:195]
TR a[90:91], v252, 10240
MF v[196:199], a[92:95], v[68:71], v[196:199]
TR a[92:93], v253, 8192
s_waitcnt lgkmcnt(7)
MF v[184:187], a[96:99], v[72:75], v[184:187]
TR a[94:95], v253, 10240
MF v[188:191], a[96:99], v[76:79], v[188:191]
TR a[96:97], v252, 12288
MF v[192:195], a[100:103], v[72:75], v[192:195]
TR a[98:99], v252, 14336
MF v[196:199], a[100:103], v[76:79], v[196:199]
TR a[100:101], v253, 12288
MF v[200:203], a[104:107], v[40:43], 0
TR a[102:103], v253, 14336
MF v[204:207], a[104:107], v[44:47], 0
TR a[104:105], v252, 16384
MF v[208:211], a[108:111], v[40:43], 0
TR a[106:107], v252, 18432
MF v[212:215], a[108:111], v[44:47], 0
TR a[108:109], v253, 16384
s_waitcnt vmcnt(2)
v_readfirstlane_b32 s68, v254
s_waitcnt lgkmcnt(7)
MF v[200:203], a[80:83], v[48:51], v[200:203]
TR a[110:111], v253, 18432
s_nop 0
s_add_u32 s68, s68, s69
s_cmp_ge_u32 s68, 8
s_cbranch_scc0 kb_kernel_spin91
kb_kernel_spb92:
MF v[204:207], a[80:83], v[52:55], v[204:207]
TR a[80:81], v250, 20480
buffer_load_dwordx4 v[128:131], v25, s[20:23], s79 offen sc1
MF v[208:211], a[84:87], v[48:51], v[208:211]
TR a[82:83], v250, 22528
MF v[212:215], a[84:87], v[52:55], v[212:215]
TR a[84:85], v251, 20480
buffer_load_dwordx4 v[132:135], v26, s[20:23], s79 offen sc1
MF v[200:203], a[88:91], v[56:59], v[200:203]
TR a[86:87], v251, 22528
MF v[204:207], a[88:91], v[60:63], v[204:207]
TR a[88:89], v250, 24576
buffer_load_dwordx4 v[136:139], v25, s[20:23], s79 offen offset:1024 sc1
MF v[208:211], a[92:95], v[56:59], v[208:211]
TR a[90:91], v250, 26624
buffer_load_dwordx4 v[140:143], v26, s[20:23], s79 offen offset:1024 sc1
MF v[212:215], a[92:95], v[60:63], v[212:215]
TR a[92:93], v251, 24576
s_waitcnt lgkmcnt(7)
MF v[200:203], a[96:99], v[64:67], v[200:203]
TR a[94:95], v251, 26624
MF v[204:207], a[96:99], v[68:71], v[204:207]
TR a[96:97], v250, 28672
MF v[208:211], a[100:103], v[64:67], v[208:211]
TR a[98:99], v250, 30720
MF v[212:215], a[100:103], v[68:71], v[212:215]
TR a[100:101], v251, 28672
MF v[200:203], a[104:107], v[72:75], v[200:203]
TR a[102:103], v251, 30720
v_mov_b32 v255, 7
MF v[204:207], a[104:107], v[76:79], v[204:207]
TR a[104:105], v250, 32768
MF v[208:211], a[108:111], v[72:75], v[208:211]
TR a[106:107], v250, 34816
MF v[212:215], a[108:111], v[76:79], v[212:215]
TR a[108:109], v251, 32768
s_waitcnt vmcnt(4)
s_waitcnt lgkmcnt(7)
MF v[184:187], a[80:83], v[80:83], v[184:187]
TR a[110:111], v251, 34816
s_cbranch_vccnz kb_kernel_pa79
buffer_store_dword v255, v27, s[60:63], s64 offen offset:4
kb_kernel_pb80:
MF v[188:191], a[80:83], v[84:87], v[188:191]
TR a[80:81], v252, 20480
MF v[192:195], a[84:87], v[80:83], v[192:195]
TR a[82:83], v252, 22528
MF v[196:199], a[84:87], v[84:87], v[196:199]
TR a[84:85], v253, 20480
MF v[184:187], a[88:91], v[88:91], v[184:187]
TR a[86:87], v253, 22528
MF v[188:191], a[88:91], v[92:95], v[188:191]
TR a[88:89], v252, 24576
MF v[192:195], a[92:95], v[88:91], v[192:195]
TR a[90:91], v252, 26624
MF v[196:199], a[92:95], v[92:95], v[196:199]
TR a[92:93], v253, 24576
s_waitcnt lgkmcnt(7)
MF v[184:187], a[96:99], v[96:99], v[184:187]
TR a[94:95], v253, 26624
MF v[188:191], a[96:99], v[100:103], v[188:191]
TR a[96:97], v252, 28672
MF v[192:195], a[100:103], v[96:99], v[192:195]
TR a[98:99], v252, 30720
MF v[196:199], a[100:103], v[100:103], v[196:199]
TR a[100:101], v253, 28672
MF v[184:187], a[104:107], v[104:107], v[184:187]
TR a[102:103], v253, 30720
MF v[188:191], a[104:107], v[108:111], v[188:191]
TR a[104:105], v252, 32768
MF v[192:195], a[108:111], v[104:107], v[192:195]
TR a[106:107], v252, 34816
MF v[196:199], a[108:111], v[108:111], v[196:199]
TR a[108:109], v253, 32768
s_waitcnt vmcnt(3)
MF v[184:187], v[154:157], v[128:131], v[184:187]
TR a[110:111], v253, 34816
MF v[188:191], v[154:157], v[132:135], v[188:191]
MF v[192:195], v[152:155], v[128:131], v[192:195]
MF v[196:199], v[152:155], v[132:135], v[196:199]
s_barrier
s_waitcnt lgkmcnt(8)
MF v[200:203], a[80:83], v[80:83], v[200:203]
MF v[204:207], a[80:83], v[84:87], v[204:207]
TR a[80:81], v21, 0
MF v[208:211], a[84:87], v[80:83], v[208:211]
TR a[82:83], v21, 2048
MF v[212:215], a[84:87], v[84:87], v[212:215]
TR a[84:85], v22, 0
v_cvt_pk_bf16_f32 v216, v184, v185
MF v[200:203], a[88:91], v[88:91], v[200:203]
TR a[86:87], v22, 2048
v_cvt_pk_bf16_f32 v217, v186, v187
MF v[204:207], a[88:91], v[92:95], v[204:207]
TR a[88:89], v21, 4096
v_cvt_pk_bf16_f32 v218, v192, v193
MF v[208:211], a[92:95], v[88:91], v[208:211]
TR a[90:91], v21, 6144
v_cvt_pk_bf16_f32 v219, v194, v195
MF v[212:215], a[92:95], v[92:95], v[212:215]
TR a[92:93], v22, 4096
s_waitcnt lgkmcnt(7)
MF v[200:203], a[96:99], v[96:99], v[200:203]
TR a[94:95], v22, 6144
buffer_store_dwordx4 v[216:219], v25, s[20:23], s79 offen
MF v[204:207], a[96:99], v[100:103], v[204:207]
TR a[96:97], v21, 8192
v_cvt_pk_bf16_f32 v220, v188, v189
MF v[208:211], a[100:103], v[96:99], v[208:211]
TR a[98:99], v21, 10240
v_cvt_pk_bf16_f32 v221, v190, v191
MF v[212:215], a[100:103], v[100:103], v[212:215]
TR a[100:101], v22, 8192
v_cvt_pk_bf16_f32 v222, v196, v197
MF v[200:203], a[104:107], v[104:107], v[200:203]
TR a[102:103], v22, 10240
v_cvt_pk_bf16_f32 v223, v198, v199
MF v[204:207], a[104:107], v[108:111], v[204:207]
TR a[104:105], v21, 12288
buffer_store_dwordx4 v[220:223], v26, s[20:23], s79 offen
MF v[208:211], a[108:111], v[104:107], v[208:211]
TR a[106:107], v21, 14336
MF v[212:215], a[108:111], v[108:111], v[212:215]
TR a[108:109], v22, 12288
s_waitcnt vmcnt(3)
MF v[200:203], v[154:157], v[136:139], v[200:203]
TR a[110:111], v22, 14336
MF v[204:207], v[154:157], v[140:143], v[204:207]
MF v[208:211], v[152:155], v[136:139], v[208:211]
MF v[212:215], v[152:155], v[140:143], v[212:215]
buffer_load_dword v254, v27, s[60:63], s65 offen offset:4 sc1
s_waitcnt lgkmcnt(8)
MF v[184:187], a[80:83], v[40:43], 0
MF v[188:191], a[80:83], v[44:47], 0
TR a[80:81], v21, 16384
MF v[192:195], a[84:87], v[40:43], 0
TR a[82:83], v21, 18432
MF v[196:199], a[84:87], v[44:47], 0
TR a[84:85], v22, 16384
v_cvt_pk_bf16_f32 v224, v200, v201
MF v[184:187], a[88:91], v[48:51], v[184:187]
TR a[86:87], v22, 18432
v_cvt_pk_bf16_f32 v225, v202, v203
MF v[188:191], a[88:91], v[52:55], v[188:191]
TR a[88:89], v23, 0
v_cvt_pk_bf16_f32 v226, v208, v209
MF v[192:195], a[92:95], v[48:51], v[192:195]
TR a[90:91], v23, 2048
v_cvt_pk_bf16_f32 v227, v210, v211
MF v[196:199], a[92:95], v[52:55], v[196:199]
TR a[92:93], v24, 0
s_waitcnt lgkmcnt(7)
MF v[184:187], a[96:99], v[56:59], v[184:187]
TR a[94:95], v24, 2048
buffer_store_dwordx4 v[224:227], v25, s[20:23], s79 offen offset:1024
MF v[188:191], a[96:99], v[60:63], v[188:191]
TR a[96:97], v23, 4096
v_cvt_pk_bf16_f32 v228, v204, v205
MF v[192:195], a[100:103], v[56:59], v[192:195]
TR a[98:99], v23, 6144
v_cvt_pk_bf16_f32 v229, v206, v207
MF v[196:199], a[100:103], v[60:63], v[196:199]
TR a[100:101], v24, 4096
v_cvt_pk_bf16_f32 v230, v212, v213
MF v[184:187], a[104:107], v[64:67], v[184:187]
TR a[102:103], v24, 6144
v_cvt_pk_bf16_f32 v231, v214, v215
MF v[188:191], a[104:107], v[68:71], v[188:191]
TR a[104:105], v23, 8192
buffer_store_dwordx4 v[228:231], v26, s[20:23], s79 offen offset:1024
MF v[192:195], a[108:111], v[64:67], v[192:195]
TR a[106:107], v23, 10240
MF v[196:199], a[108:111], v[68:71], v[196:199]
TR a[108:109], v24, 8192
s_waitcnt lgkmcnt(7)
MF v[184:187], a[80:83], v[72:75], v[184:187]
TR a[110:111], v24, 10240
MF v[188:191], a[80:83], v[76:79], v[188:191]
TR a[80:81], v23, 12288
MF v[192:195], a[84:87], v[72:75], v[192:195]
TR a[82:83], v23, 14336
MF v[196:199], a[84:87], v[76:79], v[196:199]
TR a[84:85], v24, 12288
MF v[200:203], a[88:91], v[40:43], 0
TR a[86:87], v24, 14336
MF v[204:207], a[88:91], v[44:47], 0
TR a[88:89], v23, 16384
MF v[208:211], a[92:95], v[40:43], 0
TR a[90:91], v23, 18432
MF v[212:215], a[92:95], v[44:47], 0
TR a[92:93], v24, 16384
s_waitcnt vmcnt(2)
v_readfirstlane_b32 s68, v254
s_waitcnt lgkmcnt(7)
MF v[200:203], a[96:99], v[48:51], v[200:203]
TR a[94:95], v24, 18432
s_nop 0
s_add_u32 s68, s68, s69
s_cmp_ge_u32 s68, 9
s_cbranch_scc0 kb_kernel_spin93
kb_kernel_spb94:
MF v[204:207], a[96:99], v[52:55], v[204:207]
TR a[96:97], v21, 20480
buffer_load_dwordx4 v[112:115], v25, s[20:23], s80 offen sc1
MF v[208:211], a[100:103], v[48:51], v[208:211]
TR a[98:99], v21, 22528
MF v[212:215], a[100:103], v[52:55], v[212:215]
TR a[100:101], v22, 20480
buffer_load_dwordx4 v[116:119], v26, s[20:23], s80 offen sc1
MF v[200:203], a[104:107], v[56:59], v[200:203]
TR a[102:103], v22, 22528
MF v[204:207], a[104:107], v[60:63], v[204:207]
TR a[104:105], v21, 24576
buffer_load_dwordx4 v[120:123], v25, s[20:23], s80 offen offset:1024 sc1
MF v[208:211], a[108:111], v[56:59], v[208:211]
TR a[106:107], v21, 26624
buffer_load_dwordx4 v[124:127], v26, s[20:23], s80 offen offset:1024 sc1
MF v[212:215], a[108:111], v[60:63], v[212:215]
TR a[108:109], v22, 24576
s_waitcnt lgkmcnt(7)
MF v[200:203], a[80:83], v[64:67], v[200:203]
TR a[110:111], v22, 26624
MF v[204:207], a[80:83], v[68:71], v[204:207]
TR a[80:81], v21, 28672
MF v[208:211], a[84:87], v[64:67], v[208:211]
TR a[82:83], v21, 30720
MF v[212:215], a[84:87], v[68:71], v[212:215]
TR a[84:85], v22, 28672
MF v[200:203], a[88:91], v[72:75], v[200:203]
TR a[86:87], v22, 30720
MF v[204:207], a[88:91], v[76:79], v[204:207]
TR a[88:89], v21, 32768
MF v[208:211], a[92:95], v[72:75], v[208:211]
TR a[90:91], v21, 34816
MF v[212:215], a[92:95], v[76:79], v[212:215]
TR a[92:93], v22, 32768
s_waitcnt lgkmcnt(7)
MF v[184:187], a[96:99], v[80:83], v[184:187]
TR a[94:95], v22, 34816
MF v[188:191], a[96:99], v[84:87], v[188:191]
TR a[96:97], v23, 20480
MF v[192:195], a[100:103], v[80:83], v[192:195]
TR a[98:99], v23, 22528
MF v[196:199], a[100:103], v[84:87], v[196:199]
TR a[100:101], v24, 20480
MF v[184:187], a[104:107], v[88:91], v[184:187]
TR a[102:103], v24, 22528
MF v[188:191], a[104:107], v[92:95], v[188:191]
TR a[104:105], v23, 24576
MF v[192:195], a[108:111], v[88:91], v[192:195]
TR a[106:107], v23, 26624
MF v[196:199], a[108:111], v[92:95], v[196:199]
TR a[108:109], v24, 24576
s_waitcnt lgkmcnt(7)
MF v[184:187], a[80:83], v[96:99], v[184:187]
TR a[110:111], v24, 26624
MF v[188:191], a[80:83], v[100:103], v[188:191]
TR a[80:81], v23, 28672
MF v[192:195], a[84:87], v[96:99], v[192:195]
TR a[82:83], v23, 30720
MF v[196:199], a[84:87], v[100:103], v[196:199]
TR a[84:85], v24, 28672
MF v[184:187], a[88:91], v[104:107], v[184:187]
TR a[86:87], v24, 30720
MF v[188:191], a[88:91], v[108:111], v[188:191]
TR a[88:89], v23, 32768
MF v[192:195], a[92:95], v[104:107], v[192:195]
TR a[90:91], v23, 34816
MF v[196:199], a[92:95], v[108:111], v[196:199]
TR a[92:93], v24, 32768
s_waitcnt vmcnt(2)
MF v[184:187], v[154:157], v[112:115], v[184:187]
TR a[94:95], v24, 34816
MF v[188:191], v[154:157], v[116:119], v[188:191]
MF v[192:195], v[152:155], v[112:115], v[192:195]
MF v[196:199], v[152:155], v[116:119], v[196:199]
s_waitcnt lgkmcnt(8)
MF v[200:203], a[96:99], v[80:83], v[200:203]
MF v[204:207], a[96:99], v[84:87], v[204:207]
MF v[208:211], a[100:103], v[80:83], v[208:211]
MF v[212:215], a[100:103], v[84:87], v[212:215]
v_cvt_pk_bf16_f32 v216, v184, v185
v_cvt_pk_bf16_f32 v217, v186, v187
MF v[200:203], a[104:107], v[88:91], v[200:203]
v_cvt_pk_bf16_f32 v218, v192, v193
v_cvt_pk_bf16_f32 v219, v194, v195
MF v[204:207], a[104:107], v[92:95], v[204:207]
buffer_store_dwordx4 v[216:219], v25, s[20:23], s80 offen
v_cvt_pk_bf16_f32 v220, v188, v189
MF v[208:211], a[108:111], v[88:91], v[208:211]
v_cvt_pk_bf16_f32 v221, v190, v191
v_cvt_pk_bf16_f32 v222, v196, v197
MF v[212:215], a[108:111], v[92:95], v[212:215]
v_cvt_pk_bf16_f32 v223, v198, v199
s_waitcnt lgkmcnt(0)
MF v[200:203], a[80:83], v[96:99], v[200:203]
buffer_store_dwordx4 v[220:223], v26, s[20:23], s80 offen
MF v[204:207], a[80:83], v[100:103], v[204:207]
MF v[208:211], a[84:87], v[96:99], v[208:211]
MF v[212:215], a[84:87], v[100:103], v[212:215]
MF v[200:203], a[88:91], v[104:107], v[200:203]
MF v[204:207], a[88:91], v[108:111], v[204:207]
MF v[208:211], a[92:95], v[104:107], v[208:211]
MF v[212:215], a[92:95], v[108:111], v[212:215]
s_waitcnt vmcnt(2)
MF v[200:203], v[154:157], v[120:123], v[200:203]
MF v[204:207], v[154:157], v[124:127], v[204:207]
MF v[208:211], v[152:155], v[120:123], v[208:211]
MF v[212:215], v[152:155], v[124:127], v[212:215]
s_nop 4
v_cvt_pk_bf16_f32 v224, v200, v201
v_cvt_pk_bf16_f32 v225, v202, v203
v_cvt_pk_bf16_f32 v226, v208, v209
v_cvt_pk_bf16_f32 v227, v210, v211
buffer_store_dwordx4 v[224:227], v25, s[20:23], s80 offen offset:1024
v_cvt_pk_bf16_f32 v228, v204, v205
v_cvt_pk_bf16_f32 v229, v206, v207
v_cvt_pk_bf16_f32 v230, v212, v213
v_cvt_pk_bf16_f32 v231, v214, v215
buffer_store_dwordx4 v[228:231], v26, s[20:23], s80 offen offset:1024
kb_kernel_done1:
s_endpgm
kb_kernel_pa11:
buffer_store_dwordx4 v[216:219], v25, s[20:23], s72 offen sc1
s_branch kb_kernel_pb12
kb_kernel_pa13:
buffer_store_dwordx4 v[220:223], v26, s[20:23], s72 offen sc1
s_branch kb_kernel_pb14
kb_kernel_pa15:
buffer_store_dwordx4 v[224:227], v25, s[20:23], s72 offen offset:1024 sc1
s_branch kb_kernel_pb16
kb_kernel_pa17:
buffer_store_dwordx4 v[228:231], v26, s[20:23], s72 offen offset:1024 sc1
s_branch kb_kernel_pb18
kb_kernel_pa19:
buffer_store_dword v255, v27, s[60:63], s64 offen offset:4 sc1
s_branch kb_kernel_pb20
kb_kernel_pa21:
buffer_store_dwordx4 v[216:219], v25, s[20:23], s73 offen sc1
s_branch kb_kernel_pb22
kb_kernel_pa23:
buffer_store_dwordx4 v[220:223], v26, s[20:23], s73 offen sc1
s_branch kb_kernel_pb24
kb_kernel_pa25:
buffer_store_dwordx4 v[224:227], v25, s[20:23], s73 offen offset:1024 sc1
s_branch kb_kernel_pb26
kb_kernel_pa27:
buffer_store_dwordx4 v[228:231], v26, s[20:23], s73 offen offset:1024 sc1
s_branch kb_kernel_pb28
kb_kernel_pa29:
buffer_store_dword v255, v27, s[60:63], s64 offen offset:4 sc1
s_branch kb_kernel_pb30
kb_kernel_pa31:
buffer_store_dwordx4 v[216:219], v25, s[20:23], s74 offen sc1
s_branch kb_kernel_pb32
kb_kernel_pa33:
buffer_store_dwordx4 v[220:223], v26, s[20:23], s74 offen sc1
s_branch kb_kernel_pb34
kb_kernel_pa35:
buffer_store_dwordx4 v[224:227], v25, s[20:23], s74 offen offset:1024 sc1
s_branch kb_kernel_pb36
kb_kernel_pa37:
buffer_store_dwordx4 v[228:231], v26, s[20:23], s74 offen offset:1024 sc1
s_branch kb_kernel_pb38
kb_kernel_pa39:
buffer_store_dword v255, v27, s[60:63], s64 offen offset:4 sc1
s_branch kb_kernel_pb40
kb_kernel_pa41:
buffer_store_dwordx4 v[216:219], v25, s[20:23], s75 offen sc1
s_branch kb_kernel_pb42
kb_kernel_pa43:
buffer_store_dwordx4 v[220:223], v26, s[20:23], s75 offen sc1
s_branch kb_kernel_pb44
kb_kernel_pa45:
buffer_store_dwordx4 v[224:227], v25, s[20:23], s75 offen offset:1024 sc1
s_branch kb_kernel_pb46
kb_kernel_pa47:
buffer_store_dwordx4 v[228:231], v26, s[20:23], s75 offen offset:1024 sc1
s_branch kb_kernel_pb48
kb_kernel_pa49:
buffer_store_dword v255, v27, s[60:63], s64 offen offset:4 sc1
s_branch kb_kernel_pb50
kb_kernel_pa51:
buffer_store_dwordx4 v[216:219], v25, s[20:23], s76 offen sc1
s_branch kb_kernel_pb52
kb_kernel_pa53:
buffer_store_dwordx4 v[220:223], v26, s[20:23], s76 offen sc1
s_branch kb_kernel_pb54
kb_kernel_pa55:
buffer_store_dwordx4 v[224:227], v25, s[20:23], s76 offen offset:1024 sc1
s_branch kb_kernel_pb56
kb_kernel_pa57:
buffer_store_dwordx4 v[228:231], v26, s[20:23], s76 offen offset:1024 sc1
s_branch kb_kernel_pb58
kb_kernel_pa59:
buffer_store_dword v255, v27, s[60:63], s64 offen offset:4 sc1
s_branch kb_kernel_pb60
kb_kernel_pa61:
buffer_store_dwordx4 v[216:219], v25, s[20:23], s77 offen sc1
s_branch kb_kernel_pb62
kb_kernel_pa63:
buffer_store_dwordx4 v[220:223], v26, s[20:23], s77 offen sc1
s_branch kb_kernel_pb64
kb_kernel_pa65:
buffer_store_dwordx4 v[224:227], v25, s[20:23], s77 offen offset:1024 sc1
s_branch kb_kernel_pb66
kb_kernel_pa67:
buffer_store_dwordx4 v[228:231], v26, s[20:23], s77 offen offset:1024 sc1
s_branch kb_kernel_pb68
kb_kernel_pa69:
buffer_store_dword v255, v27, s[60:63], s64 offen offset:4 sc1
s_branch kb_kernel_pb70
kb_kernel_pa71:
buffer_store_dwordx4 v[216:219], v25, s[20:23], s78 offen sc1
s_branch kb_kernel_pb72
kb_kernel_pa73:
buffer_store_dwordx4 v[220:223], v26, s[20:23], s78 offen sc1
s_branch kb_kernel_pb74
kb_kernel_pa75:
buffer_store_dwordx4 v[224:227], v25, s[20:23], s78 offen offset:1024 sc1
s_branch kb_kernel_pb76
kb_kernel_pa77:
buffer_store_dwordx4 v[228:231], v26, s[20:23], s78 offen offset:1024 sc1
s_branch kb_kernel_pb78
kb_kernel_pa79:
buffer_store_dword v255, v27, s[60:63], s64 offen offset:4 sc1
s_branch kb_kernel_pb80
kb_kernel_spin81:
buffer_load_dword v254, v27, s[60:63], s65 offen offset:4 sc1
s_add_u32 s3, s3, 1
s_cmp_gt_u32 s3, 0x80000
s_cbranch_scc1 kb_kernel_spb82
s_waitcnt vmcnt(0)
v_readfirstlane_b32 s68, v254
s_nop 0
s_add_u32 s68, s68, s69
s_cmp_ge_u32 s68, 3
s_cbranch_scc0 kb_kernel_spin81
s_branch kb_kernel_spb82
kb_kernel_spin83:
buffer_load_dword v254, v27, s[60:63], s65 offen offset:4 sc1
s_add_u32 s3, s3, 1
s_cmp_gt_u32 s3, 0x80000
s_cbranch_scc1 kb_kernel_spb84
s_waitcnt vmcnt(0)
v_readfirstlane_b32 s68, v254
s_nop 0
s_add_u32 s68, s68, s69
s_cmp_ge_u32 s68, 4
s_cbranch_scc0 kb_kernel_spin83
s_branch kb_kernel_spb84
kb_kernel_spin85:
buffer_load_dword v254, v27, s[60:63], s65 offen offset:4 sc1
s_add_u32 s3, s3, 1
s_cmp_gt_u32 s3, 0x80000
s_cbranch_scc1 kb_kernel_spb86
s_waitcnt vmcnt(0)
v_readfirstlane_b32 s68, v254
s_nop 0
s_add_u32 s68, s68, s69
s_cmp_ge_u32 s68, 5
s_cbranch_scc0 kb_kernel_spin85
s_branch kb_kernel_spb86
kb_kernel_spin87:
buffer_load_dword v254, v27, s[60:63], s65 offen offset:4 sc1
s_add_u32 s3, s3, 1
s_cmp_gt_u32 s3, 0x80000
s_cbranch_scc1 kb_kernel_spb88
s_waitcnt vmcnt(0)
v_readfirstlane_b32 s68, v254
s_nop 0
s_add_u32 s68, s68, s69
s_cmp_ge_u32 s68, 6
s_cbranch_scc0 kb_kernel_spin87
s_branch kb_kernel_spb88
kb_kernel_spin89:
buffer_load_dword v254, v27, s[60:63], s65 offen offset:4 sc1
s_add_u32 s3, s3, 1
s_cmp_gt_u32 s3, 0x80000
s_cbranch_scc1 kb_kernel_spb90
s_waitcnt vmcnt(0)
v_readfirstlane_b32 s68, v254
s_nop 0
s_add_u32 s68, s68, s69
s_cmp_ge_u32 s68, 7
s_cbranch_scc0 kb_kernel_spin89
s_branch kb_kernel_spb90
kb_kernel_spin91:
buffer_load_dword v254, v27, s[60:63], s65 offen offset:4 sc1
s_add_u32 s3, s3, 1
s_cmp_gt_u32 s3, 0x80000
s_cbranch_scc1 kb_kernel_spb92
s_waitcnt vmcnt(0)
v_readfirstlane_b32 s68, v254
s_nop 0
s_add_u32 s68, s68, s69
s_cmp_ge_u32 s68, 8
s_cbranch_scc0 kb_kernel_spin91
s_branch kb_kernel_spb92
kb_kernel_spin93:
buffer_load_dword v254, v27, s[60:63], s65 offen offset:4 sc1
s_add_u32 s3, s3, 1
s_cmp_gt_u32 s3, 0x80000
s_cbranch_scc1 kb_kernel_spb94
s_waitcnt vmcnt(0)
v_readfirstlane_b32 s68, v254
s_nop 0
s_add_u32 s68, s68, s69
s_cmp_ge_u32 s68, 9
s_cbranch_scc0 kb_kernel_spin93
s_branch kb_kernel_spb94

.globl k0_kernel
.p2align 8
.type k0_kernel,@function
k0_kernel:
s_cmp_ge_u32 s2, 256
s_cbranch_scc1 k0_kernel_done1
s_load_dwordx2 s[20:21], s[0:1], 0
s_load_dwordx4 s[64:67], s[0:1], 72
s_load_dwordx4 s[68:71], s[0:1], 96
s_load_dwordx8 s[40:47], s[0:1], 8
v_lshrrev_b32 v2, 6, v0
v_and_b32 v1, 7, v0
v_readfirstlane_b32 s72, v2
v_lshrrev_b32 v2, 3, v0
v_lshlrev_b32 v3, 8, v2
v_lshl_add_u32 v3, v1, 4, v3
v_lshrrev_b32 v4, 2, v2
v_and_b32 v5, 3, v2
v_lshlrev_b32 v6, 6, v4
v_lshl_add_u32 v6, v5, 3, v6
v_lshlrev_b32 v7, 1, v6
s_movk_i32 s26, 1152
v_mad_u32_u24 v6, v1, s26, v6
s_lshr_b32 s27, s2, 1
s_mul_i32 s27, s27, 18432
s_and_b32 s28, s2, 1
s_lshl_b32 s28, s28, 7
s_add_u32 s27, s27, s28
s_mul_i32 s28, s2, 9216
v_subrev_u32 v122, 320, v0
v_lshrrev_b32 v100, 1, v122
v_and_b32 v101, 1, v0
s_movk_i32 s26, 6912
v_mul_u32_u24 v102, s26, v100
v_lshl_add_u32 v102, v101, 4, v102
v_lshlrev_b32 v103, 1, v100
s_andn2_b32 s24, s2, 31
s_and_b32 s25, s2, 7
s_lshl_b32 s25, s25, 2
s_or_b32 s24, s24, s25
s_bfe_u32 s25, s2, 0x20003
s_or_b32 s24, s24, s25
s_lshl_b32 s29, s24, 5
s_cmp_ge_u32 s72, 5
s_cselect_b32 s73, 1, 0
s_cmp_lt_u32 s24, 216
s_cselect_b32 s73, s73, 0
s_waitcnt lgkmcnt(0)
s_mov_b32 s12, s20
s_mov_b32 s13, s21
s_mov_b32 s14, 2359296
s_mov_b32 s15, 0x00020000
s_mov_b32 s4, s70
s_mov_b32 s5, s71
s_mov_b32 s6, 36864
s_mov_b32 s7, 0x00020000
s_add_u32 s32, s70, 65536
s_addc_u32 s33, s71, 0
s_mov_b32 s34, 2359296
s_mov_b32 s35, 0x00020000
s_mov_b32 s8, s64
s_mov_b32 s9, s65
s_mov_b32 s10, 1152
s_mov_b32 s11, 0x00020000
s_mov_b32 s16, s66
s_mov_b32 s17, s67
s_mov_b32 s18, 3981312
s_mov_b32 s19, 0x00020000
s_mov_b32 s36, s68
s_mov_b32 s37, s69
s_mov_b32 s38, 256
s_mov_b32 s39, 0x00020000
s_add_u32 s20, s70, 9437184
s_addc_u32 s21, s71, 0
s_mov_b32 s22, 180224
s_mov_b32 s23, 0x00020000
v_lshlrev_b32 v104, 4, v0
v_lshlrev_b32 v105, 1, v0
s_lshl_b32 s30, s72, 10
s_add_u32 m0, s30, 8192
s_nop 0
buffer_load_dwordx4 v104, s[12:15], s28 offen lds
buffer_load_ushort v106, v105, s[8:11], 0 offen
s_cmp_eq_u32 s73, 0
s_cbranch_scc1 k0_kernel_nm12
buffer_load_dwordx4 v[32:35], v102, s[16:19], s29 offen
v_add_u32 v102, 884736, v102
buffer_load_dwordx4 v[36:39], v102, s[16:19], s29 offen
v_add_u32 v102, 884736, v102
buffer_load_dwordx4 v[40:43], v102, s[16:19], s29 offen
v_add_u32 v102, 884736, v102
buffer_load_dwordx4 v[44:47], v102, s[16:19], s29 offen
v_add_u32 v102, 884736, v102
buffer_load_dwordx4 v[48:51], v102, s[16:19], s29 offen
v_add_u32 v102, 884736, v102
k0_kernel_nm12:
s_cmp_ge_u32 s72, 4
s_cbranch_scc1 k0_kernel_nopf7
v_mov_b32 v110, v0
v_mov_b32 v111, 0
v_lshlrev_b32 v112, 2, v110
s_lshl_b32 s30, s2, 10
buffer_store_dword v111, v112, s[20:23], s30 offen
v_and_b32 v113, 63, v0
v_lshlrev_b32 v114, 4, v113
s_mov_b32 s74, s72
s_mov_b32 s48, s40
s_mov_b32 s49, s41
s_mov_b32 s50, 8388608
s_mov_b32 s51, 0x00020000
s_mov_b32 s52, s42
s_mov_b32 s53, s43
s_mov_b32 s54, 8388608
s_mov_b32 s55, 0x00020000
s_mov_b32 s56, s44
s_mov_b32 s57, s45
s_mov_b32 s58, 4718592
s_mov_b32 s59, 0x00020000
s_getreg_b32 s75, hwreg(HW_REG_XCC_ID, 0, 3)
s_andn2_b32 s60, s2, 7
s_or_b32 s75, s75, s60
s_and_b32 s60, s75, 3
s_lshl_b32 s60, s60, 2
s_bfe_u32 s61, s75, 0x20003
s_add_u32 s60, s60, s61
s_lshr_b32 s61, s75, 5
s_bitcmp1_b32 s75, 2
s_cselect_b32 vcc_lo, 8, 0
s_add_u32 s61, s61, vcc_lo
s_and_b32 s61, s61, 7
v_lshrrev_b32 v112, 5, v113
v_and_b32 v115, 31, v113
s_mov_b32 s63, 8192
v_lshlrev_b32 v115, 4, v115
v_mad_u32_u24 v112, v112, s63, v115
s_mul_i32 s62, s61, 24
s_mul_i32 s63, s74, 2
s_add_u32 s62, s62, s63
s_mul_i32 s62, s62, 8192
s_mul_i32 s63, s60, 512
s_add_u32 s62, s62, s63
buffer_load_dwordx4 v[116:119], v112, s[56:59], s62 offen
s_add_u32 s62, s62, 65536
buffer_load_dwordx4 v[116:119], v112, s[56:59], s62 offen
s_add_u32 s62, s62, 65536
buffer_load_dwordx4 v[116:119], v112, s[56:59], s62 offen
s_getpc_b64 s[56:57]
k0_kernel_pc11:
s_add_u32 s56, s56, ka_kernel-k0_kernel_pc11
s_addc_u32 s57, s57, (ka_kernel-k0_kernel_pc11)>>32
s_mov_b32 s58, kb_kernel-ka_kernel
s_mov_b32 s59, 0x00020000
s_lshr_b32 s62, s2, 3
s_mul_i32 s62, s62, 2048
buffer_load_dwordx4 v[116:119], v114, s[56:59], s62 offen
buffer_load_dwordx4 v[116:119], v114, s[56:59], s62 offen offset:1024
k0_kernel_nopf7:
s_cmp_ge_u32 s72, 4
s_cbranch_scc1 k0_kernel_xw12b
s_waitcnt vmcnt(6)
s_branch k0_kernel_xw12
k0_kernel_xw12b:
s_waitcnt vmcnt(5)
s_cmp_lg_u32 s73, 0
s_cbranch_scc1 k0_kernel_xw12
s_waitcnt vmcnt(0)
k0_kernel_xw12:
v_lshlrev_b32 v106, 16, v106
v_mul_f32 v109, 0xbfb8aa3b, v106
v_exp_f32 v109, v109
v_lshlrev_b32 v105, 2, v0
v_add_f32 v109, 1.0, v109
v_rcp_f32 v109, v109
v_mov_b32 v107, 0
v_mul_f32 v106, v106, v109
v_cvt_pk_bf16_f32 v106, v106, v106
v_and_b32 v106, 0xffff0000, v106
ds_write_b32 v105, v106 offset:4096
s_cmp_lg_u32 s72, 8
s_cbranch_scc1 k0_kernel_zl10
ds_write_b32 v105, v107 offset:4352
k0_kernel_zl10:
s_waitcnt lgkmcnt(0)
s_barrier
ds_read_b64 v[8:9], v6 offset:8192
ds_read_b64 v[10:11], v6 offset:8224
s_waitcnt lgkmcnt(0)
v_lshlrev_b32 v16, 16, v8
v_and_b32 v17, 0xffff0000, v8
v_lshlrev_b32 v18, 16, v9
v_and_b32 v19, 0xffff0000, v9
v_lshlrev_b32 v20, 16, v10
v_and_b32 v21, 0xffff0000, v10
v_lshlrev_b32 v22, 16, v11
v_and_b32 v23, 0xffff0000, v11
v_lshrrev_b32 v12, 4, v0
v_mul_u32_u24 v13, 144, v1
v_lshl_add_u32 v12, v12, 2, v13
v_and_b32 v14, 8, v0
v_cmp_eq_u32 s[76:77], 0, v14
v_add_f32 v56, v16, v17
v_add_f32 v14, v18, v19
v_add_f32 v15, v20, v21
v_add_f32 v56, v56, v14
v_add_f32 v14, v22, v23
v_add_f32 v15, v15, v14
v_add_f32 v56, v56, v15
s_nop 1
v_add_f32_dpp v56, v56, v56 row_ror:8 row_mask:0xf bank_mask:0xf
s_and_saveexec_b64 s[30:31], s[76:77]
ds_write_b32 v12, v56 offset:0
s_mov_b64 exec, s[30:31]
s_waitcnt lgkmcnt(0)
s_barrier
ds_read_b128 v[64:67], v13 offset:0
ds_read_b128 v[68:71], v13 offset:16
ds_read_b128 v[72:75], v13 offset:32
ds_read_b128 v[76:79], v13 offset:48
ds_read_b128 v[80:83], v13 offset:64
ds_read_b128 v[84:87], v13 offset:80
ds_read_b128 v[88:91], v13 offset:96
ds_read_b128 v[92:95], v13 offset:112
ds_read_b128 v[96:99], v13 offset:128
s_waitcnt lgkmcnt(0)
v_add_f32 v64, v64, v82
v_add_f32 v65, v65, v83
v_add_f32 v66, v66, v84
v_add_f32 v67, v67, v85
v_add_f32 v68, v68, v86
v_add_f32 v69, v69, v87
v_add_f32 v70, v70, v88
v_add_f32 v71, v71, v89
v_add_f32 v72, v72, v90
v_add_f32 v73, v73, v91
v_add_f32 v74, v74, v92
v_add_f32 v75, v75, v93
v_add_f32 v76, v76, v94
v_add_f32 v77, v77, v95
v_add_f32 v78, v78, v96
v_add_f32 v79, v79, v97
v_add_f32 v80, v80, v98
v_add_f32 v81, v81, v99
v_add_f32 v64, v64, v73
v_add_f32 v65, v65, v74
v_add_f32 v66, v66, v75
v_add_f32 v67, v67, v76
v_add_f32 v68, v68, v77
v_add_f32 v69, v69, v78
v_add_f32 v70, v70, v79
v_add_f32 v71, v71, v80
v_add_f32 v72, v72, v81
v_add_f32 v64, v64, v65
v_add_f32 v64, v64, v66
v_add_f32 v64, v64, v67
v_add_f32 v64, v64, v68
v_add_f32 v64, v64, v69
v_add_f32 v64, v64, v70
v_add_f32 v64, v64, v71
v_add_f32 v64, v64, v72
v_mul_f32 v56, 0x3ae38e39, v64
s_cmp_eq_u32 s73, 0
s_cbranch_scc1 k0_kernel_nm23
v_lshlrev_b32 v103, 1, v103
ds_read_b32 v104, v103 offset:4096
ds_read_b32 v105, v103 offset:4608
ds_read_b32 v106, v103 offset:5120
ds_read_b32 v107, v103 offset:5632
ds_read_b32 v108, v103 offset:6144
s_waitcnt vmcnt(0) lgkmcnt(0)
v_mov_b32 v84, 0
v_mov_b32 v85, 0
v_mov_b32 v86, 0
v_mov_b32 v87, 0
v_mov_b32 v88, 0
v_mov_b32 v89, 0
v_mov_b32 v90, 0
v_mov_b32 v91, 0
v_lshlrev_b32 v92, 16, v32
v_and_b32 v93, 0xffff0000, v32
v_lshlrev_b32 v94, 16, v33
v_and_b32 v95, 0xffff0000, v33
v_lshlrev_b32 v96, 16, v34
v_and_b32 v97, 0xffff0000, v34
v_lshlrev_b32 v98, 16, v35
v_and_b32 v99, 0xffff0000, v35
v_fmac_f32 v84, v104, v92
v_fmac_f32 v85, v104, v93
v_fmac_f32 v86, v104, v94
v_fmac_f32 v87, v104, v95
v_fmac_f32 v88, v104, v96
v_fmac_f32 v89, v104, v97
v_fmac_f32 v90, v104, v98
v_fmac_f32 v91, v104, v99
v_lshlrev_b32 v92, 16, v36
v_and_b32 v93, 0xffff0000, v36
v_lshlrev_b32 v94, 16, v37
v_and_b32 v95, 0xffff0000, v37
v_lshlrev_b32 v96, 16, v38
v_and_b32 v97, 0xffff0000, v38
v_lshlrev_b32 v98, 16, v39
v_and_b32 v99, 0xffff0000, v39
v_fmac_f32 v84, v105, v92
v_fmac_f32 v85, v105, v93
v_fmac_f32 v86, v105, v94
v_fmac_f32 v87, v105, v95
v_fmac_f32 v88, v105, v96
v_fmac_f32 v89, v105, v97
v_fmac_f32 v90, v105, v98
v_fmac_f32 v91, v105, v99
v_lshlrev_b32 v92, 16, v40
v_and_b32 v93, 0xffff0000, v40
v_lshlrev_b32 v94, 16, v41
v_and_b32 v95, 0xffff0000, v41
v_lshlrev_b32 v96, 16, v42
v_and_b32 v97, 0xffff0000, v42
v_lshlrev_b32 v98, 16, v43
v_and_b32 v99, 0xffff0000, v43
v_fmac_f32 v84, v106, v92
v_fmac_f32 v85, v106, v93
v_fmac_f32 v86, v106, v94
v_fmac_f32 v87, v106, v95
v_fmac_f32 v88, v106, v96
v_fmac_f32 v89, v106, v97
v_fmac_f32 v90, v106, v98
v_fmac_f32 v91, v106, v99
v_lshlrev_b32 v92, 16, v44
v_and_b32 v93, 0xffff0000, v44
v_lshlrev_b32 v94, 16, v45
v_and_b32 v95, 0xffff0000, v45
v_lshlrev_b32 v96, 16, v46
v_and_b32 v97, 0xffff0000, v46
v_lshlrev_b32 v98, 16, v47
v_and_b32 v99, 0xffff0000, v47
v_fmac_f32 v84, v107, v92
v_fmac_f32 v85, v107, v93
v_fmac_f32 v86, v107, v94
v_fmac_f32 v87, v107, v95
v_fmac_f32 v88, v107, v96
v_fmac_f32 v89, v107, v97
v_fmac_f32 v90, v107, v98
v_fmac_f32 v91, v107, v99
v_lshlrev_b32 v92, 16, v48
v_and_b32 v93, 0xffff0000, v48
v_lshlrev_b32 v94, 16, v49
v_and_b32 v95, 0xffff0000, v49
v_lshlrev_b32 v96, 16, v50
v_and_b32 v97, 0xffff0000, v50
v_lshlrev_b32 v98, 16, v51
v_and_b32 v99, 0xffff0000, v51
v_fmac_f32 v84, v108, v92
v_fmac_f32 v85, v108, v93
v_fmac_f32 v86, v108, v94
v_fmac_f32 v87, v108, v95
v_fmac_f32 v88, v108, v96
v_fmac_f32 v89, v108, v97
v_fmac_f32 v90, v108, v98
v_fmac_f32 v91, v108, v99
s_nop 1
v_add_f32_dpp v84, v84, v84 row_shr:2 row_mask:0xf bank_mask:0xf bound_ctrl:0
v_add_f32_dpp v85, v85, v85 row_shr:2 row_mask:0xf bank_mask:0xf bound_ctrl:0
v_add_f32_dpp v86, v86, v86 row_shr:2 row_mask:0xf bank_mask:0xf bound_ctrl:0
v_add_f32_dpp v87, v87, v87 row_shr:2 row_mask:0xf bank_mask:0xf bound_ctrl:0
v_add_f32_dpp v88, v88, v88 row_shr:2 row_mask:0xf bank_mask:0xf bound_ctrl:0
v_add_f32_dpp v89, v89, v89 row_shr:2 row_mask:0xf bank_mask:0xf bound_ctrl:0
v_add_f32_dpp v90, v90, v90 row_shr:2 row_mask:0xf bank_mask:0xf bound_ctrl:0
v_add_f32_dpp v91, v91, v91 row_shr:2 row_mask:0xf bank_mask:0xf bound_ctrl:0
s_nop 1
v_add_f32_dpp v84, v84, v84 row_shr:4 row_mask:0xf bank_mask:0xf bound_ctrl:0
v_add_f32_dpp v85, v85, v85 row_shr:4 row_mask:0xf bank_mask:0xf bound_ctrl:0
v_add_f32_dpp v86, v86, v86 row_shr:4 row_mask:0xf bank_mask:0xf bound_ctrl:0
v_add_f32_dpp v87, v87, v87 row_shr:4 row_mask:0xf bank_mask:0xf bound_ctrl:0
v_add_f32_dpp v88, v88, v88 row_shr:4 row_mask:0xf bank_mask:0xf bound_ctrl:0
v_add_f32_dpp v89, v89, v89 row_shr:4 row_mask:0xf bank_mask:0xf bound_ctrl:0
v_add_f32_dpp v90, v90, v90 row_shr:4 row_mask:0xf bank_mask:0xf bound_ctrl:0
v_add_f32_dpp v91, v91, v91 row_shr:4 row_mask:0xf bank_mask:0xf bound_ctrl:0
s_nop 1
v_add_f32_dpp v84, v84, v84 row_shr:8 row_mask:0xf bank_mask:0xf bound_ctrl:0
v_add_f32_dpp v85, v85, v85 row_shr:8 row_mask:0xf bank_mask:0xf bound_ctrl:0
v_add_f32_dpp v86, v86, v86 row_shr:8 row_mask:0xf bank_mask:0xf bound_ctrl:0
v_add_f32_dpp v87, v87, v87 row_shr:8 row_mask:0xf bank_mask:0xf bound_ctrl:0
v_add_f32_dpp v88, v88, v88 row_shr:8 row_mask:0xf bank_mask:0xf bound_ctrl:0
v_add_f32_dpp v89, v89, v89 row_shr:8 row_mask:0xf bank_mask:0xf bound_ctrl:0
v_add_f32_dpp v90, v90, v90 row_shr:8 row_mask:0xf bank_mask:0xf bound_ctrl:0
v_add_f32_dpp v91, v91, v91 row_shr:8 row_mask:0xf bank_mask:0xf bound_ctrl:0
v_and_b32 v92, 15, v0
v_cmp_le_u32 vcc, 14, v92
v_lshrrev_b32 v93, 4, v122
v_lshlrev_b32 v93, 6, v93
v_lshl_add_u32 v93, v101, 5, v93
s_and_saveexec_b64 s[30:31], vcc
ds_write_b128 v93, v[84:87] offset:2304
ds_write_b128 v93, v[88:91] offset:2320
s_mov_b64 exec, s[30:31]
k0_kernel_nm23:
v_sub_f32 v24, v16, v56
v_sub_f32 v25, v17, v56
v_sub_f32 v26, v18, v56
v_sub_f32 v27, v19, v56
v_sub_f32 v28, v20, v56
v_sub_f32 v29, v21, v56
v_sub_f32 v30, v22, v56
v_sub_f32 v31, v23, v56
v_mul_f32 v24, v24, v24
v_mul_f32 v25, v25, v25
v_mul_f32 v26, v26, v26
v_mul_f32 v27, v27, v27
v_mul_f32 v28, v28, v28
v_mul_f32 v29, v29, v29
v_mul_f32 v30, v30, v30
v_mul_f32 v31, v31, v31
v_add_f32 v57, v24, v25
v_add_f32 v14, v26, v27
v_add_f32 v15, v28, v29
v_add_f32 v57, v57, v14
v_add_f32 v14, v30, v31
v_add_f32 v15, v15, v14
v_add_f32 v57, v57, v15
s_nop 1
v_add_f32_dpp v57, v57, v57 row_ror:8 row_mask:0xf bank_mask:0xf
s_and_saveexec_b64 s[30:31], s[76:77]
ds_write_b32 v12, v57 offset:1152
s_mov_b64 exec, s[30:31]
s_waitcnt lgkmcnt(0)
s_barrier
s_cmp_lg_u32 s72, 8
s_cbranch_scc1 k0_kernel_nm34
s_cmp_eq_u32 s73, 0
s_cbranch_scc1 k0_kernel_nm34
v_and_b32 v100, 15, v0
v_lshlrev_b32 v100, 2, v100
ds_read_b32 v64, v100 offset:2304
ds_read_b32 v65, v100 offset:2368
ds_read_b32 v66, v100 offset:2432
ds_read_b32 v67, v100 offset:2496
ds_read_b32 v68, v100 offset:2560
ds_read_b32 v69, v100 offset:2624
ds_read_b32 v70, v100 offset:2688
ds_read_b32 v71, v100 offset:2752
ds_read_b32 v72, v100 offset:2816
ds_read_b32 v73, v100 offset:2880
ds_read_b32 v74, v100 offset:2944
ds_read_b32 v75, v100 offset:3008
ds_read_b32 v76, v100 offset:3072
ds_read_b32 v77, v100 offset:3136
ds_read_b32 v78, v100 offset:3200
ds_read_b32 v79, v100 offset:3264
s_waitcnt lgkmcnt(0)
v_add_f32 v64, v64, v72
v_add_f32 v65, v65, v73
v_add_f32 v66, v66, v74
v_add_f32 v67, v67, v75
v_add_f32 v68, v68, v76
v_add_f32 v69, v69, v77
v_add_f32 v70, v70, v78
v_add_f32 v71, v71, v79
v_add_f32 v64, v64, v68
v_add_f32 v65, v65, v69
v_add_f32 v66, v66, v70
v_add_f32 v67, v67, v71
v_add_f32 v64, v64, v66
v_add_f32 v65, v65, v67
v_add_f32 v64, v64, v65
v_cvt_pk_bf16_f32 v64, v64, v64
v_and_b32 v64, 0xffff0000, v64
v_add_f32 v65, 1.0, v64
v_cvt_pk_bf16_f32 v65, v65, v65
v_and_b32 v65, 0xffff0000, v65
s_mul_i32 s30, s24, 1821
s_lshr_b32 s30, s30, 16
s_cmp_eq_u32 s30, 1
s_cselect_b32 s31, 1, 0
s_cmp_eq_u32 s30, 4
s_cselect_b32 s31, 1, s31
s_cmp_eq_u32 s31, 1
s_cselect_b64 vcc, -1, 0
v_cndmask_b32 v64, v64, v65, vcc
s_lshl_b32 s30, s24, 6
buffer_store_dword v64, v100, s[4:7], s30 offen
s_cmp_lt_u32 s24, 72
s_cbranch_scc1 k0_kernel_tab18
s_cmp_lt_u32 s24, 180
s_cbranch_scc1 k0_kernel_tab29
s_sub_u32 s31, s24, 180
s_and_b32 s75, s31, 1
s_lshl_b32 s75, s75, 4
s_lshr_b32 s31, s31, 1
s_lshl_b32 s31, s31, 7
s_add_u32 s75, s75, s31
s_add_u32 s75, s75, 31744
v_and_b32 v65, 0x30, v100
v_and_b32 v66, 0xc, v100
v_lshl_add_u32 v65, v65, 1, v66
buffer_store_dword v64, v65, s[4:7], s75 offen
s_branch k0_kernel_nm34
k0_kernel_tab29:
s_mul_i32 s30, s24, 1821
s_lshr_b32 s30, s30, 16
s_mul_i32 s31, s30, 36
s_sub_u32 s31, s24, s31
s_cmp_eq_u32 s30, 2
s_cselect_b32 s75, 0, 64
s_cmp_eq_u32 s30, 4
s_cselect_b32 s75, 32, s75
s_and_b32 s30, s31, 1
s_lshl_b32 s30, s30, 4
s_add_u32 s75, s75, s30
s_lshr_b32 s31, s31, 1
s_mul_i32 s31, s31, 384
s_add_u32 s75, s75, s31
s_add_u32 s75, s75, 24576
v_lshrrev_b32 v65, 4, v100
v_mul_u32_u24 v65, 96, v65
v_and_b32 v66, 0xc, v100
v_add_u32 v65, v65, v66
buffer_store_dword v64, v65, s[4:7], s75 offen
s_branch k0_kernel_nm34
k0_kernel_tab18:
v_mul_f32 v64, 0x3e0293ee, v64
v_and_b32 v65, 0x30, v100
v_and_b32 v66, 0xc, v100
v_lshl_add_u32 v65, v65, 2, v66
s_cmp_lt_u32 s24, 36
s_cselect_b32 s31, 32, 0
s_cselect_b32 s30, 0, 36
s_sub_u32 s30, s24, s30
s_and_b32 s75, s30, 1
s_lshl_b32 s75, s75, 4
s_add_u32 s31, s31, s75
s_lshr_b32 s30, s30, 1
s_lshl_b32 s30, s30, 8
s_add_u32 s30, s30, s31
s_add_u32 s30, s30, 16384
buffer_store_dword v64, v65, s[4:7], s30 offen
k0_kernel_nm34:
ds_read_b128 v[64:67], v13 offset:1152
ds_read_b128 v[68:71], v13 offset:1168
ds_read_b128 v[72:75], v13 offset:1184
ds_read_b128 v[76:79], v13 offset:1200
ds_read_b128 v[80:83], v13 offset:1216
ds_read_b128 v[84:87], v13 offset:1232
ds_read_b128 v[88:91], v13 offset:1248
ds_read_b128 v[92:95], v13 offset:1264
ds_read_b128 v[96:99], v13 offset:1280
s_waitcnt lgkmcnt(0)
v_add_f32 v64, v64, v82
v_add_f32 v65, v65, v83
v_add_f32 v66, v66, v84
v_add_f32 v67, v67, v85
v_add_f32 v68, v68, v86
v_add_f32 v69, v69, v87
v_add_f32 v70, v70, v88
v_add_f32 v71, v71, v89
v_add_f32 v72, v72, v90
v_add_f32 v73, v73, v91
v_add_f32 v74, v74, v92
v_add_f32 v75, v75, v93
v_add_f32 v76, v76, v94
v_add_f32 v77, v77, v95
v_add_f32 v78, v78, v96
v_add_f32 v79, v79, v97
v_add_f32 v80, v80, v98
v_add_f32 v81, v81, v99
v_add_f32 v64, v64, v73
v_add_f32 v65, v65, v74
v_add_f32 v66, v66, v75
v_add_f32 v67, v67, v76
v_add_f32 v68, v68, v77
v_add_f32 v69, v69, v78
v_add_f32 v70, v70, v79
v_add_f32 v71, v71, v80
v_add_f32 v72, v72, v81
v_add_f32 v64, v64, v65
v_add_f32 v64, v64, v66
v_add_f32 v64, v64, v67
v_add_f32 v64, v64, v68
v_add_f32 v64, v64, v69
v_add_f32 v64, v64, v70
v_add_f32 v64, v64, v71
v_add_f32 v64, v64, v72
v_mul_f32 v57, 0x3ae38e39, v64
v_cvt_pk_bf16_f32 v57, v56, v57
v_lshlrev_b32 v56, 16, v57
v_and_b32 v57, 0xffff0000, v57
v_add_f32 v57, 0x3727c5ac, v57
v_cvt_pk_bf16_f32 v57, v57, v57
v_and_b32 v57, 0xffff0000, v57
v_sqrt_f32 v57, v57
s_nop 0
v_cvt_pk_bf16_f32 v57, v57, v57
v_and_b32 v57, 0xffff0000, v57
v_rcp_f32 v57, v57
v_sub_f32 v16, v16, v56
v_sub_f32 v17, v17, v56
v_sub_f32 v18, v18, v56
v_sub_f32 v19, v19, v56
v_sub_f32 v20, v20, v56
v_sub_f32 v21, v21, v56
v_sub_f32 v22, v22, v56
v_sub_f32 v23, v23, v56
v_cvt_pk_bf16_f32 v17, v16, v17
v_cvt_pk_bf16_f32 v19, v18, v19
v_cvt_pk_bf16_f32 v21, v20, v21
v_cvt_pk_bf16_f32 v23, v22, v23
v_lshlrev_b32 v16, 16, v17
v_and_b32 v17, 0xffff0000, v17
v_lshlrev_b32 v18, 16, v19
v_and_b32 v19, 0xffff0000, v19
v_lshlrev_b32 v20, 16, v21
v_and_b32 v21, 0xffff0000, v21
v_lshlrev_b32 v22, 16, v23
v_and_b32 v23, 0xffff0000, v23
v_mul_f32 v16, v16, v57
v_mul_f32 v17, v17, v57
v_mul_f32 v18, v18, v57
v_mul_f32 v19, v19, v57
v_mul_f32 v20, v20, v57
v_mul_f32 v21, v21, v57
v_mul_f32 v22, v22, v57
v_mul_f32 v23, v23, v57
v_cvt_pk_bf16_f32 v17, v16, v17
v_cvt_pk_bf16_f32 v19, v18, v19
v_cvt_pk_bf16_f32 v21, v20, v21
v_cvt_pk_bf16_f32 v23, v22, v23
v_lshlrev_b32 v16, 16, v17
v_and_b32 v17, 0xffff0000, v17
v_lshlrev_b32 v18, 16, v19
v_and_b32 v19, 0xffff0000, v19
v_lshlrev_b32 v20, 16, v21
v_and_b32 v21, 0xffff0000, v21
v_lshlrev_b32 v22, 16, v23
v_and_b32 v23, 0xffff0000, v23
v_cvt_pkrtz_f16_f32 v8, v16, v17
v_cvt_pkrtz_f16_f32 v9, v18, v19
v_cvt_pkrtz_f16_f32 v10, v20, v21
v_cvt_pkrtz_f16_f32 v11, v22, v23
buffer_store_dwordx4 v[8:11], v3, s[32:35], s27 offen
k0_kernel_done1:
s_endpgm

.globl r2_kernel
.p2align 8
.type r2_kernel,@function
r2_kernel:
s_cmp_ge_u32 s2, 256
s_cbranch_scc1 r2_kernel_done1
s_load_dwordx2 s[20:21], s[0:1], 0
s_load_dwordx2 s[22:23], s[0:1], 88
s_load_dwordx2 s[24:25], s[0:1], 104
s_load_dwordx8 s[40:47], s[0:1], 8
v_and_b32 v1, 7, v0
v_lshrrev_b32 v2, 3, v0
v_lshlrev_b32 v3, 8, v2
v_lshl_add_u32 v3, v1, 4, v3
v_lshrrev_b32 v4, 2, v2
v_and_b32 v5, 3, v2
v_lshlrev_b32 v6, 6, v4
v_lshl_add_u32 v6, v5, 3, v6
v_lshlrev_b32 v7, 1, v6
s_movk_i32 s26, 1152
v_mad_u32_u24 v6, v1, s26, v6
s_lshr_b32 s27, s2, 1
s_mul_i32 s27, s27, 18432
s_and_b32 s28, s2, 1
s_lshl_b32 s28, s28, 7
s_add_u32 s27, s27, s28
s_mul_i32 s28, s2, 9216
s_waitcnt lgkmcnt(0)
s_mov_b32 s4, s24
s_mov_b32 s5, s25
s_mov_b32 s6, 13824
s_mov_b32 s7, 0x00020000
s_add_u32 s8, s24, 26214400
s_addc_u32 s9, s25, 0
s_mov_b32 s10, 9437184
s_mov_b32 s11, 0x00020000
s_mov_b32 s12, s22
s_mov_b32 s13, s23
s_mov_b32 s14, 2359296
s_mov_b32 s15, 0x00020000
s_add_u32 s16, s24, 3145728
s_addc_u32 s17, s25, 0
s_mov_b32 s18, 2359296
s_mov_b32 s19, 0x00020000
s_add_u32 s32, s24, 6291456
s_addc_u32 s33, s25, 0
s_mov_b32 s34, 2359296
s_mov_b32 s35, 0x00020000
s_mov_b32 s29, s27
buffer_load_dwordx4 v[64:67], v3, s[8:11], s29 offen
s_add_u32 s29, s29, 2359296
buffer_load_dwordx4 v[68:71], v3, s[8:11], s29 offen
s_add_u32 s29, s29, 2359296
buffer_load_dwordx4 v[72:75], v3, s[8:11], s29 offen
s_add_u32 s29, s29, 2359296
buffer_load_dwordx4 v[76:79], v3, s[8:11], s29 offen
s_add_u32 s29, s29, 2359296
buffer_load_dwordx4 v[8:11], v3, s[16:19], s27 offen
s_movk_i32 s30, 11520
buffer_load_dwordx4 v[32:35], v7, s[4:7], s30 offen
buffer_load_dwordx4 v[36:39], v7, s[4:7], s30 offen offset:64
s_waitcnt vmcnt(6)
v_lshlrev_b32 v56, 16, v64
v_and_b32 v57, 0xffff0000, v64
v_lshlrev_b32 v58, 16, v65
v_and_b32 v59, 0xffff0000, v65
v_lshlrev_b32 v60, 16, v66
v_and_b32 v61, 0xffff0000, v66
v_lshlrev_b32 v62, 16, v67
v_and_b32 v63, 0xffff0000, v67
s_waitcnt vmcnt(5)
v_lshlrev_b32 v24, 16, v68
v_and_b32 v25, 0xffff0000, v68
v_lshlrev_b32 v26, 16, v69
v_and_b32 v27, 0xffff0000, v69
v_lshlrev_b32 v28, 16, v70
v_and_b32 v29, 0xffff0000, v70
v_lshlrev_b32 v30, 16, v71
v_and_b32 v31, 0xffff0000, v71
v_add_f32 v56, v56, v24
v_add_f32 v57, v57, v25
v_add_f32 v58, v58, v26
v_add_f32 v59, v59, v27
v_add_f32 v60, v60, v28
v_add_f32 v61, v61, v29
v_add_f32 v62, v62, v30
v_add_f32 v63, v63, v31
s_waitcnt vmcnt(4)
v_lshlrev_b32 v24, 16, v72
v_and_b32 v25, 0xffff0000, v72
v_lshlrev_b32 v26, 16, v73
v_and_b32 v27, 0xffff0000, v73
v_lshlrev_b32 v28, 16, v74
v_and_b32 v29, 0xffff0000, v74
v_lshlrev_b32 v30, 16, v75
v_and_b32 v31, 0xffff0000, v75
v_add_f32 v56, v56, v24
v_add_f32 v57, v57, v25
v_add_f32 v58, v58, v26
v_add_f32 v59, v59, v27
v_add_f32 v60, v60, v28
v_add_f32 v61, v61, v29
v_add_f32 v62, v62, v30
v_add_f32 v63, v63, v31
s_waitcnt vmcnt(3)
v_lshlrev_b32 v24, 16, v76
v_and_b32 v25, 0xffff0000, v76
v_lshlrev_b32 v26, 16, v77
v_and_b32 v27, 0xffff0000, v77
v_lshlrev_b32 v28, 16, v78
v_and_b32 v29, 0xffff0000, v78
v_lshlrev_b32 v30, 16, v79
v_and_b32 v31, 0xffff0000, v79
v_add_f32 v56, v56, v24
v_add_f32 v57, v57, v25
v_add_f32 v58, v58, v26
v_add_f32 v59, v59, v27
v_add_f32 v60, v60, v28
v_add_f32 v61, v61, v29
v_add_f32 v62, v62, v30
v_add_f32 v63, v63, v31
s_waitcnt vmcnt(0)
v_lshlrev_b32 v16, 16, v8
v_and_b32 v17, 0xffff0000, v8
v_lshlrev_b32 v18, 16, v9
v_and_b32 v19, 0xffff0000, v9
v_lshlrev_b32 v20, 16, v10
v_and_b32 v21, 0xffff0000, v10
v_lshlrev_b32 v22, 16, v11
v_and_b32 v23, 0xffff0000, v11
v_cvt_pk_bf16_f32 v57, v56, v57
v_cvt_pk_bf16_f32 v59, v58, v59
v_cvt_pk_bf16_f32 v61, v60, v61
v_cvt_pk_bf16_f32 v63, v62, v63
v_lshlrev_b32 v56, 16, v57
v_and_b32 v57, 0xffff0000, v57
v_lshlrev_b32 v58, 16, v59
v_and_b32 v59, 0xffff0000, v59
v_lshlrev_b32 v60, 16, v61
v_and_b32 v61, 0xffff0000, v61
v_lshlrev_b32 v62, 16, v63
v_and_b32 v63, 0xffff0000, v63
v_mul_f32 v56, v56, v32
v_mul_f32 v57, v57, v33
v_mul_f32 v58, v58, v34
v_mul_f32 v59, v59, v35
v_mul_f32 v60, v60, v36
v_mul_f32 v61, v61, v37
v_mul_f32 v62, v62, v38
v_mul_f32 v63, v63, v39
v_cvt_pk_bf16_f32 v57, v56, v57
v_cvt_pk_bf16_f32 v59, v58, v59
v_cvt_pk_bf16_f32 v61, v60, v61
v_cvt_pk_bf16_f32 v63, v62, v63
v_lshlrev_b32 v56, 16, v57
v_and_b32 v57, 0xffff0000, v57
v_lshlrev_b32 v58, 16, v59
v_and_b32 v59, 0xffff0000, v59
v_lshlrev_b32 v60, 16, v61
v_and_b32 v61, 0xffff0000, v61
v_lshlrev_b32 v62, 16, v63
v_and_b32 v63, 0xffff0000, v63
v_add_f32 v16, v16, v56
v_add_f32 v17, v17, v57
v_add_f32 v18, v18, v58
v_add_f32 v19, v19, v59
v_add_f32 v20, v20, v60
v_add_f32 v21, v21, v61
v_add_f32 v22, v22, v62
v_add_f32 v23, v23, v63
v_cvt_pk_bf16_f32 v8, v16, v17
v_cvt_pk_bf16_f32 v9, v18, v19
v_cvt_pk_bf16_f32 v10, v20, v21
v_cvt_pk_bf16_f32 v11, v22, v23
buffer_store_dwordx2 v[8:9], v6, s[12:15], s28 offen
buffer_store_dwordx2 v[10:11], v6, s[12:15], s28 offen offset:32
r2_kernel_done1:
s_endpgm

code_end:
s_endpgm
.section .rodata,"a"
.p2align 6
.amdhsa_kernel ka_kernel
  .amdhsa_next_free_vgpr 512
  .amdhsa_next_free_sgpr 102
  .amdhsa_accum_offset 256
  .amdhsa_group_segment_fixed_size 0
  .amdhsa_kernarg_size 112
  .amdhsa_user_sgpr_count 2
  .amdhsa_user_sgpr_kernarg_segment_ptr 1
  .amdhsa_system_sgpr_workgroup_id_x 1
.end_amdhsa_kernel

.p2align 6
.amdhsa_kernel k0_kernel
  .amdhsa_next_free_vgpr 128
  .amdhsa_next_free_sgpr 102
  .amdhsa_accum_offset 128
  .amdhsa_group_segment_fixed_size 0
  .amdhsa_kernarg_size 112
  .amdhsa_user_sgpr_count 2
  .amdhsa_user_sgpr_kernarg_segment_ptr 1
  .amdhsa_system_sgpr_workgroup_id_x 1
.end_amdhsa_kernel

.p2align 6
.amdhsa_kernel r2_kernel
  .amdhsa_next_free_vgpr 128
  .amdhsa_next_free_sgpr 102
  .amdhsa_accum_offset 128
  .amdhsa_group_segment_fixed_size 0
  .amdhsa_kernarg_size 112
  .amdhsa_user_sgpr_count 2
  .amdhsa_user_sgpr_kernarg_segment_ptr 1
  .amdhsa_system_sgpr_workgroup_id_x 1
.end_amdhsa_kernel
```
